```python
import torch

def _softmax(x, axis=-1):
    return torch.softmax(x, dim=axis)

def _gelu(x):
    return torch.nn.functional.gelu(x, approximate='tanh')

def _silu(x):
    return torch.nn.functional.silu(x)

def _sigmoid(x):
    return torch.sigmoid(x)

def _layernorm(x, axis=-1, eps=1e-05):
    m = x.mean(dim=axis, keepdim=True)
    v = x.var(dim=axis, keepdim=True, unbiased=False)
    return (x - m) / torch.sqrt(v + eps)

def _scatter_add(tgt, idx, src, axis=0):
    return tgt.clone().index_add_(axis, idx, src)

def _segment_sum(src, seg, n):
    out = torch.zeros((n,) + src.shape[1:], dtype=src.dtype)
    return out.index_add_(0, seg, src)

def _pad(x, pw):
    flat = tuple((v for pair in reversed(pw) for v in pair))
    return torch.nn.functional.pad(x, flat)
kernel_name = 'parallel_sum__memory_aug_recurrent_mem_tr__dense_activation_relu__prompt'

def setup_inputs():

    _w = lambda a: (lambda t: t.to(torch.bfloat16) if t.is_floating_point() else t)(torch.as_tensor(a))

    def _A_setup():
        B, S, Dm = (1, 2048, 448)
        H, Dh = (16, 256)
        M, seg = (8, 32)
        seg = min(seg, S)
        S = S // seg * seg
        return {'x': _w((lambda *s: torch.randn(*s, dtype=torch.bfloat16) * 0.05)(B, S, Dm)), 'mem0': _w((lambda *s: torch.randn(*s, dtype=torch.bfloat16) * 1.6)(B, M, Dm)), 'Wq': _w((lambda *s: torch.randn(*s, dtype=torch.bfloat16) * 0.8)(Dm, H, Dh) * Dm ** (-0.5)), 'Wk': _w((lambda *s: torch.randn(*s, dtype=torch.bfloat16) * 0.8)(Dm, H, Dh) * Dm ** (-0.5)), 'Wv': _w((lambda *s: torch.randn(*s, dtype=torch.bfloat16) * 1.6)(Dm, H, Dh) * Dm ** (-0.5)), 'Wo': _w((lambda *s: torch.randn(*s, dtype=torch.bfloat16) * 1.6)(H, Dh, Dm) * (H * Dh) ** (-0.5)), 'seg_len': seg}
    _A_in = _A_setup()

    def _B_setup():
        B, S, D, Dff = (1, 2048, 448, 1792)
        return {'x': _w((lambda *s: torch.randn(*s, dtype=torch.bfloat16) * 0.05)(B, S, D)), 'w1': _w((lambda *s: torch.randn(*s, dtype=torch.bfloat16) * 0.05)(D, Dff)), 'w2': _w((lambda *s: torch.randn(*s, dtype=torch.bfloat16) * 0.05)(Dff, D))}
    _B_in = _B_setup()
    return {'A_x': _A_in['x'], 'A_mem0': _A_in['mem0'], 'A_Wq': _A_in['Wq'], 'A_Wk': _A_in['Wk'], 'A_Wv': _A_in['Wv'], 'A_Wo': _A_in['Wo'], 'A_seg_len': _A_in['seg_len'], 'B_x': _B_in['x'], 'B_w1': _B_in['w1'], 'B_w2': _B_in['w2']}

def reference(A_x, A_mem0, A_Wq, A_Wk, A_Wv, A_Wo, A_seg_len, B_x, B_w1, B_w2):

    def _A_ref(x, mem0, Wq, Wk, Wv, Wo, seg_len):
        B, S, Dm = x.shape
        H, Dh = (Wq.shape[1], Wq.shape[2])
        M = mem0.shape[1]
        scale = Dh ** (-0.5)
        n_seg = S // seg_len
        L = M + seg_len
        idx = torch.arange(L)
        mask = (idx[:, None] < M) | (idx[:, None] >= idx[None, :])
        mem = mem0
        outs = []
        for s in range(n_seg):
            xs = x[:, s * seg_len:(s + 1) * seg_len, :].clone()
            h = torch.concatenate([mem, xs], axis=1)
            q = torch.einsum('btd,dhe->bhte', h, Wq)
            k = torch.einsum('btd,dhe->bhte', h, Wk)
            v = torch.einsum('btd,dhe->bhte', h, Wv)
            scores = torch.einsum('bhqe,bhke->bhqk', q, k) * scale
            scores = torch.where(mask[None, None], scores, -1000000000.0)
            p = _softmax(scores, axis=-1)
            o = torch.einsum('bhqk,bhke->bhqe', p, v)
            o = torch.einsum('bhte,hed->btd', o, Wo)
            mem = o[:, :M, :].clone()
            outs.append(o[:, M:, :])
        return torch.concatenate(outs, axis=1)

    def _B_ref(x, w1, w2):
        h = torch.einsum('bsd,df->bsf', x, w1)
        zero = torch.zeros_like(h)
        h = torch.maximum(h, zero)
        return torch.einsum('bsf,fd->bsd', h, w2)
    x = A_x
    xn = _layernorm(x, axis=-1)
    return x + _A_ref(xn, A_mem0, A_Wq, A_Wk, A_Wv, A_Wo, A_seg_len) + _B_ref(xn, B_w1, B_w2)
```

```asm
; @launch kernel=parallel_sum__memory_aug_recurrent_mem_tr__dense_activation_relu__prompt_kernel grid=(256,1,1) block=(512,1,1) lds=161920
.amdgcn_target "amdgcn-amd-amdhsa--gfx950"
.text
.globl parallel_sum__memory_aug_recurrent_mem_tr__dense_activation_relu__prompt_kernel
.type parallel_sum__memory_aug_recurrent_mem_tr__dense_activation_relu__prompt_kernel,@function
.p2align 8
parallel_sum__memory_aug_recurrent_mem_tr__dense_activation_relu__prompt_kernel:
    s_cmp_ge_u32 s2, 256
    s_cbranch_scc1 M_end
    s_load_dwordx2 s[10:11], s[0:1], 88
    s_memrealtime s[18:19]
    s_getreg_b32 s16, hwreg(HW_REG_XCC_ID)
    s_getreg_b32 s15, hwreg(HW_REG_HW_ID)
    s_and_b32 s16, s16, 7
    s_load_dwordx8 s[64:71], s[0:1], 16
    s_load_dwordx4 s[72:75], s[0:1], 64
    s_load_dwordx2 s[4:5], s[0:1], 96
    s_load_dwordx2 s[6:7], s[0:1], 0
    s_load_dwordx2 s[8:9], s[0:1], 80
    s_load_dwordx2 s[10:11], s[0:1], 88
    s_load_dwordx2 s[12:13], s[0:1], 8
    v_lshrrev_b32 v5, 6, v0
    v_and_b32 v1, 63, v0
    v_readfirstlane_b32 s14, v5
    v_lshlrev_b32 v2, 4, v1
    v_lshrrev_b32 v3, 4, v1
    v_and_b32 v4, 15, v1
    s_waitcnt lgkmcnt(0)
    s_add_u32 s4, s4, 0x9c00000
    s_addc_u32 s5, s5, 0
    s_or_b32 s18, s18, 0x40000000
    s_and_b32 s18, s18, 0x7ffffffe
    s_mov_b32 s19, 0
    s_mov_b32 s17, 0
    s_mov_b32 s101, 0
    s_mov_b32 s39, -1
    s_mov_b64 s[48:49], 0
    s_lshl_b32 s21, s16, 5
    s_cmp_eq_u32 s14, 0
    s_cbranch_scc1 M_s0
    s_bfe_u32 s22, s15, 0x2000d
    s_bfe_u32 s23, s15, 0x30008
    s_lshl_b32 s22, s22, 3
    s_add_u32 s22, s22, s23
    v_lshrrev_b32 v6, 2, v1
    v_lshlrev_b32 v6, 13, v6
    v_and_b32 v7, 3, v1
    v_lshl_add_u32 v6, v7, 7, v6
    s_sub_u32 s23, s14, 1
    s_cmp_lg_u32 s16, 0
    s_cbranch_scc1 M_t1
    s_and_b32 s24, s22, 1
    s_lshr_b32 s25, s22, 1
    s_lshl_b32 s25, s25, 9
    s_cmp_eq_u32 s14, 7
    s_cbranch_scc1 M_t0
    s_mul_i32 s24, s24, 14
    s_add_u32 s24, s24, s23
    s_add_u32 s24, s24, 8
    s_lshl_b32 s24, s24, 17
    s_add_u32 s24, s24, s25
    s_add_u32 s24, s66, s24
    s_addc_u32 s25, s67, 0
    s_branch M_t8
M_t0:
    s_mul_i32 s24, s24, 262144
    s_add_u32 s24, s24, s25
    s_add_u32 s24, s64, s24
    s_addc_u32 s25, s65, 0
    global_load_dword v102, v6, s[24:25]
    v_add_u32 v6, 0x20000, v6
M_t8:
    global_load_dword v102, v6, s[24:25]
    s_branch M_ta
M_t1:
    s_add_u32 s22, s22, s21
    s_sub_u32 s22, s22, 32
    s_lshr_b32 s26, s22, 1
    s_mul_i32 s27, s26, 147
    s_lshr_b32 s27, s27, 10
    s_mul_i32 s28, s27, 7
    s_sub_u32 s28, s26, s28
    s_and_b32 s29, s22, 1
    s_and_b32 s30, s23, 1
    s_cmp_ge_u32 s23, 2
    s_cbranch_scc1 M_t2
    s_mul_i32 s24, s29, 7
    s_add_u32 s24, s24, s28
    s_lshl_b32 s24, s24, 1
    s_add_u32 s24, s24, s30
    s_lshl_b32 s24, s24, 17
    s_lshl_b32 s25, s27, 9
    s_add_u32 s24, s24, s25
    s_add_u32 s24, s68, s24
    s_addc_u32 s25, s69, 0
    s_branch M_t9
M_t2:
    s_cmp_ge_u32 s23, 4
    s_cbranch_scc1 M_t3
    s_lshl_b32 s24, s27, 2
    s_lshl_b32 s25, s29, 1
    s_add_u32 s24, s24, s25
    s_add_u32 s24, s24, s30
    s_mul_i32 s24, s24, 57344
    s_lshl_b32 s25, s28, 7
    s_add_u32 s24, s24, s25
    s_add_u32 s24, s70, s24
    s_addc_u32 s25, s71, 0
    v_mul_u32_u24 v6, 896, v1
    s_branch M_t9
M_t3:
    s_cmp_lg_u32 s14, 7
    s_cbranch_scc1 M_t4
    s_sub_u32 s24, s21, 32
    s_mul_i32 s25, s24, 4682
    s_lshr_b32 s25, s25, 16
    s_mul_i32 s25, s25, 14
    s_sub_u32 s25, s24, s25
    s_sub_u32 s26, s22, s24
    s_cmp_lt_u32 s26, s25
    s_cselect_b32 s26, 0, 32
    s_add_u32 s26, s26, s22
    s_sub_u32 s26, s26, s25
    s_add_u32 s24, s24, 31
    s_mul_i32 s24, s24, 4682
    s_lshr_b32 s24, s24, 16
    s_mul_i32 s25, s26, 4682
    s_lshr_b32 s25, s25, 16
    s_cmp_gt_u32 s25, s24
    s_cbranch_scc1 M_ta
    s_mul_i32 s24, s25, 14
    s_sub_u32 s26, s26, s24
    s_and_b32 s24, s26, 1
    s_mul_i32 s24, s24, 7
    s_lshr_b32 s26, s26, 1
    s_add_u32 s24, s24, s26
    s_lshl_b32 s24, s24, 18
    s_lshl_b32 s25, s25, 9
    s_add_u32 s24, s24, s25
    s_add_u32 s24, s68, s24
    s_addc_u32 s25, s69, 0
    global_load_dword v102, v6, s[24:25] nt
    v_add_u32 v6, 0x20000, v6
    s_branch M_t9
    s_branch M_ta
M_t4:
    s_cmp_lt_u32 s22, 128
    s_cbranch_scc1 M_t5
    s_mul_i32 s24, s30, 224
    s_add_u32 s24, s24, s22
    s_sub_u32 s24, s24, 128
    s_lshl_b32 s24, s24, 13
    s_add_u32 s24, s66, s24
    s_addc_u32 s25, s67, 0
    v_lshlrev_b32 v6, 7, v1
    global_load_dword v102, v6, s[24:25]
    s_branch M_ta
M_t5:
    s_lshl_b32 s24, s22, 1
    s_add_u32 s24, s24, s30
    s_mul_i32 s24, s24, 7168
    s_add_u32 s24, s6, s24
    s_addc_u32 s25, s7, 0
    v_min_u32 v6, 55, v1
    v_lshlrev_b32 v6, 7, v6
M_t9:
    global_load_dword v102, v6, s[24:25] nt
M_ta:
    s_cmp_lg_u32 s14, 1
    s_cbranch_scc1 M_tk
    s_getpc_b64 s[24:25]
M_pc:
    s_cmp_eq_u32 s16, 0
    s_movk_i32 s26, 16384
    s_cselect_b32 s27, s26, M_chk-M_pc
    s_bitcmp1_b32 s22, 1
    s_cselect_b32 s27, s27, 0
    s_and_b32 s26, s22, 1
    s_lshl_b32 s26, s26, 13
    s_add_u32 s26, s26, s27
    v_lshlrev_b32 v6, 7, v1
    v_add_u32 v6, s26, v6
    global_load_dword v102, v6, s[24:25]
    s_branch M_tk
M_s0:
    v_and_b32 v6, 31, v1
    v_lshlrev_b32 v6, 2, v6
    v_add_u32 v6, 161792, v6
    v_mov_b32 v7, 0
    ds_write_b32 v6, v7
M_tk:
    s_cmp_lg_u32 s14, 0
    s_cbranch_scc1 M_r1
    v_mov_b32 v6, s21
    v_mov_b32 v7, 1
    s_mov_b64 exec, 1
    global_atomic_add v8, v6, v7, s[10:11] sc0 sc1
    s_mov_b64 exec, -1
    v_lshlrev_b32 v9, 3, v1
    v_add_u32 v9, 154624, v9
    v_mov_b32 v10, 0
    v_mov_b32 v11, 0
    ds_write_b64 v9, v[10:11]
    s_mov_b64 exec, 1
    v_mov_b32 v6, 161824
    v_mov_b32 v7, 4
    v_mov_b32 v10, s18
    s_waitcnt vmcnt(0)
    ds_write_b32 v6, v8
    v_cmp_eq_u32 vcc, s19, v8
    s_cbranch_vccz M_r0
    global_atomic_cmpswap v7, v[10:11], s[10:11] sc1
M_r0:
    s_mov_b64 exec, -1
M_r1:
    s_waitcnt lgkmcnt(0)
    s_barrier
    v_mov_b32 v6, 161824
    ds_read_b32 v8, v6
    s_waitcnt lgkmcnt(0)
    v_readfirstlane_b32 s20, v8
    s_cmp_lt_u32 s20, 32
    s_cbranch_scc1 M_r2
    s_cmp_eq_u32 s17, 0
    s_cbranch_scc1 M_chk
    s_branch M_acq
M_r2:
    s_cmp_eq_u32 s21, 0
    s_cbranch_scc1 M_chain
    s_add_u32 s20, s20, s21
    s_sub_u32 s20, s20, 32
M_ab:
    s_mov_b32 s26, 0
M_ab2:
    v_and_b32 v12, 3, v1
    v_xor_b32 v12, v12, v3
    v_lshlrev_b32 v12, 4, v12
    v_lshrrev_b32 v14, 2, v4
    v_xor_b32 v14, v14, v3
    v_lshlrev_b32 v14, 4, v14
    v_lshl_add_u32 v14, v4, 6, v14
    s_mov_b32 s40, 0x05040100
    s_mov_b32 s41, 0x07060302
    s_lshr_b32 s25, s20, 1
    s_mul_i32 s27, s25, 147
    s_lshr_b32 s27, s27, 10
    s_mul_i32 s24, s27, 7
    s_sub_u32 s24, s25, s24
    s_and_b32 s25, s20, 1
    s_mul_i32 s25, s25, 7
    s_add_u32 s25, s25, s14
    v_bfe_u32 v7, v1, 2, 2
    v_lshlrev_b32 v13, 16, v3
    v_add_u32 v13, v13, v12
    v_lshl_add_u32 v6, v7, 13, v13
    v_lshl_add_u32 v7, v7, 14, v13
    s_lshl_b32 s30, s27, 9
    s_cmp_eq_u32 s26, 0
    s_cselect_b32 s28, s68, s64
    s_cselect_b32 s29, s69, s65
    s_cselect_b64 vcc, -1, 0
    v_cndmask_b32 v15, v14, v2
    s_cbranch_scc1 P_stB
    s_lshr_b32 s31, s14, 1
    s_lshr_b32 s32, s31, 1
    s_lshl_b32 s32, s32, 5
    s_and_b32 s33, s31, 1
    s_add_u32 s32, s32, s33
    s_lshl_b32 s33, s24, 6
    s_add_u32 s32, s32, s33
    s_lshl_b32 s32, s32, 13
    s_add_u32 s32, s32, s30
    s_and_b32 s33, s14, 1
    s_lshl_b32 s34, s33, 8
    s_add_u32 s32, s32, s34
    s_add_u32 s34, s66, s32
    s_addc_u32 s35, s67, 0
    s_lshl_b32 s36, s14, 12
    s_add_u32 m0, s36, 0
    s_nop 0
    global_load_lds_dwordx4 v7, s[34:35] offset:0
    s_add_u32 m0, s36, 960
    s_nop 0
    global_load_lds_dwordx4 v7, s[34:35] offset:64
    s_add_u32 m0, s36, 1920
    s_nop 0
    global_load_lds_dwordx4 v7, s[34:35] offset:128
    s_add_u32 m0, s36, 2880
    s_nop 0
    global_load_lds_dwordx4 v7, s[34:35] offset:192
    v_mov_b32 v8, 0
    s_branch P_rows
P_stB:
    s_mul_i32 s32, s27, 229376
    s_mul_i32 s33, s14, 28672
    s_add_u32 s32, s32, s33
    s_lshl_b32 s33, s24, 7
    s_add_u32 s32, s32, s33
    s_add_u32 s34, s70, s32
    s_addc_u32 s35, s71, 0
    v_mul_u32_u24 v9, 7168, v3
    v_lshl_add_u32 v9, v4, 3, v9
    v_add_u32 v10, 3584, v9
    global_load_dwordx2 v[216:217], v9, s[34:35] offset:0
    global_load_dwordx2 v[218:219], v9, s[34:35] offset:896
    global_load_dwordx2 v[220:221], v9, s[34:35] offset:1792
    global_load_dwordx2 v[222:223], v9, s[34:35] offset:2688
    global_load_dwordx2 v[224:225], v10, s[34:35] offset:0
    global_load_dwordx2 v[226:227], v10, s[34:35] offset:896
    global_load_dwordx2 v[228:229], v10, s[34:35] offset:1792
    global_load_dwordx2 v[230:231], v10, s[34:35] offset:2688
    v_lshrrev_b32 v8, 3, v4
    v_lshlrev_b32 v8, 1, v8
    v_and_b32 v11, 1, v4
    v_add_u32 v8, v8, v11
    v_lshlrev_b32 v8, 13, v8
    v_bfe_u32 v11, v4, 1, 2
    v_lshl_add_u32 v8, v11, 6, v8
    v_lshl_add_u32 v8, v3, 8, v8
    s_lshl_b32 s36, s14, 10
    v_add_u32 v8, s36, v8
P_rows:
    s_barrier
    s_lshl_b32 s32, s25, 18
    s_add_u32 s32, s32, s30
    s_add_u32 s36, s28, s32
    s_addc_u32 s37, s29, 0
    s_lshl_b32 s42, s14, 14
    s_add_u32 s42, s42, 32768
    s_cmp_eq_u32 s14, 7
    s_cbranch_scc1 P_norows
    s_add_u32 m0, s42, 0
    s_nop 0
    global_load_lds_dwordx4 v6, s[36:37] offset:0
    s_add_u32 m0, s42, 960
    s_nop 0
    global_load_lds_dwordx4 v6, s[36:37] offset:64
    s_add_u32 m0, s42, 1920
    s_nop 0
    global_load_lds_dwordx4 v6, s[36:37] offset:128
    s_add_u32 m0, s42, 2880
    s_nop 0
    global_load_lds_dwordx4 v6, s[36:37] offset:192
    s_add_u32 m0, s42, 3840
    s_nop 0
    global_load_lds_dwordx4 v6, s[36:37] offset:256
    s_add_u32 m0, s42, 4800
    s_nop 0
    global_load_lds_dwordx4 v6, s[36:37] offset:320
    s_add_u32 m0, s42, 5760
    s_nop 0
    global_load_lds_dwordx4 v6, s[36:37] offset:384
    s_add_u32 m0, s42, 6720
    s_nop 0
    global_load_lds_dwordx4 v6, s[36:37] offset:448
    s_add_u32 s36, s36, 0x8000
    s_addc_u32 s37, s37, 0
    s_waitcnt vmcnt(8)
    s_branch P_stage
P_norows:
    s_setprio 3
    s_lshl_b32 s43, s26, 8
    s_add_u32 s43, s43, s20
    s_cmp_lt_u32 s43, 128
    s_cbranch_scc0 P_nl
    s_mul_i32 s36, s20, 14336
    s_add_u32 s36, s6, s36
    s_addc_u32 s37, s7, 0
    v_lshrrev_b32 v6, 2, v1
    v_mul_u32_u24 v6, 896, v6
    v_add_u32 v6, v6, v12
    s_mov_b32 m0, 147456
    s_nop 0
    global_load_lds_dwordx4 v6, s[36:37] offset:0
    s_mov_b32 m0, 148416
    s_nop 0
    global_load_lds_dwordx4 v6, s[36:37] offset:64
    s_mov_b32 m0, 149376
    s_nop 0
    global_load_lds_dwordx4 v6, s[36:37] offset:128
    s_mov_b32 m0, 150336
    s_nop 0
    global_load_lds_dwordx4 v6, s[36:37] offset:192
    s_mov_b32 m0, 151296
    s_nop 0
    global_load_lds_dwordx4 v6, s[36:37] offset:256
    s_mov_b32 m0, 152256
    s_nop 0
    global_load_lds_dwordx4 v6, s[36:37] offset:320
    s_mov_b32 m0, 153216
    s_nop 0
    global_load_lds_dwordx4 v6, s[36:37] offset:384
    s_mov_b32 m0, 154176
    s_nop 0
    global_load_lds_dwordx4 v6, s[36:37] offset:448
    s_mov_b32 m0, 155136
    s_nop 0
    global_load_lds_dwordx4 v6, s[36:37] offset:512
    s_mov_b32 m0, 156096
    s_nop 0
    global_load_lds_dwordx4 v6, s[36:37] offset:576
    s_mov_b32 m0, 157056
    s_nop 0
    global_load_lds_dwordx4 v6, s[36:37] offset:640
    s_mov_b32 m0, 158016
    s_nop 0
    global_load_lds_dwordx4 v6, s[36:37] offset:704
    s_mov_b32 m0, 158976
    s_nop 0
    global_load_lds_dwordx4 v6, s[36:37] offset:768
    s_mov_b32 m0, 159936
    s_nop 0
    global_load_lds_dwordx4 v6, s[36:37] offset:832
    v_mov_b32 v101, 4
    global_load_dword v100, v101, s[10:11] sc1
    s_waitcnt vmcnt(15)
    s_branch P_stage
P_nl:
    v_mov_b32 v101, 4
    global_load_dword v100, v101, s[10:11] sc1
    s_cmp_lg_u32 s26, 0
    s_cbranch_scc1 P_nw
    v_lshlrev_b32 v6, 7, v1
    s_add_u32 s36, s20, -64
    s_min_u32 s36, s36, 447
    s_lshl_b32 s36, s36, 13
    s_add_u32 s36, s64, s36
    s_addc_u32 s37, s65, 0
    global_load_dword v250, v6, s[36:37]
    s_add_u32 s36, s20, 32
    s_min_u32 s36, s36, 447
    s_lshl_b32 s36, s36, 13
    s_add_u32 s36, s64, s36
    s_addc_u32 s37, s65, 0
    global_load_dword v250, v6, s[36:37]
    s_add_u32 s36, s20, 128
    s_min_u32 s36, s36, 447
    s_lshl_b32 s36, s36, 13
    s_add_u32 s36, s64, s36
    s_addc_u32 s37, s65, 0
    global_load_dword v250, v6, s[36:37]
    s_add_u32 s36, s20, 224
    s_min_u32 s36, s36, 447
    s_lshl_b32 s36, s36, 13
    s_add_u32 s36, s64, s36
    s_addc_u32 s37, s65, 0
    global_load_dword v250, v6, s[36:37]
    s_waitcnt vmcnt(5)
    s_branch P_stage
P_nw:
    s_waitcnt vmcnt(1)
P_stage:
    s_cmp_lg_u32 s26, 0
    s_cbranch_scc1 P_staged
    v_perm_b32 v200, v218, v216, s40
    v_perm_b32 v201, v222, v220, s40
    v_perm_b32 v202, v226, v224, s40
    v_perm_b32 v203, v230, v228, s40
    v_perm_b32 v204, v218, v216, s41
    v_perm_b32 v205, v222, v220, s41
    v_perm_b32 v206, v226, v224, s41
    v_perm_b32 v207, v230, v228, s41
    v_perm_b32 v208, v219, v217, s40
    v_perm_b32 v209, v223, v221, s40
    v_perm_b32 v210, v227, v225, s40
    v_perm_b32 v211, v231, v229, s40
    v_perm_b32 v212, v219, v217, s41
    v_perm_b32 v213, v223, v221, s41
    v_perm_b32 v214, v227, v225, s41
    v_perm_b32 v215, v231, v229, s41
    ds_write_b128 v8, v[200:203] offset:0
    ds_write_b128 v8, v[204:207] offset:16
    ds_write_b128 v8, v[208:211] offset:32
    ds_write_b128 v8, v[212:215] offset:48
P_staged:
    s_waitcnt lgkmcnt(0)
    s_barrier
    s_cmp_eq_u32 s14, 7
    s_cbranch_scc1 P_w7
    ds_read_b128 v[128:131], v15 offset:0
    ds_read_b128 v[132:135], v15 offset:1024
    ds_read_b128 v[136:139], v15 offset:2048
    ds_read_b128 v[140:143], v15 offset:3072
    ds_read_b128 v[144:147], v15 offset:4096
    ds_read_b128 v[148:151], v15 offset:5120
    ds_read_b128 v[152:155], v15 offset:6144
    ds_read_b128 v[156:159], v15 offset:7168
    ds_read_b128 v[160:163], v15 offset:8192
    ds_read_b128 v[164:167], v15 offset:9216
    ds_read_b128 v[168:171], v15 offset:10240
    ds_read_b128 v[172:175], v15 offset:11264
    ds_read_b128 v[176:179], v15 offset:12288
    ds_read_b128 v[180:183], v15 offset:13312
    ds_read_b128 v[184:187], v15 offset:14336
    ds_read_b128 v[188:191], v15 offset:15360
    ds_read_b128 v[192:195], v15 offset:16384
    ds_read_b128 v[196:199], v15 offset:17408
    ds_read_b128 v[200:203], v15 offset:18432
    ds_read_b128 v[204:207], v15 offset:19456
    ds_read_b128 v[208:211], v15 offset:20480
    ds_read_b128 v[212:215], v15 offset:21504
    ds_read_b128 v[216:219], v15 offset:22528
    ds_read_b128 v[220:223], v15 offset:23552
    ds_read_b128 v[224:227], v15 offset:24576
    ds_read_b128 v[228:231], v15 offset:25600
    ds_read_b128 v[232:235], v15 offset:26624
    ds_read_b128 v[236:239], v15 offset:27648
    ds_read_b128 v[240:243], v15 offset:28672
    ds_read_b128 v[244:247], v15 offset:29696
    ds_read_b128 v[248:251], v15 offset:30720
    ds_read_b128 v[252:255], v15 offset:31744
    s_add_u32 m0, s42, 8192
    s_nop 0
    global_load_lds_dwordx4 v6, s[36:37] offset:0
    s_add_u32 m0, s42, 9152
    s_nop 0
    global_load_lds_dwordx4 v6, s[36:37] offset:64
    s_add_u32 m0, s42, 10112
    s_nop 0
    global_load_lds_dwordx4 v6, s[36:37] offset:128
    s_add_u32 m0, s42, 11072
    s_nop 0
    global_load_lds_dwordx4 v6, s[36:37] offset:192
    s_add_u32 m0, s42, 12032
    s_nop 0
    global_load_lds_dwordx4 v6, s[36:37] offset:256
    s_add_u32 m0, s42, 12992
    s_nop 0
    global_load_lds_dwordx4 v6, s[36:37] offset:320
    s_add_u32 m0, s42, 13952
    s_nop 0
    global_load_lds_dwordx4 v6, s[36:37] offset:384
    s_add_u32 m0, s42, 14912
    s_nop 0
    global_load_lds_dwordx4 v6, s[36:37] offset:448
    v_add_u32 v14, s42, v14
    s_cmp_eq_u32 s26, 0
    s_cselect_b32 s38, 1.0, 0x3db8aa3b
    s_lshl_b32 s33, s24, 2
    s_mul_i32 s32, s27, 28
    s_add_u32 s32, s32, s33
    s_add_u32 s32, s32, 448
    s_lshr_b32 s34, s27, 1
    s_mul_i32 s34, s34, 28
    s_add_u32 s34, s34, s33
    s_lshl_b32 s34, s34, 1
    s_and_b32 s33, s27, 1
    s_add_u32 s34, s34, s33
    s_movk_i32 s39, 14336
    s_cmp_eq_u32 s26, 0
    s_cselect_b32 s32, s34, s32
    s_cselect_b32 s39, 28672, s39
    s_mul_i32 s32, s32, 14
    s_add_u32 s32, s32, s25
    s_lshl_b32 s32, s32, 10
    s_add_u32 s32, s32, 0x1c0000
    s_add_u32 s44, s4, s32
    s_addc_u32 s45, s5, 0
    v_add_u32 v9, s39, v2
    v_add_u32 v10, s39, v9
    v_add_u32 v11, s39, v10
    s_mul_i32 s32, s26, 224
    s_add_u32 s32, s32, s20
    s_lshl_b32 s32, s32, 5
    s_lshl_b32 s33, s14, 2
    s_add_u32 s32, s32, s33
    s_add_u32 s32, s32, 0x5b8c000
    s_add_u32 s46, s4, s32
    s_addc_u32 s47, s5, 0
    v_mov_b32 v13, 0
    s_waitcnt vmcnt(8)
    ds_read_b128 v[64:67], v14 offset:0
    ds_read_b128 v[68:71], v14 offset:1024
    ds_read_b128 v[72:75], v14 offset:2048
    ds_read_b128 v[76:79], v14 offset:3072
    ds_read_b128 v[80:83], v14 offset:4096
    ds_read_b128 v[84:87], v14 offset:5120
    ds_read_b128 v[88:91], v14 offset:6144
    ds_read_b128 v[92:95], v14 offset:7168
    s_waitcnt lgkmcnt(7)
    v_mfma_f32_16x16x32_bf16 v[32:35], v[64:67], v[128:131], 0
    v_mfma_f32_16x16x32_bf16 v[36:39], v[64:67], v[160:163], 0
    v_mfma_f32_16x16x32_bf16 v[40:43], v[64:67], v[192:195], 0
    v_mfma_f32_16x16x32_bf16 v[44:47], v[64:67], v[224:227], 0
    s_waitcnt lgkmcnt(6)
    v_mfma_f32_16x16x32_bf16 v[32:35], v[68:71], v[132:135], v[32:35]
    v_mfma_f32_16x16x32_bf16 v[36:39], v[68:71], v[164:167], v[36:39]
    v_mfma_f32_16x16x32_bf16 v[40:43], v[68:71], v[196:199], v[40:43]
    v_mfma_f32_16x16x32_bf16 v[44:47], v[68:71], v[228:231], v[44:47]
    s_waitcnt lgkmcnt(5)
    v_mfma_f32_16x16x32_bf16 v[32:35], v[72:75], v[136:139], v[32:35]
    v_mfma_f32_16x16x32_bf16 v[36:39], v[72:75], v[168:171], v[36:39]
    v_mfma_f32_16x16x32_bf16 v[40:43], v[72:75], v[200:203], v[40:43]
    v_mfma_f32_16x16x32_bf16 v[44:47], v[72:75], v[232:235], v[44:47]
    s_waitcnt lgkmcnt(4)
    v_mfma_f32_16x16x32_bf16 v[32:35], v[76:79], v[140:143], v[32:35]
    v_mfma_f32_16x16x32_bf16 v[36:39], v[76:79], v[172:175], v[36:39]
    v_mfma_f32_16x16x32_bf16 v[40:43], v[76:79], v[204:207], v[40:43]
    v_mfma_f32_16x16x32_bf16 v[44:47], v[76:79], v[236:239], v[44:47]
    s_waitcnt lgkmcnt(3)
    v_mfma_f32_16x16x32_bf16 v[32:35], v[80:83], v[144:147], v[32:35]
    v_mfma_f32_16x16x32_bf16 v[36:39], v[80:83], v[176:179], v[36:39]
    v_mfma_f32_16x16x32_bf16 v[40:43], v[80:83], v[208:211], v[40:43]
    v_mfma_f32_16x16x32_bf16 v[44:47], v[80:83], v[240:243], v[44:47]
    s_waitcnt lgkmcnt(2)
    v_mfma_f32_16x16x32_bf16 v[32:35], v[84:87], v[148:151], v[32:35]
    v_mfma_f32_16x16x32_bf16 v[36:39], v[84:87], v[180:183], v[36:39]
    v_mfma_f32_16x16x32_bf16 v[40:43], v[84:87], v[212:215], v[40:43]
    v_mfma_f32_16x16x32_bf16 v[44:47], v[84:87], v[244:247], v[44:47]
    s_waitcnt lgkmcnt(1)
    v_mfma_f32_16x16x32_bf16 v[32:35], v[88:91], v[152:155], v[32:35]
    v_mfma_f32_16x16x32_bf16 v[36:39], v[88:91], v[184:187], v[36:39]
    v_mfma_f32_16x16x32_bf16 v[40:43], v[88:91], v[216:219], v[40:43]
    v_mfma_f32_16x16x32_bf16 v[44:47], v[88:91], v[248:251], v[44:47]
    s_waitcnt lgkmcnt(0)
    v_mfma_f32_16x16x32_bf16 v[32:35], v[92:95], v[156:159], v[32:35]
    v_mfma_f32_16x16x32_bf16 v[36:39], v[92:95], v[188:191], v[36:39]
    v_mfma_f32_16x16x32_bf16 v[40:43], v[92:95], v[220:223], v[40:43]
    v_mfma_f32_16x16x32_bf16 v[44:47], v[92:95], v[252:255], v[44:47]
    s_waitcnt vmcnt(0)
    ds_read_b128 v[96:99], v14 offset:8192
    ds_read_b128 v[100:103], v14 offset:9216
    ds_read_b128 v[104:107], v14 offset:10240
    ds_read_b128 v[108:111], v14 offset:11264
    ds_read_b128 v[112:115], v14 offset:12288
    ds_read_b128 v[116:119], v14 offset:13312
    ds_read_b128 v[120:123], v14 offset:14336
    ds_read_b128 v[124:127], v14 offset:15360
    s_waitcnt lgkmcnt(7)
    v_mfma_f32_16x16x32_bf16 v[48:51], v[96:99], v[128:131], 0
    v_mfma_f32_16x16x32_bf16 v[52:55], v[96:99], v[160:163], 0
    v_mfma_f32_16x16x32_bf16 v[56:59], v[96:99], v[192:195], 0
    v_mfma_f32_16x16x32_bf16 v[60:63], v[96:99], v[224:227], 0
    s_waitcnt lgkmcnt(6)
    v_mfma_f32_16x16x32_bf16 v[48:51], v[100:103], v[132:135], v[48:51]
    v_mfma_f32_16x16x32_bf16 v[52:55], v[100:103], v[164:167], v[52:55]
    v_mfma_f32_16x16x32_bf16 v[56:59], v[100:103], v[196:199], v[56:59]
    v_mfma_f32_16x16x32_bf16 v[60:63], v[100:103], v[228:231], v[60:63]
    s_waitcnt lgkmcnt(5)
    v_mfma_f32_16x16x32_bf16 v[48:51], v[104:107], v[136:139], v[48:51]
    v_mfma_f32_16x16x32_bf16 v[52:55], v[104:107], v[168:171], v[52:55]
    v_mfma_f32_16x16x32_bf16 v[56:59], v[104:107], v[200:203], v[56:59]
    v_mfma_f32_16x16x32_bf16 v[60:63], v[104:107], v[232:235], v[60:63]
    s_waitcnt lgkmcnt(4)
    v_mfma_f32_16x16x32_bf16 v[48:51], v[108:111], v[140:143], v[48:51]
    v_mfma_f32_16x16x32_bf16 v[52:55], v[108:111], v[172:175], v[52:55]
    v_mfma_f32_16x16x32_bf16 v[56:59], v[108:111], v[204:207], v[56:59]
    v_mfma_f32_16x16x32_bf16 v[60:63], v[108:111], v[236:239], v[60:63]
    s_waitcnt lgkmcnt(3)
    v_mfma_f32_16x16x32_bf16 v[48:51], v[112:115], v[144:147], v[48:51]
    v_mfma_f32_16x16x32_bf16 v[52:55], v[112:115], v[176:179], v[52:55]
    v_mfma_f32_16x16x32_bf16 v[56:59], v[112:115], v[208:211], v[56:59]
    v_mfma_f32_16x16x32_bf16 v[60:63], v[112:115], v[240:243], v[60:63]
    s_waitcnt lgkmcnt(2)
    v_mfma_f32_16x16x32_bf16 v[48:51], v[116:119], v[148:151], v[48:51]
    v_mfma_f32_16x16x32_bf16 v[52:55], v[116:119], v[180:183], v[52:55]
    v_mfma_f32_16x16x32_bf16 v[56:59], v[116:119], v[212:215], v[56:59]
    v_mfma_f32_16x16x32_bf16 v[60:63], v[116:119], v[244:247], v[60:63]
    s_waitcnt lgkmcnt(1)
    v_mfma_f32_16x16x32_bf16 v[48:51], v[120:123], v[152:155], v[48:51]
    v_mfma_f32_16x16x32_bf16 v[52:55], v[120:123], v[184:187], v[52:55]
    v_mfma_f32_16x16x32_bf16 v[56:59], v[120:123], v[216:219], v[56:59]
    v_mfma_f32_16x16x32_bf16 v[60:63], v[120:123], v[248:251], v[60:63]
    s_waitcnt lgkmcnt(0)
    v_mfma_f32_16x16x32_bf16 v[48:51], v[124:127], v[156:159], v[48:51]
    v_mfma_f32_16x16x32_bf16 v[52:55], v[124:127], v[188:191], v[52:55]
    v_mfma_f32_16x16x32_bf16 v[56:59], v[124:127], v[220:223], v[56:59]
    v_mfma_f32_16x16x32_bf16 v[60:63], v[124:127], v[252:255], v[60:63]
    v_mul_f32 v32, s38, v32
    v_mul_f32 v33, s38, v33
    v_mul_f32 v34, s38, v34
    v_mul_f32 v35, s38, v35
    v_cvt_pk_f16_f32 v16, v32, v33
    v_cvt_pk_f16_f32 v17, v34, v35
    v_mul_f32 v48, s38, v48
    v_mul_f32 v49, s38, v49
    v_mul_f32 v50, s38, v50
    v_mul_f32 v51, s38, v51
    v_cvt_pk_f16_f32 v18, v48, v49
    v_cvt_pk_f16_f32 v19, v50, v51
    global_store_dwordx4 v2, v[16:19], s[44:45] sc1
    v_mul_f32 v36, s38, v36
    v_mul_f32 v37, s38, v37
    v_mul_f32 v38, s38, v38
    v_mul_f32 v39, s38, v39
    v_cvt_pk_f16_f32 v20, v36, v37
    v_cvt_pk_f16_f32 v21, v38, v39
    v_mul_f32 v52, s38, v52
    v_mul_f32 v53, s38, v53
    v_mul_f32 v54, s38, v54
    v_mul_f32 v55, s38, v55
    v_cvt_pk_f16_f32 v22, v52, v53
    v_cvt_pk_f16_f32 v23, v54, v55
    global_store_dwordx4 v9, v[20:23], s[44:45] sc1
    v_mul_f32 v40, s38, v40
    v_mul_f32 v41, s38, v41
    v_mul_f32 v42, s38, v42
    v_mul_f32 v43, s38, v43
    v_cvt_pk_f16_f32 v24, v40, v41
    v_cvt_pk_f16_f32 v25, v42, v43
    v_mul_f32 v56, s38, v56
    v_mul_f32 v57, s38, v57
    v_mul_f32 v58, s38, v58
    v_mul_f32 v59, s38, v59
    v_cvt_pk_f16_f32 v26, v56, v57
    v_cvt_pk_f16_f32 v27, v58, v59
    global_store_dwordx4 v10, v[24:27], s[44:45] sc1
    v_mul_f32 v44, s38, v44
    v_mul_f32 v45, s38, v45
    v_mul_f32 v46, s38, v46
    v_mul_f32 v47, s38, v47
    v_cvt_pk_f16_f32 v28, v44, v45
    v_cvt_pk_f16_f32 v29, v46, v47
    v_mul_f32 v60, s38, v60
    v_mul_f32 v61, s38, v61
    v_mul_f32 v62, s38, v62
    v_mul_f32 v63, s38, v63
    v_cvt_pk_f16_f32 v30, v60, v61
    v_cvt_pk_f16_f32 v31, v62, v63
    global_store_dwordx4 v11, v[28:31], s[44:45] sc1
    s_mov_b32 s18, 0x1000000
NG_1:
    v_mov_b32 v8, 161840
    ds_read_b32 v8, v8
    s_sub_u32 s18, s18, 1
    s_cbranch_scc1 M_end
    s_waitcnt lgkmcnt(0)
    v_readfirstlane_b32 s19, v8
    s_cmp_eq_u32 s19, 0
    s_cbranch_scc1 NG_1
    s_waitcnt vmcnt(0)
P_fl:
    s_mov_b64 exec, 1
    global_store_dword v13, v8, s[46:47] sc1
    s_mov_b64 exec, -1
    s_branch P_abend
P_w7:
    s_waitcnt vmcnt(0)
    s_mov_b32 s18, 0x100000
    s_branch NP_2a
NP_2:
    v_mov_b32 v101, 4
    global_load_dword v100, v101, s[10:11] sc1
    s_sub_u32 s18, s18, 1
    s_cbranch_scc1 M_end
    s_waitcnt vmcnt(0)
NP_2a:
    v_readfirstlane_b32 s19, v100
    s_cmp_eq_u32 s19, 0
    s_cbranch_scc1 NP_2
    v_mov_b32 v101, 161840
    ds_write_b32 v101, v100
    s_cmp_eq_u32 s26, 0
    s_cbranch_scc1 M_w7b
    s_mov_b32 s44, s20
    s_mov_b32 s42, 147456
M_w7a:
    s_cmp_ge_u32 s44, 196
    s_cselect_b32 s45, 196, 0
    s_cselect_b32 s46, 1, 0
    s_sub_u32 s45, s44, s45
    s_mul_i32 s47, s45, 147
    s_lshr_b32 s47, s47, 10
    s_mul_i32 s48, s47, 7
    s_sub_u32 s48, s45, s48
    s_cmp_eq_u32 s46, 0
    s_cselect_b32 s49, s48, s47
    s_cselect_b32 s50, s47, s48
    s_movk_i32 s51, 896
    s_cselect_b32 s51, 3584, s51
    s_cselect_b32 s52, s72, s74
    s_cselect_b32 s53, s73, s75
    s_cselect_b32 s54, 14, 56
    s_mov_b32 s55, 0xf88000
    s_cselect_b32 s55, 0xe00000, s55
    s_mul_i32 s56, s49, s51
    s_lshl_b32 s56, s56, 6
    s_lshl_b32 s57, s50, 7
    s_add_u32 s56, s56, s57
    s_add_u32 s52, s52, s56
    s_addc_u32 s53, s53, 0
    v_mul_lo_u32 v9, v3, s51
    v_lshlrev_b32 v9, 3, v9
    v_lshl_add_u32 v9, v4, 3, v9
    global_load_dwordx2 v[16:17], v9, s[52:53]
    s_add_u32 s52, s52, s51
    s_addc_u32 s53, s53, 0
    global_load_dwordx2 v[18:19], v9, s[52:53]
    s_add_u32 s52, s52, s51
    s_addc_u32 s53, s53, 0
    global_load_dwordx2 v[20:21], v9, s[52:53]
    s_add_u32 s52, s52, s51
    s_addc_u32 s53, s53, 0
    global_load_dwordx2 v[22:23], v9, s[52:53]
    s_add_u32 s52, s52, s51
    s_addc_u32 s53, s53, 0
    global_load_dwordx2 v[24:25], v9, s[52:53]
    s_add_u32 s52, s52, s51
    s_addc_u32 s53, s53, 0
    global_load_dwordx2 v[26:27], v9, s[52:53]
    s_add_u32 s52, s52, s51
    s_addc_u32 s53, s53, 0
    global_load_dwordx2 v[28:29], v9, s[52:53]
    s_add_u32 s52, s52, s51
    s_addc_u32 s53, s53, 0
    global_load_dwordx2 v[30:31], v9, s[52:53]
    s_add_u32 s52, s52, s51
    s_addc_u32 s53, s53, 0
    s_mul_i32 s56, s51, 24
    s_add_u32 s52, s52, s56
    s_addc_u32 s53, s53, 0
    global_load_dwordx2 v[32:33], v9, s[52:53]
    s_add_u32 s52, s52, s51
    s_addc_u32 s53, s53, 0
    global_load_dwordx2 v[34:35], v9, s[52:53]
    s_add_u32 s52, s52, s51
    s_addc_u32 s53, s53, 0
    global_load_dwordx2 v[36:37], v9, s[52:53]
    s_add_u32 s52, s52, s51
    s_addc_u32 s53, s53, 0
    global_load_dwordx2 v[38:39], v9, s[52:53]
    s_add_u32 s52, s52, s51
    s_addc_u32 s53, s53, 0
    global_load_dwordx2 v[40:41], v9, s[52:53]
    s_add_u32 s52, s52, s51
    s_addc_u32 s53, s53, 0
    global_load_dwordx2 v[42:43], v9, s[52:53]
    s_add_u32 s52, s52, s51
    s_addc_u32 s53, s53, 0
    global_load_dwordx2 v[44:45], v9, s[52:53]
    s_add_u32 s52, s52, s51
    s_addc_u32 s53, s53, 0
    global_load_dwordx2 v[46:47], v9, s[52:53]
    s_add_u32 s52, s52, s51
    s_addc_u32 s53, s53, 0
    v_lshrrev_b32 v8, 3, v4
    v_lshlrev_b32 v8, 1, v8
    v_and_b32 v11, 1, v4
    v_add_u32 v8, v8, v11
    v_lshlrev_b32 v8, 10, v8
    v_bfe_u32 v11, v4, 1, 2
    v_lshl_add_u32 v8, v11, 6, v8
    v_lshl_add_u32 v8, v3, 8, v8
    v_add_u32 v8, s42, v8
    v_add_u32 v13, s42, v2
    s_mul_i32 s56, s50, s54
    s_lshl_b32 s56, s56, 2
    s_lshl_b32 s57, s49, 1
    s_add_u32 s56, s56, s57
    s_lshl_b32 s56, s56, 10
    s_add_u32 s56, s56, s55
    s_add_u32 s58, s4, s56
    s_addc_u32 s59, s5, 0
    s_lshl_b32 s54, s54, 10
    v_add_u32 v9, s54, v2
    v_add_u32 v10, s54, v9
    v_add_u32 v11, s54, v10
    s_waitcnt vmcnt(8)
    v_lshlrev_b32 v80, 16, v16
    v_lshlrev_b32 v81, 16, v18
    v_cvt_pk_f16_f32 v48, v80, v81
    v_lshlrev_b32 v82, 16, v20
    v_lshlrev_b32 v83, 16, v22
    v_cvt_pk_f16_f32 v49, v82, v83
    v_lshlrev_b32 v80, 16, v24
    v_lshlrev_b32 v81, 16, v26
    v_cvt_pk_f16_f32 v50, v80, v81
    v_lshlrev_b32 v82, 16, v28
    v_lshlrev_b32 v83, 16, v30
    v_cvt_pk_f16_f32 v51, v82, v83
    v_and_b32 v80, 0xffff0000, v16
    v_and_b32 v81, 0xffff0000, v18
    v_cvt_pk_f16_f32 v52, v80, v81
    v_and_b32 v82, 0xffff0000, v20
    v_and_b32 v83, 0xffff0000, v22
    v_cvt_pk_f16_f32 v53, v82, v83
    v_and_b32 v80, 0xffff0000, v24
    v_and_b32 v81, 0xffff0000, v26
    v_cvt_pk_f16_f32 v54, v80, v81
    v_and_b32 v82, 0xffff0000, v28
    v_and_b32 v83, 0xffff0000, v30
    v_cvt_pk_f16_f32 v55, v82, v83
    v_lshlrev_b32 v80, 16, v17
    v_lshlrev_b32 v81, 16, v19
    v_cvt_pk_f16_f32 v56, v80, v81
    v_lshlrev_b32 v82, 16, v21
    v_lshlrev_b32 v83, 16, v23
    v_cvt_pk_f16_f32 v57, v82, v83
    v_lshlrev_b32 v80, 16, v25
    v_lshlrev_b32 v81, 16, v27
    v_cvt_pk_f16_f32 v58, v80, v81
    v_lshlrev_b32 v82, 16, v29
    v_lshlrev_b32 v83, 16, v31
    v_cvt_pk_f16_f32 v59, v82, v83
    v_and_b32 v80, 0xffff0000, v17
    v_and_b32 v81, 0xffff0000, v19
    v_cvt_pk_f16_f32 v60, v80, v81
    v_and_b32 v82, 0xffff0000, v21
    v_and_b32 v83, 0xffff0000, v23
    v_cvt_pk_f16_f32 v61, v82, v83
    v_and_b32 v80, 0xffff0000, v25
    v_and_b32 v81, 0xffff0000, v27
    v_cvt_pk_f16_f32 v62, v80, v81
    v_and_b32 v82, 0xffff0000, v29
    v_and_b32 v83, 0xffff0000, v31
    v_cvt_pk_f16_f32 v63, v82, v83
    ds_write_b128 v8, v[48:51] offset:0
    ds_write_b128 v8, v[52:55] offset:16
    ds_write_b128 v8, v[56:59] offset:32
    ds_write_b128 v8, v[60:63] offset:48
    s_waitcnt vmcnt(0)
    v_lshlrev_b32 v80, 16, v32
    v_lshlrev_b32 v81, 16, v34
    v_cvt_pk_f16_f32 v64, v80, v81
    v_lshlrev_b32 v82, 16, v36
    v_lshlrev_b32 v83, 16, v38
    v_cvt_pk_f16_f32 v65, v82, v83
    v_lshlrev_b32 v80, 16, v40
    v_lshlrev_b32 v81, 16, v42
    v_cvt_pk_f16_f32 v66, v80, v81
    v_lshlrev_b32 v82, 16, v44
    v_lshlrev_b32 v83, 16, v46
    v_cvt_pk_f16_f32 v67, v82, v83
    v_and_b32 v80, 0xffff0000, v32
    v_and_b32 v81, 0xffff0000, v34
    v_cvt_pk_f16_f32 v68, v80, v81
    v_and_b32 v82, 0xffff0000, v36
    v_and_b32 v83, 0xffff0000, v38
    v_cvt_pk_f16_f32 v69, v82, v83
    v_and_b32 v80, 0xffff0000, v40
    v_and_b32 v81, 0xffff0000, v42
    v_cvt_pk_f16_f32 v70, v80, v81
    v_and_b32 v82, 0xffff0000, v44
    v_and_b32 v83, 0xffff0000, v46
    v_cvt_pk_f16_f32 v71, v82, v83
    v_lshlrev_b32 v80, 16, v33
    v_lshlrev_b32 v81, 16, v35
    v_cvt_pk_f16_f32 v72, v80, v81
    v_lshlrev_b32 v82, 16, v37
    v_lshlrev_b32 v83, 16, v39
    v_cvt_pk_f16_f32 v73, v82, v83
    v_lshlrev_b32 v80, 16, v41
    v_lshlrev_b32 v81, 16, v43
    v_cvt_pk_f16_f32 v74, v80, v81
    v_lshlrev_b32 v82, 16, v45
    v_lshlrev_b32 v83, 16, v47
    v_cvt_pk_f16_f32 v75, v82, v83
    v_and_b32 v80, 0xffff0000, v33
    v_and_b32 v81, 0xffff0000, v35
    v_cvt_pk_f16_f32 v76, v80, v81
    v_and_b32 v82, 0xffff0000, v37
    v_and_b32 v83, 0xffff0000, v39
    v_cvt_pk_f16_f32 v77, v82, v83
    v_and_b32 v80, 0xffff0000, v41
    v_and_b32 v81, 0xffff0000, v43
    v_cvt_pk_f16_f32 v78, v80, v81
    v_and_b32 v82, 0xffff0000, v45
    v_and_b32 v83, 0xffff0000, v47
    v_cvt_pk_f16_f32 v79, v82, v83
    ds_write_b128 v8, v[64:67] offset:4096
    ds_write_b128 v8, v[68:71] offset:4112
    ds_write_b128 v8, v[72:75] offset:4128
    ds_write_b128 v8, v[76:79] offset:4144
    s_waitcnt lgkmcnt(0)
    ds_read_b128 v[16:19], v13 offset:0
    ds_read_b128 v[20:23], v13 offset:1024
    ds_read_b128 v[24:27], v13 offset:2048
    ds_read_b128 v[28:31], v13 offset:3072
    ds_read_b128 v[32:35], v13 offset:4096
    ds_read_b128 v[36:39], v13 offset:5120
    ds_read_b128 v[40:43], v13 offset:6144
    ds_read_b128 v[44:47], v13 offset:7168
    s_waitcnt lgkmcnt(7)
    global_store_dwordx4 v2, v[16:19], s[58:59] offset:0 sc1
    s_waitcnt lgkmcnt(6)
    global_store_dwordx4 v9, v[20:23], s[58:59] offset:0 sc1
    s_waitcnt lgkmcnt(5)
    global_store_dwordx4 v10, v[24:27], s[58:59] offset:0 sc1
    s_waitcnt lgkmcnt(4)
    global_store_dwordx4 v11, v[28:31], s[58:59] offset:0 sc1
    s_waitcnt lgkmcnt(3)
    global_store_dwordx4 v2, v[32:35], s[58:59] offset:1024 sc1
    s_waitcnt lgkmcnt(2)
    global_store_dwordx4 v9, v[36:39], s[58:59] offset:1024 sc1
    s_waitcnt lgkmcnt(1)
    global_store_dwordx4 v10, v[40:43], s[58:59] offset:1024 sc1
    s_waitcnt lgkmcnt(0)
    global_store_dwordx4 v11, v[44:47], s[58:59] offset:1024 sc1
    s_add_u32 s44, s44, 224
    s_cmp_lt_u32 s44, 392
    s_cbranch_scc1 M_w7a
    s_branch P_abend
M_w7b:
    s_cmp_ge_u32 s20, 128
    s_cbranch_scc1 M_w7c
    v_add_u32 v14, 147456, v14
    ds_read_b128 v[16:19], v14 offset:0
    ds_read_b128 v[20:23], v14 offset:1024
    ds_read_b128 v[24:27], v14 offset:2048
    ds_read_b128 v[28:31], v14 offset:3072
    ds_read_b128 v[32:35], v14 offset:4096
    ds_read_b128 v[36:39], v14 offset:5120
    ds_read_b128 v[40:43], v14 offset:6144
    ds_read_b128 v[44:47], v14 offset:7168
    ds_read_b128 v[48:51], v14 offset:8192
    ds_read_b128 v[52:55], v14 offset:9216
    ds_read_b128 v[56:59], v14 offset:10240
    ds_read_b128 v[60:63], v14 offset:11264
    ds_read_b128 v[64:67], v14 offset:12288
    ds_read_b128 v[68:71], v14 offset:13312
    s_waitcnt lgkmcnt(13)
    v_lshlrev_b32 v80, 16, v16
    v_and_b32 v81, 0xffff0000, v16
    v_lshlrev_b32 v82, 16, v17
    v_and_b32 v83, 0xffff0000, v17
    v_lshlrev_b32 v84, 16, v18
    v_and_b32 v85, 0xffff0000, v18
    v_lshlrev_b32 v86, 16, v19
    v_and_b32 v87, 0xffff0000, v19
    s_waitcnt lgkmcnt(12)
    v_lshlrev_b32 v88, 16, v20
    v_and_b32 v89, 0xffff0000, v20
    v_lshlrev_b32 v90, 16, v21
    v_and_b32 v91, 0xffff0000, v21
    v_lshlrev_b32 v92, 16, v22
    v_and_b32 v93, 0xffff0000, v22
    v_lshlrev_b32 v94, 16, v23
    v_and_b32 v95, 0xffff0000, v23
    s_waitcnt lgkmcnt(11)
    v_lshlrev_b32 v96, 16, v24
    v_and_b32 v97, 0xffff0000, v24
    v_lshlrev_b32 v98, 16, v25
    v_and_b32 v99, 0xffff0000, v25
    v_lshlrev_b32 v100, 16, v26
    v_and_b32 v101, 0xffff0000, v26
    v_lshlrev_b32 v102, 16, v27
    v_and_b32 v103, 0xffff0000, v27
    s_waitcnt lgkmcnt(10)
    v_lshlrev_b32 v104, 16, v28
    v_and_b32 v105, 0xffff0000, v28
    v_lshlrev_b32 v106, 16, v29
    v_and_b32 v107, 0xffff0000, v29
    v_lshlrev_b32 v108, 16, v30
    v_and_b32 v109, 0xffff0000, v30
    v_lshlrev_b32 v110, 16, v31
    v_and_b32 v111, 0xffff0000, v31
    s_waitcnt lgkmcnt(9)
    v_lshlrev_b32 v112, 16, v32
    v_and_b32 v113, 0xffff0000, v32
    v_lshlrev_b32 v114, 16, v33
    v_and_b32 v115, 0xffff0000, v33
    v_lshlrev_b32 v116, 16, v34
    v_and_b32 v117, 0xffff0000, v34
    v_lshlrev_b32 v118, 16, v35
    v_and_b32 v119, 0xffff0000, v35
    s_waitcnt lgkmcnt(8)
    v_lshlrev_b32 v120, 16, v36
    v_and_b32 v121, 0xffff0000, v36
    v_lshlrev_b32 v122, 16, v37
    v_and_b32 v123, 0xffff0000, v37
    v_lshlrev_b32 v124, 16, v38
    v_and_b32 v125, 0xffff0000, v38
    v_lshlrev_b32 v126, 16, v39
    v_and_b32 v127, 0xffff0000, v39
    s_waitcnt lgkmcnt(7)
    v_lshlrev_b32 v128, 16, v40
    v_and_b32 v129, 0xffff0000, v40
    v_lshlrev_b32 v130, 16, v41
    v_and_b32 v131, 0xffff0000, v41
    v_lshlrev_b32 v132, 16, v42
    v_and_b32 v133, 0xffff0000, v42
    v_lshlrev_b32 v134, 16, v43
    v_and_b32 v135, 0xffff0000, v43
    s_waitcnt lgkmcnt(6)
    v_lshlrev_b32 v136, 16, v44
    v_and_b32 v137, 0xffff0000, v44
    v_lshlrev_b32 v138, 16, v45
    v_and_b32 v139, 0xffff0000, v45
    v_lshlrev_b32 v140, 16, v46
    v_and_b32 v141, 0xffff0000, v46
    v_lshlrev_b32 v142, 16, v47
    v_and_b32 v143, 0xffff0000, v47
    s_waitcnt lgkmcnt(5)
    v_lshlrev_b32 v144, 16, v48
    v_and_b32 v145, 0xffff0000, v48
    v_lshlrev_b32 v146, 16, v49
    v_and_b32 v147, 0xffff0000, v49
    v_lshlrev_b32 v148, 16, v50
    v_and_b32 v149, 0xffff0000, v50
    v_lshlrev_b32 v150, 16, v51
    v_and_b32 v151, 0xffff0000, v51
    s_waitcnt lgkmcnt(4)
    v_lshlrev_b32 v152, 16, v52
    v_and_b32 v153, 0xffff0000, v52
    v_lshlrev_b32 v154, 16, v53
    v_and_b32 v155, 0xffff0000, v53
    v_lshlrev_b32 v156, 16, v54
    v_and_b32 v157, 0xffff0000, v54
    v_lshlrev_b32 v158, 16, v55
    v_and_b32 v159, 0xffff0000, v55
    s_waitcnt lgkmcnt(3)
    v_lshlrev_b32 v160, 16, v56
    v_and_b32 v161, 0xffff0000, v56
    v_lshlrev_b32 v162, 16, v57
    v_and_b32 v163, 0xffff0000, v57
    v_lshlrev_b32 v164, 16, v58
    v_and_b32 v165, 0xffff0000, v58
    v_lshlrev_b32 v166, 16, v59
    v_and_b32 v167, 0xffff0000, v59
    s_waitcnt lgkmcnt(2)
    v_lshlrev_b32 v168, 16, v60
    v_and_b32 v169, 0xffff0000, v60
    v_lshlrev_b32 v170, 16, v61
    v_and_b32 v171, 0xffff0000, v61
    v_lshlrev_b32 v172, 16, v62
    v_and_b32 v173, 0xffff0000, v62
    v_lshlrev_b32 v174, 16, v63
    v_and_b32 v175, 0xffff0000, v63
    s_waitcnt lgkmcnt(1)
    v_lshlrev_b32 v176, 16, v64
    v_and_b32 v177, 0xffff0000, v64
    v_lshlrev_b32 v178, 16, v65
    v_and_b32 v179, 0xffff0000, v65
    v_lshlrev_b32 v180, 16, v66
    v_and_b32 v181, 0xffff0000, v66
    v_lshlrev_b32 v182, 16, v67
    v_and_b32 v183, 0xffff0000, v67
    s_waitcnt lgkmcnt(0)
    v_lshlrev_b32 v184, 16, v68
    v_and_b32 v185, 0xffff0000, v68
    v_lshlrev_b32 v186, 16, v69
    v_and_b32 v187, 0xffff0000, v69
    v_lshlrev_b32 v188, 16, v70
    v_and_b32 v189, 0xffff0000, v70
    v_lshlrev_b32 v190, 16, v71
    v_and_b32 v191, 0xffff0000, v71
    v_pk_add_f32 v[8:9], v[80:81], v[84:85]
    v_pk_add_f32 v[10:11], v[82:83], v[86:87]
    v_pk_add_f32 v[8:9], v[8:9], v[88:89]
    v_pk_add_f32 v[10:11], v[10:11], v[90:91]
    v_pk_add_f32 v[8:9], v[8:9], v[92:93]
    v_pk_add_f32 v[10:11], v[10:11], v[94:95]
    v_pk_add_f32 v[8:9], v[8:9], v[96:97]
    v_pk_add_f32 v[10:11], v[10:11], v[98:99]
    v_pk_add_f32 v[8:9], v[8:9], v[100:101]
    v_pk_add_f32 v[10:11], v[10:11], v[102:103]
    v_pk_add_f32 v[8:9], v[8:9], v[104:105]
    v_pk_add_f32 v[10:11], v[10:11], v[106:107]
    v_pk_add_f32 v[8:9], v[8:9], v[108:109]
    v_pk_add_f32 v[10:11], v[10:11], v[110:111]
    v_pk_add_f32 v[8:9], v[8:9], v[112:113]
    v_pk_add_f32 v[10:11], v[10:11], v[114:115]
    v_pk_add_f32 v[8:9], v[8:9], v[116:117]
    v_pk_add_f32 v[10:11], v[10:11], v[118:119]
    v_pk_add_f32 v[8:9], v[8:9], v[120:121]
    v_pk_add_f32 v[10:11], v[10:11], v[122:123]
    v_pk_add_f32 v[8:9], v[8:9], v[124:125]
    v_pk_add_f32 v[10:11], v[10:11], v[126:127]
    v_pk_add_f32 v[8:9], v[8:9], v[128:129]
    v_pk_add_f32 v[10:11], v[10:11], v[130:131]
    v_pk_add_f32 v[8:9], v[8:9], v[132:133]
    v_pk_add_f32 v[10:11], v[10:11], v[134:135]
    v_pk_add_f32 v[8:9], v[8:9], v[136:137]
    v_pk_add_f32 v[10:11], v[10:11], v[138:139]
    v_pk_add_f32 v[8:9], v[8:9], v[140:141]
    v_pk_add_f32 v[10:11], v[10:11], v[142:143]
    v_pk_add_f32 v[8:9], v[8:9], v[144:145]
    v_pk_add_f32 v[10:11], v[10:11], v[146:147]
    v_pk_add_f32 v[8:9], v[8:9], v[148:149]
    v_pk_add_f32 v[10:11], v[10:11], v[150:151]
    v_pk_add_f32 v[8:9], v[8:9], v[152:153]
    v_pk_add_f32 v[10:11], v[10:11], v[154:155]
    v_pk_add_f32 v[8:9], v[8:9], v[156:157]
    v_pk_add_f32 v[10:11], v[10:11], v[158:159]
    v_pk_add_f32 v[8:9], v[8:9], v[160:161]
    v_pk_add_f32 v[10:11], v[10:11], v[162:163]
    v_pk_add_f32 v[8:9], v[8:9], v[164:165]
    v_pk_add_f32 v[10:11], v[10:11], v[166:167]
    v_pk_add_f32 v[8:9], v[8:9], v[168:169]
    v_pk_add_f32 v[10:11], v[10:11], v[170:171]
    v_pk_add_f32 v[8:9], v[8:9], v[172:173]
    v_pk_add_f32 v[10:11], v[10:11], v[174:175]
    v_pk_add_f32 v[8:9], v[8:9], v[176:177]
    v_pk_add_f32 v[10:11], v[10:11], v[178:179]
    v_pk_add_f32 v[8:9], v[8:9], v[180:181]
    v_pk_add_f32 v[10:11], v[10:11], v[182:183]
    v_pk_add_f32 v[8:9], v[8:9], v[184:185]
    v_pk_add_f32 v[10:11], v[10:11], v[186:187]
    v_pk_add_f32 v[8:9], v[8:9], v[188:189]
    v_pk_add_f32 v[10:11], v[10:11], v[190:191]
    v_pk_add_f32 v[8:9], v[8:9], v[10:11]
    v_add_f32 v8, v8, v9
    v_mov_b32 v9, v8
    s_nop 1
    v_permlane32_swap_b32 v8, v9
    v_add_f32 v8, v8, v9
    v_mov_b32 v9, v8
    s_nop 1
    v_permlane16_swap_b32 v8, v9
    v_add_f32 v8, v8, v9
    v_mul_f32 v12, 0xbb124925, v8
    v_mov_b32 v13, v12
    v_pk_add_f32 v[80:81], v[80:81], v[12:13]
    v_pk_add_f32 v[82:83], v[82:83], v[12:13]
    v_pk_add_f32 v[84:85], v[84:85], v[12:13]
    v_pk_add_f32 v[86:87], v[86:87], v[12:13]
    v_pk_add_f32 v[88:89], v[88:89], v[12:13]
    v_pk_add_f32 v[90:91], v[90:91], v[12:13]
    v_pk_add_f32 v[92:93], v[92:93], v[12:13]
    v_pk_add_f32 v[94:95], v[94:95], v[12:13]
    v_pk_add_f32 v[96:97], v[96:97], v[12:13]
    v_pk_add_f32 v[98:99], v[98:99], v[12:13]
    v_pk_add_f32 v[100:101], v[100:101], v[12:13]
    v_pk_add_f32 v[102:103], v[102:103], v[12:13]
    v_pk_add_f32 v[104:105], v[104:105], v[12:13]
    v_pk_add_f32 v[106:107], v[106:107], v[12:13]
    v_pk_add_f32 v[108:109], v[108:109], v[12:13]
    v_pk_add_f32 v[110:111], v[110:111], v[12:13]
    v_pk_add_f32 v[112:113], v[112:113], v[12:13]
    v_pk_add_f32 v[114:115], v[114:115], v[12:13]
    v_pk_add_f32 v[116:117], v[116:117], v[12:13]
    v_pk_add_f32 v[118:119], v[118:119], v[12:13]
    v_pk_add_f32 v[120:121], v[120:121], v[12:13]
    v_pk_add_f32 v[122:123], v[122:123], v[12:13]
    v_pk_add_f32 v[124:125], v[124:125], v[12:13]
    v_pk_add_f32 v[126:127], v[126:127], v[12:13]
    v_pk_add_f32 v[128:129], v[128:129], v[12:13]
    v_pk_add_f32 v[130:131], v[130:131], v[12:13]
    v_pk_add_f32 v[132:133], v[132:133], v[12:13]
    v_pk_add_f32 v[134:135], v[134:135], v[12:13]
    v_pk_add_f32 v[136:137], v[136:137], v[12:13]
    v_pk_add_f32 v[138:139], v[138:139], v[12:13]
    v_pk_add_f32 v[140:141], v[140:141], v[12:13]
    v_pk_add_f32 v[142:143], v[142:143], v[12:13]
    v_pk_add_f32 v[144:145], v[144:145], v[12:13]
    v_pk_add_f32 v[146:147], v[146:147], v[12:13]
    v_pk_add_f32 v[148:149], v[148:149], v[12:13]
    v_pk_add_f32 v[150:151], v[150:151], v[12:13]
    v_pk_add_f32 v[152:153], v[152:153], v[12:13]
    v_pk_add_f32 v[154:155], v[154:155], v[12:13]
    v_pk_add_f32 v[156:157], v[156:157], v[12:13]
    v_pk_add_f32 v[158:159], v[158:159], v[12:13]
    v_pk_add_f32 v[160:161], v[160:161], v[12:13]
    v_pk_add_f32 v[162:163], v[162:163], v[12:13]
    v_pk_add_f32 v[164:165], v[164:165], v[12:13]
    v_pk_add_f32 v[166:167], v[166:167], v[12:13]
    v_pk_add_f32 v[168:169], v[168:169], v[12:13]
    v_pk_add_f32 v[170:171], v[170:171], v[12:13]
    v_pk_add_f32 v[172:173], v[172:173], v[12:13]
    v_pk_add_f32 v[174:175], v[174:175], v[12:13]
    v_pk_add_f32 v[176:177], v[176:177], v[12:13]
    v_pk_add_f32 v[178:179], v[178:179], v[12:13]
    v_pk_add_f32 v[180:181], v[180:181], v[12:13]
    v_pk_add_f32 v[182:183], v[182:183], v[12:13]
    v_pk_add_f32 v[184:185], v[184:185], v[12:13]
    v_pk_add_f32 v[186:187], v[186:187], v[12:13]
    v_pk_add_f32 v[188:189], v[188:189], v[12:13]
    v_pk_add_f32 v[190:191], v[190:191], v[12:13]
    v_pk_mul_f32 v[8:9], v[80:81], v[80:81]
    v_pk_mul_f32 v[10:11], v[82:83], v[82:83]
    v_pk_fma_f32 v[8:9], v[84:85], v[84:85], v[8:9]
    v_pk_fma_f32 v[10:11], v[86:87], v[86:87], v[10:11]
    v_pk_fma_f32 v[8:9], v[88:89], v[88:89], v[8:9]
    v_pk_fma_f32 v[10:11], v[90:91], v[90:91], v[10:11]
    v_pk_fma_f32 v[8:9], v[92:93], v[92:93], v[8:9]
    v_pk_fma_f32 v[10:11], v[94:95], v[94:95], v[10:11]
    v_pk_fma_f32 v[8:9], v[96:97], v[96:97], v[8:9]
    v_pk_fma_f32 v[10:11], v[98:99], v[98:99], v[10:11]
    v_pk_fma_f32 v[8:9], v[100:101], v[100:101], v[8:9]
    v_pk_fma_f32 v[10:11], v[102:103], v[102:103], v[10:11]
    v_pk_fma_f32 v[8:9], v[104:105], v[104:105], v[8:9]
    v_pk_fma_f32 v[10:11], v[106:107], v[106:107], v[10:11]
    v_pk_fma_f32 v[8:9], v[108:109], v[108:109], v[8:9]
    v_pk_fma_f32 v[10:11], v[110:111], v[110:111], v[10:11]
    v_pk_fma_f32 v[8:9], v[112:113], v[112:113], v[8:9]
    v_pk_fma_f32 v[10:11], v[114:115], v[114:115], v[10:11]
    v_pk_fma_f32 v[8:9], v[116:117], v[116:117], v[8:9]
    v_pk_fma_f32 v[10:11], v[118:119], v[118:119], v[10:11]
    v_pk_fma_f32 v[8:9], v[120:121], v[120:121], v[8:9]
    v_pk_fma_f32 v[10:11], v[122:123], v[122:123], v[10:11]
    v_pk_fma_f32 v[8:9], v[124:125], v[124:125], v[8:9]
    v_pk_fma_f32 v[10:11], v[126:127], v[126:127], v[10:11]
    v_pk_fma_f32 v[8:9], v[128:129], v[128:129], v[8:9]
    v_pk_fma_f32 v[10:11], v[130:131], v[130:131], v[10:11]
    v_pk_fma_f32 v[8:9], v[132:133], v[132:133], v[8:9]
    v_pk_fma_f32 v[10:11], v[134:135], v[134:135], v[10:11]
    v_pk_fma_f32 v[8:9], v[136:137], v[136:137], v[8:9]
    v_pk_fma_f32 v[10:11], v[138:139], v[138:139], v[10:11]
    v_pk_fma_f32 v[8:9], v[140:141], v[140:141], v[8:9]
    v_pk_fma_f32 v[10:11], v[142:143], v[142:143], v[10:11]
    v_pk_fma_f32 v[8:9], v[144:145], v[144:145], v[8:9]
    v_pk_fma_f32 v[10:11], v[146:147], v[146:147], v[10:11]
    v_pk_fma_f32 v[8:9], v[148:149], v[148:149], v[8:9]
    v_pk_fma_f32 v[10:11], v[150:151], v[150:151], v[10:11]
    v_pk_fma_f32 v[8:9], v[152:153], v[152:153], v[8:9]
    v_pk_fma_f32 v[10:11], v[154:155], v[154:155], v[10:11]
    v_pk_fma_f32 v[8:9], v[156:157], v[156:157], v[8:9]
    v_pk_fma_f32 v[10:11], v[158:159], v[158:159], v[10:11]
    v_pk_fma_f32 v[8:9], v[160:161], v[160:161], v[8:9]
    v_pk_fma_f32 v[10:11], v[162:163], v[162:163], v[10:11]
    v_pk_fma_f32 v[8:9], v[164:165], v[164:165], v[8:9]
    v_pk_fma_f32 v[10:11], v[166:167], v[166:167], v[10:11]
    v_pk_fma_f32 v[8:9], v[168:169], v[168:169], v[8:9]
    v_pk_fma_f32 v[10:11], v[170:171], v[170:171], v[10:11]
    v_pk_fma_f32 v[8:9], v[172:173], v[172:173], v[8:9]
    v_pk_fma_f32 v[10:11], v[174:175], v[174:175], v[10:11]
    v_pk_fma_f32 v[8:9], v[176:177], v[176:177], v[8:9]
    v_pk_fma_f32 v[10:11], v[178:179], v[178:179], v[10:11]
    v_pk_fma_f32 v[8:9], v[180:181], v[180:181], v[8:9]
    v_pk_fma_f32 v[10:11], v[182:183], v[182:183], v[10:11]
    v_pk_fma_f32 v[8:9], v[184:185], v[184:185], v[8:9]
    v_pk_fma_f32 v[10:11], v[186:187], v[186:187], v[10:11]
    v_pk_fma_f32 v[8:9], v[188:189], v[188:189], v[8:9]
    v_pk_fma_f32 v[10:11], v[190:191], v[190:191], v[10:11]
    v_pk_add_f32 v[8:9], v[8:9], v[10:11]
    v_add_f32 v8, v8, v9
    v_mov_b32 v9, v8
    s_nop 1
    v_permlane32_swap_b32 v8, v9
    v_add_f32 v8, v8, v9
    v_mov_b32 v9, v8
    s_nop 1
    v_permlane16_swap_b32 v8, v9
    v_add_f32 v8, v8, v9
    v_mov_b32 v12, 0x3727c5ac
    v_fmac_f32 v12, 0x3b124925, v8
    v_sqrt_f32 v12, v12
    s_nop 0
    v_rcp_f32 v12, v12
    s_mul_i32 s36, s20, 14336
    s_add_u32 s36, s36, 0x1000
    s_add_u32 s36, s4, s36
    s_addc_u32 s37, s5, 0
    v_mov_b32 v13, v12
    v_pk_mul_f32 v[80:81], v[80:81], v[12:13]
    v_pk_mul_f32 v[82:83], v[82:83], v[12:13]
    v_pk_mul_f32 v[84:85], v[84:85], v[12:13]
    v_pk_mul_f32 v[86:87], v[86:87], v[12:13]
    v_cvt_pk_f16_f32 v16, v80, v81
    v_cvt_pk_f16_f32 v17, v82, v83
    v_cvt_pk_f16_f32 v18, v84, v85
    v_cvt_pk_f16_f32 v19, v86, v87
    global_store_dwordx4 v2, v[16:19], s[36:37] offset:-4096 sc1
    v_pk_mul_f32 v[88:89], v[88:89], v[12:13]
    v_pk_mul_f32 v[90:91], v[90:91], v[12:13]
    v_pk_mul_f32 v[92:93], v[92:93], v[12:13]
    v_pk_mul_f32 v[94:95], v[94:95], v[12:13]
    v_cvt_pk_f16_f32 v20, v88, v89
    v_cvt_pk_f16_f32 v21, v90, v91
    v_cvt_pk_f16_f32 v22, v92, v93
    v_cvt_pk_f16_f32 v23, v94, v95
    global_store_dwordx4 v2, v[20:23], s[36:37] offset:-3072 sc1
    v_pk_mul_f32 v[96:97], v[96:97], v[12:13]
    v_pk_mul_f32 v[98:99], v[98:99], v[12:13]
    v_pk_mul_f32 v[100:101], v[100:101], v[12:13]
    v_pk_mul_f32 v[102:103], v[102:103], v[12:13]
    v_cvt_pk_f16_f32 v24, v96, v97
    v_cvt_pk_f16_f32 v25, v98, v99
    v_cvt_pk_f16_f32 v26, v100, v101
    v_cvt_pk_f16_f32 v27, v102, v103
    global_store_dwordx4 v2, v[24:27], s[36:37] offset:-2048 sc1
    v_pk_mul_f32 v[104:105], v[104:105], v[12:13]
    v_pk_mul_f32 v[106:107], v[106:107], v[12:13]
    v_pk_mul_f32 v[108:109], v[108:109], v[12:13]
    v_pk_mul_f32 v[110:111], v[110:111], v[12:13]
    v_cvt_pk_f16_f32 v28, v104, v105
    v_cvt_pk_f16_f32 v29, v106, v107
    v_cvt_pk_f16_f32 v30, v108, v109
    v_cvt_pk_f16_f32 v31, v110, v111
    global_store_dwordx4 v2, v[28:31], s[36:37] offset:-1024 sc1
    v_pk_mul_f32 v[112:113], v[112:113], v[12:13]
    v_pk_mul_f32 v[114:115], v[114:115], v[12:13]
    v_pk_mul_f32 v[116:117], v[116:117], v[12:13]
    v_pk_mul_f32 v[118:119], v[118:119], v[12:13]
    v_cvt_pk_f16_f32 v32, v112, v113
    v_cvt_pk_f16_f32 v33, v114, v115
    v_cvt_pk_f16_f32 v34, v116, v117
    v_cvt_pk_f16_f32 v35, v118, v119
    global_store_dwordx4 v2, v[32:35], s[36:37] offset:0 sc1
    v_pk_mul_f32 v[120:121], v[120:121], v[12:13]
    v_pk_mul_f32 v[122:123], v[122:123], v[12:13]
    v_pk_mul_f32 v[124:125], v[124:125], v[12:13]
    v_pk_mul_f32 v[126:127], v[126:127], v[12:13]
    v_cvt_pk_f16_f32 v36, v120, v121
    v_cvt_pk_f16_f32 v37, v122, v123
    v_cvt_pk_f16_f32 v38, v124, v125
    v_cvt_pk_f16_f32 v39, v126, v127
    global_store_dwordx4 v2, v[36:39], s[36:37] offset:1024 sc1
    v_pk_mul_f32 v[128:129], v[128:129], v[12:13]
    v_pk_mul_f32 v[130:131], v[130:131], v[12:13]
    v_pk_mul_f32 v[132:133], v[132:133], v[12:13]
    v_pk_mul_f32 v[134:135], v[134:135], v[12:13]
    v_cvt_pk_f16_f32 v40, v128, v129
    v_cvt_pk_f16_f32 v41, v130, v131
    v_cvt_pk_f16_f32 v42, v132, v133
    v_cvt_pk_f16_f32 v43, v134, v135
    global_store_dwordx4 v2, v[40:43], s[36:37] offset:2048 sc1
    v_pk_mul_f32 v[136:137], v[136:137], v[12:13]
    v_pk_mul_f32 v[138:139], v[138:139], v[12:13]
    v_pk_mul_f32 v[140:141], v[140:141], v[12:13]
    v_pk_mul_f32 v[142:143], v[142:143], v[12:13]
    v_cvt_pk_f16_f32 v44, v136, v137
    v_cvt_pk_f16_f32 v45, v138, v139
    v_cvt_pk_f16_f32 v46, v140, v141
    v_cvt_pk_f16_f32 v47, v142, v143
    global_store_dwordx4 v2, v[44:47], s[36:37] offset:3072 sc1
    s_add_u32 s36, s36, 8192
    s_addc_u32 s37, s37, 0
    v_pk_mul_f32 v[144:145], v[144:145], v[12:13]
    v_pk_mul_f32 v[146:147], v[146:147], v[12:13]
    v_pk_mul_f32 v[148:149], v[148:149], v[12:13]
    v_pk_mul_f32 v[150:151], v[150:151], v[12:13]
    v_cvt_pk_f16_f32 v48, v144, v145
    v_cvt_pk_f16_f32 v49, v146, v147
    v_cvt_pk_f16_f32 v50, v148, v149
    v_cvt_pk_f16_f32 v51, v150, v151
    global_store_dwordx4 v2, v[48:51], s[36:37] offset:-4096 sc1
    v_pk_mul_f32 v[152:153], v[152:153], v[12:13]
    v_pk_mul_f32 v[154:155], v[154:155], v[12:13]
    v_pk_mul_f32 v[156:157], v[156:157], v[12:13]
    v_pk_mul_f32 v[158:159], v[158:159], v[12:13]
    v_cvt_pk_f16_f32 v52, v152, v153
    v_cvt_pk_f16_f32 v53, v154, v155
    v_cvt_pk_f16_f32 v54, v156, v157
    v_cvt_pk_f16_f32 v55, v158, v159
    global_store_dwordx4 v2, v[52:55], s[36:37] offset:-3072 sc1
    v_pk_mul_f32 v[160:161], v[160:161], v[12:13]
    v_pk_mul_f32 v[162:163], v[162:163], v[12:13]
    v_pk_mul_f32 v[164:165], v[164:165], v[12:13]
    v_pk_mul_f32 v[166:167], v[166:167], v[12:13]
    v_cvt_pk_f16_f32 v56, v160, v161
    v_cvt_pk_f16_f32 v57, v162, v163
    v_cvt_pk_f16_f32 v58, v164, v165
    v_cvt_pk_f16_f32 v59, v166, v167
    global_store_dwordx4 v2, v[56:59], s[36:37] offset:-2048 sc1
    v_pk_mul_f32 v[168:169], v[168:169], v[12:13]
    v_pk_mul_f32 v[170:171], v[170:171], v[12:13]
    v_pk_mul_f32 v[172:173], v[172:173], v[12:13]
    v_pk_mul_f32 v[174:175], v[174:175], v[12:13]
    v_cvt_pk_f16_f32 v60, v168, v169
    v_cvt_pk_f16_f32 v61, v170, v171
    v_cvt_pk_f16_f32 v62, v172, v173
    v_cvt_pk_f16_f32 v63, v174, v175
    global_store_dwordx4 v2, v[60:63], s[36:37] offset:-1024 sc1
    v_pk_mul_f32 v[176:177], v[176:177], v[12:13]
    v_pk_mul_f32 v[178:179], v[178:179], v[12:13]
    v_pk_mul_f32 v[180:181], v[180:181], v[12:13]
    v_pk_mul_f32 v[182:183], v[182:183], v[12:13]
    v_cvt_pk_f16_f32 v64, v176, v177
    v_cvt_pk_f16_f32 v65, v178, v179
    v_cvt_pk_f16_f32 v66, v180, v181
    v_cvt_pk_f16_f32 v67, v182, v183
    global_store_dwordx4 v2, v[64:67], s[36:37] offset:0 sc1
    v_pk_mul_f32 v[184:185], v[184:185], v[12:13]
    v_pk_mul_f32 v[186:187], v[186:187], v[12:13]
    v_pk_mul_f32 v[188:189], v[188:189], v[12:13]
    v_pk_mul_f32 v[190:191], v[190:191], v[12:13]
    v_cvt_pk_f16_f32 v68, v184, v185
    v_cvt_pk_f16_f32 v69, v186, v187
    v_cvt_pk_f16_f32 v70, v188, v189
    v_cvt_pk_f16_f32 v71, v190, v191
    global_store_dwordx4 v2, v[68:71], s[36:37] offset:1024 sc1
    s_lshl_b32 s36, s20, 2
    s_add_u32 s36, s36, 0x5b91000
    v_lshlrev_b32 v8, 9, v1
    v_add_u32 v8, s36, v8
    v_mov_b32 v9, s19
    s_waitcnt vmcnt(0)
    s_mov_b32 exec_hi, 0
    global_store_dword v8, v9, s[4:5] sc1
    s_mov_b64 exec, -1
M_w7c:
    s_lshr_b32 s21, s20, 5
    s_lshl_b32 s21, s21, 2
    s_add_u32 s21, s21, 161856
    s_lshl_b32 s22, 1, s20
    v_mov_b32 v6, s21
    v_mov_b32 v7, s22
    ds_or_b32 v6, v7
    v_and_b32 v6, 7, v1
    v_lshlrev_b32 v6, 5, v6
    s_mov_b32 s22, 3
M_l0:
    global_load_dword v8, v6, s[10:11] sc1
    s_waitcnt vmcnt(0)
    v_cmp_gt_u32 vcc, 32, v8
    s_and_b32 s21, vcc_lo, 0xff
    s_cbranch_scc0 M_l1
    s_sub_u32 s22, s22, 1
    s_cbranch_scc0 M_l0
M_l1:
    v_mov_b32 v6, 161828
    v_mov_b32 v9, s21
    ds_write_b32 v6, v9
    s_waitcnt lgkmcnt(0)
P_abend:
    s_setprio 0
    s_cmp_eq_u32 s26, 0
    s_cbranch_scc1 M_ab3
    s_mov_b32 s38, 44
    s_waitcnt vmcnt(0)
    s_barrier
    s_cmp_lg_u32 s14, 0
    s_cbranch_scc1 SG_3
    v_mov_b32 v6, s38
    v_mov_b32 v7, 1
    s_mov_b64 s[90:91], exec
    s_mov_b64 exec, 1
    global_atomic_add v6, v7, s[10:11] sc1
    s_mov_b64 exec, s[90:91]
SG_3:
    s_mov_b32 s39, -1
    s_mov_b64 s[48:49], 0
    s_branch M_u
M_ab3:
    s_barrier
    s_mov_b32 s39, s20
    s_mov_b64 s[48:49], 0
    v_mov_b32 v6, 161828
    ds_read_b32 v8, v6
    v_and_b32 v6, 7, v1
    v_lshlrev_b32 v6, 2, v6
    v_add_u32 v6, 161856, v6
    ds_read_b32 v9, v6
    s_waitcnt lgkmcnt(0)
    v_readfirstlane_b32 s16, v8
    s_and_b32 s21, s16, 0xfe
    s_or_b32 s21, s21, s101
    s_cbranch_scc0 M_uph
M_cl:
    s_cmp_eq_u32 s101, 0
    s_cbranch_scc1 M_chk
    s_ff1_i32_b32 s21, s101
    s_bitset0_b32 s101, s21
    v_readlane_b32 s20, v0, s21
    s_lshl_b32 s21, s21, 5
    s_add_u32 s20, s20, s21
    s_sub_u32 s20, s20, 32
    s_branch M_ab
M_chain:
    s_lshr_b32 s21, s20, 1
    s_and_b32 s22, s20, 1
    s_cmp_lt_u32 s20, 28
    s_cselect_b32 s23, 1, 0
    s_mov_b32 s25, 0x100000
    s_and_b32 s60, s14, 3
    s_lshr_b32 s61, s14, 2
    s_xor_b32 s61, s61, s22
    s_xor_b32 s61, s61, 1
    v_and_b32 v12, 3, v1
    v_xor_b32 v12, v12, v3
    v_lshlrev_b32 v12, 4, v12
    v_lshrrev_b32 v14, 2, v4
    v_xor_b32 v14, v14, v3
    v_lshlrev_b32 v14, 4, v14
    v_lshl_add_u32 v14, v4, 6, v14
    v_bfe_u32 v7, v1, 2, 2
    s_lshl_b32 s30, s21, 9
    s_cmp_eq_u32 s14, 7
    s_cbranch_scc1 LA_w7
    v_lshlrev_b32 v13, 16, v3
    v_add_u32 v13, v13, v12
    v_lshl_add_u32 v9, v7, 14, v13
    s_mul_i32 s34, s22, 7
    s_add_u32 s34, s34, s14
    s_lshl_b32 s34, s34, 18
    s_add_u32 s34, s34, s30
    s_add_u32 s34, s66, s34
    s_addc_u32 s35, s67, 0
    s_add_u32 s36, s34, 0x2000
    s_addc_u32 s37, s35, 0
    s_mul_i32 s32, s20, 7
    s_add_u32 s32, s32, s14
    s_lshl_b32 s32, s32, 10
    s_add_u32 s32, s32, 0x5b2c000
    s_add_u32 s32, s4, s32
    s_addc_u32 s33, s5, 0
    v_mov_b32 v16, -1
    v_mov_b32 v17, -1
    v_mov_b32 v18, -1
    v_mov_b32 v19, -1
    global_store_dwordx4 v2, v[16:19], s[32:33] sc1
    v_lshlrev_b32 v0, 2, v1
    v_add_u32 v0, 154624, v0
    v_mov_b32 v8, 161840
    v_cmp_gt_u32 vcc, 16, v1
    s_nop 1
    v_cndmask_b32 v0, v8, v0
    s_lshr_b32 s50, s60, 1
    s_lshl_b32 s50, s50, 2
    s_add_u32 s50, s50, 155008
    v_mov_b32 v8, s50
    v_cmp_gt_u32 vcc, 17, v1
    s_nop 1
    v_cndmask_b32 v0, v8, v0
    v_mov_b32 v8, 155016
    v_cmp_gt_u32 vcc, 18, v1
    s_nop 1
    v_cndmask_b32 v0, v8, v0
    v_and_b32 v8, 1, v3
    v_lshrrev_b32 v13, 1, v3
    s_cmp_ge_u32 s14, 4
    s_cbranch_scc1 LA_i0
    s_barrier
    global_load_dwordx4 v[32:35], v9, s[34:35] offset:0
    global_load_dwordx4 v[36:39], v9, s[36:37] offset:0
    global_load_dwordx4 v[40:43], v9, s[34:35] offset:64
    global_load_dwordx4 v[44:47], v9, s[36:37] offset:64
    global_load_dwordx4 v[48:51], v9, s[34:35] offset:128
    global_load_dwordx4 v[52:55], v9, s[36:37] offset:128
    global_load_dwordx4 v[56:59], v9, s[34:35] offset:192
    global_load_dwordx4 v[60:63], v9, s[36:37] offset:192
    global_load_dwordx4 v[64:67], v9, s[34:35] offset:256
    global_load_dwordx4 v[68:71], v9, s[36:37] offset:256
    global_load_dwordx4 v[72:75], v9, s[34:35] offset:320
    global_load_dwordx4 v[76:79], v9, s[36:37] offset:320
    global_load_dwordx4 v[80:83], v9, s[34:35] offset:384
    global_load_dwordx4 v[84:87], v9, s[36:37] offset:384
    global_load_dwordx4 v[88:91], v9, s[34:35] offset:448
    global_load_dwordx4 v[92:95], v9, s[36:37] offset:448
    s_branch LA_i1
LA_i0:
    global_load_dwordx4 v[32:35], v9, s[34:35] offset:0
    global_load_dwordx4 v[36:39], v9, s[36:37] offset:0
    global_load_dwordx4 v[40:43], v9, s[34:35] offset:64
    global_load_dwordx4 v[44:47], v9, s[36:37] offset:64
    global_load_dwordx4 v[48:51], v9, s[34:35] offset:128
    global_load_dwordx4 v[52:55], v9, s[36:37] offset:128
    global_load_dwordx4 v[56:59], v9, s[34:35] offset:192
    global_load_dwordx4 v[60:63], v9, s[36:37] offset:192
    global_load_dwordx4 v[64:67], v9, s[34:35] offset:256
    global_load_dwordx4 v[68:71], v9, s[36:37] offset:256
    global_load_dwordx4 v[72:75], v9, s[34:35] offset:320
    global_load_dwordx4 v[76:79], v9, s[36:37] offset:320
    global_load_dwordx4 v[80:83], v9, s[34:35] offset:384
    global_load_dwordx4 v[84:87], v9, s[36:37] offset:384
    global_load_dwordx4 v[88:91], v9, s[34:35] offset:448
    global_load_dwordx4 v[92:95], v9, s[36:37] offset:448
    s_setprio 1
    s_barrier
LA_i1:
    s_lshl_b32 s50, s22, 2
    s_add_u32 s50, s50, s60
    s_mul_i32 s50, s50, 14
    s_min_u32 s51, s21, 13
    s_add_u32 s50, s50, s51
    s_mul_i32 s50, s50, 57344
    s_mul_i32 s51, s61, 7168
    s_add_u32 s50, s50, s51
    s_add_u32 s50, s50, 0x1c1000
    s_add_u32 s80, s4, s50
    s_addc_u32 s81, s5, 0
    s_add_u32 s82, s80, 0x3800
    s_addc_u32 s83, s81, 0
    s_add_u32 s84, s80, 0x7000
    s_addc_u32 s85, s81, 0
    s_add_u32 s86, s80, 0xa800
    s_addc_u32 s87, s81, 0
    v_mov_b32 v96, 0
    v_mov_b32 v97, 0
    v_mov_b32 v98, 0
    v_mov_b32 v99, 0
    s_mul_i32 s50, s22, 56
    s_min_u32 s51, s21, 13
    s_lshr_b32 s51, s51, 1
    s_add_u32 s50, s50, s51
    s_lshl_b32 s50, s50, 6
    s_add_u32 s50, s50, 0x5b8c000
    s_lshl_b32 s36, s14, 11
    s_add_u32 s36, s36, 72704
    v_lshrrev_b32 v14, 2, v4
    v_xor_b32 v14, v14, v13
    v_lshlrev_b32 v14, 4, v14
    v_lshl_add_u32 v14, v4, 6, v14
    v_lshl_add_u32 v5, v8, 13, v14
    v_add_u32 v5, 23552, v5
    v_xor_b32 v6, 32, v5
    v_lshl_add_u32 v10, v8, 10, v14
    v_add_u32 v10, s36, v10
    v_xor_b32 v11, 32, v10
    v_add_u32 v12, s36, v2
    s_lshl_b32 s50, s14, 2
    s_add_u32 s50, s50, 154688
    v_mov_b32 v1, s50
    s_and_b32 s50, s60, 1
    s_lshl_b32 s50, s50, 2
    s_add_u32 s50, s50, s61
    s_lshl_b32 s50, s50, 2
    s_lshl_b32 s88, 0x0f0f, s50
    s_cmp_eq_u32 s23, 0
    s_cselect_b32 s89, -1, s88
    s_mov_b32 s96, 0x3db8aa3b
    s_mul_i32 s50, s14, 0
    s_lshl_b32 s72, 0, s50
    s_mov_b32 s73, -1
    s_mul_i32 s50, s20, 7
    s_add_u32 s50, s50, s14
    s_lshl_b32 s50, s50, 13
    s_add_u32 s50, s50, 0x5fac000
    s_add_u32 s74, s4, s50
    s_addc_u32 s75, s5, 0
    s_mov_b32 s46, 0x00ff00ff
    s_mov_b32 s47, 0x00ff00ff
    s_add_u32 s26, s4, 0x5b2c000
    s_addc_u32 s27, s5, 0
    s_add_u32 s28, s4, 0x5b3c000
    s_addc_u32 s29, s5, 0
    s_mov_b64 s[30:31], s[26:27]
    s_mov_b64 s[32:33], s[26:27]
    s_mov_b64 s[58:59], s[26:27]
    s_mov_b64 s[34:35], s[28:29]
    s_mov_b64 s[36:37], s[28:29]
    s_mul_i32 s42, s22, 7168
    s_and_b32 s43, s14, 1
    s_xor_b32 s43, s43, 1
    s_mul_i32 s43, s43, 14336
    s_add_u32 s42, s42, s43
    s_add_u32 s42, s42, 0x1000
    s_add_u32 s42, s4, s42
    s_addc_u32 s43, s5, 0
    s_sub_u32 s44, s20, 28
    s_max_i32 s44, s44, 0
    s_mul_i32 s44, s44, 7168
    s_add_u32 s44, s44, 0xe000
    s_add_u32 s44, s4, s44
    s_addc_u32 s45, s5, 0
    s_mov_b32 s24, 0
    s_mov_b64 s[62:63], 0
    s_min_u32 s38, s20, 27
    s_mul_i32 s38, s38, 16384
    s_add_u32 s38, s38, 0x1110000
    s_add_u32 s38, s4, s38
    s_addc_u32 s39, s5, 0
    s_lshl_b32 s40, s21, 13
    s_lshl_b32 s41, s22, 11
    s_add_u32 s40, s40, s41
    s_add_u32 s40, s40, 0x5410800
    s_add_u32 s40, s4, s40
    s_addc_u32 s41, s5, 0
    s_add_u32 s48, s4, 0x5390000
    s_addc_u32 s49, s5, 0
    s_mov_b64 s[54:55], s[38:39]
    s_sub_u32 s56, s20, 28
    s_max_i32 s56, s56, 0
    s_mul_i32 s56, s56, 114688
    s_add_u32 s56, s56, 0x11f0000
    s_add_u32 s56, s4, s56
    s_addc_u32 s57, s5, 0
    s_add_u32 s52, s4, 0x5b6c000
    s_addc_u32 s53, s5, 0
    s_waitcnt vmcnt(14)
    ds_write_b128 v12, v[32:35] offset:0
    ds_write_b128 v12, v[36:39] offset:1024
    ds_read_b128 v[32:35], v10
    ds_read_b128 v[36:39], v11
    s_waitcnt vmcnt(12)
    ds_write_b128 v12, v[40:43] offset:0
    ds_write_b128 v12, v[44:47] offset:1024
    ds_read_b128 v[40:43], v10
    ds_read_b128 v[44:47], v11
    s_waitcnt vmcnt(10)
    ds_write_b128 v12, v[48:51] offset:0
    ds_write_b128 v12, v[52:55] offset:1024
    ds_read_b128 v[48:51], v10
    ds_read_b128 v[52:55], v11
    s_waitcnt vmcnt(8)
    ds_write_b128 v12, v[56:59] offset:0
    ds_write_b128 v12, v[60:63] offset:1024
    ds_read_b128 v[56:59], v10
    ds_read_b128 v[60:63], v11
    s_waitcnt vmcnt(6)
    ds_write_b128 v12, v[64:67] offset:0
    ds_write_b128 v12, v[68:71] offset:1024
    ds_read_b128 v[64:67], v10
    ds_read_b128 v[68:71], v11
    s_waitcnt vmcnt(4)
    ds_write_b128 v12, v[72:75] offset:0
    ds_write_b128 v12, v[76:79] offset:1024
    ds_read_b128 v[72:75], v10
    ds_read_b128 v[76:79], v11
    s_waitcnt vmcnt(2)
    ds_write_b128 v12, v[80:83] offset:0
    ds_write_b128 v12, v[84:87] offset:1024
    ds_read_b128 v[80:83], v10
    ds_read_b128 v[84:87], v11
    s_waitcnt vmcnt(0)
    ds_write_b128 v12, v[88:91] offset:0
    ds_write_b128 v12, v[92:95] offset:1024
    ds_read_b128 v[88:91], v10
    ds_read_b128 v[92:95], v11
LA_l0:
    ds_read_b32 v3, v0
    s_sub_u32 s25, s25, 1
    s_cbranch_scc1 M_end
    s_waitcnt lgkmcnt(0)
LA_l0a:
    v_cmp_ne_u32 vcc, 0, v3
    s_bitcmp1_b32 vcc_lo, 0
    s_cbranch_scc0 LA_l0
    ds_read_b128 v[240:243], v5 offset:0
    ds_read_b128 v[244:247], v6 offset:0
    ds_read_b128 v[248:251], v5 offset:1024
    ds_read_b128 v[252:255], v6 offset:1024
    ds_read_b128 v[8:11], v5 offset:2048
    ds_read_b128 v[12:15], v6 offset:2048
    ds_read_b128 v[136:139], v5 offset:3072
    ds_read_b128 v[140:143], v6 offset:3072
    s_waitcnt lgkmcnt(7)
    v_mfma_f32_32x32x16_bf16 v[144:159], v[240:243], v[32:35], 0
    ds_write_b32 v1, v0 offset:0
    ds_read_b32 v3, v0
    ds_read_b128 v[240:243], v5 offset:4096
    s_waitcnt lgkmcnt(9)
    v_mfma_f32_32x32x16_bf16 v[144:159], v[244:247], v[36:39], v[144:159]
    ds_read_b128 v[244:247], v6 offset:4096
    s_waitcnt lgkmcnt(9)
    v_mfma_f32_32x32x16_bf16 v[144:159], v[248:251], v[40:43], v[144:159]
    ds_read_b128 v[248:251], v5 offset:5120
    s_waitcnt lgkmcnt(9)
    v_mfma_f32_32x32x16_bf16 v[144:159], v[252:255], v[44:47], v[144:159]
    ds_read_b128 v[252:255], v6 offset:5120
    s_waitcnt lgkmcnt(9)
    v_mfma_f32_32x32x16_bf16 v[144:159], v[8:11], v[48:51], v[144:159]
    ds_read_b128 v[8:11], v5 offset:6144
    s_waitcnt lgkmcnt(9)
    v_mfma_f32_32x32x16_bf16 v[144:159], v[12:15], v[52:55], v[144:159]
    s_waitcnt lgkmcnt(5)
    v_cmp_ne_u32 vcc, 0, v3
    v_readlane_b32 s50, v3, 17
    ds_read_b128 v[12:15], v6 offset:6144
    v_mfma_f32_32x32x16_bf16 v[144:159], v[136:139], v[56:59], v[144:159]
    s_bitcmp1_b32 vcc_lo, 1
    s_cbranch_scc0 LA_l1
LA_m1:
    ds_read_b128 v[136:139], v5 offset:7168
    v_mfma_f32_32x32x16_bf16 v[144:159], v[140:143], v[60:63], v[144:159]
    ds_read_b128 v[140:143], v6 offset:7168
    s_waitcnt lgkmcnt(7)
    v_mfma_f32_32x32x16_bf16 v[144:159], v[240:243], v[64:67], v[144:159]
    v_add_u32 v5, 16384, v5
    v_add_u32 v6, 16384, v6
    ds_read_b128 v[240:243], v5 offset:0
    s_waitcnt lgkmcnt(7)
    v_mfma_f32_32x32x16_bf16 v[144:159], v[244:247], v[68:71], v[144:159]
    ds_read_b128 v[244:247], v6 offset:0
    s_waitcnt lgkmcnt(7)
    v_mfma_f32_32x32x16_bf16 v[144:159], v[248:251], v[72:75], v[144:159]
    ds_read_b128 v[248:251], v5 offset:1024
    s_waitcnt lgkmcnt(7)
    v_mfma_f32_32x32x16_bf16 v[144:159], v[252:255], v[76:79], v[144:159]
    ds_read_b128 v[252:255], v6 offset:1024
    s_waitcnt lgkmcnt(7)
    v_mfma_f32_32x32x16_bf16 v[144:159], v[8:11], v[80:83], v[144:159]
    ds_read_b128 v[8:11], v5 offset:2048
    s_waitcnt lgkmcnt(7)
    v_mfma_f32_32x32x16_bf16 v[144:159], v[12:15], v[84:87], v[144:159]
    ds_read_b32 v3, v0
    ds_read_b128 v[12:15], v6 offset:2048
    s_waitcnt lgkmcnt(8)
    v_mfma_f32_32x32x16_bf16 v[144:159], v[136:139], v[88:91], v[144:159]
    ds_read_b128 v[136:139], v5 offset:3072
    s_waitcnt lgkmcnt(8)
    v_mfma_f32_32x32x16_bf16 v[144:159], v[140:143], v[92:95], v[144:159]
    ds_read_b128 v[140:143], v6 offset:3072
    s_waitcnt lgkmcnt(8)
    v_mfma_f32_32x32x16_bf16 v[16:31], v[240:243], v[32:35], 0
    ds_write_b32 v1, v0 offset:32
    ds_read_b128 v[240:243], v5 offset:4096
    s_waitcnt lgkmcnt(9)
    v_mfma_f32_32x32x16_bf16 v[16:31], v[244:247], v[36:39], v[16:31]
    ds_read_b128 v[244:247], v6 offset:4096
    s_waitcnt lgkmcnt(9)
    v_mfma_f32_32x32x16_bf16 v[16:31], v[248:251], v[40:43], v[16:31]
    s_nop 1
    v_mul_f32 v144, s96, v144
    v_mul_f32 v145, s96, v145
    v_cvt_pk_f16_f32 v144, v144, v145
    ds_read_b128 v[248:251], v5 offset:5120
    s_waitcnt lgkmcnt(9)
    v_mfma_f32_32x32x16_bf16 v[16:31], v[252:255], v[44:47], v[16:31]
    v_mul_f32 v152, s96, v152
    v_mul_f32 v153, s96, v153
    v_cvt_pk_f16_f32 v145, v152, v153
    ds_read_b128 v[252:255], v6 offset:5120
    s_waitcnt lgkmcnt(9)
    v_mfma_f32_32x32x16_bf16 v[16:31], v[8:11], v[48:51], v[16:31]
    v_mul_f32 v146, s96, v146
    v_mul_f32 v147, s96, v147
    v_cvt_pk_f16_f32 v146, v146, v147
    ds_read_b128 v[8:11], v5 offset:6144
    s_waitcnt lgkmcnt(8)
    v_mfma_f32_32x32x16_bf16 v[16:31], v[12:15], v[52:55], v[16:31]
    v_cmp_ne_u32 vcc, 0, v3
    v_readlane_b32 s50, v3, 17
    ds_read_b128 v[12:15], v6 offset:6144
    s_waitcnt lgkmcnt(8)
    v_mfma_f32_32x32x16_bf16 v[16:31], v[136:139], v[56:59], v[16:31]
    s_bitcmp1_b32 vcc_lo, 2
    s_cbranch_scc0 LA_l2
LA_m2:
    ds_read_b128 v[136:139], v5 offset:7168
    s_waitcnt lgkmcnt(8)
    v_mfma_f32_32x32x16_bf16 v[16:31], v[140:143], v[60:63], v[16:31]
    ds_read_b128 v[140:143], v6 offset:7168
    s_and_b32 s50, s50, s88
    s_cmp_eq_u32 s50, s89
    s_cbranch_scc1 LA_g1
LA_h1:
    s_waitcnt lgkmcnt(7)
    v_mfma_f32_32x32x16_bf16 v[16:31], v[240:243], v[64:67], v[16:31]
    v_mul_f32 v154, s96, v154
    v_mul_f32 v155, s96, v155
    v_cvt_pk_f16_f32 v147, v154, v155
    v_permlane16_swap_b32 v144, v145
    v_add_u32 v5, 16384, v5
    v_add_u32 v6, 16384, v6
    ds_read_b128 v[240:243], v5 offset:0
    s_waitcnt lgkmcnt(7)
    v_mfma_f32_32x32x16_bf16 v[16:31], v[244:247], v[68:71], v[16:31]
    v_mul_f32 v148, s96, v148
    v_mul_f32 v149, s96, v149
    v_cvt_pk_f16_f32 v148, v148, v149
    ds_read_b128 v[244:247], v6 offset:0
    s_waitcnt lgkmcnt(7)
    v_mfma_f32_32x32x16_bf16 v[16:31], v[248:251], v[72:75], v[16:31]
    v_mul_f32 v156, s96, v156
    v_mul_f32 v157, s96, v157
    v_cvt_pk_f16_f32 v149, v156, v157
    v_permlane16_swap_b32 v146, v147
    ds_read_b128 v[248:251], v5 offset:1024
    s_waitcnt lgkmcnt(7)
    v_mfma_f32_32x32x16_bf16 v[16:31], v[252:255], v[76:79], v[16:31]
    v_mul_f32 v150, s96, v150
    v_mul_f32 v151, s96, v151
    v_cvt_pk_f16_f32 v150, v150, v151
    ds_read_b128 v[252:255], v6 offset:1024
    s_waitcnt lgkmcnt(7)
    v_mfma_f32_32x32x16_bf16 v[16:31], v[8:11], v[80:83], v[16:31]
    v_mul_f32 v158, s96, v158
    v_mul_f32 v159, s96, v159
    v_cvt_pk_f16_f32 v151, v158, v159
    v_permlane16_swap_b32 v148, v149
    ds_read_b128 v[8:11], v5 offset:2048
    s_waitcnt lgkmcnt(7)
    v_mfma_f32_32x32x16_bf16 v[16:31], v[12:15], v[84:87], v[16:31]
    v_permlane16_swap_b32 v150, v151
    ds_read_b32 v3, v0
    ds_read_b128 v[12:15], v6 offset:2048
    s_waitcnt lgkmcnt(8)
    v_mfma_f32_32x32x16_bf16 v[16:31], v[136:139], v[88:91], v[16:31]
    ds_read_b128 v[136:139], v5 offset:3072
    s_waitcnt lgkmcnt(8)
    v_mfma_f32_32x32x16_bf16 v[16:31], v[140:143], v[92:95], v[16:31]
    ds_read_b128 v[140:143], v6 offset:3072
    s_waitcnt lgkmcnt(8)
    v_mfma_f32_32x32x16_bf16 v[160:175], v[240:243], v[32:35], 0
    ds_write_b32 v1, v0 offset:64
    ds_read_b128 v[240:243], v5 offset:4096
    s_waitcnt lgkmcnt(9)
    v_mfma_f32_32x32x16_bf16 v[160:175], v[244:247], v[36:39], v[160:175]
    ds_read_b128 v[244:247], v6 offset:4096
    s_waitcnt lgkmcnt(9)
    v_mfma_f32_32x32x16_bf16 v[160:175], v[248:251], v[40:43], v[160:175]
    s_nop 1
    v_mul_f32 v16, s96, v16
    v_mul_f32 v17, s96, v17
    v_cvt_pk_f16_f32 v152, v16, v17
    ds_read_b128 v[248:251], v5 offset:5120
    s_waitcnt lgkmcnt(9)
    v_mfma_f32_32x32x16_bf16 v[160:175], v[252:255], v[44:47], v[160:175]
    v_mul_f32 v24, s96, v24
    v_mul_f32 v25, s96, v25
    v_cvt_pk_f16_f32 v153, v24, v25
    ds_read_b128 v[252:255], v6 offset:5120
    s_waitcnt lgkmcnt(9)
    v_mfma_f32_32x32x16_bf16 v[160:175], v[8:11], v[48:51], v[160:175]
    v_mul_f32 v18, s96, v18
    v_mul_f32 v19, s96, v19
    v_cvt_pk_f16_f32 v154, v18, v19
    ds_read_b128 v[8:11], v5 offset:6144
    s_waitcnt lgkmcnt(8)
    v_mfma_f32_32x32x16_bf16 v[160:175], v[12:15], v[52:55], v[160:175]
    v_cmp_ne_u32 vcc, 0, v3
    v_readlane_b32 s50, v3, 17
    ds_read_b128 v[12:15], v6 offset:6144
    s_waitcnt lgkmcnt(8)
    v_mfma_f32_32x32x16_bf16 v[160:175], v[136:139], v[56:59], v[160:175]
    s_bitcmp1_b32 vcc_lo, 3
    s_cbranch_scc0 LA_l3
LA_m3:
    ds_read_b128 v[136:139], v5 offset:7168
    s_waitcnt lgkmcnt(8)
    v_mfma_f32_32x32x16_bf16 v[160:175], v[140:143], v[60:63], v[160:175]
    ds_read_b128 v[140:143], v6 offset:7168
    s_and_b32 s50, s50, s88
    s_cmp_eq_u32 s50, s89
    s_cbranch_scc1 LA_g2
LA_h2:
    s_waitcnt lgkmcnt(7)
    v_mfma_f32_32x32x16_bf16 v[160:175], v[240:243], v[64:67], v[160:175]
    v_mul_f32 v26, s96, v26
    v_mul_f32 v27, s96, v27
    v_cvt_pk_f16_f32 v155, v26, v27
    v_permlane16_swap_b32 v152, v153
    v_add_u32 v5, -56320, v5
    v_add_u32 v6, -56320, v6
    ds_read_b128 v[240:243], v5 offset:0
    s_waitcnt lgkmcnt(7)
    v_mfma_f32_32x32x16_bf16 v[160:175], v[244:247], v[68:71], v[160:175]
    v_mul_f32 v20, s96, v20
    v_mul_f32 v21, s96, v21
    v_cvt_pk_f16_f32 v156, v20, v21
    ds_read_b128 v[244:247], v6 offset:0
    s_waitcnt lgkmcnt(7)
    v_mfma_f32_32x32x16_bf16 v[160:175], v[248:251], v[72:75], v[160:175]
    v_mul_f32 v28, s96, v28
    v_mul_f32 v29, s96, v29
    v_cvt_pk_f16_f32 v157, v28, v29
    v_permlane16_swap_b32 v154, v155
    ds_read_b128 v[248:251], v5 offset:1024
    s_waitcnt lgkmcnt(7)
    v_mfma_f32_32x32x16_bf16 v[160:175], v[252:255], v[76:79], v[160:175]
    v_mul_f32 v22, s96, v22
    v_mul_f32 v23, s96, v23
    v_cvt_pk_f16_f32 v158, v22, v23
    ds_read_b128 v[252:255], v6 offset:1024
    s_waitcnt lgkmcnt(7)
    v_mfma_f32_32x32x16_bf16 v[160:175], v[8:11], v[80:83], v[160:175]
    v_mul_f32 v30, s96, v30
    v_mul_f32 v31, s96, v31
    v_cvt_pk_f16_f32 v159, v30, v31
    v_permlane16_swap_b32 v156, v157
    ds_read_b128 v[8:11], v5 offset:2048
    s_waitcnt lgkmcnt(7)
    v_mfma_f32_32x32x16_bf16 v[160:175], v[12:15], v[84:87], v[160:175]
    v_permlane16_swap_b32 v158, v159
    ds_read_b32 v3, v0
    ds_read_b128 v[12:15], v6 offset:2048
    s_waitcnt lgkmcnt(8)
    v_mfma_f32_32x32x16_bf16 v[160:175], v[136:139], v[88:91], v[160:175]
    ds_read_b128 v[136:139], v5 offset:3072
    s_waitcnt lgkmcnt(8)
    v_mfma_f32_32x32x16_bf16 v[160:175], v[140:143], v[92:95], v[160:175]
    ds_read_b128 v[140:143], v6 offset:3072
    s_waitcnt lgkmcnt(8)
    v_mfma_f32_32x32x16_bf16 v[16:31], v[240:243], v[32:35], 0
    ds_write_b32 v1, v0 offset:96
    ds_read_b128 v[240:243], v5 offset:4096
    s_waitcnt lgkmcnt(9)
    v_mfma_f32_32x32x16_bf16 v[16:31], v[244:247], v[36:39], v[16:31]
    ds_read_b128 v[244:247], v6 offset:4096
    s_waitcnt lgkmcnt(9)
    v_mfma_f32_32x32x16_bf16 v[16:31], v[248:251], v[40:43], v[16:31]
    s_nop 1
    v_mul_f32 v160, s96, v160
    v_mul_f32 v161, s96, v161
    v_cvt_pk_f16_f32 v160, v160, v161
    ds_read_b128 v[248:251], v5 offset:5120
    s_waitcnt lgkmcnt(9)
    v_mfma_f32_32x32x16_bf16 v[16:31], v[252:255], v[44:47], v[16:31]
    v_mul_f32 v168, s96, v168
    v_mul_f32 v169, s96, v169
    v_cvt_pk_f16_f32 v161, v168, v169
    ds_read_b128 v[252:255], v6 offset:5120
    s_waitcnt lgkmcnt(9)
    v_mfma_f32_32x32x16_bf16 v[16:31], v[8:11], v[48:51], v[16:31]
    v_mul_f32 v162, s96, v162
    v_mul_f32 v163, s96, v163
    v_cvt_pk_f16_f32 v162, v162, v163
    ds_read_b128 v[8:11], v5 offset:6144
    s_waitcnt lgkmcnt(8)
    v_mfma_f32_32x32x16_bf16 v[16:31], v[12:15], v[52:55], v[16:31]
    v_cmp_ne_u32 vcc, 0, v3
    v_readlane_b32 s50, v3, 17
    ds_read_b128 v[12:15], v6 offset:6144
    s_waitcnt lgkmcnt(8)
    v_mfma_f32_32x32x16_bf16 v[16:31], v[136:139], v[56:59], v[16:31]
    s_bitcmp1_b32 vcc_lo, 4
    s_cbranch_scc0 LA_l4
LA_m4:
    ds_read_b128 v[136:139], v5 offset:7168
    s_waitcnt lgkmcnt(8)
    v_mfma_f32_32x32x16_bf16 v[16:31], v[140:143], v[60:63], v[16:31]
    ds_read_b128 v[140:143], v6 offset:7168
    s_and_b32 s50, s50, s88
    s_cmp_eq_u32 s50, s89
    s_cbranch_scc1 LA_g3
LA_h3:
    s_waitcnt lgkmcnt(7)
    v_mfma_f32_32x32x16_bf16 v[16:31], v[240:243], v[64:67], v[16:31]
    v_mul_f32 v170, s96, v170
    v_mul_f32 v171, s96, v171
    v_cvt_pk_f16_f32 v163, v170, v171
    v_permlane16_swap_b32 v160, v161
    v_add_u32 v5, 138240, v5
    v_add_u32 v6, 138240, v6
    ds_read_b128 v[240:243], v5 offset:0
    s_waitcnt lgkmcnt(7)
    v_mfma_f32_32x32x16_bf16 v[16:31], v[244:247], v[68:71], v[16:31]
    v_mul_f32 v164, s96, v164
    v_mul_f32 v165, s96, v165
    v_cvt_pk_f16_f32 v164, v164, v165
    ds_read_b128 v[244:247], v6 offset:0
    s_waitcnt lgkmcnt(7)
    v_mfma_f32_32x32x16_bf16 v[16:31], v[248:251], v[72:75], v[16:31]
    v_mul_f32 v172, s96, v172
    v_mul_f32 v173, s96, v173
    v_cvt_pk_f16_f32 v165, v172, v173
    v_permlane16_swap_b32 v162, v163
    ds_read_b128 v[248:251], v5 offset:1024
    s_waitcnt lgkmcnt(7)
    v_mfma_f32_32x32x16_bf16 v[16:31], v[252:255], v[76:79], v[16:31]
    v_mul_f32 v166, s96, v166
    v_mul_f32 v167, s96, v167
    v_cvt_pk_f16_f32 v166, v166, v167
    ds_read_b128 v[252:255], v6 offset:1024
    s_waitcnt lgkmcnt(7)
    v_mfma_f32_32x32x16_bf16 v[16:31], v[8:11], v[80:83], v[16:31]
    v_mul_f32 v174, s96, v174
    v_mul_f32 v175, s96, v175
    v_cvt_pk_f16_f32 v167, v174, v175
    v_permlane16_swap_b32 v164, v165
    ds_read_b128 v[8:11], v5 offset:2048
    s_waitcnt lgkmcnt(7)
    v_mfma_f32_32x32x16_bf16 v[16:31], v[12:15], v[84:87], v[16:31]
    v_permlane16_swap_b32 v166, v167
    ds_read_b32 v3, v0
    ds_read_b128 v[12:15], v6 offset:2048
    s_waitcnt lgkmcnt(8)
    v_mfma_f32_32x32x16_bf16 v[16:31], v[136:139], v[88:91], v[16:31]
    ds_read_b128 v[136:139], v5 offset:3072
    s_waitcnt lgkmcnt(8)
    v_mfma_f32_32x32x16_bf16 v[16:31], v[140:143], v[92:95], v[16:31]
    ds_read_b128 v[140:143], v6 offset:3072
    s_waitcnt lgkmcnt(8)
    v_mfma_f32_32x32x16_bf16 v[176:191], v[240:243], v[32:35], 0
    ds_write_b32 v1, v0 offset:128
    ds_read_b128 v[240:243], v5 offset:4096
    s_waitcnt lgkmcnt(9)
    v_mfma_f32_32x32x16_bf16 v[176:191], v[244:247], v[36:39], v[176:191]
    ds_read_b128 v[244:247], v6 offset:4096
    s_waitcnt lgkmcnt(9)
    v_mfma_f32_32x32x16_bf16 v[176:191], v[248:251], v[40:43], v[176:191]
    s_nop 1
    v_mul_f32 v16, s96, v16
    v_mul_f32 v17, s96, v17
    v_cvt_pk_f16_f32 v168, v16, v17
    ds_read_b128 v[248:251], v5 offset:5120
    s_waitcnt lgkmcnt(9)
    v_mfma_f32_32x32x16_bf16 v[176:191], v[252:255], v[44:47], v[176:191]
    v_mul_f32 v24, s96, v24
    v_mul_f32 v25, s96, v25
    v_cvt_pk_f16_f32 v169, v24, v25
    ds_read_b128 v[252:255], v6 offset:5120
    s_waitcnt lgkmcnt(9)
    v_mfma_f32_32x32x16_bf16 v[176:191], v[8:11], v[48:51], v[176:191]
    v_mul_f32 v18, s96, v18
    v_mul_f32 v19, s96, v19
    v_cvt_pk_f16_f32 v170, v18, v19
    ds_read_b128 v[8:11], v5 offset:6144
    s_waitcnt lgkmcnt(8)
    v_mfma_f32_32x32x16_bf16 v[176:191], v[12:15], v[52:55], v[176:191]
    v_cmp_ne_u32 vcc, 0, v3
    v_readlane_b32 s50, v3, 17
    ds_read_b128 v[12:15], v6 offset:6144
    s_waitcnt lgkmcnt(8)
    v_mfma_f32_32x32x16_bf16 v[176:191], v[136:139], v[56:59], v[176:191]
    s_bitcmp1_b32 vcc_lo, 5
    s_cbranch_scc0 LA_l5
LA_m5:
    ds_read_b128 v[136:139], v5 offset:7168
    s_waitcnt lgkmcnt(8)
    v_mfma_f32_32x32x16_bf16 v[176:191], v[140:143], v[60:63], v[176:191]
    ds_read_b128 v[140:143], v6 offset:7168
    s_and_b32 s50, s50, s88
    s_cmp_eq_u32 s50, s89
    s_cbranch_scc1 LA_g4
LA_h4:
    s_waitcnt lgkmcnt(7)
    v_mfma_f32_32x32x16_bf16 v[176:191], v[240:243], v[64:67], v[176:191]
    v_mul_f32 v26, s96, v26
    v_mul_f32 v27, s96, v27
    v_cvt_pk_f16_f32 v171, v26, v27
    v_permlane16_swap_b32 v168, v169
    v_add_u32 v5, -49152, v5
    v_add_u32 v6, -49152, v6
    ds_read_b128 v[240:243], v5 offset:0
    s_waitcnt lgkmcnt(7)
    v_mfma_f32_32x32x16_bf16 v[176:191], v[244:247], v[68:71], v[176:191]
    v_mul_f32 v20, s96, v20
    v_mul_f32 v21, s96, v21
    v_cvt_pk_f16_f32 v172, v20, v21
    ds_read_b128 v[244:247], v6 offset:0
    s_waitcnt lgkmcnt(7)
    v_mfma_f32_32x32x16_bf16 v[176:191], v[248:251], v[72:75], v[176:191]
    v_mul_f32 v28, s96, v28
    v_mul_f32 v29, s96, v29
    v_cvt_pk_f16_f32 v173, v28, v29
    v_permlane16_swap_b32 v170, v171
    ds_read_b128 v[248:251], v5 offset:1024
    s_waitcnt lgkmcnt(7)
    v_mfma_f32_32x32x16_bf16 v[176:191], v[252:255], v[76:79], v[176:191]
    v_mul_f32 v22, s96, v22
    v_mul_f32 v23, s96, v23
    v_cvt_pk_f16_f32 v174, v22, v23
    ds_read_b128 v[252:255], v6 offset:1024
    s_waitcnt lgkmcnt(7)
    v_mfma_f32_32x32x16_bf16 v[176:191], v[8:11], v[80:83], v[176:191]
    v_mul_f32 v30, s96, v30
    v_mul_f32 v31, s96, v31
    v_cvt_pk_f16_f32 v175, v30, v31
    v_permlane16_swap_b32 v172, v173
    ds_read_b128 v[8:11], v5 offset:2048
    s_waitcnt lgkmcnt(7)
    v_mfma_f32_32x32x16_bf16 v[176:191], v[12:15], v[84:87], v[176:191]
    v_permlane16_swap_b32 v174, v175
    ds_read_b32 v3, v0
    ds_read_b128 v[12:15], v6 offset:2048
    s_waitcnt lgkmcnt(8)
    v_mfma_f32_32x32x16_bf16 v[176:191], v[136:139], v[88:91], v[176:191]
    ds_read_b128 v[136:139], v5 offset:3072
    s_waitcnt lgkmcnt(8)
    v_mfma_f32_32x32x16_bf16 v[176:191], v[140:143], v[92:95], v[176:191]
    ds_read_b128 v[140:143], v6 offset:3072
    s_waitcnt lgkmcnt(8)
    v_mfma_f32_32x32x16_bf16 v[16:31], v[240:243], v[32:35], 0
    ds_write_b32 v1, v0 offset:160
    ds_read_b128 v[240:243], v5 offset:4096
    s_waitcnt lgkmcnt(9)
    v_mfma_f32_32x32x16_bf16 v[16:31], v[244:247], v[36:39], v[16:31]
    ds_read_b128 v[244:247], v6 offset:4096
    s_waitcnt lgkmcnt(9)
    v_mfma_f32_32x32x16_bf16 v[16:31], v[248:251], v[40:43], v[16:31]
    s_nop 1
    v_mul_f32 v176, s96, v176
    v_mul_f32 v177, s96, v177
    v_cvt_pk_f16_f32 v176, v176, v177
    ds_read_b128 v[248:251], v5 offset:5120
    s_waitcnt lgkmcnt(9)
    v_mfma_f32_32x32x16_bf16 v[16:31], v[252:255], v[44:47], v[16:31]
    v_mul_f32 v184, s96, v184
    v_mul_f32 v185, s96, v185
    v_cvt_pk_f16_f32 v177, v184, v185
    ds_read_b128 v[252:255], v6 offset:5120
    s_waitcnt lgkmcnt(9)
    v_mfma_f32_32x32x16_bf16 v[16:31], v[8:11], v[48:51], v[16:31]
    v_mul_f32 v178, s96, v178
    v_mul_f32 v179, s96, v179
    v_cvt_pk_f16_f32 v178, v178, v179
    ds_read_b128 v[8:11], v5 offset:6144
    s_waitcnt lgkmcnt(8)
    v_mfma_f32_32x32x16_bf16 v[16:31], v[12:15], v[52:55], v[16:31]
    v_cmp_ne_u32 vcc, 0, v3
    v_readlane_b32 s50, v3, 17
    ds_read_b128 v[12:15], v6 offset:6144
    s_waitcnt lgkmcnt(8)
    v_mfma_f32_32x32x16_bf16 v[16:31], v[136:139], v[56:59], v[16:31]
    s_bitcmp1_b32 vcc_lo, 6
    s_cbranch_scc0 LA_l6
LA_m6:
    ds_read_b128 v[136:139], v5 offset:7168
    s_waitcnt lgkmcnt(8)
    v_mfma_f32_32x32x16_bf16 v[16:31], v[140:143], v[60:63], v[16:31]
    ds_read_b128 v[140:143], v6 offset:7168
    s_and_b32 s50, s50, s88
    s_cmp_eq_u32 s50, s89
    s_cbranch_scc1 LA_g5
LA_h5:
    s_waitcnt lgkmcnt(7)
    v_mfma_f32_32x32x16_bf16 v[16:31], v[240:243], v[64:67], v[16:31]
    v_mul_f32 v186, s96, v186
    v_mul_f32 v187, s96, v187
    v_cvt_pk_f16_f32 v179, v186, v187
    v_permlane16_swap_b32 v176, v177
    v_add_u32 v5, 16384, v5
    v_add_u32 v6, 16384, v6
    ds_read_b128 v[240:243], v5 offset:0
    s_waitcnt lgkmcnt(7)
    v_mfma_f32_32x32x16_bf16 v[16:31], v[244:247], v[68:71], v[16:31]
    v_mul_f32 v180, s96, v180
    v_mul_f32 v181, s96, v181
    v_cvt_pk_f16_f32 v180, v180, v181
    ds_read_b128 v[244:247], v6 offset:0
    s_waitcnt lgkmcnt(7)
    v_mfma_f32_32x32x16_bf16 v[16:31], v[248:251], v[72:75], v[16:31]
    v_mul_f32 v188, s96, v188
    v_mul_f32 v189, s96, v189
    v_cvt_pk_f16_f32 v181, v188, v189
    v_permlane16_swap_b32 v178, v179
    ds_read_b128 v[248:251], v5 offset:1024
    s_waitcnt lgkmcnt(7)
    v_mfma_f32_32x32x16_bf16 v[16:31], v[252:255], v[76:79], v[16:31]
    v_mul_f32 v182, s96, v182
    v_mul_f32 v183, s96, v183
    v_cvt_pk_f16_f32 v182, v182, v183
    ds_read_b128 v[252:255], v6 offset:1024
    s_waitcnt lgkmcnt(7)
    v_mfma_f32_32x32x16_bf16 v[16:31], v[8:11], v[80:83], v[16:31]
    v_mul_f32 v190, s96, v190
    v_mul_f32 v191, s96, v191
    v_cvt_pk_f16_f32 v183, v190, v191
    v_permlane16_swap_b32 v180, v181
    ds_read_b128 v[8:11], v5 offset:2048
    s_waitcnt lgkmcnt(7)
    v_mfma_f32_32x32x16_bf16 v[16:31], v[12:15], v[84:87], v[16:31]
    v_permlane16_swap_b32 v182, v183
    ds_read_b32 v3, v0
    ds_read_b128 v[12:15], v6 offset:2048
    s_waitcnt lgkmcnt(8)
    v_mfma_f32_32x32x16_bf16 v[16:31], v[136:139], v[88:91], v[16:31]
    ds_read_b128 v[136:139], v5 offset:3072
    s_waitcnt lgkmcnt(8)
    v_mfma_f32_32x32x16_bf16 v[16:31], v[140:143], v[92:95], v[16:31]
    ds_read_b128 v[140:143], v6 offset:3072
    s_waitcnt lgkmcnt(8)
    v_mfma_f32_32x32x16_bf16 v[192:207], v[240:243], v[32:35], 0
    ds_read_b128 v[240:243], v5 offset:4096
    s_waitcnt lgkmcnt(8)
    v_mfma_f32_32x32x16_bf16 v[192:207], v[244:247], v[36:39], v[192:207]
    ds_read_b128 v[244:247], v6 offset:4096
    s_waitcnt lgkmcnt(8)
    v_mfma_f32_32x32x16_bf16 v[192:207], v[248:251], v[40:43], v[192:207]
    s_nop 2
    v_mul_f32 v16, s96, v16
    v_mul_f32 v17, s96, v17
    v_cvt_pk_f16_f32 v184, v16, v17
    ds_read_b128 v[248:251], v5 offset:5120
    s_waitcnt lgkmcnt(8)
    v_mfma_f32_32x32x16_bf16 v[192:207], v[252:255], v[44:47], v[192:207]
    v_mul_f32 v24, s96, v24
    v_mul_f32 v25, s96, v25
    v_cvt_pk_f16_f32 v185, v24, v25
    ds_read_b128 v[252:255], v6 offset:5120
    s_waitcnt lgkmcnt(8)
    v_mfma_f32_32x32x16_bf16 v[192:207], v[8:11], v[48:51], v[192:207]
    v_mul_f32 v18, s96, v18
    v_mul_f32 v19, s96, v19
    v_cvt_pk_f16_f32 v186, v18, v19
    ds_read_b128 v[8:11], v5 offset:6144
    s_waitcnt lgkmcnt(7)
    v_mfma_f32_32x32x16_bf16 v[192:207], v[12:15], v[52:55], v[192:207]
    v_cmp_ne_u32 vcc, 0, v3
    v_readlane_b32 s50, v3, 17
    ds_read_b128 v[12:15], v6 offset:6144
    s_waitcnt lgkmcnt(7)
    v_mfma_f32_32x32x16_bf16 v[192:207], v[136:139], v[56:59], v[192:207]
    s_bitcmp1_b32 vcc_lo, 7
    s_cbranch_scc0 LA_l7
LA_m7:
    ds_read_b128 v[136:139], v5 offset:7168
    s_waitcnt lgkmcnt(7)
    v_mfma_f32_32x32x16_bf16 v[192:207], v[140:143], v[60:63], v[192:207]
    ds_read_b128 v[140:143], v6 offset:7168
    s_and_b32 s50, s50, s88
    s_cmp_eq_u32 s50, s89
    s_cbranch_scc1 LA_g6
LA_h6:
    s_waitcnt lgkmcnt(7)
    v_mfma_f32_32x32x16_bf16 v[192:207], v[240:243], v[64:67], v[192:207]
    v_mul_f32 v26, s96, v26
    v_mul_f32 v27, s96, v27
    v_cvt_pk_f16_f32 v187, v26, v27
    v_permlane16_swap_b32 v184, v185
    v_add_u32 v5, 16384, v5
    v_add_u32 v6, 16384, v6
    ds_read_b128 v[240:243], v5 offset:0
    s_waitcnt lgkmcnt(7)
    v_mfma_f32_32x32x16_bf16 v[192:207], v[244:247], v[68:71], v[192:207]
    v_mul_f32 v20, s96, v20
    v_mul_f32 v21, s96, v21
    v_cvt_pk_f16_f32 v188, v20, v21
    ds_read_b128 v[244:247], v6 offset:0
    s_waitcnt lgkmcnt(7)
    v_mfma_f32_32x32x16_bf16 v[192:207], v[248:251], v[72:75], v[192:207]
    v_mul_f32 v28, s96, v28
    v_mul_f32 v29, s96, v29
    v_cvt_pk_f16_f32 v189, v28, v29
    v_permlane16_swap_b32 v186, v187
    ds_read_b128 v[248:251], v5 offset:1024
    s_waitcnt lgkmcnt(7)
    v_mfma_f32_32x32x16_bf16 v[192:207], v[252:255], v[76:79], v[192:207]
    v_mul_f32 v22, s96, v22
    v_mul_f32 v23, s96, v23
    v_cvt_pk_f16_f32 v190, v22, v23
    ds_read_b128 v[252:255], v6 offset:1024
    s_waitcnt lgkmcnt(7)
    v_mfma_f32_32x32x16_bf16 v[192:207], v[8:11], v[80:83], v[192:207]
    v_mul_f32 v30, s96, v30
    v_mul_f32 v31, s96, v31
    v_cvt_pk_f16_f32 v191, v30, v31
    v_permlane16_swap_b32 v188, v189
    ds_read_b128 v[8:11], v5 offset:2048
    s_waitcnt lgkmcnt(7)
    v_mfma_f32_32x32x16_bf16 v[192:207], v[12:15], v[84:87], v[192:207]
    v_permlane16_swap_b32 v190, v191
    ds_read_b32 v3, v0
    ds_read_b128 v[12:15], v6 offset:2048
    s_waitcnt lgkmcnt(8)
    v_mfma_f32_32x32x16_bf16 v[192:207], v[136:139], v[88:91], v[192:207]
    ds_read_b128 v[136:139], v5 offset:3072
    s_waitcnt lgkmcnt(8)
    v_mfma_f32_32x32x16_bf16 v[192:207], v[140:143], v[92:95], v[192:207]
    ds_read_b128 v[140:143], v6 offset:3072
    s_waitcnt lgkmcnt(8)
    v_mfma_f32_32x32x16_bf16 v[16:31], v[240:243], v[32:35], 0
    ds_read_b128 v[240:243], v5 offset:4096
    s_waitcnt lgkmcnt(8)
    v_mfma_f32_32x32x16_bf16 v[16:31], v[244:247], v[36:39], v[16:31]
    ds_read_b128 v[244:247], v6 offset:4096
    s_waitcnt lgkmcnt(8)
    v_mfma_f32_32x32x16_bf16 v[16:31], v[248:251], v[40:43], v[16:31]
    s_nop 2
    v_mul_f32 v192, s96, v192
    v_mul_f32 v193, s96, v193
    v_cvt_pk_f16_f32 v192, v192, v193
    ds_read_b128 v[248:251], v5 offset:5120
    s_waitcnt lgkmcnt(8)
    v_mfma_f32_32x32x16_bf16 v[16:31], v[252:255], v[44:47], v[16:31]
    v_mul_f32 v200, s96, v200
    v_mul_f32 v201, s96, v201
    v_cvt_pk_f16_f32 v193, v200, v201
    ds_read_b128 v[252:255], v6 offset:5120
    s_waitcnt lgkmcnt(8)
    v_mfma_f32_32x32x16_bf16 v[16:31], v[8:11], v[48:51], v[16:31]
    v_mul_f32 v194, s96, v194
    v_mul_f32 v195, s96, v195
    v_cvt_pk_f16_f32 v194, v194, v195
    ds_read_b128 v[8:11], v5 offset:6144
    s_waitcnt lgkmcnt(7)
    v_mfma_f32_32x32x16_bf16 v[16:31], v[12:15], v[52:55], v[16:31]
    v_cmp_ne_u32 vcc, 0, v3
    v_readlane_b32 s50, v3, 17
    ds_read_b128 v[12:15], v6 offset:6144
    s_waitcnt lgkmcnt(7)
    v_mfma_f32_32x32x16_bf16 v[16:31], v[136:139], v[56:59], v[16:31]
    s_bitcmp1_b32 vcc_lo, 8
    s_cbranch_scc0 LA_l8
LA_m8:
    ds_read_b128 v[136:139], v5 offset:7168
    s_waitcnt lgkmcnt(7)
    v_mfma_f32_32x32x16_bf16 v[16:31], v[140:143], v[60:63], v[16:31]
    ds_read_b128 v[140:143], v6 offset:7168
    s_and_b32 s50, s50, s88
    s_cmp_eq_u32 s50, s89
    s_cbranch_scc1 LA_g7
LA_h7:
    s_waitcnt lgkmcnt(7)
    v_mfma_f32_32x32x16_bf16 v[16:31], v[240:243], v[64:67], v[16:31]
    v_mul_f32 v202, s96, v202
    v_mul_f32 v203, s96, v203
    v_cvt_pk_f16_f32 v195, v202, v203
    v_permlane16_swap_b32 v192, v193
    v_add_u32 v5, -49152, v5
    v_add_u32 v6, -49152, v6
    ds_read_b128 v[240:243], v5 offset:0
    s_waitcnt lgkmcnt(7)
    v_mfma_f32_32x32x16_bf16 v[16:31], v[244:247], v[68:71], v[16:31]
    v_mul_f32 v196, s96, v196
    v_mul_f32 v197, s96, v197
    v_cvt_pk_f16_f32 v196, v196, v197
    ds_read_b128 v[244:247], v6 offset:0
    s_waitcnt lgkmcnt(7)
    v_mfma_f32_32x32x16_bf16 v[16:31], v[248:251], v[72:75], v[16:31]
    v_mul_f32 v204, s96, v204
    v_mul_f32 v205, s96, v205
    v_cvt_pk_f16_f32 v197, v204, v205
    v_permlane16_swap_b32 v194, v195
    ds_read_b128 v[248:251], v5 offset:1024
    s_waitcnt lgkmcnt(7)
    v_mfma_f32_32x32x16_bf16 v[16:31], v[252:255], v[76:79], v[16:31]
    v_mul_f32 v198, s96, v198
    v_mul_f32 v199, s96, v199
    v_cvt_pk_f16_f32 v198, v198, v199
    ds_read_b128 v[252:255], v6 offset:1024
    s_waitcnt lgkmcnt(7)
    v_mfma_f32_32x32x16_bf16 v[16:31], v[8:11], v[80:83], v[16:31]
    v_mul_f32 v206, s96, v206
    v_mul_f32 v207, s96, v207
    v_cvt_pk_f16_f32 v199, v206, v207
    v_permlane16_swap_b32 v196, v197
    ds_read_b128 v[8:11], v5 offset:2048
    s_waitcnt lgkmcnt(7)
    v_mfma_f32_32x32x16_bf16 v[16:31], v[12:15], v[84:87], v[16:31]
    v_permlane16_swap_b32 v198, v199
    ds_read_b32 v3, v0
    ds_read_b128 v[12:15], v6 offset:2048
    s_waitcnt lgkmcnt(8)
    v_mfma_f32_32x32x16_bf16 v[16:31], v[136:139], v[88:91], v[16:31]
    ds_read_b128 v[136:139], v5 offset:3072
    s_waitcnt lgkmcnt(8)
    v_mfma_f32_32x32x16_bf16 v[16:31], v[140:143], v[92:95], v[16:31]
    ds_read_b128 v[140:143], v6 offset:3072
    s_waitcnt lgkmcnt(8)
    v_mfma_f32_32x32x16_bf16 v[208:223], v[240:243], v[32:35], 0
    ds_read_b128 v[240:243], v5 offset:4096
    s_waitcnt lgkmcnt(8)
    v_mfma_f32_32x32x16_bf16 v[208:223], v[244:247], v[36:39], v[208:223]
    ds_read_b128 v[244:247], v6 offset:4096
    s_waitcnt lgkmcnt(8)
    v_mfma_f32_32x32x16_bf16 v[208:223], v[248:251], v[40:43], v[208:223]
    s_nop 2
    v_mul_f32 v16, s96, v16
    v_mul_f32 v17, s96, v17
    v_cvt_pk_f16_f32 v200, v16, v17
    ds_read_b128 v[248:251], v5 offset:5120
    s_waitcnt lgkmcnt(8)
    v_mfma_f32_32x32x16_bf16 v[208:223], v[252:255], v[44:47], v[208:223]
    v_mul_f32 v24, s96, v24
    v_mul_f32 v25, s96, v25
    v_cvt_pk_f16_f32 v201, v24, v25
    ds_read_b128 v[252:255], v6 offset:5120
    s_waitcnt lgkmcnt(8)
    v_mfma_f32_32x32x16_bf16 v[208:223], v[8:11], v[48:51], v[208:223]
    v_mul_f32 v18, s96, v18
    v_mul_f32 v19, s96, v19
    v_cvt_pk_f16_f32 v202, v18, v19
    ds_read_b128 v[8:11], v5 offset:6144
    s_waitcnt lgkmcnt(7)
    v_mfma_f32_32x32x16_bf16 v[208:223], v[12:15], v[52:55], v[208:223]
    v_cmp_ne_u32 vcc, 0, v3
    v_readlane_b32 s50, v3, 17
    ds_read_b128 v[12:15], v6 offset:6144
    s_waitcnt lgkmcnt(7)
    v_mfma_f32_32x32x16_bf16 v[208:223], v[136:139], v[56:59], v[208:223]
    s_bitcmp1_b32 vcc_lo, 9
    s_cbranch_scc0 LA_l9
LA_m9:
    ds_read_b128 v[136:139], v5 offset:7168
    s_waitcnt lgkmcnt(7)
    v_mfma_f32_32x32x16_bf16 v[208:223], v[140:143], v[60:63], v[208:223]
    ds_read_b128 v[140:143], v6 offset:7168
    s_and_b32 s50, s50, s88
    s_cmp_eq_u32 s50, s89
    s_cbranch_scc1 LA_g8
LA_h8:
    s_waitcnt lgkmcnt(7)
    v_mfma_f32_32x32x16_bf16 v[208:223], v[240:243], v[64:67], v[208:223]
    v_mul_f32 v26, s96, v26
    v_mul_f32 v27, s96, v27
    v_cvt_pk_f16_f32 v203, v26, v27
    v_permlane16_swap_b32 v200, v201
    v_add_u32 v5, -49152, v5
    v_add_u32 v6, -49152, v6
    ds_read_b128 v[240:243], v5 offset:0
    s_waitcnt lgkmcnt(7)
    v_mfma_f32_32x32x16_bf16 v[208:223], v[244:247], v[68:71], v[208:223]
    v_mul_f32 v20, s96, v20
    v_mul_f32 v21, s96, v21
    v_cvt_pk_f16_f32 v204, v20, v21
    ds_read_b128 v[244:247], v6 offset:0
    s_waitcnt lgkmcnt(7)
    v_mfma_f32_32x32x16_bf16 v[208:223], v[248:251], v[72:75], v[208:223]
    v_mul_f32 v28, s96, v28
    v_mul_f32 v29, s96, v29
    v_cvt_pk_f16_f32 v205, v28, v29
    v_permlane16_swap_b32 v202, v203
    ds_read_b128 v[248:251], v5 offset:1024
    s_waitcnt lgkmcnt(7)
    v_mfma_f32_32x32x16_bf16 v[208:223], v[252:255], v[76:79], v[208:223]
    v_mul_f32 v22, s96, v22
    v_mul_f32 v23, s96, v23
    v_cvt_pk_f16_f32 v206, v22, v23
    ds_read_b128 v[252:255], v6 offset:1024
    s_waitcnt lgkmcnt(7)
    v_mfma_f32_32x32x16_bf16 v[208:223], v[8:11], v[80:83], v[208:223]
    v_mul_f32 v30, s96, v30
    v_mul_f32 v31, s96, v31
    v_cvt_pk_f16_f32 v207, v30, v31
    v_permlane16_swap_b32 v204, v205
    ds_read_b128 v[8:11], v5 offset:2048
    s_waitcnt lgkmcnt(7)
    v_mfma_f32_32x32x16_bf16 v[208:223], v[12:15], v[84:87], v[208:223]
    v_permlane16_swap_b32 v206, v207
    ds_read_b32 v3, v0
    ds_read_b128 v[12:15], v6 offset:2048
    s_waitcnt lgkmcnt(8)
    v_mfma_f32_32x32x16_bf16 v[208:223], v[136:139], v[88:91], v[208:223]
    ds_read_b128 v[136:139], v5 offset:3072
    s_waitcnt lgkmcnt(8)
    v_mfma_f32_32x32x16_bf16 v[208:223], v[140:143], v[92:95], v[208:223]
    ds_read_b128 v[140:143], v6 offset:3072
    s_waitcnt lgkmcnt(8)
    v_mfma_f32_32x32x16_bf16 v[16:31], v[240:243], v[32:35], 0
    ds_write_b32 v1, v0 offset:224
    ds_read_b128 v[240:243], v5 offset:4096
    s_waitcnt lgkmcnt(9)
    v_mfma_f32_32x32x16_bf16 v[16:31], v[244:247], v[36:39], v[16:31]
    ds_read_b128 v[244:247], v6 offset:4096
    s_waitcnt lgkmcnt(9)
    v_mfma_f32_32x32x16_bf16 v[16:31], v[248:251], v[40:43], v[16:31]
    s_nop 1
    v_mul_f32 v208, s96, v208
    v_mul_f32 v209, s96, v209
    v_cvt_pk_f16_f32 v208, v208, v209
    ds_read_b128 v[248:251], v5 offset:5120
    s_waitcnt lgkmcnt(9)
    v_mfma_f32_32x32x16_bf16 v[16:31], v[252:255], v[44:47], v[16:31]
    v_mul_f32 v216, s96, v216
    v_mul_f32 v217, s96, v217
    v_cvt_pk_f16_f32 v209, v216, v217
    ds_read_b128 v[252:255], v6 offset:5120
    s_waitcnt lgkmcnt(9)
    v_mfma_f32_32x32x16_bf16 v[16:31], v[8:11], v[48:51], v[16:31]
    v_mul_f32 v210, s96, v210
    v_mul_f32 v211, s96, v211
    v_cvt_pk_f16_f32 v210, v210, v211
    ds_read_b128 v[8:11], v5 offset:6144
    s_waitcnt lgkmcnt(8)
    v_mfma_f32_32x32x16_bf16 v[16:31], v[12:15], v[52:55], v[16:31]
    v_cmp_ne_u32 vcc, 0, v3
    v_readlane_b32 s50, v3, 17
    ds_read_b128 v[12:15], v6 offset:6144
    s_waitcnt lgkmcnt(8)
    v_mfma_f32_32x32x16_bf16 v[16:31], v[136:139], v[56:59], v[16:31]
    s_bitcmp1_b32 vcc_lo, 10
    s_cbranch_scc0 LA_l10
LA_m10:
    ds_read_b128 v[136:139], v5 offset:7168
    s_waitcnt lgkmcnt(8)
    v_mfma_f32_32x32x16_bf16 v[16:31], v[140:143], v[60:63], v[16:31]
    ds_read_b128 v[140:143], v6 offset:7168
    s_and_b32 s50, s50, s88
    s_cmp_eq_u32 s50, s89
    s_cbranch_scc1 LA_g9
LA_h9:
    s_waitcnt lgkmcnt(7)
    v_mfma_f32_32x32x16_bf16 v[16:31], v[240:243], v[64:67], v[16:31]
    v_mul_f32 v218, s96, v218
    v_mul_f32 v219, s96, v219
    v_cvt_pk_f16_f32 v211, v218, v219
    v_permlane16_swap_b32 v208, v209
    v_add_u32 v5, 16384, v5
    v_add_u32 v6, 16384, v6
    ds_read_b128 v[240:243], v5 offset:0
    s_waitcnt lgkmcnt(7)
    v_mfma_f32_32x32x16_bf16 v[16:31], v[244:247], v[68:71], v[16:31]
    v_mul_f32 v212, s96, v212
    v_mul_f32 v213, s96, v213
    v_cvt_pk_f16_f32 v212, v212, v213
    ds_read_b128 v[244:247], v6 offset:0
    s_waitcnt lgkmcnt(7)
    v_mfma_f32_32x32x16_bf16 v[16:31], v[248:251], v[72:75], v[16:31]
    v_mul_f32 v220, s96, v220
    v_mul_f32 v221, s96, v221
    v_cvt_pk_f16_f32 v213, v220, v221
    v_permlane16_swap_b32 v210, v211
    ds_read_b128 v[248:251], v5 offset:1024
    s_waitcnt lgkmcnt(7)
    v_mfma_f32_32x32x16_bf16 v[16:31], v[252:255], v[76:79], v[16:31]
    v_mul_f32 v214, s96, v214
    v_mul_f32 v215, s96, v215
    v_cvt_pk_f16_f32 v214, v214, v215
    ds_read_b128 v[252:255], v6 offset:1024
    s_waitcnt lgkmcnt(7)
    v_mfma_f32_32x32x16_bf16 v[16:31], v[8:11], v[80:83], v[16:31]
    v_mul_f32 v222, s96, v222
    v_mul_f32 v223, s96, v223
    v_cvt_pk_f16_f32 v215, v222, v223
    v_permlane16_swap_b32 v212, v213
    ds_read_b128 v[8:11], v5 offset:2048
    s_waitcnt lgkmcnt(7)
    v_mfma_f32_32x32x16_bf16 v[16:31], v[12:15], v[84:87], v[16:31]
    v_permlane16_swap_b32 v214, v215
    ds_read_b32 v3, v0
    ds_read_b128 v[12:15], v6 offset:2048
    s_waitcnt lgkmcnt(8)
    v_mfma_f32_32x32x16_bf16 v[16:31], v[136:139], v[88:91], v[16:31]
    ds_read_b128 v[136:139], v5 offset:3072
    s_waitcnt lgkmcnt(8)
    v_mfma_f32_32x32x16_bf16 v[16:31], v[140:143], v[92:95], v[16:31]
    ds_read_b128 v[140:143], v6 offset:3072
    s_waitcnt lgkmcnt(8)
    v_mfma_f32_32x32x16_bf16 v[224:239], v[240:243], v[32:35], 0
    ds_read_b128 v[240:243], v5 offset:4096
    s_waitcnt lgkmcnt(8)
    v_mfma_f32_32x32x16_bf16 v[224:239], v[244:247], v[36:39], v[224:239]
    ds_read_b128 v[244:247], v6 offset:4096
    s_waitcnt lgkmcnt(8)
    v_mfma_f32_32x32x16_bf16 v[224:239], v[248:251], v[40:43], v[224:239]
    s_nop 2
    v_mul_f32 v16, s96, v16
    v_mul_f32 v17, s96, v17
    v_cvt_pk_f16_f32 v216, v16, v17
    ds_read_b128 v[248:251], v5 offset:5120
    s_waitcnt lgkmcnt(8)
    v_mfma_f32_32x32x16_bf16 v[224:239], v[252:255], v[44:47], v[224:239]
    v_mul_f32 v24, s96, v24
    v_mul_f32 v25, s96, v25
    v_cvt_pk_f16_f32 v217, v24, v25
    ds_read_b128 v[252:255], v6 offset:5120
    s_waitcnt lgkmcnt(8)
    v_mfma_f32_32x32x16_bf16 v[224:239], v[8:11], v[48:51], v[224:239]
    v_mul_f32 v18, s96, v18
    v_mul_f32 v19, s96, v19
    v_cvt_pk_f16_f32 v218, v18, v19
    ds_read_b128 v[8:11], v5 offset:6144
    s_waitcnt lgkmcnt(7)
    v_mfma_f32_32x32x16_bf16 v[224:239], v[12:15], v[52:55], v[224:239]
    v_cmp_ne_u32 vcc, 0, v3
    v_readlane_b32 s50, v3, 17
    ds_read_b128 v[12:15], v6 offset:6144
    s_waitcnt lgkmcnt(7)
    v_mfma_f32_32x32x16_bf16 v[224:239], v[136:139], v[56:59], v[224:239]
    s_bitcmp1_b32 vcc_lo, 11
    s_cbranch_scc0 LA_l11
LA_m11:
    ds_read_b128 v[136:139], v5 offset:7168
    s_waitcnt lgkmcnt(7)
    v_mfma_f32_32x32x16_bf16 v[224:239], v[140:143], v[60:63], v[224:239]
    ds_read_b128 v[140:143], v6 offset:7168
    s_and_b32 s50, s50, s88
    s_cmp_eq_u32 s50, s89
    s_cbranch_scc1 LA_g10
LA_h10:
    s_waitcnt lgkmcnt(7)
    v_mfma_f32_32x32x16_bf16 v[224:239], v[240:243], v[64:67], v[224:239]
    v_mul_f32 v26, s96, v26
    v_mul_f32 v27, s96, v27
    v_cvt_pk_f16_f32 v219, v26, v27
    v_permlane16_swap_b32 v216, v217
    v_add_u32 v5, 16384, v5
    v_add_u32 v6, 16384, v6
    ds_read_b128 v[240:243], v5 offset:0
    s_waitcnt lgkmcnt(7)
    v_mfma_f32_32x32x16_bf16 v[224:239], v[244:247], v[68:71], v[224:239]
    v_mul_f32 v20, s96, v20
    v_mul_f32 v21, s96, v21
    v_cvt_pk_f16_f32 v220, v20, v21
    ds_read_b128 v[244:247], v6 offset:0
    s_waitcnt lgkmcnt(7)
    v_mfma_f32_32x32x16_bf16 v[224:239], v[248:251], v[72:75], v[224:239]
    v_mul_f32 v28, s96, v28
    v_mul_f32 v29, s96, v29
    v_cvt_pk_f16_f32 v221, v28, v29
    v_permlane16_swap_b32 v218, v219
    ds_read_b128 v[248:251], v5 offset:1024
    s_waitcnt lgkmcnt(7)
    v_mfma_f32_32x32x16_bf16 v[224:239], v[252:255], v[76:79], v[224:239]
    v_mul_f32 v22, s96, v22
    v_mul_f32 v23, s96, v23
    v_cvt_pk_f16_f32 v222, v22, v23
    ds_read_b128 v[252:255], v6 offset:1024
    s_waitcnt lgkmcnt(7)
    v_mfma_f32_32x32x16_bf16 v[224:239], v[8:11], v[80:83], v[224:239]
    v_mul_f32 v30, s96, v30
    v_mul_f32 v31, s96, v31
    v_cvt_pk_f16_f32 v223, v30, v31
    v_permlane16_swap_b32 v220, v221
    ds_read_b128 v[8:11], v5 offset:2048
    s_waitcnt lgkmcnt(7)
    v_mfma_f32_32x32x16_bf16 v[224:239], v[12:15], v[84:87], v[224:239]
    v_permlane16_swap_b32 v222, v223
    ds_read_b32 v3, v0
    ds_read_b128 v[12:15], v6 offset:2048
    s_waitcnt lgkmcnt(8)
    v_mfma_f32_32x32x16_bf16 v[224:239], v[136:139], v[88:91], v[224:239]
    ds_read_b128 v[136:139], v5 offset:3072
    s_waitcnt lgkmcnt(8)
    v_mfma_f32_32x32x16_bf16 v[224:239], v[140:143], v[92:95], v[224:239]
    ds_read_b128 v[140:143], v6 offset:3072
    s_waitcnt lgkmcnt(8)
    v_mfma_f32_32x32x16_bf16 v[16:31], v[240:243], v[32:35], 0
    ds_read_b128 v[240:243], v5 offset:4096
    s_waitcnt lgkmcnt(8)
    v_mfma_f32_32x32x16_bf16 v[16:31], v[244:247], v[36:39], v[16:31]
    ds_read_b128 v[244:247], v6 offset:4096
    s_waitcnt lgkmcnt(8)
    v_mfma_f32_32x32x16_bf16 v[16:31], v[248:251], v[40:43], v[16:31]
    s_nop 2
    v_mul_f32 v224, s96, v224
    v_mul_f32 v225, s96, v225
    v_cvt_pk_f16_f32 v224, v224, v225
    ds_read_b128 v[248:251], v5 offset:5120
    s_waitcnt lgkmcnt(8)
    v_mfma_f32_32x32x16_bf16 v[16:31], v[252:255], v[44:47], v[16:31]
    v_mul_f32 v232, s96, v232
    v_mul_f32 v233, s96, v233
    v_cvt_pk_f16_f32 v225, v232, v233
    ds_read_b128 v[252:255], v6 offset:5120
    s_waitcnt lgkmcnt(8)
    v_mfma_f32_32x32x16_bf16 v[16:31], v[8:11], v[48:51], v[16:31]
    v_mul_f32 v226, s96, v226
    v_mul_f32 v227, s96, v227
    v_cvt_pk_f16_f32 v226, v226, v227
    ds_read_b128 v[8:11], v5 offset:6144
    s_waitcnt lgkmcnt(7)
    v_mfma_f32_32x32x16_bf16 v[16:31], v[12:15], v[52:55], v[16:31]
    v_cmp_ne_u32 vcc, 0, v3
    v_readlane_b32 s50, v3, 17
    ds_read_b128 v[12:15], v6 offset:6144
    s_waitcnt lgkmcnt(7)
    v_mfma_f32_32x32x16_bf16 v[16:31], v[136:139], v[56:59], v[16:31]
    s_bitcmp1_b32 vcc_lo, 12
    s_cbranch_scc0 LA_l12
LA_m12:
    ds_read_b128 v[136:139], v5 offset:7168
    s_waitcnt lgkmcnt(7)
    v_mfma_f32_32x32x16_bf16 v[16:31], v[140:143], v[60:63], v[16:31]
    ds_read_b128 v[140:143], v6 offset:7168
    s_and_b32 s50, s50, s88
    s_cmp_eq_u32 s50, s89
    s_cbranch_scc1 LA_g11
LA_h11:
    s_waitcnt lgkmcnt(7)
    v_mfma_f32_32x32x16_bf16 v[16:31], v[240:243], v[64:67], v[16:31]
    v_mul_f32 v234, s96, v234
    v_mul_f32 v235, s96, v235
    v_cvt_pk_f16_f32 v227, v234, v235
    v_permlane16_swap_b32 v224, v225
    s_waitcnt lgkmcnt(6)
    v_mfma_f32_32x32x16_bf16 v[16:31], v[244:247], v[68:71], v[16:31]
    v_mul_f32 v228, s96, v228
    v_mul_f32 v229, s96, v229
    v_cvt_pk_f16_f32 v228, v228, v229
    s_waitcnt lgkmcnt(5)
    v_mfma_f32_32x32x16_bf16 v[16:31], v[248:251], v[72:75], v[16:31]
    v_mul_f32 v236, s96, v236
    v_mul_f32 v237, s96, v237
    v_cvt_pk_f16_f32 v229, v236, v237
    v_permlane16_swap_b32 v226, v227
    s_waitcnt lgkmcnt(4)
    v_mfma_f32_32x32x16_bf16 v[16:31], v[252:255], v[76:79], v[16:31]
    v_mul_f32 v230, s96, v230
    v_mul_f32 v231, s96, v231
    v_cvt_pk_f16_f32 v230, v230, v231
    s_waitcnt lgkmcnt(3)
    v_mfma_f32_32x32x16_bf16 v[16:31], v[8:11], v[80:83], v[16:31]
    v_mul_f32 v238, s96, v238
    v_mul_f32 v239, s96, v239
    v_cvt_pk_f16_f32 v231, v238, v239
    v_permlane16_swap_b32 v228, v229
    v_add_u32 v5, -56320, v5
    v_add_u32 v6, -56320, v6
    ds_read_b128 v[8:11], v5 offset:0
    s_waitcnt lgkmcnt(3)
    v_mfma_f32_32x32x16_bf16 v[16:31], v[12:15], v[84:87], v[16:31]
    v_permlane16_swap_b32 v230, v231
    ds_read_b32 v3, v0
    ds_read_b128 v[12:15], v6 offset:0
    s_waitcnt lgkmcnt(4)
    v_mfma_f32_32x32x16_bf16 v[16:31], v[136:139], v[88:91], v[16:31]
    ds_read_b128 v[136:139], v5 offset:1024
    s_waitcnt lgkmcnt(4)
    v_mfma_f32_32x32x16_bf16 v[16:31], v[140:143], v[92:95], v[16:31]
    ds_read_b128 v[140:143], v6 offset:1024
    s_waitcnt lgkmcnt(4)
    v_mfma_f32_32x32x16_bf16 v[240:255], v[8:11], v[32:35], 0
    ds_read_b128 v[8:11], v5 offset:2048
    s_waitcnt lgkmcnt(3)
    v_mfma_f32_32x32x16_bf16 v[240:255], v[12:15], v[36:39], v[240:255]
    ds_read_b128 v[12:15], v6 offset:2048
    s_waitcnt lgkmcnt(3)
    v_mfma_f32_32x32x16_bf16 v[240:255], v[136:139], v[40:43], v[240:255]
    s_nop 2
    v_mul_f32 v16, s96, v16
    v_mul_f32 v17, s96, v17
    v_cvt_pk_f16_f32 v232, v16, v17
    ds_read_b128 v[136:139], v5 offset:3072
    s_waitcnt lgkmcnt(3)
    v_mfma_f32_32x32x16_bf16 v[240:255], v[140:143], v[44:47], v[240:255]
    v_mul_f32 v24, s96, v24
    v_mul_f32 v25, s96, v25
    v_cvt_pk_f16_f32 v233, v24, v25
    ds_read_b128 v[140:143], v6 offset:3072
    s_waitcnt lgkmcnt(3)
    v_mfma_f32_32x32x16_bf16 v[240:255], v[8:11], v[48:51], v[240:255]
    v_mul_f32 v18, s96, v18
    v_mul_f32 v19, s96, v19
    v_cvt_pk_f16_f32 v234, v18, v19
    ds_read_b128 v[8:11], v5 offset:4096
    s_waitcnt lgkmcnt(3)
    v_mfma_f32_32x32x16_bf16 v[240:255], v[12:15], v[52:55], v[240:255]
    v_cmp_ne_u32 vcc, 0, v3
    v_readlane_b32 s50, v3, 17
    v_readlane_b32 s19, v3, 16
    ds_read_b128 v[12:15], v6 offset:4096
    s_waitcnt lgkmcnt(3)
    v_mfma_f32_32x32x16_bf16 v[240:255], v[136:139], v[56:59], v[240:255]
    s_bitcmp1_b32 vcc_lo, 13
    s_cbranch_scc0 LA_l13
LA_m13:
    ds_read_b128 v[136:139], v5 offset:5120
    s_waitcnt lgkmcnt(3)
    v_mfma_f32_32x32x16_bf16 v[240:255], v[140:143], v[60:63], v[240:255]
    ds_read_b128 v[140:143], v6 offset:5120
    s_and_b32 s50, s50, s88
    s_cmp_eq_u32 s50, s89
    s_cbranch_scc1 LA_g12
LA_h12:
    s_waitcnt lgkmcnt(3)
    v_mfma_f32_32x32x16_bf16 v[240:255], v[8:11], v[64:67], v[240:255]
    v_mul_f32 v26, s96, v26
    v_mul_f32 v27, s96, v27
    v_cvt_pk_f16_f32 v235, v26, v27
    v_permlane16_swap_b32 v232, v233
    ds_read_b128 v[8:11], v5 offset:6144
    s_waitcnt lgkmcnt(3)
    v_mfma_f32_32x32x16_bf16 v[240:255], v[12:15], v[68:71], v[240:255]
    v_mul_f32 v20, s96, v20
    v_mul_f32 v21, s96, v21
    v_cvt_pk_f16_f32 v236, v20, v21
    ds_read_b128 v[12:15], v6 offset:6144
    s_waitcnt lgkmcnt(3)
    v_mfma_f32_32x32x16_bf16 v[240:255], v[136:139], v[72:75], v[240:255]
    v_mul_f32 v28, s96, v28
    v_mul_f32 v29, s96, v29
    v_cvt_pk_f16_f32 v237, v28, v29
    v_permlane16_swap_b32 v234, v235
    ds_read_b128 v[136:139], v5 offset:7168
    s_waitcnt lgkmcnt(3)
    v_mfma_f32_32x32x16_bf16 v[240:255], v[140:143], v[76:79], v[240:255]
    v_mul_f32 v22, s96, v22
    v_mul_f32 v23, s96, v23
    v_cvt_pk_f16_f32 v238, v22, v23
    ds_read_b128 v[140:143], v6 offset:7168
    s_waitcnt lgkmcnt(3)
    v_mfma_f32_32x32x16_bf16 v[240:255], v[8:11], v[80:83], v[240:255]
    v_mul_f32 v30, s96, v30
    v_mul_f32 v31, s96, v31
    v_cvt_pk_f16_f32 v239, v30, v31
    v_permlane16_swap_b32 v236, v237
    v_add_u32 v5, 138240, v5
    v_add_u32 v6, 138240, v6
    ds_read_b128 v[8:11], v5 offset:0
    s_waitcnt lgkmcnt(3)
    v_mfma_f32_32x32x16_bf16 v[240:255], v[12:15], v[84:87], v[240:255]
    v_permlane16_swap_b32 v238, v239
    ds_read_b128 v[12:15], v6 offset:0
    s_waitcnt lgkmcnt(3)
    v_mfma_f32_32x32x16_bf16 v[240:255], v[136:139], v[88:91], v[240:255]
    ds_read_b128 v[136:139], v5 offset:1024
    s_waitcnt lgkmcnt(3)
    v_mfma_f32_32x32x16_bf16 v[240:255], v[140:143], v[92:95], v[240:255]
    ds_read_b128 v[140:143], v6 offset:1024
    s_waitcnt lgkmcnt(3)
    v_mfma_f32_32x32x16_bf16 v[16:31], v[8:11], v[32:35], 0
    ds_write_b32 v1, v0 offset:256
    ds_read_b128 v[32:35], v5 offset:2048
    ds_read_b128 v[8:11], v6 offset:2048
    s_waitcnt lgkmcnt(5)
    v_mfma_f32_32x32x16_bf16 v[16:31], v[12:15], v[36:39], v[16:31]
    ds_read_b128 v[36:39], v5 offset:3072
    ds_read_b128 v[12:15], v6 offset:3072
    s_waitcnt lgkmcnt(6)
    v_mfma_f32_32x32x16_bf16 v[16:31], v[136:139], v[40:43], v[16:31]
    v_mul_f32 v240, s96, v240
    v_mul_f32 v241, s96, v241
    v_cvt_pk_f16_f32 v240, v240, v241
    ds_read_b128 v[40:43], v5 offset:4096
    ds_read_b128 v[136:139], v6 offset:4096
    s_waitcnt lgkmcnt(7)
    v_mfma_f32_32x32x16_bf16 v[16:31], v[140:143], v[44:47], v[16:31]
    v_mul_f32 v248, s96, v248
    v_mul_f32 v249, s96, v249
    v_cvt_pk_f16_f32 v241, v248, v249
    ds_read_b128 v[44:47], v5 offset:5120
    ds_read_b128 v[140:143], v6 offset:5120
    s_waitcnt lgkmcnt(7)
    v_mfma_f32_32x32x16_bf16 v[16:31], v[32:35], v[48:51], v[16:31]
    v_mul_f32 v242, s96, v242
    v_mul_f32 v243, s96, v243
    v_cvt_pk_f16_f32 v242, v242, v243
    ds_read_b128 v[48:51], v5 offset:6144
    s_waitcnt lgkmcnt(7)
    v_mfma_f32_32x32x16_bf16 v[16:31], v[8:11], v[52:55], v[16:31]
    ds_read_b128 v[32:35], v6 offset:6144
    s_waitcnt lgkmcnt(7)
    v_mfma_f32_32x32x16_bf16 v[16:31], v[36:39], v[56:59], v[16:31]
    ds_read_b128 v[52:55], v5 offset:7168
    s_waitcnt lgkmcnt(7)
    v_mfma_f32_32x32x16_bf16 v[16:31], v[12:15], v[60:63], v[16:31]
    ds_read_b128 v[8:11], v6 offset:7168
    s_waitcnt lgkmcnt(7)
    v_mfma_f32_32x32x16_bf16 v[16:31], v[40:43], v[64:67], v[16:31]
    v_mul_f32 v250, s96, v250
    v_mul_f32 v251, s96, v251
    v_cvt_pk_f16_f32 v243, v250, v251
    v_permlane16_swap_b32 v240, v241
    s_waitcnt lgkmcnt(6)
    v_mfma_f32_32x32x16_bf16 v[16:31], v[136:139], v[68:71], v[16:31]
    v_mul_f32 v244, s96, v244
    v_mul_f32 v245, s96, v245
    v_cvt_pk_f16_f32 v244, v244, v245
    s_waitcnt lgkmcnt(5)
    v_mfma_f32_32x32x16_bf16 v[16:31], v[44:47], v[72:75], v[16:31]
    v_mul_f32 v252, s96, v252
    v_mul_f32 v253, s96, v253
    v_cvt_pk_f16_f32 v245, v252, v253
    v_permlane16_swap_b32 v242, v243
    s_waitcnt lgkmcnt(4)
    v_mfma_f32_32x32x16_bf16 v[16:31], v[140:143], v[76:79], v[16:31]
    v_mul_f32 v246, s96, v246
    v_mul_f32 v247, s96, v247
    v_cvt_pk_f16_f32 v246, v246, v247
    s_waitcnt lgkmcnt(3)
    v_mfma_f32_32x32x16_bf16 v[16:31], v[48:51], v[80:83], v[16:31]
    v_mul_f32 v254, s96, v254
    v_mul_f32 v255, s96, v255
    v_cvt_pk_f16_f32 v247, v254, v255
    v_permlane16_swap_b32 v244, v245
    s_waitcnt lgkmcnt(2)
    v_mfma_f32_32x32x16_bf16 v[16:31], v[32:35], v[84:87], v[16:31]
    v_permlane16_swap_b32 v246, v247
    s_waitcnt lgkmcnt(1)
    v_mfma_f32_32x32x16_bf16 v[16:31], v[52:55], v[88:91], v[16:31]
    s_waitcnt lgkmcnt(0)
    v_mfma_f32_32x32x16_bf16 v[16:31], v[8:11], v[92:95], v[16:31]
LA_e0:
    s_cmp_eq_u32 s89, -1
    s_cbranch_scc1 LA_e1
    ds_read_b32 v3, v0
    s_sub_u32 s25, s25, 1
    s_cbranch_scc1 M_end
    s_waitcnt lgkmcnt(0)
    v_readlane_b32 s50, v3, 17
    s_and_b32 s50, s50, s88
    s_cmp_eq_u32 s50, s89
    s_cbranch_scc0 LA_e0
    global_load_dwordx4 v[96:99], v2, s[80:81] offset:-4096 sc1
    global_load_dwordx4 v[100:103], v2, s[82:83] offset:-4096 sc1
    global_load_dwordx4 v[104:107], v2, s[84:85] offset:-4096 sc1
    global_load_dwordx4 v[108:111], v2, s[86:87] offset:-4096 sc1
    global_load_dwordx4 v[112:115], v2, s[80:81] offset:-3072 sc1
    global_load_dwordx4 v[116:119], v2, s[82:83] offset:-3072 sc1
    global_load_dwordx4 v[120:123], v2, s[84:85] offset:-3072 sc1
    global_load_dwordx4 v[124:127], v2, s[86:87] offset:-3072 sc1
    global_load_dwordx4 v[128:131], v2, s[80:81] offset:-2048 sc1
    global_load_dwordx4 v[132:135], v2, s[82:83] offset:-2048 sc1
    ds_write_b32 v1, v0 offset:192
    s_mov_b32 s89, -1
LA_e1:
    s_setprio 0
    v_lshrrev_b32 v1, 4, v2
    s_cmp_eq_u32 s23, 0
    s_cbranch_scc1 LA_e2
    global_load_dwordx4 v[136:139], v2, s[84:85] offset:-2048 sc1
    global_load_dwordx4 v[140:143], v2, s[86:87] offset:-2048 sc1
    global_load_dwordx4 v[64:67], v2, s[80:81] offset:1024 sc1
    global_load_dwordx4 v[68:71], v2, s[82:83] offset:1024 sc1
    global_load_dwordx4 v[72:75], v2, s[84:85] offset:1024 sc1
    global_load_dwordx4 v[76:79], v2, s[86:87] offset:1024 sc1
    global_load_dwordx4 v[80:83], v2, s[80:81] offset:2048 sc1
    global_load_dwordx4 v[84:87], v2, s[82:83] offset:2048 sc1
    global_load_dwordx4 v[88:91], v2, s[84:85] offset:2048 sc1
    global_load_dwordx4 v[92:95], v2, s[86:87] offset:2048 sc1
    global_load_dwordx4 v[32:35], v2, s[80:81] offset:-1024 sc1
    global_load_dwordx4 v[36:39], v2, s[82:83] offset:-1024 sc1
    global_load_dwordx4 v[40:43], v2, s[84:85] offset:-1024 sc1
    global_load_dwordx4 v[44:47], v2, s[86:87] offset:-1024 sc1
    global_load_dwordx4 v[48:51], v2, s[80:81] offset:0 sc1
    global_load_dwordx4 v[52:55], v2, s[82:83] offset:0 sc1
    global_load_dwordx4 v[56:59], v2, s[84:85] offset:0 sc1
    global_load_dwordx4 v[60:63], v2, s[86:87] offset:0 sc1
LA_e2:
    s_nop 5
    v_mul_f32 v16, s96, v16
    v_mul_f32 v17, s96, v17
    v_cvt_pk_f16_f32 v248, v16, v17
    v_mul_f32 v24, s96, v24
    v_mul_f32 v25, s96, v25
    v_cvt_pk_f16_f32 v249, v24, v25
    v_mul_f32 v18, s96, v18
    v_mul_f32 v19, s96, v19
    v_cvt_pk_f16_f32 v250, v18, v19
    v_mul_f32 v26, s96, v26
    v_mul_f32 v27, s96, v27
    v_cvt_pk_f16_f32 v251, v26, v27
    v_mul_f32 v20, s96, v20
    v_mul_f32 v21, s96, v21
    v_cvt_pk_f16_f32 v252, v20, v21
    v_mul_f32 v28, s96, v28
    v_mul_f32 v29, s96, v29
    v_cvt_pk_f16_f32 v253, v28, v29
    v_mul_f32 v22, s96, v22
    v_mul_f32 v23, s96, v23
    v_cvt_pk_f16_f32 v254, v22, v23
    v_mul_f32 v30, s96, v30
    v_mul_f32 v31, s96, v31
    v_cvt_pk_f16_f32 v255, v30, v31
    v_permlane16_swap_b32 v248, v249
    v_permlane16_swap_b32 v250, v251
    v_permlane16_swap_b32 v252, v253
    v_permlane16_swap_b32 v254, v255
    v_lshrrev_b32 v3, 4, v1
    s_mov_b32 s96, 0
    s_cmp_eq_u32 s61, 1
    s_cbranch_scc1 LA_end
    v_swap_b32 v144, v200
    v_swap_b32 v145, v201
    v_swap_b32 v146, v202
    v_swap_b32 v147, v203
    v_swap_b32 v148, v204
    v_swap_b32 v149, v205
    v_swap_b32 v150, v206
    v_swap_b32 v151, v207
    v_swap_b32 v152, v208
    v_swap_b32 v153, v209
    v_swap_b32 v154, v210
    v_swap_b32 v155, v211
    v_swap_b32 v156, v212
    v_swap_b32 v157, v213
    v_swap_b32 v158, v214
    v_swap_b32 v159, v215
    v_swap_b32 v160, v216
    v_swap_b32 v161, v217
    v_swap_b32 v162, v218
    v_swap_b32 v163, v219
    v_swap_b32 v164, v220
    v_swap_b32 v165, v221
    v_swap_b32 v166, v222
    v_swap_b32 v167, v223
    v_swap_b32 v168, v224
    v_swap_b32 v169, v225
    v_swap_b32 v170, v226
    v_swap_b32 v171, v227
    v_swap_b32 v172, v228
    v_swap_b32 v173, v229
    v_swap_b32 v174, v230
    v_swap_b32 v175, v231
    v_swap_b32 v176, v232
    v_swap_b32 v177, v233
    v_swap_b32 v178, v234
    v_swap_b32 v179, v235
    v_swap_b32 v180, v236
    v_swap_b32 v181, v237
    v_swap_b32 v182, v238
    v_swap_b32 v183, v239
    v_swap_b32 v184, v240
    v_swap_b32 v185, v241
    v_swap_b32 v186, v242
    v_swap_b32 v187, v243
    v_swap_b32 v188, v244
    v_swap_b32 v189, v245
    v_swap_b32 v190, v246
    v_swap_b32 v191, v247
    v_swap_b32 v192, v248
    v_swap_b32 v193, v249
    v_swap_b32 v194, v250
    v_swap_b32 v195, v251
    v_swap_b32 v196, v252
    v_swap_b32 v197, v253
    v_swap_b32 v198, v254
    v_swap_b32 v199, v255
    s_branch LA_end
LA_l1:
    ds_read_b32 v3, v0
    s_sub_u32 s25, s25, 1
    s_cbranch_scc1 M_end
    s_waitcnt lgkmcnt(0)
LA_l1a:
    v_cmp_ne_u32 vcc, 0, v3
    s_bitcmp1_b32 vcc_lo, 1
    s_cbranch_scc0 LA_l1
    s_branch LA_m1
LA_l2:
    ds_read_b32 v3, v0
    s_sub_u32 s25, s25, 1
    s_cbranch_scc1 M_end
    s_waitcnt lgkmcnt(0)
LA_l2a:
    v_cmp_ne_u32 vcc, 0, v3
    s_bitcmp1_b32 vcc_lo, 2
    s_cbranch_scc0 LA_l2
    s_branch LA_m2
LA_g1:
    global_load_dwordx4 v[96:99], v2, s[80:81] offset:-4096 sc1
    global_load_dwordx4 v[100:103], v2, s[82:83] offset:-4096 sc1
    global_load_dwordx4 v[104:107], v2, s[84:85] offset:-4096 sc1
    global_load_dwordx4 v[108:111], v2, s[86:87] offset:-4096 sc1
    global_load_dwordx4 v[112:115], v2, s[80:81] offset:-3072 sc1
    global_load_dwordx4 v[116:119], v2, s[82:83] offset:-3072 sc1
    global_load_dwordx4 v[120:123], v2, s[84:85] offset:-3072 sc1
    global_load_dwordx4 v[124:127], v2, s[86:87] offset:-3072 sc1
    global_load_dwordx4 v[128:131], v2, s[80:81] offset:-2048 sc1
    global_load_dwordx4 v[132:135], v2, s[82:83] offset:-2048 sc1
    ds_write_b32 v1, v0 offset:192
    s_mov_b32 s89, -1
    s_waitcnt lgkmcnt(0)
    s_branch LA_h1
LA_l3:
    ds_read_b32 v3, v0
    s_sub_u32 s25, s25, 1
    s_cbranch_scc1 M_end
    s_waitcnt lgkmcnt(0)
LA_l3a:
    v_cmp_ne_u32 vcc, 0, v3
    s_bitcmp1_b32 vcc_lo, 3
    s_cbranch_scc0 LA_l3
    s_branch LA_m3
LA_g2:
    global_load_dwordx4 v[96:99], v2, s[80:81] offset:-4096 sc1
    global_load_dwordx4 v[100:103], v2, s[82:83] offset:-4096 sc1
    global_load_dwordx4 v[104:107], v2, s[84:85] offset:-4096 sc1
    global_load_dwordx4 v[108:111], v2, s[86:87] offset:-4096 sc1
    global_load_dwordx4 v[112:115], v2, s[80:81] offset:-3072 sc1
    global_load_dwordx4 v[116:119], v2, s[82:83] offset:-3072 sc1
    global_load_dwordx4 v[120:123], v2, s[84:85] offset:-3072 sc1
    global_load_dwordx4 v[124:127], v2, s[86:87] offset:-3072 sc1
    global_load_dwordx4 v[128:131], v2, s[80:81] offset:-2048 sc1
    global_load_dwordx4 v[132:135], v2, s[82:83] offset:-2048 sc1
    ds_write_b32 v1, v0 offset:192
    s_mov_b32 s89, -1
    s_waitcnt lgkmcnt(0)
    s_branch LA_h2
LA_l4:
    ds_read_b32 v3, v0
    s_sub_u32 s25, s25, 1
    s_cbranch_scc1 M_end
    s_waitcnt lgkmcnt(0)
LA_l4a:
    v_cmp_ne_u32 vcc, 0, v3
    s_bitcmp1_b32 vcc_lo, 4
    s_cbranch_scc0 LA_l4
    s_branch LA_m4
LA_g3:
    global_load_dwordx4 v[96:99], v2, s[80:81] offset:-4096 sc1
    global_load_dwordx4 v[100:103], v2, s[82:83] offset:-4096 sc1
    global_load_dwordx4 v[104:107], v2, s[84:85] offset:-4096 sc1
    global_load_dwordx4 v[108:111], v2, s[86:87] offset:-4096 sc1
    global_load_dwordx4 v[112:115], v2, s[80:81] offset:-3072 sc1
    global_load_dwordx4 v[116:119], v2, s[82:83] offset:-3072 sc1
    global_load_dwordx4 v[120:123], v2, s[84:85] offset:-3072 sc1
    global_load_dwordx4 v[124:127], v2, s[86:87] offset:-3072 sc1
    global_load_dwordx4 v[128:131], v2, s[80:81] offset:-2048 sc1
    global_load_dwordx4 v[132:135], v2, s[82:83] offset:-2048 sc1
    ds_write_b32 v1, v0 offset:192
    s_mov_b32 s89, -1
    s_waitcnt lgkmcnt(0)
    s_branch LA_h3
LA_l5:
    ds_read_b32 v3, v0
    s_sub_u32 s25, s25, 1
    s_cbranch_scc1 M_end
    s_waitcnt lgkmcnt(0)
LA_l5a:
    v_cmp_ne_u32 vcc, 0, v3
    s_bitcmp1_b32 vcc_lo, 5
    s_cbranch_scc0 LA_l5
    s_branch LA_m5
LA_g4:
    global_load_dwordx4 v[96:99], v2, s[80:81] offset:-4096 sc1
    global_load_dwordx4 v[100:103], v2, s[82:83] offset:-4096 sc1
    global_load_dwordx4 v[104:107], v2, s[84:85] offset:-4096 sc1
    global_load_dwordx4 v[108:111], v2, s[86:87] offset:-4096 sc1
    global_load_dwordx4 v[112:115], v2, s[80:81] offset:-3072 sc1
    global_load_dwordx4 v[116:119], v2, s[82:83] offset:-3072 sc1
    global_load_dwordx4 v[120:123], v2, s[84:85] offset:-3072 sc1
    global_load_dwordx4 v[124:127], v2, s[86:87] offset:-3072 sc1
    global_load_dwordx4 v[128:131], v2, s[80:81] offset:-2048 sc1
    global_load_dwordx4 v[132:135], v2, s[82:83] offset:-2048 sc1
    ds_write_b32 v1, v0 offset:192
    s_mov_b32 s89, -1
    s_waitcnt lgkmcnt(0)
    s_branch LA_h4
LA_l6:
    ds_read_b32 v3, v0
    s_sub_u32 s25, s25, 1
    s_cbranch_scc1 M_end
    s_waitcnt lgkmcnt(0)
LA_l6a:
    v_cmp_ne_u32 vcc, 0, v3
    s_bitcmp1_b32 vcc_lo, 6
    s_cbranch_scc0 LA_l6
    s_branch LA_m6
LA_g5:
    global_load_dwordx4 v[96:99], v2, s[80:81] offset:-4096 sc1
    global_load_dwordx4 v[100:103], v2, s[82:83] offset:-4096 sc1
    global_load_dwordx4 v[104:107], v2, s[84:85] offset:-4096 sc1
    global_load_dwordx4 v[108:111], v2, s[86:87] offset:-4096 sc1
    global_load_dwordx4 v[112:115], v2, s[80:81] offset:-3072 sc1
    global_load_dwordx4 v[116:119], v2, s[82:83] offset:-3072 sc1
    global_load_dwordx4 v[120:123], v2, s[84:85] offset:-3072 sc1
    global_load_dwordx4 v[124:127], v2, s[86:87] offset:-3072 sc1
    global_load_dwordx4 v[128:131], v2, s[80:81] offset:-2048 sc1
    global_load_dwordx4 v[132:135], v2, s[82:83] offset:-2048 sc1
    ds_write_b32 v1, v0 offset:192
    s_mov_b32 s89, -1
    s_waitcnt lgkmcnt(0)
    s_branch LA_h5
LA_l7:
    ds_read_b32 v3, v0
    s_sub_u32 s25, s25, 1
    s_cbranch_scc1 M_end
    s_waitcnt lgkmcnt(0)
LA_l7a:
    v_cmp_ne_u32 vcc, 0, v3
    s_bitcmp1_b32 vcc_lo, 7
    s_cbranch_scc0 LA_l7
    s_branch LA_m7
LA_g6:
    global_load_dwordx4 v[96:99], v2, s[80:81] offset:-4096 sc1
    global_load_dwordx4 v[100:103], v2, s[82:83] offset:-4096 sc1
    global_load_dwordx4 v[104:107], v2, s[84:85] offset:-4096 sc1
    global_load_dwordx4 v[108:111], v2, s[86:87] offset:-4096 sc1
    global_load_dwordx4 v[112:115], v2, s[80:81] offset:-3072 sc1
    global_load_dwordx4 v[116:119], v2, s[82:83] offset:-3072 sc1
    global_load_dwordx4 v[120:123], v2, s[84:85] offset:-3072 sc1
    global_load_dwordx4 v[124:127], v2, s[86:87] offset:-3072 sc1
    global_load_dwordx4 v[128:131], v2, s[80:81] offset:-2048 sc1
    global_load_dwordx4 v[132:135], v2, s[82:83] offset:-2048 sc1
    ds_write_b32 v1, v0 offset:192
    s_mov_b32 s89, -1
    s_waitcnt lgkmcnt(0)
    s_branch LA_h6
LA_l8:
    ds_read_b32 v3, v0
    s_sub_u32 s25, s25, 1
    s_cbranch_scc1 M_end
    s_waitcnt lgkmcnt(0)
LA_l8a:
    v_cmp_ne_u32 vcc, 0, v3
    s_bitcmp1_b32 vcc_lo, 8
    s_cbranch_scc0 LA_l8
    s_branch LA_m8
LA_g7:
    global_load_dwordx4 v[96:99], v2, s[80:81] offset:-4096 sc1
    global_load_dwordx4 v[100:103], v2, s[82:83] offset:-4096 sc1
    global_load_dwordx4 v[104:107], v2, s[84:85] offset:-4096 sc1
    global_load_dwordx4 v[108:111], v2, s[86:87] offset:-4096 sc1
    global_load_dwordx4 v[112:115], v2, s[80:81] offset:-3072 sc1
    global_load_dwordx4 v[116:119], v2, s[82:83] offset:-3072 sc1
    global_load_dwordx4 v[120:123], v2, s[84:85] offset:-3072 sc1
    global_load_dwordx4 v[124:127], v2, s[86:87] offset:-3072 sc1
    global_load_dwordx4 v[128:131], v2, s[80:81] offset:-2048 sc1
    global_load_dwordx4 v[132:135], v2, s[82:83] offset:-2048 sc1
    ds_write_b32 v1, v0 offset:192
    s_mov_b32 s89, -1
    s_waitcnt lgkmcnt(0)
    s_branch LA_h7
LA_l9:
    ds_read_b32 v3, v0
    s_sub_u32 s25, s25, 1
    s_cbranch_scc1 M_end
    s_waitcnt lgkmcnt(0)
LA_l9a:
    v_cmp_ne_u32 vcc, 0, v3
    s_bitcmp1_b32 vcc_lo, 9
    s_cbranch_scc0 LA_l9
    s_branch LA_m9
LA_g8:
    global_load_dwordx4 v[96:99], v2, s[80:81] offset:-4096 sc1
    global_load_dwordx4 v[100:103], v2, s[82:83] offset:-4096 sc1
    global_load_dwordx4 v[104:107], v2, s[84:85] offset:-4096 sc1
    global_load_dwordx4 v[108:111], v2, s[86:87] offset:-4096 sc1
    global_load_dwordx4 v[112:115], v2, s[80:81] offset:-3072 sc1
    global_load_dwordx4 v[116:119], v2, s[82:83] offset:-3072 sc1
    global_load_dwordx4 v[120:123], v2, s[84:85] offset:-3072 sc1
    global_load_dwordx4 v[124:127], v2, s[86:87] offset:-3072 sc1
    global_load_dwordx4 v[128:131], v2, s[80:81] offset:-2048 sc1
    global_load_dwordx4 v[132:135], v2, s[82:83] offset:-2048 sc1
    ds_write_b32 v1, v0 offset:192
    s_mov_b32 s89, -1
    s_waitcnt lgkmcnt(0)
    s_branch LA_h8
LA_l10:
    ds_read_b32 v3, v0
    s_sub_u32 s25, s25, 1
    s_cbranch_scc1 M_end
    s_waitcnt lgkmcnt(0)
LA_l10a:
    v_cmp_ne_u32 vcc, 0, v3
    s_bitcmp1_b32 vcc_lo, 10
    s_cbranch_scc0 LA_l10
    s_branch LA_m10
LA_g9:
    global_load_dwordx4 v[96:99], v2, s[80:81] offset:-4096 sc1
    global_load_dwordx4 v[100:103], v2, s[82:83] offset:-4096 sc1
    global_load_dwordx4 v[104:107], v2, s[84:85] offset:-4096 sc1
    global_load_dwordx4 v[108:111], v2, s[86:87] offset:-4096 sc1
    global_load_dwordx4 v[112:115], v2, s[80:81] offset:-3072 sc1
    global_load_dwordx4 v[116:119], v2, s[82:83] offset:-3072 sc1
    global_load_dwordx4 v[120:123], v2, s[84:85] offset:-3072 sc1
    global_load_dwordx4 v[124:127], v2, s[86:87] offset:-3072 sc1
    global_load_dwordx4 v[128:131], v2, s[80:81] offset:-2048 sc1
    global_load_dwordx4 v[132:135], v2, s[82:83] offset:-2048 sc1
    ds_write_b32 v1, v0 offset:192
    s_mov_b32 s89, -1
    s_waitcnt lgkmcnt(0)
    s_branch LA_h9
LA_l11:
    ds_read_b32 v3, v0
    s_sub_u32 s25, s25, 1
    s_cbranch_scc1 M_end
    s_waitcnt lgkmcnt(0)
LA_l11a:
    v_cmp_ne_u32 vcc, 0, v3
    s_bitcmp1_b32 vcc_lo, 11
    s_cbranch_scc0 LA_l11
    s_branch LA_m11
LA_g10:
    global_load_dwordx4 v[96:99], v2, s[80:81] offset:-4096 sc1
    global_load_dwordx4 v[100:103], v2, s[82:83] offset:-4096 sc1
    global_load_dwordx4 v[104:107], v2, s[84:85] offset:-4096 sc1
    global_load_dwordx4 v[108:111], v2, s[86:87] offset:-4096 sc1
    global_load_dwordx4 v[112:115], v2, s[80:81] offset:-3072 sc1
    global_load_dwordx4 v[116:119], v2, s[82:83] offset:-3072 sc1
    global_load_dwordx4 v[120:123], v2, s[84:85] offset:-3072 sc1
    global_load_dwordx4 v[124:127], v2, s[86:87] offset:-3072 sc1
    global_load_dwordx4 v[128:131], v2, s[80:81] offset:-2048 sc1
    global_load_dwordx4 v[132:135], v2, s[82:83] offset:-2048 sc1
    ds_write_b32 v1, v0 offset:192
    s_mov_b32 s89, -1
    s_waitcnt lgkmcnt(0)
    s_branch LA_h10
LA_l12:
    ds_read_b32 v3, v0
    s_sub_u32 s25, s25, 1
    s_cbranch_scc1 M_end
    s_waitcnt lgkmcnt(0)
LA_l12a:
    v_cmp_ne_u32 vcc, 0, v3
    s_bitcmp1_b32 vcc_lo, 12
    s_cbranch_scc0 LA_l12
    s_branch LA_m12
LA_g11:
    global_load_dwordx4 v[96:99], v2, s[80:81] offset:-4096 sc1
    global_load_dwordx4 v[100:103], v2, s[82:83] offset:-4096 sc1
    global_load_dwordx4 v[104:107], v2, s[84:85] offset:-4096 sc1
    global_load_dwordx4 v[108:111], v2, s[86:87] offset:-4096 sc1
    global_load_dwordx4 v[112:115], v2, s[80:81] offset:-3072 sc1
    global_load_dwordx4 v[116:119], v2, s[82:83] offset:-3072 sc1
    global_load_dwordx4 v[120:123], v2, s[84:85] offset:-3072 sc1
    global_load_dwordx4 v[124:127], v2, s[86:87] offset:-3072 sc1
    global_load_dwordx4 v[128:131], v2, s[80:81] offset:-2048 sc1
    global_load_dwordx4 v[132:135], v2, s[82:83] offset:-2048 sc1
    ds_write_b32 v1, v0 offset:192
    s_mov_b32 s89, -1
    s_waitcnt lgkmcnt(0)
    s_branch LA_h11
LA_l13:
    ds_read_b32 v3, v0
    s_sub_u32 s25, s25, 1
    s_cbranch_scc1 M_end
    s_waitcnt lgkmcnt(0)
LA_l13a:
    v_cmp_ne_u32 vcc, 0, v3
    s_bitcmp1_b32 vcc_lo, 13
    s_cbranch_scc0 LA_l13
    s_branch LA_m13
LA_g12:
    global_load_dwordx4 v[96:99], v2, s[80:81] offset:-4096 sc1
    global_load_dwordx4 v[100:103], v2, s[82:83] offset:-4096 sc1
    global_load_dwordx4 v[104:107], v2, s[84:85] offset:-4096 sc1
    global_load_dwordx4 v[108:111], v2, s[86:87] offset:-4096 sc1
    global_load_dwordx4 v[112:115], v2, s[80:81] offset:-3072 sc1
    global_load_dwordx4 v[116:119], v2, s[82:83] offset:-3072 sc1
    global_load_dwordx4 v[120:123], v2, s[84:85] offset:-3072 sc1
    global_load_dwordx4 v[124:127], v2, s[86:87] offset:-3072 sc1
    global_load_dwordx4 v[128:131], v2, s[80:81] offset:-2048 sc1
    global_load_dwordx4 v[132:135], v2, s[82:83] offset:-2048 sc1
    ds_write_b32 v1, v0 offset:192
    s_mov_b32 s89, -1
    s_waitcnt lgkmcnt(0)
    s_branch LA_h12
LA_w7:
    s_setprio 0
    v_and_b32 v13, 1, v3
    v_lshl_add_u32 v8, v13, 17, v12
    v_lshrrev_b32 v13, 1, v3
    v_lshl_add_u32 v8, v13, 15, v8
    v_lshl_add_u32 v8, v7, 13, v8
    s_mul_i32 s31, s22, 0
    s_add_u32 s32, s30, s31
    s_add_u32 s32, s64, s32
    s_addc_u32 s33, s65, 0
    s_sub_u32 s31, 1835008, s31
    s_add_u32 s30, s30, s31
    s_add_u32 s30, s64, s30
    s_addc_u32 s31, s65, 0
    s_add_u32 s34, s32, 0x0
    s_addc_u32 s35, s33, 0
    s_mov_b32 m0, 23552
    s_nop 0
    global_load_lds_dwordx4 v8, s[34:35] offset:0
    s_mov_b32 m0, 24512
    s_nop 0
    global_load_lds_dwordx4 v8, s[34:35] offset:64
    s_mov_b32 m0, 25472
    s_nop 0
    global_load_lds_dwordx4 v8, s[34:35] offset:128
    s_mov_b32 m0, 26432
    s_nop 0
    global_load_lds_dwordx4 v8, s[34:35] offset:192
    s_mov_b32 m0, 27392
    s_nop 0
    global_load_lds_dwordx4 v8, s[34:35] offset:256
    s_mov_b32 m0, 28352
    s_nop 0
    global_load_lds_dwordx4 v8, s[34:35] offset:320
    s_mov_b32 m0, 29312
    s_nop 0
    global_load_lds_dwordx4 v8, s[34:35] offset:384
    s_mov_b32 m0, 30272
    s_nop 0
    global_load_lds_dwordx4 v8, s[34:35] offset:448
    s_add_u32 s34, s32, 0x10000
    s_addc_u32 s35, s33, 0
    s_mov_b32 m0, 31744
    s_nop 0
    global_load_lds_dwordx4 v8, s[34:35] offset:0
    s_mov_b32 m0, 32704
    s_nop 0
    global_load_lds_dwordx4 v8, s[34:35] offset:64
    s_mov_b32 m0, 33664
    s_nop 0
    global_load_lds_dwordx4 v8, s[34:35] offset:128
    s_mov_b32 m0, 34624
    s_nop 0
    global_load_lds_dwordx4 v8, s[34:35] offset:192
    s_mov_b32 m0, 35584
    s_nop 0
    global_load_lds_dwordx4 v8, s[34:35] offset:256
    s_mov_b32 m0, 36544
    s_nop 0
    global_load_lds_dwordx4 v8, s[34:35] offset:320
    s_mov_b32 m0, 37504
    s_nop 0
    global_load_lds_dwordx4 v8, s[34:35] offset:384
    s_mov_b32 m0, 38464
    s_nop 0
    global_load_lds_dwordx4 v8, s[34:35] offset:448
    v_mov_b32 v101, 4
    global_load_dword v100, v101, s[10:11] sc1
    s_barrier
    s_lshl_b32 s50, s22, 2
    s_add_u32 s50, s50, s60
    s_mul_i32 s50, s50, 14
    s_min_u32 s51, s21, 13
    s_add_u32 s50, s50, s51
    s_mul_i32 s50, s50, 57344
    s_mul_i32 s51, s61, 7168
    s_add_u32 s50, s50, s51
    s_add_u32 s50, s50, 0x1c1000
    s_add_u32 s80, s4, s50
    s_addc_u32 s81, s5, 0
    s_add_u32 s82, s80, 0x3800
    s_addc_u32 s83, s81, 0
    s_add_u32 s84, s80, 0x7000
    s_addc_u32 s85, s81, 0
    s_add_u32 s86, s80, 0xa800
    s_addc_u32 s87, s81, 0
    v_mov_b32 v96, 0
    v_mov_b32 v97, 0
    v_mov_b32 v98, 0
    v_mov_b32 v99, 0
    s_mul_i32 s50, s22, 56
    s_min_u32 s51, s21, 13
    s_lshr_b32 s51, s51, 1
    s_add_u32 s50, s50, s51
    s_lshl_b32 s50, s50, 6
    s_add_u32 s50, s50, 0x5b8c000
    v_lshlrev_b32 v10, 3, v1
    s_lshl_b32 s51, s20, 9
    s_add_u32 s51, s51, 0x5b91000
    v_add_u32 v12, s51, v10
    v_lshrrev_b32 v13, 3, v1
    v_mul_u32_u24 v13, 448, v13
    v_and_b32 v14, 7, v1
    v_lshl_add_u32 v13, v14, 3, v13
    v_add_u32 v13, s50, v13
    v_min_u32 v11, 6, v14
    v_lshlrev_b32 v11, 2, v11
    v_add_u32 v11, 154688, v11
    v_and_b32 v14, 31, v1
    v_lshlrev_b32 v9, 7, v14
    v_lshlrev_b32 v14, 2, v14
    v_add_u32 v14, 0x5b90000, v14
    v_lshrrev_b32 v10, 5, v1
    v_mul_u32_u24 v10, 14336, v10
    v_add_u32 v9, v9, v10
    s_lshl_b32 s50, s20, 2
    s_add_u32 s50, s50, 0x5b90000
    v_mov_b32 v15, s50
    v_mov_b32 v5, 154624
    v_min_u32 v27, 0, v1
    v_lshlrev_b32 v27, 2, v27
    s_lshl_b32 s50, s20, 7
    s_add_u32 s50, s50, 0x5b96000
    v_add_u32 v27, s50, v27
    s_and_b32 s50, s20, 3
    s_lshl_b32 s50, s50, 13
    v_lshlrev_b32 v23, 7, v1
    v_add_u32 v23, s50, v23
    v_and_b32 v24, 0x3fff, v23
    v_lshrrev_b32 v25, 2, v1
    v_lshlrev_b32 v25, 13, v25
    v_and_b32 v26, 3, v1
    v_lshl_add_u32 v25, v26, 7, v25
    s_lshl_b32 s50, s22, 17
    v_add_u32 v25, s50, v25
    s_waitcnt vmcnt(9)
    s_waitcnt vmcnt(1)
    ds_write_b32 v5, v5 offset:0
    s_add_u32 s34, s32, 0x40000
    s_addc_u32 s35, s33, 0
    s_mov_b32 m0, 39936
    s_nop 0
    global_load_lds_dwordx4 v8, s[34:35] offset:0
    s_mov_b32 m0, 40896
    s_nop 0
    global_load_lds_dwordx4 v8, s[34:35] offset:64
    s_mov_b32 m0, 41856
    s_nop 0
    global_load_lds_dwordx4 v8, s[34:35] offset:128
    s_mov_b32 m0, 42816
    s_nop 0
    global_load_lds_dwordx4 v8, s[34:35] offset:192
    s_mov_b32 m0, 43776
    s_nop 0
    global_load_lds_dwordx4 v8, s[34:35] offset:256
    s_mov_b32 m0, 44736
    s_nop 0
    global_load_lds_dwordx4 v8, s[34:35] offset:320
    s_mov_b32 m0, 45696
    s_nop 0
    global_load_lds_dwordx4 v8, s[34:35] offset:384
    s_mov_b32 m0, 46656
    s_nop 0
    global_load_lds_dwordx4 v8, s[34:35] offset:448
    s_add_u32 s34, s32, 0x50000
    s_addc_u32 s35, s33, 0
    s_mov_b32 m0, 48128
    s_nop 0
    global_load_lds_dwordx4 v8, s[34:35] offset:0
    s_mov_b32 m0, 49088
    s_nop 0
    global_load_lds_dwordx4 v8, s[34:35] offset:64
    s_mov_b32 m0, 50048
    s_nop 0
    global_load_lds_dwordx4 v8, s[34:35] offset:128
    s_mov_b32 m0, 51008
    s_nop 0
    global_load_lds_dwordx4 v8, s[34:35] offset:192
    s_mov_b32 m0, 51968
    s_nop 0
    global_load_lds_dwordx4 v8, s[34:35] offset:256
    s_mov_b32 m0, 52928
    s_nop 0
    global_load_lds_dwordx4 v8, s[34:35] offset:320
    s_mov_b32 m0, 53888
    s_nop 0
    global_load_lds_dwordx4 v8, s[34:35] offset:384
    s_mov_b32 m0, 54848
    s_nop 0
    global_load_lds_dwordx4 v8, s[34:35] offset:448
    s_add_u32 s34, s32, 0x80000
    s_addc_u32 s35, s33, 0
    s_mov_b32 m0, 56320
    s_nop 0
    global_load_lds_dwordx4 v8, s[34:35] offset:0
    s_mov_b32 m0, 57280
    s_nop 0
    global_load_lds_dwordx4 v8, s[34:35] offset:64
    s_mov_b32 m0, 58240
    s_nop 0
    global_load_lds_dwordx4 v8, s[34:35] offset:128
    s_mov_b32 m0, 59200
    s_nop 0
    global_load_lds_dwordx4 v8, s[34:35] offset:192
    s_mov_b32 m0, 60160
    s_nop 0
    global_load_lds_dwordx4 v8, s[34:35] offset:256
    s_mov_b32 m0, 61120
    s_nop 0
    global_load_lds_dwordx4 v8, s[34:35] offset:320
    s_mov_b32 m0, 62080
    s_nop 0
    global_load_lds_dwordx4 v8, s[34:35] offset:384
    s_mov_b32 m0, 63040
    s_nop 0
    global_load_lds_dwordx4 v8, s[34:35] offset:448
    s_add_u32 s34, s32, 0x90000
    s_addc_u32 s35, s33, 0
    s_mov_b32 m0, 64512
    s_nop 0
    global_load_lds_dwordx4 v8, s[34:35] offset:0
    s_mov_b32 m0, 65472
    s_nop 0
    global_load_lds_dwordx4 v8, s[34:35] offset:64
    s_mov_b32 m0, 66432
    s_nop 0
    global_load_lds_dwordx4 v8, s[34:35] offset:128
    s_mov_b32 m0, 67392
    s_nop 0
    global_load_lds_dwordx4 v8, s[34:35] offset:192
    s_mov_b32 m0, 68352
    s_nop 0
    global_load_lds_dwordx4 v8, s[34:35] offset:256
    s_mov_b32 m0, 69312
    s_nop 0
    global_load_lds_dwordx4 v8, s[34:35] offset:320
    s_mov_b32 m0, 70272
    s_nop 0
    global_load_lds_dwordx4 v8, s[34:35] offset:384
    s_mov_b32 m0, 71232
    s_nop 0
    global_load_lds_dwordx4 v8, s[34:35] offset:448
    s_waitcnt vmcnt(24)
    s_waitcnt vmcnt(16)
    ds_write_b32 v5, v5 offset:4
    s_add_u32 s34, s32, 0xc0000
    s_addc_u32 s35, s33, 0
    s_mov_b32 m0, 0
    s_nop 0
    global_load_lds_dwordx4 v8, s[34:35] offset:0
    s_mov_b32 m0, 960
    s_nop 0
    global_load_lds_dwordx4 v8, s[34:35] offset:64
    s_mov_b32 m0, 1920
    s_nop 0
    global_load_lds_dwordx4 v8, s[34:35] offset:128
    s_mov_b32 m0, 2880
    s_nop 0
    global_load_lds_dwordx4 v8, s[34:35] offset:192
    s_mov_b32 m0, 3840
    s_nop 0
    global_load_lds_dwordx4 v8, s[34:35] offset:256
    s_mov_b32 m0, 4800
    s_nop 0
    global_load_lds_dwordx4 v8, s[34:35] offset:320
    s_mov_b32 m0, 5760
    s_nop 0
    global_load_lds_dwordx4 v8, s[34:35] offset:384
    s_mov_b32 m0, 6720
    s_nop 0
    global_load_lds_dwordx4 v8, s[34:35] offset:448
    s_add_u32 s34, s32, 0xd0000
    s_addc_u32 s35, s33, 0
    s_mov_b32 m0, 8192
    s_nop 0
    global_load_lds_dwordx4 v8, s[34:35] offset:0
    s_mov_b32 m0, 9152
    s_nop 0
    global_load_lds_dwordx4 v8, s[34:35] offset:64
    s_mov_b32 m0, 10112
    s_nop 0
    global_load_lds_dwordx4 v8, s[34:35] offset:128
    s_mov_b32 m0, 11072
    s_nop 0
    global_load_lds_dwordx4 v8, s[34:35] offset:192
    s_mov_b32 m0, 12032
    s_nop 0
    global_load_lds_dwordx4 v8, s[34:35] offset:256
    s_mov_b32 m0, 12992
    s_nop 0
    global_load_lds_dwordx4 v8, s[34:35] offset:320
    s_mov_b32 m0, 13952
    s_nop 0
    global_load_lds_dwordx4 v8, s[34:35] offset:384
    s_mov_b32 m0, 14912
    s_nop 0
    global_load_lds_dwordx4 v8, s[34:35] offset:448
    s_add_u32 s34, s32, 0x100000
    s_addc_u32 s35, s33, 0
    s_mov_b32 m0, 138240
    s_nop 0
    global_load_lds_dwordx4 v8, s[34:35] offset:0
    s_mov_b32 m0, 139200
    s_nop 0
    global_load_lds_dwordx4 v8, s[34:35] offset:64
    s_mov_b32 m0, 140160
    s_nop 0
    global_load_lds_dwordx4 v8, s[34:35] offset:128
    s_mov_b32 m0, 141120
    s_nop 0
    global_load_lds_dwordx4 v8, s[34:35] offset:192
    s_mov_b32 m0, 142080
    s_nop 0
    global_load_lds_dwordx4 v8, s[34:35] offset:256
    s_mov_b32 m0, 143040
    s_nop 0
    global_load_lds_dwordx4 v8, s[34:35] offset:320
    s_mov_b32 m0, 144000
    s_nop 0
    global_load_lds_dwordx4 v8, s[34:35] offset:384
    s_mov_b32 m0, 144960
    s_nop 0
    global_load_lds_dwordx4 v8, s[34:35] offset:448
    s_add_u32 s34, s32, 0x110000
    s_addc_u32 s35, s33, 0
    s_mov_b32 m0, 146432
    s_nop 0
    global_load_lds_dwordx4 v8, s[34:35] offset:0
    s_mov_b32 m0, 147392
    s_nop 0
    global_load_lds_dwordx4 v8, s[34:35] offset:64
    s_mov_b32 m0, 148352
    s_nop 0
    global_load_lds_dwordx4 v8, s[34:35] offset:128
    s_mov_b32 m0, 149312
    s_nop 0
    global_load_lds_dwordx4 v8, s[34:35] offset:192
    s_mov_b32 m0, 150272
    s_nop 0
    global_load_lds_dwordx4 v8, s[34:35] offset:256
    s_mov_b32 m0, 151232
    s_nop 0
    global_load_lds_dwordx4 v8, s[34:35] offset:320
    s_mov_b32 m0, 152192
    s_nop 0
    global_load_lds_dwordx4 v8, s[34:35] offset:384
    s_mov_b32 m0, 153152
    s_nop 0
    global_load_lds_dwordx4 v8, s[34:35] offset:448
    s_add_u32 s34, s32, 0x140000
    s_addc_u32 s35, s33, 0
    s_mov_b32 m0, 89088
    s_nop 0
    global_load_lds_dwordx4 v8, s[34:35] offset:0
    s_mov_b32 m0, 90048
    s_nop 0
    global_load_lds_dwordx4 v8, s[34:35] offset:64
    s_mov_b32 m0, 91008
    s_nop 0
    global_load_lds_dwordx4 v8, s[34:35] offset:128
    s_mov_b32 m0, 91968
    s_nop 0
    global_load_lds_dwordx4 v8, s[34:35] offset:192
    s_mov_b32 m0, 92928
    s_nop 0
    global_load_lds_dwordx4 v8, s[34:35] offset:256
    s_mov_b32 m0, 93888
    s_nop 0
    global_load_lds_dwordx4 v8, s[34:35] offset:320
    s_mov_b32 m0, 94848
    s_nop 0
    global_load_lds_dwordx4 v8, s[34:35] offset:384
    s_mov_b32 m0, 95808
    s_nop 0
    global_load_lds_dwordx4 v8, s[34:35] offset:448
    s_waitcnt vmcnt(48)
    s_mov_b32 s18, 0x100000
    s_branch NP_4a
NP_4:
    v_mov_b32 v101, 4
    global_load_dword v100, v101, s[10:11] sc1
    s_sub_u32 s18, s18, 1
    s_cbranch_scc1 M_end
    s_waitcnt vmcnt(0)
NP_4a:
    v_readfirstlane_b32 s19, v100
    s_cmp_eq_u32 s19, 0
    s_cbranch_scc1 NP_4
    v_mov_b32 v101, 161840
    ds_write_b32 v101, v100
    s_add_u32 s34, s32, 0x150000
    s_addc_u32 s35, s33, 0
    s_mov_b32 m0, 97280
    s_nop 0
    global_load_lds_dwordx4 v8, s[34:35] offset:0
    s_mov_b32 m0, 98240
    s_nop 0
    global_load_lds_dwordx4 v8, s[34:35] offset:64
    s_mov_b32 m0, 99200
    s_nop 0
    global_load_lds_dwordx4 v8, s[34:35] offset:128
    s_mov_b32 m0, 100160
    s_nop 0
    global_load_lds_dwordx4 v8, s[34:35] offset:192
    s_mov_b32 m0, 101120
    s_nop 0
    global_load_lds_dwordx4 v8, s[34:35] offset:256
    s_mov_b32 m0, 102080
    s_nop 0
    global_load_lds_dwordx4 v8, s[34:35] offset:320
    s_mov_b32 m0, 103040
    s_nop 0
    global_load_lds_dwordx4 v8, s[34:35] offset:384
    s_mov_b32 m0, 104000
    s_nop 0
    global_load_lds_dwordx4 v8, s[34:35] offset:448
    s_waitcnt vmcnt(48)
    ds_write_b32 v5, v5 offset:8
    s_add_u32 s34, s32, 0x180000
    s_addc_u32 s35, s33, 0
    s_mov_b32 m0, 105472
    s_nop 0
    global_load_lds_dwordx4 v8, s[34:35] offset:0
    s_mov_b32 m0, 106432
    s_nop 0
    global_load_lds_dwordx4 v8, s[34:35] offset:64
    s_mov_b32 m0, 107392
    s_nop 0
    global_load_lds_dwordx4 v8, s[34:35] offset:128
    s_mov_b32 m0, 108352
    s_nop 0
    global_load_lds_dwordx4 v8, s[34:35] offset:192
    s_mov_b32 m0, 109312
    s_nop 0
    global_load_lds_dwordx4 v8, s[34:35] offset:256
    s_mov_b32 m0, 110272
    s_nop 0
    global_load_lds_dwordx4 v8, s[34:35] offset:320
    s_mov_b32 m0, 111232
    s_nop 0
    global_load_lds_dwordx4 v8, s[34:35] offset:384
    s_mov_b32 m0, 112192
    s_nop 0
    global_load_lds_dwordx4 v8, s[34:35] offset:448
    s_waitcnt vmcnt(48)
    s_add_u32 s34, s32, 0x190000
    s_addc_u32 s35, s33, 0
    s_mov_b32 m0, 113664
    s_nop 0
    global_load_lds_dwordx4 v8, s[34:35] offset:0
    s_mov_b32 m0, 114624
    s_nop 0
    global_load_lds_dwordx4 v8, s[34:35] offset:64
    s_mov_b32 m0, 115584
    s_nop 0
    global_load_lds_dwordx4 v8, s[34:35] offset:128
    s_mov_b32 m0, 116544
    s_nop 0
    global_load_lds_dwordx4 v8, s[34:35] offset:192
    s_mov_b32 m0, 117504
    s_nop 0
    global_load_lds_dwordx4 v8, s[34:35] offset:256
    s_mov_b32 m0, 118464
    s_nop 0
    global_load_lds_dwordx4 v8, s[34:35] offset:320
    s_mov_b32 m0, 119424
    s_nop 0
    global_load_lds_dwordx4 v8, s[34:35] offset:384
    s_mov_b32 m0, 120384
    s_nop 0
    global_load_lds_dwordx4 v8, s[34:35] offset:448
    s_waitcnt vmcnt(48)
    ds_write_b32 v5, v5 offset:12
    s_add_u32 s34, s30, 0x0
    s_addc_u32 s35, s31, 0
    s_mov_b32 m0, 121856
    s_nop 0
    global_load_lds_dwordx4 v8, s[34:35] offset:0
    s_mov_b32 m0, 122816
    s_nop 0
    global_load_lds_dwordx4 v8, s[34:35] offset:64
    s_mov_b32 m0, 123776
    s_nop 0
    global_load_lds_dwordx4 v8, s[34:35] offset:128
    s_mov_b32 m0, 124736
    s_nop 0
    global_load_lds_dwordx4 v8, s[34:35] offset:192
    s_mov_b32 m0, 125696
    s_nop 0
    global_load_lds_dwordx4 v8, s[34:35] offset:256
    s_mov_b32 m0, 126656
    s_nop 0
    global_load_lds_dwordx4 v8, s[34:35] offset:320
    s_mov_b32 m0, 127616
    s_nop 0
    global_load_lds_dwordx4 v8, s[34:35] offset:384
    s_mov_b32 m0, 128576
    s_nop 0
    global_load_lds_dwordx4 v8, s[34:35] offset:448
    s_waitcnt vmcnt(48)
    s_add_u32 s34, s30, 0x10000
    s_addc_u32 s35, s31, 0
    s_mov_b32 m0, 130048
    s_nop 0
    global_load_lds_dwordx4 v8, s[34:35] offset:0
    s_mov_b32 m0, 131008
    s_nop 0
    global_load_lds_dwordx4 v8, s[34:35] offset:64
    s_mov_b32 m0, 131968
    s_nop 0
    global_load_lds_dwordx4 v8, s[34:35] offset:128
    s_mov_b32 m0, 132928
    s_nop 0
    global_load_lds_dwordx4 v8, s[34:35] offset:192
    s_mov_b32 m0, 133888
    s_nop 0
    global_load_lds_dwordx4 v8, s[34:35] offset:256
    s_mov_b32 m0, 134848
    s_nop 0
    global_load_lds_dwordx4 v8, s[34:35] offset:320
    s_mov_b32 m0, 135808
    s_nop 0
    global_load_lds_dwordx4 v8, s[34:35] offset:384
    s_mov_b32 m0, 136768
    s_nop 0
    global_load_lds_dwordx4 v8, s[34:35] offset:448
    s_waitcnt vmcnt(48)
    ds_write_b32 v5, v5 offset:16
    s_add_u32 s34, s30, 0x40000
    s_addc_u32 s35, s31, 0
    global_load_dword v21, v25, s[34:35]
    s_waitcnt vmcnt(41)
    s_add_u32 s34, s30, 0x80000
    s_addc_u32 s35, s31, 0
    global_load_dword v21, v25, s[34:35]
    s_waitcnt vmcnt(34)
    ds_write_b32 v5, v5 offset:20
    s_add_u32 s34, s30, 0xc0000
    s_addc_u32 s35, s31, 0
    global_load_dword v21, v25, s[34:35]
    s_waitcnt vmcnt(27)
    s_add_u32 s34, s30, 0x100000
    s_addc_u32 s35, s31, 0
    global_load_dword v21, v25, s[34:35]
    s_waitcnt vmcnt(20)
    ds_write_b32 v5, v5 offset:24
    s_add_u32 s34, s30, 0x140000
    s_addc_u32 s35, s31, 0
    global_load_dword v21, v25, s[34:35]
    s_waitcnt vmcnt(13)
    s_add_u32 s34, s30, 0x180000
    s_addc_u32 s35, s31, 0
    global_load_dword v21, v25, s[34:35]
    s_waitcnt vmcnt(6)
    ds_write_b32 v5, v5 offset:28
    s_branch LA_f8a
LA_f8:
    global_load_dwordx2 v[16:17], v13, s[4:5] sc1
    s_sub_u32 s25, s25, 1
    s_cbranch_scc1 M_end
    s_waitcnt vmcnt(0)
    v_cmp_eq_u32 vcc, s19, v17
    s_or_b32 vcc_lo, vcc_lo, 0x88888888
    s_or_b32 vcc_hi, vcc_hi, 0x88888888
    v_cmp_eq_u32 s[50:51], s19, v16
    s_and_b64 s[50:51], s[50:51], vcc
    s_nop 0
    v_mov_b32 v16, s50
    v_mov_b32 v17, s51
    ds_write_b64 v5, v[16:17] offset:384
LA_f8a:
    ds_read_b32 v6, v11 offset:0
    s_waitcnt lgkmcnt(0)
    v_cmp_eq_u32 vcc, 0, v6
    s_cbranch_vccnz LA_f8
    s_or_b32 s50, s19, s17
    v_mov_b32 v16, s50
    s_mov_b64 exec, 1
    global_store_dword v15, v16, s[4:5] sc1
    s_mov_b64 exec, -1
    s_add_u32 s34, s30, 0x40000
    s_addc_u32 s35, s31, 0
    s_mov_b32 m0, 72704
    s_nop 0
    global_load_lds_dwordx4 v8, s[34:35] offset:0
    s_mov_b32 m0, 73664
    s_nop 0
    global_load_lds_dwordx4 v8, s[34:35] offset:64
    s_mov_b32 m0, 74624
    s_nop 0
    global_load_lds_dwordx4 v8, s[34:35] offset:128
    s_mov_b32 m0, 75584
    s_nop 0
    global_load_lds_dwordx4 v8, s[34:35] offset:192
    s_mov_b32 m0, 76544
    s_nop 0
    global_load_lds_dwordx4 v8, s[34:35] offset:256
    s_mov_b32 m0, 77504
    s_nop 0
    global_load_lds_dwordx4 v8, s[34:35] offset:320
    s_mov_b32 m0, 78464
    s_nop 0
    global_load_lds_dwordx4 v8, s[34:35] offset:384
    s_mov_b32 m0, 79424
    s_nop 0
    global_load_lds_dwordx4 v8, s[34:35] offset:448
    s_add_u32 s34, s30, 0x50000
    s_addc_u32 s35, s31, 0
    s_mov_b32 m0, 80896
    s_nop 0
    global_load_lds_dwordx4 v8, s[34:35] offset:0
    s_mov_b32 m0, 81856
    s_nop 0
    global_load_lds_dwordx4 v8, s[34:35] offset:64
    s_mov_b32 m0, 82816
    s_nop 0
    global_load_lds_dwordx4 v8, s[34:35] offset:128
    s_mov_b32 m0, 83776
    s_nop 0
    global_load_lds_dwordx4 v8, s[34:35] offset:192
    s_mov_b32 m0, 84736
    s_nop 0
    global_load_lds_dwordx4 v8, s[34:35] offset:256
    s_mov_b32 m0, 85696
    s_nop 0
    global_load_lds_dwordx4 v8, s[34:35] offset:320
    s_mov_b32 m0, 86656
    s_nop 0
    global_load_lds_dwordx4 v8, s[34:35] offset:384
    s_mov_b32 m0, 87616
    s_nop 0
    global_load_lds_dwordx4 v8, s[34:35] offset:448
    s_branch LA_f9a
LA_f9:
    global_load_dwordx2 v[16:17], v13, s[4:5] sc1
    s_sub_u32 s25, s25, 1
    s_cbranch_scc1 M_end
    s_waitcnt vmcnt(0)
    v_cmp_eq_u32 vcc, s19, v17
    s_or_b32 vcc_lo, vcc_lo, 0x88888888
    s_or_b32 vcc_hi, vcc_hi, 0x88888888
    v_cmp_eq_u32 s[50:51], s19, v16
    s_and_b64 s[50:51], s[50:51], vcc
    s_nop 0
    v_mov_b32 v16, s50
    v_mov_b32 v17, s51
    ds_write_b64 v5, v[16:17] offset:384
    ds_write_b32 v5, v5 offset:32
LA_f9a:
    ds_read_b32 v6, v11 offset:32
    s_waitcnt lgkmcnt(0)
    v_cmp_eq_u32 vcc, 0, v6
    s_cbranch_vccnz LA_f9
    s_add_u32 s34, s30, 0x80000
    s_addc_u32 s35, s31, 0
    s_mov_b32 m0, 23552
    s_nop 0
    global_load_lds_dwordx4 v8, s[34:35] offset:0
    s_mov_b32 m0, 24512
    s_nop 0
    global_load_lds_dwordx4 v8, s[34:35] offset:64
    s_mov_b32 m0, 25472
    s_nop 0
    global_load_lds_dwordx4 v8, s[34:35] offset:128
    s_mov_b32 m0, 26432
    s_nop 0
    global_load_lds_dwordx4 v8, s[34:35] offset:192
    s_mov_b32 m0, 27392
    s_nop 0
    global_load_lds_dwordx4 v8, s[34:35] offset:256
    s_mov_b32 m0, 28352
    s_nop 0
    global_load_lds_dwordx4 v8, s[34:35] offset:320
    s_mov_b32 m0, 29312
    s_nop 0
    global_load_lds_dwordx4 v8, s[34:35] offset:384
    s_mov_b32 m0, 30272
    s_nop 0
    global_load_lds_dwordx4 v8, s[34:35] offset:448
    s_add_u32 s34, s30, 0x90000
    s_addc_u32 s35, s31, 0
    s_mov_b32 m0, 31744
    s_nop 0
    global_load_lds_dwordx4 v8, s[34:35] offset:0
    s_mov_b32 m0, 32704
    s_nop 0
    global_load_lds_dwordx4 v8, s[34:35] offset:64
    s_mov_b32 m0, 33664
    s_nop 0
    global_load_lds_dwordx4 v8, s[34:35] offset:128
    s_mov_b32 m0, 34624
    s_nop 0
    global_load_lds_dwordx4 v8, s[34:35] offset:192
    s_mov_b32 m0, 35584
    s_nop 0
    global_load_lds_dwordx4 v8, s[34:35] offset:256
    s_mov_b32 m0, 36544
    s_nop 0
    global_load_lds_dwordx4 v8, s[34:35] offset:320
    s_mov_b32 m0, 37504
    s_nop 0
    global_load_lds_dwordx4 v8, s[34:35] offset:384
    s_mov_b32 m0, 38464
    s_nop 0
    global_load_lds_dwordx4 v8, s[34:35] offset:448
    s_branch LA_f10a
LA_f10:
    global_load_dwordx2 v[16:17], v13, s[4:5] sc1
    s_sub_u32 s25, s25, 1
    s_cbranch_scc1 M_end
    s_waitcnt vmcnt(0)
    v_cmp_eq_u32 vcc, s19, v17
    s_or_b32 vcc_lo, vcc_lo, 0x88888888
    s_or_b32 vcc_hi, vcc_hi, 0x88888888
    v_cmp_eq_u32 s[50:51], s19, v16
    s_and_b64 s[50:51], s[50:51], vcc
    s_nop 0
    v_mov_b32 v16, s50
    v_mov_b32 v17, s51
    ds_write_b64 v5, v[16:17] offset:384
    ds_write_b32 v5, v5 offset:32
    ds_write_b32 v5, v5 offset:36
LA_f10a:
    ds_read_b32 v6, v11 offset:64
    s_waitcnt lgkmcnt(0)
    v_cmp_eq_u32 vcc, 0, v6
    s_cbranch_vccnz LA_f10
    s_waitcnt vmcnt(16)
    ds_write_b32 v5, v5 offset:32
    s_add_u32 s34, s30, 0xc0000
    s_addc_u32 s35, s31, 0
    s_mov_b32 m0, 39936
    s_nop 0
    global_load_lds_dwordx4 v8, s[34:35] offset:0
    s_mov_b32 m0, 40896
    s_nop 0
    global_load_lds_dwordx4 v8, s[34:35] offset:64
    s_mov_b32 m0, 41856
    s_nop 0
    global_load_lds_dwordx4 v8, s[34:35] offset:128
    s_mov_b32 m0, 42816
    s_nop 0
    global_load_lds_dwordx4 v8, s[34:35] offset:192
    s_mov_b32 m0, 43776
    s_nop 0
    global_load_lds_dwordx4 v8, s[34:35] offset:256
    s_mov_b32 m0, 44736
    s_nop 0
    global_load_lds_dwordx4 v8, s[34:35] offset:320
    s_mov_b32 m0, 45696
    s_nop 0
    global_load_lds_dwordx4 v8, s[34:35] offset:384
    s_mov_b32 m0, 46656
    s_nop 0
    global_load_lds_dwordx4 v8, s[34:35] offset:448
    s_add_u32 s34, s30, 0xd0000
    s_addc_u32 s35, s31, 0
    s_mov_b32 m0, 48128
    s_nop 0
    global_load_lds_dwordx4 v8, s[34:35] offset:0
    s_mov_b32 m0, 49088
    s_nop 0
    global_load_lds_dwordx4 v8, s[34:35] offset:64
    s_mov_b32 m0, 50048
    s_nop 0
    global_load_lds_dwordx4 v8, s[34:35] offset:128
    s_mov_b32 m0, 51008
    s_nop 0
    global_load_lds_dwordx4 v8, s[34:35] offset:192
    s_mov_b32 m0, 51968
    s_nop 0
    global_load_lds_dwordx4 v8, s[34:35] offset:256
    s_mov_b32 m0, 52928
    s_nop 0
    global_load_lds_dwordx4 v8, s[34:35] offset:320
    s_mov_b32 m0, 53888
    s_nop 0
    global_load_lds_dwordx4 v8, s[34:35] offset:384
    s_mov_b32 m0, 54848
    s_nop 0
    global_load_lds_dwordx4 v8, s[34:35] offset:448
    s_branch LA_f11a
LA_f11:
    global_load_dwordx2 v[16:17], v13, s[4:5] sc1
    s_sub_u32 s25, s25, 1
    s_cbranch_scc1 M_end
    s_waitcnt vmcnt(0)
    v_cmp_eq_u32 vcc, s19, v17
    s_or_b32 vcc_lo, vcc_lo, 0x88888888
    s_or_b32 vcc_hi, vcc_hi, 0x88888888
    v_cmp_eq_u32 s[50:51], s19, v16
    s_and_b64 s[50:51], s[50:51], vcc
    s_nop 0
    v_mov_b32 v16, s50
    v_mov_b32 v17, s51
    ds_write_b64 v5, v[16:17] offset:384
    ds_write_b32 v5, v5 offset:36
    ds_write_b32 v5, v5 offset:40
LA_f11a:
    ds_read_b32 v6, v11 offset:96
    s_waitcnt lgkmcnt(0)
    v_cmp_eq_u32 vcc, 0, v6
    s_cbranch_vccnz LA_f11
    s_waitcnt vmcnt(16)
    ds_write_b32 v5, v5 offset:36
    s_add_u32 s34, s30, 0x100000
    s_addc_u32 s35, s31, 0
    s_mov_b32 m0, 56320
    s_nop 0
    global_load_lds_dwordx4 v8, s[34:35] offset:0
    s_mov_b32 m0, 57280
    s_nop 0
    global_load_lds_dwordx4 v8, s[34:35] offset:64
    s_mov_b32 m0, 58240
    s_nop 0
    global_load_lds_dwordx4 v8, s[34:35] offset:128
    s_mov_b32 m0, 59200
    s_nop 0
    global_load_lds_dwordx4 v8, s[34:35] offset:192
    s_mov_b32 m0, 60160
    s_nop 0
    global_load_lds_dwordx4 v8, s[34:35] offset:256
    s_mov_b32 m0, 61120
    s_nop 0
    global_load_lds_dwordx4 v8, s[34:35] offset:320
    s_mov_b32 m0, 62080
    s_nop 0
    global_load_lds_dwordx4 v8, s[34:35] offset:384
    s_mov_b32 m0, 63040
    s_nop 0
    global_load_lds_dwordx4 v8, s[34:35] offset:448
    s_add_u32 s34, s30, 0x110000
    s_addc_u32 s35, s31, 0
    s_mov_b32 m0, 64512
    s_nop 0
    global_load_lds_dwordx4 v8, s[34:35] offset:0
    s_mov_b32 m0, 65472
    s_nop 0
    global_load_lds_dwordx4 v8, s[34:35] offset:64
    s_mov_b32 m0, 66432
    s_nop 0
    global_load_lds_dwordx4 v8, s[34:35] offset:128
    s_mov_b32 m0, 67392
    s_nop 0
    global_load_lds_dwordx4 v8, s[34:35] offset:192
    s_mov_b32 m0, 68352
    s_nop 0
    global_load_lds_dwordx4 v8, s[34:35] offset:256
    s_mov_b32 m0, 69312
    s_nop 0
    global_load_lds_dwordx4 v8, s[34:35] offset:320
    s_mov_b32 m0, 70272
    s_nop 0
    global_load_lds_dwordx4 v8, s[34:35] offset:384
    s_mov_b32 m0, 71232
    s_nop 0
    global_load_lds_dwordx4 v8, s[34:35] offset:448
    s_branch LA_f12a
LA_f12:
    global_load_dwordx2 v[16:17], v13, s[4:5] sc1
    s_sub_u32 s25, s25, 1
    s_cbranch_scc1 M_end
    s_waitcnt vmcnt(0)
    v_cmp_eq_u32 vcc, s19, v17
    s_or_b32 vcc_lo, vcc_lo, 0x88888888
    s_or_b32 vcc_hi, vcc_hi, 0x88888888
    v_cmp_eq_u32 s[50:51], s19, v16
    s_and_b64 s[50:51], s[50:51], vcc
    s_nop 0
    v_mov_b32 v16, s50
    v_mov_b32 v17, s51
    ds_write_b64 v5, v[16:17] offset:384
    ds_write_b32 v5, v5 offset:40
    ds_write_b32 v5, v5 offset:44
LA_f12a:
    ds_read_b32 v6, v11 offset:128
    s_waitcnt lgkmcnt(0)
    v_cmp_eq_u32 vcc, 0, v6
    s_cbranch_vccnz LA_f12
    s_waitcnt vmcnt(16)
    ds_write_b32 v5, v5 offset:40
    s_add_u32 s34, s30, 0x140000
    s_addc_u32 s35, s31, 0
    s_mov_b32 m0, 0
    s_nop 0
    global_load_lds_dwordx4 v8, s[34:35] offset:0
    s_mov_b32 m0, 960
    s_nop 0
    global_load_lds_dwordx4 v8, s[34:35] offset:64
    s_mov_b32 m0, 1920
    s_nop 0
    global_load_lds_dwordx4 v8, s[34:35] offset:128
    s_mov_b32 m0, 2880
    s_nop 0
    global_load_lds_dwordx4 v8, s[34:35] offset:192
    s_mov_b32 m0, 3840
    s_nop 0
    global_load_lds_dwordx4 v8, s[34:35] offset:256
    s_mov_b32 m0, 4800
    s_nop 0
    global_load_lds_dwordx4 v8, s[34:35] offset:320
    s_mov_b32 m0, 5760
    s_nop 0
    global_load_lds_dwordx4 v8, s[34:35] offset:384
    s_mov_b32 m0, 6720
    s_nop 0
    global_load_lds_dwordx4 v8, s[34:35] offset:448
    s_add_u32 s34, s30, 0x150000
    s_addc_u32 s35, s31, 0
    s_mov_b32 m0, 8192
    s_nop 0
    global_load_lds_dwordx4 v8, s[34:35] offset:0
    s_mov_b32 m0, 9152
    s_nop 0
    global_load_lds_dwordx4 v8, s[34:35] offset:64
    s_mov_b32 m0, 10112
    s_nop 0
    global_load_lds_dwordx4 v8, s[34:35] offset:128
    s_mov_b32 m0, 11072
    s_nop 0
    global_load_lds_dwordx4 v8, s[34:35] offset:192
    s_mov_b32 m0, 12032
    s_nop 0
    global_load_lds_dwordx4 v8, s[34:35] offset:256
    s_mov_b32 m0, 12992
    s_nop 0
    global_load_lds_dwordx4 v8, s[34:35] offset:320
    s_mov_b32 m0, 13952
    s_nop 0
    global_load_lds_dwordx4 v8, s[34:35] offset:384
    s_mov_b32 m0, 14912
    s_nop 0
    global_load_lds_dwordx4 v8, s[34:35] offset:448
    s_branch LA_f13a
LA_f13:
    global_load_dwordx2 v[16:17], v13, s[4:5] sc1
    s_sub_u32 s25, s25, 1
    s_cbranch_scc1 M_end
    s_waitcnt vmcnt(0)
    v_cmp_eq_u32 vcc, s19, v17
    s_or_b32 vcc_lo, vcc_lo, 0x88888888
    s_or_b32 vcc_hi, vcc_hi, 0x88888888
    v_cmp_eq_u32 s[50:51], s19, v16
    s_and_b64 s[50:51], s[50:51], vcc
    s_nop 0
    v_mov_b32 v16, s50
    v_mov_b32 v17, s51
    ds_write_b64 v5, v[16:17] offset:384
    ds_write_b32 v5, v5 offset:44
    ds_write_b32 v5, v5 offset:48
LA_f13a:
    ds_read_b32 v6, v11 offset:160
    s_waitcnt lgkmcnt(0)
    v_cmp_eq_u32 vcc, 0, v6
    s_cbranch_vccnz LA_f13
    s_waitcnt vmcnt(16)
    ds_write_b32 v5, v5 offset:44
    s_add_u32 s34, s30, 0x180000
    s_addc_u32 s35, s31, 0
    s_mov_b32 m0, 138240
    s_nop 0
    global_load_lds_dwordx4 v8, s[34:35] offset:0
    s_mov_b32 m0, 139200
    s_nop 0
    global_load_lds_dwordx4 v8, s[34:35] offset:64
    s_mov_b32 m0, 140160
    s_nop 0
    global_load_lds_dwordx4 v8, s[34:35] offset:128
    s_mov_b32 m0, 141120
    s_nop 0
    global_load_lds_dwordx4 v8, s[34:35] offset:192
    s_mov_b32 m0, 142080
    s_nop 0
    global_load_lds_dwordx4 v8, s[34:35] offset:256
    s_mov_b32 m0, 143040
    s_nop 0
    global_load_lds_dwordx4 v8, s[34:35] offset:320
    s_mov_b32 m0, 144000
    s_nop 0
    global_load_lds_dwordx4 v8, s[34:35] offset:384
    s_mov_b32 m0, 144960
    s_nop 0
    global_load_lds_dwordx4 v8, s[34:35] offset:448
    s_add_u32 s34, s30, 0x190000
    s_addc_u32 s35, s31, 0
    s_mov_b32 m0, 146432
    s_nop 0
    global_load_lds_dwordx4 v8, s[34:35] offset:0
    s_mov_b32 m0, 147392
    s_nop 0
    global_load_lds_dwordx4 v8, s[34:35] offset:64
    s_mov_b32 m0, 148352
    s_nop 0
    global_load_lds_dwordx4 v8, s[34:35] offset:128
    s_mov_b32 m0, 149312
    s_nop 0
    global_load_lds_dwordx4 v8, s[34:35] offset:192
    s_mov_b32 m0, 150272
    s_nop 0
    global_load_lds_dwordx4 v8, s[34:35] offset:256
    s_mov_b32 m0, 151232
    s_nop 0
    global_load_lds_dwordx4 v8, s[34:35] offset:320
    s_mov_b32 m0, 152192
    s_nop 0
    global_load_lds_dwordx4 v8, s[34:35] offset:384
    s_mov_b32 m0, 153152
    s_nop 0
    global_load_lds_dwordx4 v8, s[34:35] offset:448
    s_waitcnt vmcnt(16)
    ds_write_b32 v5, v5 offset:48
LA_p:
    global_load_dwordx2 v[16:17], v13, s[4:5] sc1
    s_sub_u32 s25, s25, 1
    s_cbranch_scc1 M_end
    s_waitcnt vmcnt(0)
    v_cmp_eq_u32 vcc, s19, v17
    s_or_b32 vcc_lo, vcc_lo, 0x88888888
    s_or_b32 vcc_hi, vcc_hi, 0x88888888
    v_cmp_eq_u32 s[50:51], s19, v16
    s_and_b64 s[50:51], s[50:51], vcc
    s_nop 0
    v_mov_b32 v16, s50
    v_mov_b32 v17, s51
    ds_write_b64 v5, v[16:17] offset:384
    ds_write_b32 v5, v5 offset:52
    s_cmp_eq_u32 s23, 0
    s_cbranch_scc1 LA_q
    s_cmp_eq_u64 s[50:51], -1
    s_cbranch_scc0 LA_p
LA_p2:
    s_sub_u32 s25, s25, 1
    s_cbranch_scc1 M_end
    ds_read_b32 v6, v11 offset:192
    s_waitcnt lgkmcnt(0)
    v_cmp_eq_u32 vcc, 0, v6
    s_cbranch_vccnz LA_p2
    global_load_dwordx2 v[18:19], v12, s[4:5] sc1
    global_load_dword v20, v14, s[4:5] sc1
    global_load_dwordx4 v[96:99], v2, s[80:81] offset:-4096 sc1
    global_load_dwordx4 v[100:103], v2, s[82:83] offset:-4096 sc1
    global_load_dwordx4 v[104:107], v2, s[84:85] offset:-4096 sc1
    global_load_dwordx4 v[108:111], v2, s[86:87] offset:-4096 sc1
    global_load_dwordx4 v[112:115], v2, s[80:81] offset:-3072 sc1
    global_load_dwordx4 v[116:119], v2, s[82:83] offset:-3072 sc1
    global_load_dwordx4 v[120:123], v2, s[84:85] offset:-3072 sc1
    global_load_dwordx4 v[124:127], v2, s[86:87] offset:-3072 sc1
    global_load_dwordx4 v[128:131], v2, s[80:81] offset:-2048 sc1
    global_load_dwordx4 v[132:135], v2, s[82:83] offset:-2048 sc1
    global_load_dwordx4 v[136:139], v2, s[84:85] offset:-2048 sc1
    global_load_dwordx4 v[140:143], v2, s[86:87] offset:-2048 sc1
    global_load_dwordx4 v[64:67], v2, s[80:81] offset:1024 sc1
    global_load_dwordx4 v[68:71], v2, s[82:83] offset:1024 sc1
    global_load_dwordx4 v[72:75], v2, s[84:85] offset:1024 sc1
    global_load_dwordx4 v[76:79], v2, s[86:87] offset:1024 sc1
    global_load_dwordx4 v[80:83], v2, s[80:81] offset:2048 sc1
    global_load_dwordx4 v[84:87], v2, s[82:83] offset:2048 sc1
    global_load_dwordx4 v[88:91], v2, s[84:85] offset:2048 sc1
    global_load_dwordx4 v[92:95], v2, s[86:87] offset:2048 sc1
    global_load_dwordx4 v[32:35], v2, s[80:81] offset:-1024 sc1
    global_load_dwordx4 v[36:39], v2, s[82:83] offset:-1024 sc1
    global_load_dwordx4 v[40:43], v2, s[84:85] offset:-1024 sc1
    global_load_dwordx4 v[44:47], v2, s[86:87] offset:-1024 sc1
    global_load_dwordx4 v[48:51], v2, s[80:81] offset:0 sc1
    global_load_dwordx4 v[52:55], v2, s[82:83] offset:0 sc1
    global_load_dwordx4 v[56:59], v2, s[84:85] offset:0 sc1
    global_load_dwordx4 v[60:63], v2, s[86:87] offset:0 sc1
    s_waitcnt vmcnt(28)
    s_branch LA_q1
LA_q:
    global_load_dwordx2 v[18:19], v12, s[4:5] sc1
    global_load_dword v20, v14, s[4:5] sc1
    s_sub_u32 s25, s25, 1
    s_cbranch_scc1 M_end
    s_waitcnt vmcnt(0)
LA_q1:
    v_and_b32 v22, -2, v20
    v_xor_b32 v18, s19, v18
    v_bitop3_b32 v18, v18, v19, s19 bitop3:0xf6
    v_bitop3_b32 v18, v18, v22, s19 bitop3:0xf6
    v_cmp_ne_u32 vcc, 0, v18
    s_cbranch_vccnz LA_q
    v_cmp_ne_u32 vcc, s19, v20
    s_or_b32 s50, vcc_lo, vcc_hi
    s_cselect_b32 s50, 3, 1
    v_mov_b32 v7, s50
    ds_write2_b32 v5, v7, v7 offset0:79 offset1:87
    s_lshr_b32 s97, s50, 1
    s_mov_b32 s96, 0
    s_mov_b32 s72, 0
    s_mov_b32 s73, -1
    v_mov_b32 v0, v5
    s_mov_b64 s[74:75], s[4:5]
    s_setprio 0
    s_mov_b32 s46, 0x00ff00ff
    s_mov_b32 s47, 0x00ff00ff
    s_add_u32 s26, s4, 0x5b2c000
    s_addc_u32 s27, s5, 0
    s_add_u32 s28, s4, 0x5b3c000
    s_addc_u32 s29, s5, 0
    s_mov_b64 s[30:31], s[26:27]
    s_mov_b64 s[32:33], s[26:27]
    s_mov_b64 s[58:59], s[26:27]
    s_mov_b64 s[34:35], s[28:29]
    s_mov_b64 s[36:37], s[28:29]
    s_mul_i32 s42, s22, 7168
    s_and_b32 s43, s14, 1
    s_xor_b32 s43, s43, 1
    s_mul_i32 s43, s43, 14336
    s_add_u32 s42, s42, s43
    s_add_u32 s42, s42, 0x1000
    s_add_u32 s42, s4, s42
    s_addc_u32 s43, s5, 0
    s_sub_u32 s44, s20, 28
    s_max_i32 s44, s44, 0
    s_mul_i32 s44, s44, 7168
    s_add_u32 s44, s44, 0xe000
    s_add_u32 s44, s4, s44
    s_addc_u32 s45, s5, 0
    s_mov_b32 s24, 0
    s_mov_b64 s[62:63], 0
    s_min_u32 s38, s20, 27
    s_mul_i32 s38, s38, 16384
    s_add_u32 s38, s38, 0x1110000
    s_add_u32 s38, s4, s38
    s_addc_u32 s39, s5, 0
    s_lshl_b32 s40, s21, 13
    s_lshl_b32 s41, s22, 11
    s_add_u32 s40, s40, s41
    s_add_u32 s40, s40, 0x5410800
    s_add_u32 s40, s4, s40
    s_addc_u32 s41, s5, 0
    s_add_u32 s48, s4, 0x5390000
    s_addc_u32 s49, s5, 0
    s_mov_b64 s[54:55], s[38:39]
    s_sub_u32 s56, s20, 28
    s_max_i32 s56, s56, 0
    s_mul_i32 s56, s56, 114688
    s_add_u32 s56, s56, 0x11f0000
    s_add_u32 s56, s4, s56
    s_addc_u32 s57, s5, 0
    s_add_u32 s52, s4, 0x5b6c000
    s_addc_u32 s53, s5, 0
    s_waitcnt lgkmcnt(0)
LA_end:
    s_min_u32 s50, s14, 6
    s_lshl_b32 s50, s50, 10
    v_add_u32 v14, s50, v2
    s_sub_u32 s50, s14, 3
    s_cmp_ge_u32 s50, 4
    s_cbranch_scc1 CH_m0
    v_bfe_u32 v16, v14, 4, 3
    v_mul_u32_u24 v16, 896, v16
    v_lshrrev_b32 v17, 9, v14
    v_lshl_add_u32 v16, v17, 6, v16
    v_bfe_u32 v17, v14, 7, 1
    v_lshl_add_u32 v16, v17, 5, v16
    v_bfe_u32 v17, v14, 8, 1
    v_lshl_add_u32 v16, v17, 3, v16
    global_load_dwordx2 v[20:21], v16, s[12:13]
    global_load_dwordx2 v[22:23], v16, s[12:13] offset:16
    s_cmp_eq_u32 s14, 3
    s_cbranch_scc1 CH_m0
    global_load_dwordx2 v[24:25], v16, s[12:13] offset:-512
    global_load_dwordx2 v[26:27], v16, s[12:13] offset:-496
CH_m0:
    v_bfe_u32 v5, v4, 1, 1
    v_mul_u32_u24 v5, 0xaaaa, v5
    v_add_u32 v5, 0x4444, v5
    v_lshrrev_b32 v6, 2, v4
    v_lshlrev_b32 v6, 1, v6
    v_and_b32 v7, 1, v4
    v_add_u32 v6, v6, v7
    v_lshlrev_b32 v6, 4, v6
    v_lshl_add_u32 v6, v3, 7, v6
    s_mul_i32 s50, s61, 3584
    v_add_u32 v6, s50, v6
    v_lshrrev_b32 v7, 2, v4
    v_lshlrev_b32 v7, 7, v7
    v_lshl_add_u32 v7, v3, 5, v7
    v_and_b32 v8, 3, v4
    v_lshl_add_u32 v7, v8, 2, v7
    s_lshl_b32 s50, s14, 9
    s_add_u32 s50, s50, 7168
    v_add_u32 v7, s50, v7
    s_lshl_b32 s50, s60, 10
    s_add_u32 s50, s50, 15360
    v_add_u32 v12, s50, v2
    s_cmp_ge_u32 s14, 4
    s_cbranch_scc1 CH_c4
    s_lshr_b32 s50, s60, 1
    s_lshl_b32 s50, s50, 10
    s_and_b32 s51, s60, 1
    s_lshl_b32 s51, s51, 3
    s_add_u32 s50, s50, s51
    s_add_u32 s50, s50, 19456
    v_add_u32 v8, s50, v2
    s_lshl_b32 s50, s60, 10
    s_add_u32 s50, s50, 11264
    v_and_b32 v9, 7, v1
    v_lshlrev_b32 v9, 2, v9
    v_lshl_add_u32 v9, v3, 6, v9
    v_bfe_u32 v16, v1, 3, 1
    v_lshl_add_u32 v9, v16, 8, v9
    v_add_u32 v9, s50, v9
    s_lshl_b32 s50, s22, 2
    s_add_u32 s50, s50, s60
    s_lshl_b32 s51, s50, 11
    v_add_u32 v10, s51, v2
    s_lshl_b32 s51, s50, 9
    s_add_u32 s51, s51, 16384
    v_lshlrev_b32 v11, 2, v1
    v_add_u32 v11, s51, v11
    s_lshl_b32 s50, s60, 12
    v_add_u32 v13, s50, v2
    s_branch CH_c5
CH_c4:
    v_mov_b32 v11, 0
    v_and_b32 v16, 7, v4
    s_cmp_eq_u32 s14, 5
    s_cselect_b64 vcc, -1, 0
    v_lshlrev_b32 v8, 4, v16
    v_lshl_add_u32 v17, v3, 7, v8
    v_and_b32 v18, 1, v3
    v_lshl_add_u32 v8, v18, 8, v8
    v_lshrrev_b32 v18, 1, v3
    v_lshl_add_u32 v8, v18, 3, v8
    v_cndmask_b32 v8, v17, v8
    v_add_u32 v8, 7168, v8
    v_lshrrev_b32 v17, 1, v16
    v_lshlrev_b32 v17, 2, v17
    v_and_b32 v18, 1, v16
    v_add_u32 v17, v17, v18
    s_and_b32 s50, s21, 1
    s_lshl_b32 s50, s50, 1
    v_add_u32 v17, s50, v17
    s_lshr_b32 s50, s21, 1
    s_lshl_b32 s50, s50, 1
    s_add_u32 s50, s50, s22
    s_lshl_b32 s51, s50, 1
    s_add_u32 s51, s51, 7
    s_sub_u32 s51, s51, s14
    s_lshl_b32 s51, s51, 9
    v_lshlrev_b32 v9, 4, v17
    v_lshrrev_b32 v18, 1, v3
    v_lshl_add_u32 v9, v18, 8, v9
    v_and_b32 v18, 1, v3
    v_lshl_add_u32 v9, v18, 3, v9
    v_add_u32 v9, s51, v9
    s_lshl_b32 s51, s50, 8
    s_add_u32 s51, s51, 16384
    v_lshl_add_u32 v17, v3, 4, v17
    v_lshlrev_b32 v18, 2, v17
    v_add_u32 v18, s51, v18
    v_cndmask_b32 v9, v9, v18
    v_bfe_u32 v13, v1, 1, 1
    v_lshlrev_b32 v13, 7, v13
    v_and_b32 v16, 1, v1
    v_lshl_add_u32 v13, v16, 3, v13
    v_bfe_u32 v16, v1, 2, 2
    v_lshl_add_u32 v13, v16, 5, v13
    v_lshrrev_b32 v16, 5, v1
    v_lshl_add_u32 v13, v16, 4, v13
    v_bfe_u32 v16, v1, 4, 1
    v_lshl_add_u32 v13, v16, 8, v13
    v_lshlrev_b32 v13, 3, v1
    s_mul_i32 s50, s22, 7168
    s_lshl_b32 s51, s21, 9
    s_add_u32 s50, s50, s51
    v_add_u32 v13, s50, v13
    v_min_u32 v10, 53, v1
    v_lshlrev_b32 v10, 7, v10
    v_add_u32 v16, 2048, v8
    v_cndmask_b32 v10, v10, v16
CH_c5:
    s_mul_i32 s50, s61, 7168
    s_sub_u32 s50, 3584, s50
    v_add_u32 v3, s50, v6
    s_lshl_b32 s50, s20, 7
    s_add_u32 s50, s50, 196608
    v_mov_b32 v4, s50
    s_cmp_lg_u32 s23, 0
    s_cbranch_scc1 CH_hs
    s_and_b32 s50, s20, 1
    s_lshl_b32 s50, s50, 2
    s_add_u32 s50, s50, s60
    s_min_u32 s50, s50, 6
    s_lshl_b32 s50, s50, 10
    v_lshrrev_b32 v4, 5, v1
    v_lshlrev_b32 v4, 9, v4
    v_bfe_u32 v16, v1, 4, 1
    v_lshl_add_u32 v4, v16, 7, v4
    v_and_b32 v16, 7, v1
    v_lshl_add_u32 v4, v16, 4, v4
    v_bfe_u32 v16, v1, 3, 1
    v_lshl_add_u32 v4, v16, 3, v4
    v_add_u32 v4, s50, v4
    v_add_u32 v13, s50, v2
    s_sub_u32 s50, s20, 28
    s_lshl_b32 s50, s50, 7
    s_add_u32 s50, s50, 196608
    v_mov_b32 v11, s50
    s_cmp_lg_u32 s14, 7
    s_cbranch_scc1 CH_h7
    v_min_u32 v10, 55, v1
    v_lshlrev_b32 v10, 7, v10
CH_h7:
    s_min_u32 s50, s14, 4
    s_add_u32 s50, s50, 0
    s_lshl_b32 s50, s50, 6
    v_add_u32 v16, s50, v1
    v_min_u32 v16, 223, v16
    v_cvt_f32_u32 v17, v16
    v_add_f32 v17, 0.5, v17
    v_mul_f32 v17, 0x3d000000, v17
    v_cvt_u32_f32 v17, v17
    v_mul_u32_u24 v18, 32, v17
    v_sub_u32 v16, v16, v18
    v_add_u32 v16, 96, v16
    v_lshlrev_b32 v16, 7, v16
    v_lshl_add_u32 v96, v17, 14, v16
CH_hs:
    s_mul_i32 s50, s14, 16384
    s_add_u32 s50, s50, 23552
    v_add_u32 v15, s50, v2
    v_min_u32 v16, 55, v1
    v_lshlrev_b32 v16, 4, v16
    v_and_b32 v30, 7, v1
    v_lshlrev_b32 v30, 2, v30
    v_add_u32 v30, 154944, v30
    s_cmp_ge_u32 s14, 3
    s_cselect_b32 s50, 32, 0
    v_subrev_u32 v31, s50, v30
    s_cmp_eq_u32 s14, 7
    s_cbranch_scc1 CIc1
CR_5:
    ds_read_b32 v28, v31
    s_sub_u32 s25, s25, 1
    s_cbranch_scc1 M_end
    s_waitcnt lgkmcnt(0)
    v_cmp_eq_u32 vcc, 0, v28
    s_cbranch_vccnz CR_5
    v_readlane_b32 s97, v28, 7
    s_lshr_b32 s97, s97, 1
CIc0:
    s_cmp_eq_u32 s23, 0
    s_cbranch_scc1 CIh
    s_waitcnt vmcnt(16)
    v_swap_b32 v97, v100
    v_swap_b32 v99, v101
    v_swap_b32 v98, v100
    v_swap_b32 v101, v102
    v_swap_b32 v105, v108
    v_swap_b32 v107, v109
    v_swap_b32 v106, v108
    v_swap_b32 v109, v110
    v_swap_b32 v113, v116
    v_swap_b32 v115, v117
    v_swap_b32 v114, v116
    v_swap_b32 v117, v118
    v_swap_b32 v121, v124
    v_swap_b32 v123, v125
    v_swap_b32 v122, v124
    v_swap_b32 v125, v126
    v_swap_b32 v129, v132
    v_swap_b32 v131, v133
    v_swap_b32 v130, v132
    v_swap_b32 v133, v134
    v_swap_b32 v137, v140
    v_swap_b32 v139, v141
    v_swap_b32 v138, v140
    v_swap_b32 v141, v142
    s_waitcnt vmcnt(14)
    v_swap_b32 v65, v68
    v_swap_b32 v67, v69
    v_swap_b32 v66, v68
    v_swap_b32 v69, v70
    ds_write_b128 v15, v[64:67] offset:8192
    ds_write_b128 v15, v[68:71] offset:9216
    s_waitcnt vmcnt(12)
    v_swap_b32 v73, v76
    v_swap_b32 v75, v77
    v_swap_b32 v74, v76
    v_swap_b32 v77, v78
    ds_write_b128 v15, v[72:75] offset:10240
    ds_write_b128 v15, v[76:79] offset:11264
    s_waitcnt vmcnt(10)
    v_swap_b32 v81, v84
    v_swap_b32 v83, v85
    v_swap_b32 v82, v84
    v_swap_b32 v85, v86
    ds_write_b128 v15, v[80:83] offset:12288
    ds_write_b128 v15, v[84:87] offset:13312
    s_waitcnt vmcnt(8)
    v_swap_b32 v89, v92
    v_swap_b32 v91, v93
    v_swap_b32 v90, v92
    v_swap_b32 v93, v94
    ds_write_b128 v15, v[88:91] offset:14336
    ds_write_b128 v15, v[92:95] offset:15360
    s_waitcnt vmcnt(6)
    v_swap_b32 v33, v36
    v_swap_b32 v35, v37
    v_swap_b32 v34, v36
    v_swap_b32 v37, v38
    ds_write_b128 v15, v[32:35] offset:0
    ds_write_b128 v15, v[36:39] offset:1024
    s_waitcnt vmcnt(4)
    v_swap_b32 v41, v44
    v_swap_b32 v43, v45
    v_swap_b32 v42, v44
    v_swap_b32 v45, v46
    ds_write_b128 v15, v[40:43] offset:2048
    ds_write_b128 v15, v[44:47] offset:3072
    s_waitcnt vmcnt(2)
    v_swap_b32 v49, v52
    v_swap_b32 v51, v53
    v_swap_b32 v50, v52
    v_swap_b32 v53, v54
    ds_write_b128 v15, v[48:51] offset:4096
    ds_write_b128 v15, v[52:55] offset:5120
    s_waitcnt vmcnt(0)
    v_swap_b32 v57, v60
    v_swap_b32 v59, v61
    v_swap_b32 v58, v60
    v_swap_b32 v61, v62
    ds_write_b128 v15, v[56:59] offset:6144
    ds_write_b128 v15, v[60:63] offset:7168
    s_branch CIh
CIc1:
    s_cmp_eq_u32 s23, 0
    s_cbranch_scc1 CIh
    s_waitcnt vmcnt(16)
    v_swap_b32 v97, v100
    v_swap_b32 v99, v101
    v_swap_b32 v98, v100
    v_swap_b32 v101, v102
    v_swap_b32 v105, v108
    v_swap_b32 v107, v109
    v_swap_b32 v106, v108
    v_swap_b32 v109, v110
    v_swap_b32 v113, v116
    v_swap_b32 v115, v117
    v_swap_b32 v114, v116
    v_swap_b32 v117, v118
    v_swap_b32 v121, v124
    v_swap_b32 v123, v125
    v_swap_b32 v122, v124
    v_swap_b32 v125, v126
    v_swap_b32 v129, v132
    v_swap_b32 v131, v133
    v_swap_b32 v130, v132
    v_swap_b32 v133, v134
    v_swap_b32 v137, v140
    v_swap_b32 v139, v141
    v_swap_b32 v138, v140
    v_swap_b32 v141, v142
    s_waitcnt vmcnt(14)
    v_mov_b32 v176, v64
    v_mov_b32 v177, v68
    v_mov_b32 v178, v65
    v_mov_b32 v179, v69
    v_mov_b32 v180, v66
    v_mov_b32 v181, v70
    v_mov_b32 v182, v67
    v_mov_b32 v183, v71
    s_waitcnt vmcnt(12)
    v_mov_b32 v184, v72
    v_mov_b32 v185, v76
    v_mov_b32 v186, v73
    v_mov_b32 v187, v77
    v_mov_b32 v188, v74
    v_mov_b32 v189, v78
    v_mov_b32 v190, v75
    v_mov_b32 v191, v79
    s_waitcnt vmcnt(10)
    v_mov_b32 v192, v80
    v_mov_b32 v193, v84
    v_mov_b32 v194, v81
    v_mov_b32 v195, v85
    v_mov_b32 v196, v82
    v_mov_b32 v197, v86
    v_mov_b32 v198, v83
    v_mov_b32 v199, v87
    s_waitcnt vmcnt(8)
    v_mov_b32 v200, v88
    v_mov_b32 v201, v92
    v_mov_b32 v202, v89
    v_mov_b32 v203, v93
    v_mov_b32 v204, v90
    v_mov_b32 v205, v94
    v_mov_b32 v206, v91
    v_mov_b32 v207, v95
    s_waitcnt vmcnt(6)
    v_mov_b32 v144, v32
    v_mov_b32 v145, v36
    v_mov_b32 v146, v33
    v_mov_b32 v147, v37
    v_mov_b32 v148, v34
    v_mov_b32 v149, v38
    v_mov_b32 v150, v35
    v_mov_b32 v151, v39
    s_waitcnt vmcnt(4)
    v_mov_b32 v152, v40
    v_mov_b32 v153, v44
    v_mov_b32 v154, v41
    v_mov_b32 v155, v45
    v_mov_b32 v156, v42
    v_mov_b32 v157, v46
    v_mov_b32 v158, v43
    v_mov_b32 v159, v47
    s_waitcnt vmcnt(2)
    v_mov_b32 v160, v48
    v_mov_b32 v161, v52
    v_mov_b32 v162, v49
    v_mov_b32 v163, v53
    v_mov_b32 v164, v50
    v_mov_b32 v165, v54
    v_mov_b32 v166, v51
    v_mov_b32 v167, v55
    s_waitcnt vmcnt(0)
    v_mov_b32 v168, v56
    v_mov_b32 v169, v60
    v_mov_b32 v170, v57
    v_mov_b32 v171, v61
    v_mov_b32 v172, v58
    v_mov_b32 v173, v62
    v_mov_b32 v174, v59
    v_mov_b32 v175, v63
CIh:
    s_cmp_lt_u32 s14, 3
    s_cbranch_scc1 CI2
    s_waitcnt lgkmcnt(0)
    s_cmp_lt_u32 s14, 6
    s_cbranch_scc1 CIx
    global_load_dwordx4 v[68:71], v2, s[42:43] offset:-4096 sc1
    global_load_dwordx4 v[72:75], v2, s[42:43] offset:-3072 sc1
    global_load_dwordx4 v[76:79], v2, s[42:43] offset:-2048 sc1
    global_load_dwordx4 v[80:83], v2, s[42:43] offset:-1024 sc1
    global_load_dwordx4 v[84:87], v2, s[42:43] offset:0 sc1
    global_load_dwordx4 v[88:91], v2, s[42:43] offset:1024 sc1
    global_load_dwordx4 v[92:95], v2, s[42:43] offset:2048 sc1
CIx:
    s_cmp_lg_u32 s60, 3
    s_cbranch_scc1 CIu
    s_cmp_lg_u32 s14, 7
    s_cbranch_scc1 CIt
    s_mul_i32 s50, s20, 5120
    s_add_u32 s50, s26, s50
    s_addc_u32 s51, s27, 0
    v_min_u32 v19, 39, v1
    v_lshlrev_b32 v19, 7, v19
    global_load_dword v29, v19, s[50:51] sc1
    s_getpc_b64 s[50:51]
CT_6:
    s_add_u32 s50, s50, CI2-CT_6
    s_addc_u32 s51, s51, 0
    global_load_dword v29, v23, s[50:51]
CIt:
    s_lshr_b32 s50, s14, 2
    s_lshl_b32 s50, s50, 12
    v_add_u32 v17, s50, v16
CH_t0:
    global_load_dwordx4 v[32:35], v17, s[52:53] offset:0 sc1
    global_load_dwordx4 v[36:39], v17, s[52:53] offset:1024 sc1
    global_load_dwordx4 v[40:43], v17, s[52:53] offset:2048 sc1
    global_load_dwordx4 v[44:47], v17, s[52:53] offset:3072 sc1
    s_sub_u32 s25, s25, 1
    s_cbranch_scc1 M_end
    s_waitcnt vmcnt(0)
    v_xor_b32 v32, s19, v32
    v_bitop3_b32 v32, v32, v33, s19 bitop3:0xf6
    v_bitop3_b32 v32, v32, v34, s19 bitop3:0xf6
    v_bitop3_b32 v32, v32, v35, s19 bitop3:0xf6
    v_bitop3_b32 v32, v32, v36, s19 bitop3:0xf6
    v_bitop3_b32 v32, v32, v37, s19 bitop3:0xf6
    v_bitop3_b32 v32, v32, v38, s19 bitop3:0xf6
    v_bitop3_b32 v32, v32, v39, s19 bitop3:0xf6
    v_bitop3_b32 v32, v32, v40, s19 bitop3:0xf6
    v_bitop3_b32 v32, v32, v41, s19 bitop3:0xf6
    v_bitop3_b32 v32, v32, v42, s19 bitop3:0xf6
    v_bitop3_b32 v32, v32, v43, s19 bitop3:0xf6
    v_bitop3_b32 v32, v32, v44, s19 bitop3:0xf6
    v_bitop3_b32 v32, v32, v45, s19 bitop3:0xf6
    v_bitop3_b32 v32, v32, v46, s19 bitop3:0xf6
    v_bitop3_b32 v32, v32, v47, s19 bitop3:0xf6
    v_cmp_ne_u32 vcc, 0, v32
    s_cbranch_vccnz CH_t0
CIu:
CR_7:
    ds_read_b32 v28, v30
    s_sub_u32 s25, s25, 1
    s_cbranch_scc1 M_end
    s_waitcnt lgkmcnt(0)
    v_cmp_eq_u32 vcc, 0, v28
    s_cbranch_vccnz CR_7
    s_cmp_eq_u32 s14, 7
    s_cbranch_scc1 CI2
    s_waitcnt vmcnt(0)
    v_lshlrev_b32 v18, 16, v20
    v_and_b32 v20, 0xffff0000, v20
    v_cvt_pk_f16_f32 v20, v18, v20
    v_lshlrev_b32 v18, 16, v21
    v_and_b32 v21, 0xffff0000, v21
    v_cvt_pk_f16_f32 v21, v18, v21
    v_lshlrev_b32 v18, 16, v22
    v_and_b32 v22, 0xffff0000, v22
    v_cvt_pk_f16_f32 v22, v18, v22
    v_lshlrev_b32 v18, 16, v23
    v_and_b32 v23, 0xffff0000, v23
    v_cvt_pk_f16_f32 v23, v18, v23
    ds_write_b128 v14, v[20:23]
    s_cmp_eq_u32 s14, 3
    s_cbranch_scc1 CI2
    v_lshlrev_b32 v18, 16, v24
    v_and_b32 v24, 0xffff0000, v24
    v_cvt_pk_f16_f32 v24, v18, v24
    v_lshlrev_b32 v18, 16, v25
    v_and_b32 v25, 0xffff0000, v25
    v_cvt_pk_f16_f32 v25, v18, v25
    v_lshlrev_b32 v18, 16, v26
    v_and_b32 v26, 0xffff0000, v26
    v_cvt_pk_f16_f32 v26, v18, v26
    v_lshlrev_b32 v18, 16, v27
    v_and_b32 v27, 0xffff0000, v27
    v_cvt_pk_f16_f32 v27, v18, v27
    v_subrev_u32 v18, 4096, v14
    ds_write_b128 v18, v[24:27]
CI2:
    v_mov_b32 v0, 0
    s_waitcnt vmcnt(0) lgkmcnt(0)
    v_mov_b32 v60, v16
    v_mov_b32 v52, s19
    v_mov_b32 v53, s19
    v_mov_b32 v54, s19
    v_mov_b32 v55, s19
    v_mov_b32 v56, s19
    v_mov_b32 v57, s19
    v_mov_b32 v58, s19
    v_mov_b32 v59, s19
    s_cmp_lg_u32 s97, 0
    s_cbranch_scc1 CH_mixed
    s_cmp_eq_u32 s23, 0
    s_cbranch_scc1 CH_hdisp
    s_cmp_eq_u32 s14, 3
    s_cbranch_scc1 C3_entry
    s_cmp_eq_u32 s14, 4
    s_cbranch_scc1 C4_entry
    s_cmp_eq_u32 s14, 5
    s_cbranch_scc1 C5_entry
    s_cmp_eq_u32 s14, 6
    s_cbranch_scc1 C6_entry
    s_cmp_eq_u32 s14, 7
    s_cbranch_scc1 C7_entry
C0_entry:
    s_add_u32 s50, s24, 0
    s_and_b32 s50, s50, 3
    s_mul_i32 s50, s50, 24576
    s_add_u32 s34, s28, s50
    s_addc_u32 s35, s29, 0
    s_add_u32 s50, s24, 1
    s_and_b32 s50, s50, 3
    s_mul_i32 s50, s50, 16384
    s_add_u32 s30, s26, s50
    s_addc_u32 s31, s27, 0
    ds_read_b128 v[52:55], v15 offset:0
    ds_read_b128 v[56:59], v15 offset:1024
    ds_read_b128 v[60:63], v15 offset:2048
    ds_read_b128 v[64:67], v15 offset:3072
    v_mov_b32 v84, 0
    v_mov_b32 v85, 0
    v_mov_b32 v86, 0
    v_mov_b32 v87, 0
    v_mov_b32 v44, 0
    v_mov_b32 v45, 0
    v_mov_b32 v46, 0
    v_mov_b32 v47, 0
    v_mov_b32 v48, 0
    v_mov_b32 v49, 0
    v_mov_b32 v50, 0
    v_mov_b32 v51, 0
    s_setprio 1
    s_branch C0_top
.p2align 6
C0_loop:
    s_waitcnt vmcnt(0)
    v_pk_add_f16 v16, v68, v72
    v_pk_add_f16 v17, v69, v73
    v_pk_add_f16 v18, v70, v74
    v_pk_add_f16 v19, v71, v75
    ds_write_b128 v14, v[16:19]
    v_pk_maximum3_f16 v20, v16, v17, v18
    v_pk_maximum3_f16 v20, v20, v19, v19
    v_cmp_u_f16 vcc, v20, v20
    s_cbranch_vccnz C0_mre
C0_got:
C0_top:
    s_cmp_eq_u32 s24, 63
    s_waitcnt lgkmcnt(0)
    s_barrier
    s_cbranch_scc1 C0_fin
    ds_read_b128 v[16:19], v3 offset:0
    ds_read_b128 v[20:23], v3 offset:512
    ds_read_b128 v[24:27], v3 offset:1024
    ds_read_b128 v[28:31], v3 offset:1536
    ds_read_b128 v[32:35], v3 offset:2048
    ds_read_b128 v[36:39], v3 offset:2560
    s_waitcnt lgkmcnt(5)
    v_smfmac_f32_16x16x64_f16 v[84:87], v[16:19], v[144:151], v5
    ds_read_b128 v[40:43], v3 offset:3072
    s_waitcnt lgkmcnt(5)
    v_smfmac_f32_16x16x64_f16 v[84:87], v[20:23], v[152:159], v5
    ds_read_b128 v[16:19], v6 offset:0
    s_waitcnt lgkmcnt(5)
    v_smfmac_f32_16x16x64_f16 v[84:87], v[24:27], v[160:167], v5
    ds_read_b128 v[20:23], v6 offset:512
    s_waitcnt lgkmcnt(5)
    v_smfmac_f32_16x16x64_f16 v[84:87], v[28:31], v[168:175], v5
    ds_read_b128 v[24:27], v6 offset:1024
    s_waitcnt lgkmcnt(5)
    v_smfmac_f32_16x16x64_f16 v[84:87], v[32:35], v[176:183], v5
    ds_read_b128 v[28:31], v6 offset:1536
    s_waitcnt lgkmcnt(5)
    v_smfmac_f32_16x16x64_f16 v[84:87], v[36:39], v[184:191], v5
    ds_read_b128 v[32:35], v6 offset:2048
    s_waitcnt lgkmcnt(5)
    v_smfmac_f32_16x16x64_f16 v[84:87], v[40:43], v[192:199], v5
    ds_read_b128 v[36:39], v6 offset:2560
    s_waitcnt lgkmcnt(5)
    v_smfmac_f32_16x16x64_f16 v[84:87], v[16:19], v[200:207], v5
    ds_read_b128 v[40:43], v6 offset:3072
    s_waitcnt lgkmcnt(5)
    v_smfmac_f32_16x16x64_f16 v[84:87], v[20:23], v[208:215], v5
    s_waitcnt lgkmcnt(4)
    v_smfmac_f32_16x16x64_f16 v[84:87], v[24:27], v[216:223], v5
    s_waitcnt lgkmcnt(3)
    v_smfmac_f32_16x16x64_f16 v[84:87], v[28:31], v[224:231], v5
    s_waitcnt lgkmcnt(2)
    v_smfmac_f32_16x16x64_f16 v[84:87], v[32:35], v[232:239], v5
    s_waitcnt lgkmcnt(1)
    v_smfmac_f32_16x16x64_f16 v[84:87], v[36:39], v[240:247], v5
    s_waitcnt lgkmcnt(0)
    v_smfmac_f32_16x16x64_f16 v[84:87], v[40:43], v[248:255], v5
    global_load_dwordx4 v[68:71], v13, s[38:39] offset:0 sc1
    global_load_dwordx4 v[72:75], v13, s[38:39] offset:1024 sc1
    s_nop 5
    v_cvt_pk_f16_f32 v84, v84, v86
    v_cvt_pk_f16_f32 v85, v85, v87
    ds_write2_b32 v7, v84, v85 offset0:0 offset1:4
    s_setprio 0
    global_load_dwordx4 v[76:79], v13, s[38:39] offset:2048 sc1
    global_load_dwordx4 v[80:83], v13, s[38:39] offset:3072 sc1
    v_smfmac_f32_16x16x64_f16 v[44:47], v[28:31], v[52:59], v5
    ds_read_b128 v[52:55], v15 offset:4096
    ds_read_b128 v[56:59], v15 offset:5120
    v_smfmac_f32_16x16x64_f16 v[44:47], v[16:19], v[96:103], v5
    v_smfmac_f32_16x16x64_f16 v[48:51], v[28:31], v[60:67], v5
    ds_read_b128 v[60:63], v15 offset:6144
    ds_read_b128 v[64:67], v15 offset:7168
    v_smfmac_f32_16x16x64_f16 v[48:51], v[16:19], v[104:111], v5
    s_waitcnt lgkmcnt(4)
    s_barrier
    s_waitcnt lgkmcnt(2)
    v_smfmac_f32_16x16x64_f16 v[44:47], v[32:35], v[52:59], v5
    ds_read_b128 v[52:55], v15 offset:8192
    ds_read_b128 v[56:59], v15 offset:9216
    v_smfmac_f32_16x16x64_f16 v[44:47], v[20:23], v[112:119], v5
    s_waitcnt lgkmcnt(2)
    v_smfmac_f32_16x16x64_f16 v[48:51], v[32:35], v[60:67], v5
    ds_read_b128 v[60:63], v15 offset:10240
    ds_read_b128 v[64:67], v15 offset:11264
    v_smfmac_f32_16x16x64_f16 v[48:51], v[20:23], v[120:127], v5
    s_barrier
    s_waitcnt lgkmcnt(2)
    v_smfmac_f32_16x16x64_f16 v[44:47], v[36:39], v[52:59], v5
    ds_read_b128 v[52:55], v15 offset:12288
    ds_read_b128 v[56:59], v15 offset:13312
    v_smfmac_f32_16x16x64_f16 v[44:47], v[24:27], v[128:135], v5
    s_waitcnt lgkmcnt(2)
    v_smfmac_f32_16x16x64_f16 v[48:51], v[36:39], v[60:67], v5
    ds_read_b128 v[60:63], v15 offset:14336
    ds_read_b128 v[64:67], v15 offset:15360
    v_smfmac_f32_16x16x64_f16 v[48:51], v[24:27], v[136:143], v5
    s_waitcnt lgkmcnt(2)
    v_smfmac_f32_16x16x64_f16 v[44:47], v[40:43], v[52:59], v5
    s_waitcnt lgkmcnt(0)
    v_smfmac_f32_16x16x64_f16 v[48:51], v[40:43], v[60:67], v5
    v_mov_b32 v52, 0x3c003c00
    v_mov_b32 v53, 0x3c003c00
    v_mov_b32 v54, 0x3c003c00
    v_mov_b32 v55, 0x3c003c00
    v_mov_b32 v56, 0x3c003c00
    v_mov_b32 v57, 0x3c003c00
    v_mov_b32 v58, 0x3c003c00
    v_mov_b32 v59, 0x3c003c00
    v_mov_b32 v60, 0
    v_mov_b32 v61, 0
    v_mov_b32 v62, 0
    v_mov_b32 v63, 0
    v_cvt_pk_f16_f32 v16, v44, v45
    v_cvt_pk_f16_f32 v17, v46, v47
    v_cvt_pk_f16_f32 v18, v48, v49
    v_cvt_pk_f16_f32 v19, v50, v51
    global_load_dwordx4 v[84:87], v10, s[34:35] sc1
    global_load_dwordx4 v[88:91], v10, s[34:35] offset:1024 sc1
    global_load_dword v92, v11, s[34:35] sc1
    global_load_dword v93, v11, s[34:35] offset:256 sc1
    v_mov_b32 v20, 0
    v_mov_b32 v21, 0
    v_mov_b32 v33, 0
    v_mov_b32 v44, 0
    v_mov_b32 v45, 0
    v_mov_b32 v46, 0
    v_mov_b32 v47, 0
    v_mov_b32 v48, 0
    v_mov_b32 v49, 0
    v_mov_b32 v50, 0
    v_mov_b32 v51, 0
C0_sp:
    s_waitcnt vmcnt(0)
    v_pk_add_f16 v28, v84, v88
    v_pk_add_f16 v29, v85, v89
    v_pk_add_f16 v30, v86, v90
    v_pk_add_f16 v31, v87, v91
    v_pk_add_f16 v32, v92, v93
    v_pk_maximum3_f16 v34, v28, v29, v30
    v_pk_maximum3_f16 v34, v34, v31, v32
    v_pk_maximum3_f16 v34, v34, v34, v34 op_sel:[0,1,0] op_sel_hi:[1,0,1]
    v_mov_b32 v35, v34
    v_cmp_u_f16 vcc, v34, v34
    s_nop 0
    v_permlane32_swap_b32 v34, v35
    v_pk_max_f16 v34, v34, v35
    v_mov_b32 v35, v34
    s_cbranch_vccnz C0_gre
C0_sok:
    s_nop 0
    v_permlane16_swap_b32 v34, v35
    v_pk_max_f16 v34, v34, v35
    v_pk_add_f16 v32, v32, v34 neg_lo:[0,1] neg_hi:[0,1]
    v_pk_add_f16 v28, v28, v34 neg_lo:[0,1] neg_hi:[0,1]
    v_pk_add_f16 v29, v29, v34 neg_lo:[0,1] neg_hi:[0,1]
    v_pk_add_f16 v30, v30, v34 neg_lo:[0,1] neg_hi:[0,1]
    v_pk_add_f16 v31, v31, v34 neg_lo:[0,1] neg_hi:[0,1]
    v_exp_f16_sdwa v32, v32 dst_sel:WORD_0 dst_unused:UNUSED_PRESERVE src0_sel:WORD_0
    v_exp_f16_sdwa v28, v28 dst_sel:WORD_0 dst_unused:UNUSED_PRESERVE src0_sel:WORD_0
    s_barrier
    ds_read_b128 v[24:27], v12
    v_exp_f16_sdwa v32, v32 dst_sel:WORD_1 dst_unused:UNUSED_PRESERVE src0_sel:WORD_1
    v_exp_f16_sdwa v29, v29 dst_sel:WORD_0 dst_unused:UNUSED_PRESERVE src0_sel:WORD_0
    v_exp_f16_sdwa v28, v28 dst_sel:WORD_1 dst_unused:UNUSED_PRESERVE src0_sel:WORD_1
    v_smfmac_f32_16x16x32_f16 v[60:63], v[32:33], v[52:55], v5
    v_exp_f16_sdwa v30, v30 dst_sel:WORD_0 dst_unused:UNUSED_PRESERVE src0_sel:WORD_0
    v_exp_f16_sdwa v29, v29 dst_sel:WORD_1 dst_unused:UNUSED_PRESERVE src0_sel:WORD_1
    v_exp_f16_sdwa v31, v31 dst_sel:WORD_0 dst_unused:UNUSED_PRESERVE src0_sel:WORD_0
    v_exp_f16_sdwa v30, v30 dst_sel:WORD_1 dst_unused:UNUSED_PRESERVE src0_sel:WORD_1
    v_exp_f16_sdwa v31, v31 dst_sel:WORD_1 dst_unused:UNUSED_PRESERVE src0_sel:WORD_1
    s_nop 1
    v_smfmac_f32_16x16x64_f16 v[60:63], v[28:31], v[52:59], v5
    v_smfmac_f32_16x16x64_f16 v[44:47], v[28:31], v[68:75], v5
    v_smfmac_f32_16x16x64_f16 v[48:51], v[28:31], v[76:83], v5
    s_waitcnt lgkmcnt(0)
    v_pk_add_f16 v16, v16, v24
    v_pk_add_f16 v17, v17, v25
    v_pk_add_f16 v18, v18, v26
    v_pk_add_f16 v19, v19, v27
    s_nop 1
    v_smfmac_f32_16x16x32_f16 v[44:47], v[32:33], v[16:19], v5
    v_smfmac_f32_16x16x32_f16 v[48:51], v[32:33], v[18:21], v5
    v_rcp_f32 v36, v60
    v_rcp_f32 v37, v61
    v_rcp_f32 v38, v62
    v_rcp_f32 v39, v63
    s_nop 2
    v_pk_mul_f32 v[44:45], v[44:45], v[36:37]
    v_pk_fma_f32 v[44:45], v[46:47], v[38:39], v[44:45]
    ds_write2_b32 v9, v44, v45 offset0:0 offset1:8
    v_pk_mul_f32 v[48:49], v[48:49], v[36:37]
    v_pk_fma_f32 v[48:49], v[50:51], v[38:39], v[48:49]
    ds_write2_b32 v9, v48, v49 offset0:128 offset1:136
    ds_write_b64 v8, v[16:17] offset:0
    ds_write_b64 v8, v[18:19] offset:2048
    s_waitcnt lgkmcnt(2)
    s_barrier
    s_barrier
    s_add_u32 s58, s30, 3584
    s_addc_u32 s59, s31, 0
    s_add_u32 s24, s24, 1
    s_add_u32 s50, s24, 0
    s_and_b32 s50, s50, 3
    s_mul_i32 s50, s50, 24576
    s_add_u32 s34, s28, s50
    s_addc_u32 s35, s29, 0
    s_add_u32 s50, s24, 1
    s_and_b32 s50, s50, 3
    s_mul_i32 s50, s50, 16384
    s_add_u32 s30, s26, s50
    s_addc_u32 s31, s27, 0
    s_add_u32 s38, s38, 458752
    s_addc_u32 s39, s39, 0
    s_add_u32 s48, s48, 8192
    s_addc_u32 s49, s49, 0
    s_add_u32 s56, s56, 458752
    s_addc_u32 s57, s57, 0
    s_waitcnt vmcnt(0)
    ds_read_b128 v[52:55], v15 offset:0
    ds_read_b128 v[56:59], v15 offset:1024
    ds_read_b128 v[60:63], v15 offset:2048
    ds_read_b128 v[64:67], v15 offset:3072
    v_mov_b32 v84, 0
    v_mov_b32 v85, 0
    v_mov_b32 v86, 0
    v_mov_b32 v87, 0
    v_mov_b32 v44, 0
    v_mov_b32 v45, 0
    v_mov_b32 v46, 0
    v_mov_b32 v47, 0
    v_mov_b32 v48, 0
    v_mov_b32 v49, 0
    v_mov_b32 v50, 0
    v_mov_b32 v51, 0
    s_setprio 1
    global_load_dwordx4 v[68:71], v14, s[58:59] offset:-3584 sc1
    global_load_dwordx4 v[72:75], v14, s[58:59] offset:3584 sc1
    s_branch C0_loop
C0_mre:
    global_load_dwordx4 v[68:71], v14, s[58:59] offset:-3584 sc1
    global_load_dwordx4 v[72:75], v14, s[58:59] offset:3584 sc1
    s_sub_u32 s25, s25, 1
    s_cbranch_scc1 M_end
    s_waitcnt lgkmcnt(0)
    s_branch C0_loop
C0_gre:
    global_load_dwordx4 v[84:87], v10, s[34:35] sc1
    global_load_dwordx4 v[88:91], v10, s[34:35] offset:1024 sc1
    global_load_dword v92, v11, s[34:35] sc1
    global_load_dword v93, v11, s[34:35] offset:256 sc1
    s_sub_u32 s25, s25, 1
    s_cbranch_scc1 M_end
    s_branch C0_sp
C0_fin:
    s_setprio 0
    s_waitcnt vmcnt(0)
    ds_read_b128 v[16:19], v6 offset:0
    ds_read_b128 v[20:23], v6 offset:512
    ds_read_b128 v[24:27], v6 offset:1024
    ds_read_b128 v[28:31], v6 offset:1536
    ds_read_b128 v[32:35], v6 offset:2048
    ds_read_b128 v[36:39], v6 offset:2560
    ds_read_b128 v[40:43], v6 offset:3072
    s_add_u32 s40, s40, 7320576
    s_addc_u32 s41, s41, 0
    s_waitcnt lgkmcnt(0)
    v_smfmac_f32_16x16x64_f16 v[44:47], v[28:31], v[52:59], v5
    ds_read_b128 v[52:55], v15 offset:4096
    ds_read_b128 v[56:59], v15 offset:5120
    v_smfmac_f32_16x16x64_f16 v[44:47], v[16:19], v[96:103], v5
    v_smfmac_f32_16x16x64_f16 v[48:51], v[28:31], v[60:67], v5
    ds_read_b128 v[60:63], v15 offset:6144
    ds_read_b128 v[64:67], v15 offset:7168
    v_smfmac_f32_16x16x64_f16 v[48:51], v[16:19], v[104:111], v5
    s_waitcnt lgkmcnt(2)
    v_smfmac_f32_16x16x64_f16 v[44:47], v[32:35], v[52:59], v5
    ds_read_b128 v[52:55], v15 offset:8192
    ds_read_b128 v[56:59], v15 offset:9216
    v_smfmac_f32_16x16x64_f16 v[44:47], v[20:23], v[112:119], v5
    s_waitcnt lgkmcnt(2)
    v_smfmac_f32_16x16x64_f16 v[48:51], v[32:35], v[60:67], v5
    ds_read_b128 v[60:63], v15 offset:10240
    ds_read_b128 v[64:67], v15 offset:11264
    v_smfmac_f32_16x16x64_f16 v[48:51], v[20:23], v[120:127], v5
    s_waitcnt lgkmcnt(2)
    v_smfmac_f32_16x16x64_f16 v[44:47], v[36:39], v[52:59], v5
    ds_read_b128 v[52:55], v15 offset:12288
    ds_read_b128 v[56:59], v15 offset:13312
    v_smfmac_f32_16x16x64_f16 v[44:47], v[24:27], v[128:135], v5
    s_waitcnt lgkmcnt(2)
    v_smfmac_f32_16x16x64_f16 v[48:51], v[36:39], v[60:67], v5
    ds_read_b128 v[60:63], v15 offset:14336
    ds_read_b128 v[64:67], v15 offset:15360
    v_smfmac_f32_16x16x64_f16 v[48:51], v[24:27], v[136:143], v5
    s_waitcnt lgkmcnt(2)
    v_smfmac_f32_16x16x64_f16 v[44:47], v[40:43], v[52:59], v5
    s_waitcnt lgkmcnt(0)
    v_smfmac_f32_16x16x64_f16 v[48:51], v[40:43], v[60:67], v5
    s_nop 5
    v_cvt_pk_f16_f32 v16, v44, v45
    v_cvt_pk_f16_f32 v17, v46, v47
    v_cvt_pk_f16_f32 v18, v48, v49
    v_cvt_pk_f16_f32 v19, v50, v51
    s_barrier
    ds_read_b128 v[24:27], v12
    s_waitcnt lgkmcnt(0)
    v_pk_add_f16 v16, v16, v24
    v_pk_add_f16 v17, v17, v25
    v_pk_add_f16 v18, v18, v26
    v_pk_add_f16 v19, v19, v27
    global_store_dwordx2 v8, v[16:17], s[40:41] offset:-2048 sc1
    global_store_dwordx2 v8, v[18:19], s[40:41] offset:2048 sc1
    s_endpgm
C3_entry:
    s_add_u32 s50, s24, 0
    s_and_b32 s50, s50, 3
    s_mul_i32 s50, s50, 24576
    s_add_u32 s34, s28, s50
    s_addc_u32 s35, s29, 0
    s_add_u32 s50, s24, 1
    s_and_b32 s50, s50, 3
    s_mul_i32 s50, s50, 16384
    s_add_u32 s30, s26, s50
    s_addc_u32 s31, s27, 0
    ds_read_b128 v[52:55], v15 offset:0
    ds_read_b128 v[56:59], v15 offset:1024
    ds_read_b128 v[60:63], v15 offset:2048
    ds_read_b128 v[64:67], v15 offset:3072
    v_mov_b32 v84, 0
    v_mov_b32 v85, 0
    v_mov_b32 v86, 0
    v_mov_b32 v87, 0
    v_mov_b32 v44, 0
    v_mov_b32 v45, 0
    v_mov_b32 v46, 0
    v_mov_b32 v47, 0
    v_mov_b32 v48, 0
    v_mov_b32 v49, 0
    v_mov_b32 v50, 0
    v_mov_b32 v51, 0
    s_setprio 1
    s_branch C3_top
.p2align 6
C3_loop:
    s_waitcnt vmcnt(0)
    v_pk_add_f16 v16, v68, v72
    v_pk_add_f16 v17, v69, v73
    v_pk_add_f16 v18, v70, v74
    v_pk_add_f16 v19, v71, v75
    ds_write_b128 v14, v[16:19]
    v_pk_maximum3_f16 v20, v16, v17, v18
    v_pk_maximum3_f16 v20, v20, v19, v19
    v_cmp_u_f16 vcc, v20, v20
    s_cbranch_vccnz C3_mre
C3_got:
C3_top:
    s_cmp_eq_u32 s24, 63
    s_waitcnt lgkmcnt(0)
    s_barrier
    s_cbranch_scc1 C3_fin
    ds_read_b128 v[16:19], v3 offset:0
    ds_read_b128 v[20:23], v3 offset:512
    ds_read_b128 v[24:27], v3 offset:1024
    ds_read_b128 v[28:31], v3 offset:1536
    ds_read_b128 v[32:35], v3 offset:2048
    ds_read_b128 v[36:39], v3 offset:2560
    s_waitcnt lgkmcnt(5)
    v_smfmac_f32_16x16x64_f16 v[84:87], v[16:19], v[144:151], v5
    ds_read_b128 v[40:43], v3 offset:3072
    s_waitcnt lgkmcnt(5)
    v_smfmac_f32_16x16x64_f16 v[84:87], v[20:23], v[152:159], v5
    ds_read_b128 v[16:19], v6 offset:0
    s_waitcnt lgkmcnt(5)
    v_smfmac_f32_16x16x64_f16 v[84:87], v[24:27], v[160:167], v5
    ds_read_b128 v[20:23], v6 offset:512
    s_waitcnt lgkmcnt(5)
    v_smfmac_f32_16x16x64_f16 v[84:87], v[28:31], v[168:175], v5
    ds_read_b128 v[24:27], v6 offset:1024
    s_waitcnt lgkmcnt(5)
    v_smfmac_f32_16x16x64_f16 v[84:87], v[32:35], v[176:183], v5
    ds_read_b128 v[28:31], v6 offset:1536
    s_waitcnt lgkmcnt(5)
    v_smfmac_f32_16x16x64_f16 v[84:87], v[36:39], v[184:191], v5
    ds_read_b128 v[32:35], v6 offset:2048
    s_waitcnt lgkmcnt(5)
    v_smfmac_f32_16x16x64_f16 v[84:87], v[40:43], v[192:199], v5
    ds_read_b128 v[36:39], v6 offset:2560
    s_waitcnt lgkmcnt(5)
    v_smfmac_f32_16x16x64_f16 v[84:87], v[16:19], v[200:207], v5
    ds_read_b128 v[40:43], v6 offset:3072
    s_waitcnt lgkmcnt(5)
    v_smfmac_f32_16x16x64_f16 v[84:87], v[20:23], v[208:215], v5
    s_waitcnt lgkmcnt(4)
    v_smfmac_f32_16x16x64_f16 v[84:87], v[24:27], v[216:223], v5
    s_waitcnt lgkmcnt(3)
    v_smfmac_f32_16x16x64_f16 v[84:87], v[28:31], v[224:231], v5
    s_waitcnt lgkmcnt(2)
    v_smfmac_f32_16x16x64_f16 v[84:87], v[32:35], v[232:239], v5
    s_waitcnt lgkmcnt(1)
    v_smfmac_f32_16x16x64_f16 v[84:87], v[36:39], v[240:247], v5
    s_waitcnt lgkmcnt(0)
    v_smfmac_f32_16x16x64_f16 v[84:87], v[40:43], v[248:255], v5
    global_load_dwordx4 v[68:71], v13, s[38:39] offset:0 sc1
    global_load_dwordx4 v[72:75], v13, s[38:39] offset:1024 sc1
    s_nop 5
    v_cvt_pk_f16_f32 v84, v84, v86
    v_cvt_pk_f16_f32 v85, v85, v87
    ds_write2_b32 v7, v84, v85 offset0:0 offset1:4
    s_setprio 0
    global_load_dwordx4 v[76:79], v13, s[38:39] offset:2048 sc1
    global_load_dwordx4 v[80:83], v13, s[38:39] offset:3072 sc1
    v_smfmac_f32_16x16x64_f16 v[44:47], v[28:31], v[52:59], v5
    ds_read_b128 v[52:55], v15 offset:4096
    ds_read_b128 v[56:59], v15 offset:5120
    v_smfmac_f32_16x16x64_f16 v[44:47], v[16:19], v[96:103], v5
    v_smfmac_f32_16x16x64_f16 v[48:51], v[28:31], v[60:67], v5
    ds_read_b128 v[60:63], v15 offset:6144
    ds_read_b128 v[64:67], v15 offset:7168
    v_smfmac_f32_16x16x64_f16 v[48:51], v[16:19], v[104:111], v5
    s_waitcnt lgkmcnt(4)
    s_barrier
    s_waitcnt lgkmcnt(2)
    v_smfmac_f32_16x16x64_f16 v[44:47], v[32:35], v[52:59], v5
    ds_read_b128 v[52:55], v15 offset:8192
    ds_read_b128 v[56:59], v15 offset:9216
    v_smfmac_f32_16x16x64_f16 v[44:47], v[20:23], v[112:119], v5
    s_waitcnt lgkmcnt(2)
    v_smfmac_f32_16x16x64_f16 v[48:51], v[32:35], v[60:67], v5
    ds_read_b128 v[60:63], v15 offset:10240
    ds_read_b128 v[64:67], v15 offset:11264
    v_smfmac_f32_16x16x64_f16 v[48:51], v[20:23], v[120:127], v5
    s_barrier
    s_waitcnt lgkmcnt(2)
    v_smfmac_f32_16x16x64_f16 v[44:47], v[36:39], v[52:59], v5
    ds_read_b128 v[52:55], v15 offset:12288
    ds_read_b128 v[56:59], v15 offset:13312
    v_smfmac_f32_16x16x64_f16 v[44:47], v[24:27], v[128:135], v5
    s_waitcnt lgkmcnt(2)
    v_smfmac_f32_16x16x64_f16 v[48:51], v[36:39], v[60:67], v5
    ds_read_b128 v[60:63], v15 offset:14336
    ds_read_b128 v[64:67], v15 offset:15360
    v_smfmac_f32_16x16x64_f16 v[48:51], v[24:27], v[136:143], v5
    s_waitcnt lgkmcnt(2)
    v_smfmac_f32_16x16x64_f16 v[44:47], v[40:43], v[52:59], v5
    s_waitcnt lgkmcnt(0)
    v_smfmac_f32_16x16x64_f16 v[48:51], v[40:43], v[60:67], v5
    v_mov_b32 v52, 0x3c003c00
    v_mov_b32 v53, 0x3c003c00
    v_mov_b32 v54, 0x3c003c00
    v_mov_b32 v55, 0x3c003c00
    v_mov_b32 v56, 0x3c003c00
    v_mov_b32 v57, 0x3c003c00
    v_mov_b32 v58, 0x3c003c00
    v_mov_b32 v59, 0x3c003c00
    v_mov_b32 v60, 0
    v_mov_b32 v61, 0
    v_mov_b32 v62, 0
    v_mov_b32 v63, 0
    v_cvt_pk_f16_f32 v16, v44, v45
    v_cvt_pk_f16_f32 v17, v46, v47
    v_cvt_pk_f16_f32 v18, v48, v49
    v_cvt_pk_f16_f32 v19, v50, v51
    global_load_dwordx4 v[84:87], v10, s[34:35] sc1
    global_load_dwordx4 v[88:91], v10, s[34:35] offset:1024 sc1
    global_load_dword v92, v11, s[34:35] sc1
    global_load_dword v93, v11, s[34:35] offset:256 sc1
    v_mov_b32 v20, 0
    v_mov_b32 v21, 0
    v_mov_b32 v33, 0
    v_mov_b32 v44, 0
    v_mov_b32 v45, 0
    v_mov_b32 v46, 0
    v_mov_b32 v47, 0
    v_mov_b32 v48, 0
    v_mov_b32 v49, 0
    v_mov_b32 v50, 0
    v_mov_b32 v51, 0
    v_mov_b32 v36, s24
C3_sp:
    s_waitcnt vmcnt(0)
    v_pk_add_f16 v28, v84, v88
    v_pk_add_f16 v29, v85, v89
    v_pk_add_f16 v30, v86, v90
    v_pk_add_f16 v31, v87, v91
    v_pk_add_f16 v32, v92, v93
    v_pk_maximum3_f16 v34, v28, v29, v30
    v_pk_maximum3_f16 v34, v34, v31, v32
    v_pk_maximum3_f16 v34, v34, v34, v34 op_sel:[0,1,0] op_sel_hi:[1,0,1]
    v_mov_b32 v35, v34
    v_cmp_u_f16 vcc, v34, v34
    s_nop 0
    v_permlane32_swap_b32 v34, v35
    v_pk_max_f16 v34, v34, v35
    v_mov_b32 v35, v34
    s_cbranch_vccnz C3_gre
C3_sok:
    s_nop 0
    v_permlane16_swap_b32 v34, v35
    v_pk_max_f16 v34, v34, v35
    v_pk_add_f16 v32, v32, v34 neg_lo:[0,1] neg_hi:[0,1]
    v_pk_add_f16 v28, v28, v34 neg_lo:[0,1] neg_hi:[0,1]
    v_pk_add_f16 v29, v29, v34 neg_lo:[0,1] neg_hi:[0,1]
    v_pk_add_f16 v30, v30, v34 neg_lo:[0,1] neg_hi:[0,1]
    v_pk_add_f16 v31, v31, v34 neg_lo:[0,1] neg_hi:[0,1]
    v_exp_f16_sdwa v32, v32 dst_sel:WORD_0 dst_unused:UNUSED_PRESERVE src0_sel:WORD_0
    v_exp_f16_sdwa v28, v28 dst_sel:WORD_0 dst_unused:UNUSED_PRESERVE src0_sel:WORD_0
    s_barrier
    ds_read_b128 v[24:27], v12
    v_exp_f16_sdwa v32, v32 dst_sel:WORD_1 dst_unused:UNUSED_PRESERVE src0_sel:WORD_1
    v_exp_f16_sdwa v29, v29 dst_sel:WORD_0 dst_unused:UNUSED_PRESERVE src0_sel:WORD_0
    v_exp_f16_sdwa v28, v28 dst_sel:WORD_1 dst_unused:UNUSED_PRESERVE src0_sel:WORD_1
    v_smfmac_f32_16x16x32_f16 v[60:63], v[32:33], v[52:55], v5
    v_exp_f16_sdwa v30, v30 dst_sel:WORD_0 dst_unused:UNUSED_PRESERVE src0_sel:WORD_0
    v_exp_f16_sdwa v29, v29 dst_sel:WORD_1 dst_unused:UNUSED_PRESERVE src0_sel:WORD_1
    v_exp_f16_sdwa v31, v31 dst_sel:WORD_0 dst_unused:UNUSED_PRESERVE src0_sel:WORD_0
    global_store_dword v4, v36, s[26:27]
    v_exp_f16_sdwa v30, v30 dst_sel:WORD_1 dst_unused:UNUSED_PRESERVE src0_sel:WORD_1
    v_exp_f16_sdwa v31, v31 dst_sel:WORD_1 dst_unused:UNUSED_PRESERVE src0_sel:WORD_1
    s_nop 1
    v_smfmac_f32_16x16x64_f16 v[60:63], v[28:31], v[52:59], v5
    v_smfmac_f32_16x16x64_f16 v[44:47], v[28:31], v[68:75], v5
    v_smfmac_f32_16x16x64_f16 v[48:51], v[28:31], v[76:83], v5
    s_waitcnt lgkmcnt(0)
    v_pk_add_f16 v16, v16, v24
    v_pk_add_f16 v17, v17, v25
    v_pk_add_f16 v18, v18, v26
    v_pk_add_f16 v19, v19, v27
    s_nop 1
    v_smfmac_f32_16x16x32_f16 v[44:47], v[32:33], v[16:19], v5
    v_smfmac_f32_16x16x32_f16 v[48:51], v[32:33], v[18:21], v5
    v_rcp_f32 v36, v60
    v_rcp_f32 v37, v61
    v_rcp_f32 v38, v62
    v_rcp_f32 v39, v63
    s_nop 2
    v_pk_mul_f32 v[44:45], v[44:45], v[36:37]
    v_pk_fma_f32 v[44:45], v[46:47], v[38:39], v[44:45]
    ds_write2_b32 v9, v44, v45 offset0:0 offset1:8
    v_pk_mul_f32 v[48:49], v[48:49], v[36:37]
    v_pk_fma_f32 v[48:49], v[50:51], v[38:39], v[48:49]
    ds_write2_b32 v9, v48, v49 offset0:128 offset1:136
    ds_write_b64 v8, v[16:17] offset:0
    ds_write_b64 v8, v[18:19] offset:2048
    s_waitcnt lgkmcnt(2)
    s_barrier
    s_barrier
    s_add_u32 s58, s30, 3584
    s_addc_u32 s59, s31, 0
    s_add_u32 s24, s24, 1
    s_add_u32 s50, s24, 0
    s_and_b32 s50, s50, 3
    s_mul_i32 s50, s50, 24576
    s_add_u32 s34, s28, s50
    s_addc_u32 s35, s29, 0
    s_add_u32 s50, s24, 1
    s_and_b32 s50, s50, 3
    s_mul_i32 s50, s50, 16384
    s_add_u32 s30, s26, s50
    s_addc_u32 s31, s27, 0
    s_add_u32 s38, s38, 458752
    s_addc_u32 s39, s39, 0
    s_add_u32 s48, s48, 8192
    s_addc_u32 s49, s49, 0
    s_add_u32 s56, s56, 458752
    s_addc_u32 s57, s57, 0
    s_waitcnt vmcnt(0)
    ds_read_b128 v[52:55], v15 offset:0
    ds_read_b128 v[56:59], v15 offset:1024
    ds_read_b128 v[60:63], v15 offset:2048
    ds_read_b128 v[64:67], v15 offset:3072
    v_mov_b32 v84, 0
    v_mov_b32 v85, 0
    v_mov_b32 v86, 0
    v_mov_b32 v87, 0
    v_mov_b32 v44, 0
    v_mov_b32 v45, 0
    v_mov_b32 v46, 0
    v_mov_b32 v47, 0
    v_mov_b32 v48, 0
    v_mov_b32 v49, 0
    v_mov_b32 v50, 0
    v_mov_b32 v51, 0
    s_setprio 1
    global_load_dwordx4 v[68:71], v14, s[58:59] offset:-3584 sc1
    global_load_dwordx4 v[72:75], v14, s[58:59] offset:3584 sc1
    s_branch C3_loop
C3_mre:
    global_load_dwordx4 v[68:71], v14, s[58:59] offset:-3584 sc1
    global_load_dwordx4 v[72:75], v14, s[58:59] offset:3584 sc1
    s_sub_u32 s25, s25, 1
    s_cbranch_scc1 M_end
    s_waitcnt lgkmcnt(0)
    s_branch C3_loop
C3_gre:
    global_load_dwordx4 v[84:87], v10, s[34:35] sc1
    global_load_dwordx4 v[88:91], v10, s[34:35] offset:1024 sc1
    global_load_dword v92, v11, s[34:35] sc1
    global_load_dword v93, v11, s[34:35] offset:256 sc1
    s_sub_u32 s25, s25, 1
    s_cbranch_scc1 M_end
    s_branch C3_sp
C3_fin:
    s_setprio 0
    s_waitcnt vmcnt(0)
    ds_read_b128 v[16:19], v6 offset:0
    ds_read_b128 v[20:23], v6 offset:512
    ds_read_b128 v[24:27], v6 offset:1024
    ds_read_b128 v[28:31], v6 offset:1536
    ds_read_b128 v[32:35], v6 offset:2048
    ds_read_b128 v[36:39], v6 offset:2560
    ds_read_b128 v[40:43], v6 offset:3072
    s_add_u32 s40, s40, 7320576
    s_addc_u32 s41, s41, 0
    s_waitcnt lgkmcnt(0)
    v_smfmac_f32_16x16x64_f16 v[44:47], v[28:31], v[52:59], v5
    ds_read_b128 v[52:55], v15 offset:4096
    ds_read_b128 v[56:59], v15 offset:5120
    v_smfmac_f32_16x16x64_f16 v[44:47], v[16:19], v[96:103], v5
    v_smfmac_f32_16x16x64_f16 v[48:51], v[28:31], v[60:67], v5
    ds_read_b128 v[60:63], v15 offset:6144
    ds_read_b128 v[64:67], v15 offset:7168
    v_smfmac_f32_16x16x64_f16 v[48:51], v[16:19], v[104:111], v5
    s_waitcnt lgkmcnt(2)
    v_smfmac_f32_16x16x64_f16 v[44:47], v[32:35], v[52:59], v5
    ds_read_b128 v[52:55], v15 offset:8192
    ds_read_b128 v[56:59], v15 offset:9216
    v_smfmac_f32_16x16x64_f16 v[44:47], v[20:23], v[112:119], v5
    s_waitcnt lgkmcnt(2)
    v_smfmac_f32_16x16x64_f16 v[48:51], v[32:35], v[60:67], v5
    ds_read_b128 v[60:63], v15 offset:10240
    ds_read_b128 v[64:67], v15 offset:11264
    v_smfmac_f32_16x16x64_f16 v[48:51], v[20:23], v[120:127], v5
    s_waitcnt lgkmcnt(2)
    v_smfmac_f32_16x16x64_f16 v[44:47], v[36:39], v[52:59], v5
    ds_read_b128 v[52:55], v15 offset:12288
    ds_read_b128 v[56:59], v15 offset:13312
    v_smfmac_f32_16x16x64_f16 v[44:47], v[24:27], v[128:135], v5
    s_waitcnt lgkmcnt(2)
    v_smfmac_f32_16x16x64_f16 v[48:51], v[36:39], v[60:67], v5
    ds_read_b128 v[60:63], v15 offset:14336
    ds_read_b128 v[64:67], v15 offset:15360
    v_smfmac_f32_16x16x64_f16 v[48:51], v[24:27], v[136:143], v5
    s_waitcnt lgkmcnt(2)
    v_smfmac_f32_16x16x64_f16 v[44:47], v[40:43], v[52:59], v5
    s_waitcnt lgkmcnt(0)
    v_smfmac_f32_16x16x64_f16 v[48:51], v[40:43], v[60:67], v5
    s_nop 5
    v_cvt_pk_f16_f32 v16, v44, v45
    v_cvt_pk_f16_f32 v17, v46, v47
    v_cvt_pk_f16_f32 v18, v48, v49
    v_cvt_pk_f16_f32 v19, v50, v51
    s_barrier
    ds_read_b128 v[24:27], v12
    s_waitcnt lgkmcnt(0)
    v_pk_add_f16 v16, v16, v24
    v_pk_add_f16 v17, v17, v25
    v_pk_add_f16 v18, v18, v26
    v_pk_add_f16 v19, v19, v27
    global_store_dwordx2 v8, v[16:17], s[40:41] offset:-2048 sc1
    global_store_dwordx2 v8, v[18:19], s[40:41] offset:2048 sc1
    s_endpgm
C4_entry:
    s_add_u32 s50, s24, 1
    s_and_b32 s50, s50, 3
    s_mul_i32 s50, s50, 16384
    s_add_u32 s30, s26, s50
    s_addc_u32 s31, s27, 0
    s_add_u32 s54, s54, 458752
    s_addc_u32 s55, s55, 0
    ds_read_b128 v[52:55], v15 offset:0
    ds_read_b128 v[56:59], v15 offset:1024
    ds_read_b128 v[60:63], v15 offset:2048
    ds_read_b128 v[64:67], v15 offset:3072
    v_mov_b32 v44, 0
    v_mov_b32 v45, 0
    v_mov_b32 v46, 0
    v_mov_b32 v47, 0
    s_setprio 1
    s_branch C4_top
.p2align 6
C4_loop:
    s_waitcnt vmcnt(0)
    v_pk_add_f16 v16, v68, v72
    v_pk_add_f16 v17, v69, v73
    v_pk_add_f16 v18, v70, v74
    v_pk_add_f16 v19, v71, v75
    ds_write_b128 v14, v[16:19]
    v_pk_maximum3_f16 v20, v16, v17, v18
    v_pk_maximum3_f16 v20, v20, v19, v19
    v_cmp_u_f16 vcc, v20, v20
    s_cbranch_vccnz C4_mre
C4_got:
C4_top:
    s_cmp_eq_u32 s24, 63
    s_waitcnt lgkmcnt(0)
    s_barrier
    s_cbranch_scc1 C4_fin
    ds_read_b128 v[16:19], v3 offset:0
    ds_read_b128 v[20:23], v3 offset:512
    ds_read_b128 v[24:27], v3 offset:1024
    ds_read_b128 v[28:31], v3 offset:1536
    ds_read_b128 v[32:35], v3 offset:2048
    ds_read_b128 v[36:39], v3 offset:2560
    ds_read_b128 v[40:43], v3 offset:3072
    s_waitcnt lgkmcnt(6)
    v_smfmac_f32_16x16x64_f16 v[44:47], v[16:19], v[144:151], v5
    ds_read_b128 v[16:19], v6 offset:0
    s_waitcnt lgkmcnt(6)
    v_smfmac_f32_16x16x64_f16 v[44:47], v[20:23], v[152:159], v5
    ds_read_b128 v[20:23], v6 offset:512
    s_waitcnt lgkmcnt(6)
    v_smfmac_f32_16x16x64_f16 v[44:47], v[24:27], v[160:167], v5
    ds_read_b128 v[24:27], v6 offset:1024
    s_waitcnt lgkmcnt(6)
    v_smfmac_f32_16x16x64_f16 v[44:47], v[28:31], v[168:175], v5
    ds_read_b128 v[28:31], v6 offset:1536
    s_waitcnt lgkmcnt(6)
    v_smfmac_f32_16x16x64_f16 v[44:47], v[32:35], v[176:183], v5
    ds_read_b128 v[32:35], v6 offset:2048
    s_waitcnt lgkmcnt(6)
    v_smfmac_f32_16x16x64_f16 v[44:47], v[36:39], v[184:191], v5
    ds_read_b128 v[36:39], v6 offset:2560
    s_waitcnt lgkmcnt(6)
    v_smfmac_f32_16x16x64_f16 v[44:47], v[40:43], v[192:199], v5
    ds_read_b128 v[40:43], v6 offset:3072
    s_waitcnt lgkmcnt(6)
    v_smfmac_f32_16x16x64_f16 v[44:47], v[16:19], v[200:207], v5
    s_waitcnt lgkmcnt(5)
    v_smfmac_f32_16x16x64_f16 v[44:47], v[20:23], v[208:215], v5
    s_waitcnt lgkmcnt(4)
    v_smfmac_f32_16x16x64_f16 v[44:47], v[24:27], v[216:223], v5
    s_waitcnt lgkmcnt(3)
    v_smfmac_f32_16x16x64_f16 v[44:47], v[28:31], v[224:231], v5
    s_waitcnt lgkmcnt(2)
    v_smfmac_f32_16x16x64_f16 v[44:47], v[32:35], v[232:239], v5
    s_waitcnt lgkmcnt(1)
    v_smfmac_f32_16x16x64_f16 v[44:47], v[36:39], v[240:247], v5
    s_waitcnt lgkmcnt(0)
    v_smfmac_f32_16x16x64_f16 v[44:47], v[40:43], v[248:255], v5
    s_nop 7
    v_cvt_pk_f16_f32 v44, v44, v46
    v_cvt_pk_f16_f32 v45, v45, v47
    ds_write2_b32 v7, v44, v45 offset0:0 offset1:4
    s_waitcnt lgkmcnt(0)
    s_barrier
    s_setprio 0
    v_mov_b32 v44, 0
    v_mov_b32 v45, 0
    v_mov_b32 v46, 0
    v_mov_b32 v47, 0
    v_mov_b32 v48, 0
    v_mov_b32 v49, 0
    v_mov_b32 v50, 0
    v_mov_b32 v51, 0
    v_smfmac_f32_16x16x64_f16 v[44:47], v[28:31], v[52:59], v5
    ds_read_b128 v[52:55], v15 offset:4096
    ds_read_b128 v[56:59], v15 offset:5120
    v_smfmac_f32_16x16x64_f16 v[44:47], v[16:19], v[96:103], v5
    v_smfmac_f32_16x16x64_f16 v[48:51], v[28:31], v[60:67], v5
    ds_read_b128 v[60:63], v15 offset:6144
    ds_read_b128 v[64:67], v15 offset:7168
    v_smfmac_f32_16x16x64_f16 v[48:51], v[16:19], v[104:111], v5
    s_waitcnt lgkmcnt(2)
    v_smfmac_f32_16x16x64_f16 v[44:47], v[32:35], v[52:59], v5
    ds_read_b128 v[52:55], v15 offset:8192
    ds_read_b128 v[56:59], v15 offset:9216
    v_smfmac_f32_16x16x64_f16 v[44:47], v[20:23], v[112:119], v5
    s_waitcnt lgkmcnt(2)
    v_smfmac_f32_16x16x64_f16 v[48:51], v[32:35], v[60:67], v5
    ds_read_b128 v[60:63], v15 offset:10240
    ds_read_b128 v[64:67], v15 offset:11264
    v_smfmac_f32_16x16x64_f16 v[48:51], v[20:23], v[120:127], v5
    s_barrier
    s_waitcnt lgkmcnt(2)
    v_smfmac_f32_16x16x64_f16 v[44:47], v[36:39], v[52:59], v5
    ds_read_b128 v[52:55], v15 offset:12288
    ds_read_b128 v[56:59], v15 offset:13312
    v_smfmac_f32_16x16x64_f16 v[44:47], v[24:27], v[128:135], v5
    s_waitcnt lgkmcnt(2)
    v_smfmac_f32_16x16x64_f16 v[48:51], v[36:39], v[60:67], v5
    ds_read_b128 v[60:63], v15 offset:14336
    ds_read_b128 v[64:67], v15 offset:15360
    v_smfmac_f32_16x16x64_f16 v[48:51], v[24:27], v[136:143], v5
    s_waitcnt lgkmcnt(2)
    v_smfmac_f32_16x16x64_f16 v[44:47], v[40:43], v[52:59], v5
    s_waitcnt lgkmcnt(0)
    v_smfmac_f32_16x16x64_f16 v[48:51], v[40:43], v[60:67], v5
    s_nop 5
    v_cvt_pk_f16_f32 v16, v44, v45
    v_cvt_pk_f16_f32 v17, v46, v47
    v_cvt_pk_f16_f32 v18, v48, v49
    v_cvt_pk_f16_f32 v19, v50, v51
    ds_write_b128 v12, v[16:19]
    s_waitcnt lgkmcnt(0)
    s_load_dword s96, s[54:55], 6912
    s_load_dword s96, s[54:55], 7040
    s_load_dword s96, s[54:55], 7168
    s_load_dword s96, s[54:55], 7296
    s_load_dword s96, s[54:55], 7424
    s_load_dword s96, s[54:55], 7552
    s_load_dword s96, s[54:55], 7680
    s_load_dword s96, s[54:55], 7808
    s_load_dword s96, s[54:55], 7936
    s_load_dword s96, s[54:55], 8064
    s_load_dword s96, s[54:55], 8192
    s_load_dword s96, s[54:55], 8320
    s_load_dword s96, s[54:55], 8448
    s_load_dword s96, s[54:55], 8576
    s_barrier
    s_barrier
    s_barrier
    s_add_u32 s58, s30, 3584
    s_addc_u32 s59, s31, 0
    s_add_u32 s24, s24, 1
    s_add_u32 s50, s24, 1
    s_and_b32 s50, s50, 3
    s_mul_i32 s50, s50, 16384
    s_add_u32 s30, s26, s50
    s_addc_u32 s31, s27, 0
    s_add_u32 s54, s54, 458752
    s_addc_u32 s55, s55, 0
    s_add_u32 s56, s56, 458752
    s_addc_u32 s57, s57, 0
    ds_read_b128 v[52:55], v15 offset:0
    ds_read_b128 v[56:59], v15 offset:1024
    ds_read_b128 v[60:63], v15 offset:2048
    ds_read_b128 v[64:67], v15 offset:3072
    v_mov_b32 v44, 0
    v_mov_b32 v45, 0
    v_mov_b32 v46, 0
    v_mov_b32 v47, 0
    s_setprio 1
    global_load_dwordx4 v[68:71], v14, s[58:59] offset:-3584 sc1
    global_load_dwordx4 v[72:75], v14, s[58:59] offset:3584 sc1
    s_branch C4_loop
C4_mre:
    global_load_dwordx4 v[68:71], v14, s[58:59] offset:-3584 sc1
    global_load_dwordx4 v[72:75], v14, s[58:59] offset:3584 sc1
    s_sub_u32 s25, s25, 1
    s_cbranch_scc1 M_end
    s_waitcnt lgkmcnt(0)
    s_branch C4_loop
C4_fin:
    s_setprio 0
    s_waitcnt vmcnt(0)
    ds_read_b128 v[16:19], v6 offset:0
    ds_read_b128 v[20:23], v6 offset:512
    ds_read_b128 v[24:27], v6 offset:1024
    ds_read_b128 v[28:31], v6 offset:1536
    ds_read_b128 v[32:35], v6 offset:2048
    ds_read_b128 v[36:39], v6 offset:2560
    ds_read_b128 v[40:43], v6 offset:3072
    v_mov_b32 v48, 0
    v_mov_b32 v49, 0
    v_mov_b32 v50, 0
    v_mov_b32 v51, 0
    s_waitcnt lgkmcnt(0)
    v_smfmac_f32_16x16x64_f16 v[44:47], v[28:31], v[52:59], v5
    ds_read_b128 v[52:55], v15 offset:4096
    ds_read_b128 v[56:59], v15 offset:5120
    v_smfmac_f32_16x16x64_f16 v[44:47], v[16:19], v[96:103], v5
    v_smfmac_f32_16x16x64_f16 v[48:51], v[28:31], v[60:67], v5
    ds_read_b128 v[60:63], v15 offset:6144
    ds_read_b128 v[64:67], v15 offset:7168
    v_smfmac_f32_16x16x64_f16 v[48:51], v[16:19], v[104:111], v5
    s_waitcnt lgkmcnt(2)
    v_smfmac_f32_16x16x64_f16 v[44:47], v[32:35], v[52:59], v5
    ds_read_b128 v[52:55], v15 offset:8192
    ds_read_b128 v[56:59], v15 offset:9216
    v_smfmac_f32_16x16x64_f16 v[44:47], v[20:23], v[112:119], v5
    s_waitcnt lgkmcnt(2)
    v_smfmac_f32_16x16x64_f16 v[48:51], v[32:35], v[60:67], v5
    ds_read_b128 v[60:63], v15 offset:10240
    ds_read_b128 v[64:67], v15 offset:11264
    v_smfmac_f32_16x16x64_f16 v[48:51], v[20:23], v[120:127], v5
    s_waitcnt lgkmcnt(2)
    v_smfmac_f32_16x16x64_f16 v[44:47], v[36:39], v[52:59], v5
    ds_read_b128 v[52:55], v15 offset:12288
    ds_read_b128 v[56:59], v15 offset:13312
    v_smfmac_f32_16x16x64_f16 v[44:47], v[24:27], v[128:135], v5
    s_waitcnt lgkmcnt(2)
    v_smfmac_f32_16x16x64_f16 v[48:51], v[36:39], v[60:67], v5
    ds_read_b128 v[60:63], v15 offset:14336
    ds_read_b128 v[64:67], v15 offset:15360
    v_smfmac_f32_16x16x64_f16 v[48:51], v[24:27], v[136:143], v5
    s_waitcnt lgkmcnt(2)
    v_smfmac_f32_16x16x64_f16 v[44:47], v[40:43], v[52:59], v5
    s_waitcnt lgkmcnt(0)
    v_smfmac_f32_16x16x64_f16 v[48:51], v[40:43], v[60:67], v5
    s_nop 5
    v_cvt_pk_f16_f32 v16, v44, v45
    v_cvt_pk_f16_f32 v17, v46, v47
    v_cvt_pk_f16_f32 v18, v48, v49
    v_cvt_pk_f16_f32 v19, v50, v51
    ds_write_b128 v12, v[16:19]
    s_waitcnt lgkmcnt(0)
    s_barrier
    s_endpgm
C5_entry:
    s_add_u32 s50, s24, 0
    s_and_b32 s50, s50, 3
    s_mul_i32 s50, s50, 24576
    s_add_u32 s34, s28, s50
    s_addc_u32 s35, s29, 0
    s_add_u32 s50, s24, 3
    s_and_b32 s50, s50, 3
    s_mul_i32 s50, s50, 24576
    s_add_u32 s36, s28, s50
    s_addc_u32 s37, s29, 0
    s_add_u32 s50, s24, 1
    s_and_b32 s50, s50, 3
    s_mul_i32 s50, s50, 16384
    s_add_u32 s30, s26, s50
    s_addc_u32 s31, s27, 0
    s_add_u32 s54, s54, 458752
    s_addc_u32 s55, s55, 0
    ds_read_b128 v[52:55], v15 offset:0
    ds_read_b128 v[56:59], v15 offset:1024
    ds_read_b128 v[60:63], v15 offset:2048
    ds_read_b128 v[64:67], v15 offset:3072
    v_mov_b32 v44, 0
    v_mov_b32 v45, 0
    v_mov_b32 v46, 0
    v_mov_b32 v47, 0
    s_setprio 1
    s_branch C5_top
.p2align 6
C5_loop:
    s_waitcnt vmcnt(0)
    v_pk_add_f16 v16, v68, v72
    v_pk_add_f16 v17, v69, v73
    v_pk_add_f16 v18, v70, v74
    v_pk_add_f16 v19, v71, v75
    ds_write_b128 v14, v[16:19]
    v_pk_maximum3_f16 v20, v16, v17, v18
    v_pk_maximum3_f16 v20, v20, v19, v19
    v_cmp_u_f16 vcc, v20, v20
    s_cbranch_vccnz C5_mre
C5_got:
C5_top:
    s_cmp_eq_u32 s24, 63
    s_waitcnt lgkmcnt(0)
    s_barrier
    s_cbranch_scc1 C5_fin
    ds_read_b128 v[16:19], v3 offset:0
    ds_read_b128 v[20:23], v3 offset:512
    ds_read_b128 v[24:27], v3 offset:1024
    ds_read_b128 v[28:31], v3 offset:1536
    ds_read_b128 v[32:35], v3 offset:2048
    ds_read_b128 v[36:39], v3 offset:2560
    ds_read_b128 v[40:43], v3 offset:3072
    s_waitcnt lgkmcnt(6)
    v_smfmac_f32_16x16x64_f16 v[44:47], v[16:19], v[144:151], v5
    ds_read_b128 v[16:19], v6 offset:0
    s_waitcnt lgkmcnt(6)
    v_smfmac_f32_16x16x64_f16 v[44:47], v[20:23], v[152:159], v5
    ds_read_b128 v[20:23], v6 offset:512
    s_waitcnt lgkmcnt(6)
    v_smfmac_f32_16x16x64_f16 v[44:47], v[24:27], v[160:167], v5
    ds_read_b128 v[24:27], v6 offset:1024
    s_waitcnt lgkmcnt(6)
    v_smfmac_f32_16x16x64_f16 v[44:47], v[28:31], v[168:175], v5
    ds_read_b128 v[28:31], v6 offset:1536
    s_waitcnt lgkmcnt(6)
    v_smfmac_f32_16x16x64_f16 v[44:47], v[32:35], v[176:183], v5
    ds_read_b128 v[32:35], v6 offset:2048
    s_waitcnt lgkmcnt(6)
    v_smfmac_f32_16x16x64_f16 v[44:47], v[36:39], v[184:191], v5
    ds_read_b128 v[36:39], v6 offset:2560
    s_waitcnt lgkmcnt(6)
    v_smfmac_f32_16x16x64_f16 v[44:47], v[40:43], v[192:199], v5
    ds_read_b128 v[40:43], v6 offset:3072
    s_waitcnt lgkmcnt(6)
    v_smfmac_f32_16x16x64_f16 v[44:47], v[16:19], v[200:207], v5
    s_waitcnt lgkmcnt(5)
    v_smfmac_f32_16x16x64_f16 v[44:47], v[20:23], v[208:215], v5
    s_waitcnt lgkmcnt(4)
    v_smfmac_f32_16x16x64_f16 v[44:47], v[24:27], v[216:223], v5
    s_waitcnt lgkmcnt(3)
    v_smfmac_f32_16x16x64_f16 v[44:47], v[28:31], v[224:231], v5
    s_waitcnt lgkmcnt(2)
    v_smfmac_f32_16x16x64_f16 v[44:47], v[32:35], v[232:239], v5
    s_waitcnt lgkmcnt(1)
    v_smfmac_f32_16x16x64_f16 v[44:47], v[36:39], v[240:247], v5
    s_waitcnt lgkmcnt(0)
    v_smfmac_f32_16x16x64_f16 v[44:47], v[40:43], v[248:255], v5
    s_nop 7
    v_cvt_pk_f16_f32 v44, v44, v46
    v_cvt_pk_f16_f32 v45, v45, v47
    ds_write2_b32 v7, v44, v45 offset0:0 offset1:4
    s_waitcnt lgkmcnt(0)
    s_waitcnt vmcnt(0)
    s_barrier
    s_setprio 0
    ds_read2_b64 v[68:71], v8 offset0:0 offset1:16
    ds_read2_b64 v[72:75], v8 offset0:64 offset1:80
    ds_read2_b64 v[76:79], v8 offset0:128 offset1:144
    ds_read2_b64 v[80:83], v8 offset0:192 offset1:208
    ds_read2_b64 v[84:87], v10 offset0:0 offset1:16
    ds_read2_b64 v[88:91], v10 offset0:64 offset1:80
    ds_read2_b64 v[92:95], v10 offset0:128 offset1:144
    s_waitcnt lgkmcnt(6)
    v_mfma_f32_16x16x32_f16 v[44:47], v[16:19], v[68:71], 0
    s_waitcnt lgkmcnt(5)
    v_mfma_f32_16x16x32_f16 v[44:47], v[20:23], v[72:75], v[44:47]
    s_waitcnt lgkmcnt(4)
    v_mfma_f32_16x16x32_f16 v[44:47], v[24:27], v[76:79], v[44:47]
    s_waitcnt lgkmcnt(3)
    v_mfma_f32_16x16x32_f16 v[44:47], v[28:31], v[80:83], v[44:47]
    s_waitcnt lgkmcnt(2)
    v_mfma_f32_16x16x32_f16 v[44:47], v[32:35], v[84:87], v[44:47]
    s_waitcnt lgkmcnt(1)
    v_mfma_f32_16x16x32_f16 v[44:47], v[36:39], v[88:91], v[44:47]
    s_waitcnt lgkmcnt(0)
    v_mfma_f32_16x16x32_f16 v[44:47], v[40:43], v[92:95], v[44:47]
    s_mov_b64 exec, s[46:47]
    s_nop 6
    v_cvt_pk_f16_f32 v76, v44, v45
    global_store_dword v9, v76, s[34:35]
    s_mov_b64 exec, -1
    s_setprio 0
    s_barrier
    v_mov_b32 v44, 0
    v_mov_b32 v45, 0
    v_mov_b32 v46, 0
    v_mov_b32 v47, 0
    v_mov_b32 v48, 0
    v_mov_b32 v49, 0
    v_mov_b32 v50, 0
    v_mov_b32 v51, 0
    v_smfmac_f32_16x16x64_f16 v[44:47], v[28:31], v[52:59], v5
    ds_read_b128 v[52:55], v15 offset:4096
    ds_read_b128 v[56:59], v15 offset:5120
    v_smfmac_f32_16x16x64_f16 v[44:47], v[16:19], v[96:103], v5
    v_smfmac_f32_16x16x64_f16 v[48:51], v[28:31], v[60:67], v5
    ds_read_b128 v[60:63], v15 offset:6144
    ds_read_b128 v[64:67], v15 offset:7168
    v_smfmac_f32_16x16x64_f16 v[48:51], v[16:19], v[104:111], v5
    s_waitcnt lgkmcnt(2)
    v_smfmac_f32_16x16x64_f16 v[44:47], v[32:35], v[52:59], v5
    ds_read_b128 v[52:55], v15 offset:8192
    ds_read_b128 v[56:59], v15 offset:9216
    v_smfmac_f32_16x16x64_f16 v[44:47], v[20:23], v[112:119], v5
    s_waitcnt lgkmcnt(2)
    v_smfmac_f32_16x16x64_f16 v[48:51], v[32:35], v[60:67], v5
    ds_read_b128 v[60:63], v15 offset:10240
    ds_read_b128 v[64:67], v15 offset:11264
    v_smfmac_f32_16x16x64_f16 v[48:51], v[20:23], v[120:127], v5
    s_waitcnt lgkmcnt(2)
    v_smfmac_f32_16x16x64_f16 v[44:47], v[36:39], v[52:59], v5
    ds_read_b128 v[52:55], v15 offset:12288
    ds_read_b128 v[56:59], v15 offset:13312
    v_smfmac_f32_16x16x64_f16 v[44:47], v[24:27], v[128:135], v5
    s_waitcnt lgkmcnt(2)
    v_smfmac_f32_16x16x64_f16 v[48:51], v[36:39], v[60:67], v5
    ds_read_b128 v[60:63], v15 offset:14336
    ds_read_b128 v[64:67], v15 offset:15360
    v_smfmac_f32_16x16x64_f16 v[48:51], v[24:27], v[136:143], v5
    s_waitcnt lgkmcnt(2)
    v_smfmac_f32_16x16x64_f16 v[44:47], v[40:43], v[52:59], v5
    s_waitcnt lgkmcnt(0)
    v_smfmac_f32_16x16x64_f16 v[48:51], v[40:43], v[60:67], v5
    s_nop 5
    v_cvt_pk_f16_f32 v16, v44, v45
    v_cvt_pk_f16_f32 v17, v46, v47
    v_cvt_pk_f16_f32 v18, v48, v49
    v_cvt_pk_f16_f32 v19, v50, v51
    ds_write_b128 v12, v[16:19]
    s_waitcnt lgkmcnt(0)
    s_barrier
    v_mov_b32 v48, -1
    v_mov_b32 v49, -1
    s_mov_b64 exec, s[46:47]
    global_store_dword v9, v48, s[36:37]
    s_mov_b64 exec, -1
    s_load_dword s96, s[54:55], 8704
    s_load_dword s96, s[54:55], 8832
    s_load_dword s96, s[54:55], 8960
    s_load_dword s96, s[54:55], 9088
    s_load_dword s96, s[54:55], 9216
    s_load_dword s96, s[54:55], 9344
    s_load_dword s96, s[54:55], 9472
    s_load_dword s96, s[54:55], 9600
    s_load_dword s96, s[54:55], 9728
    s_load_dword s96, s[54:55], 9856
    s_load_dword s96, s[54:55], 9984
    s_load_dword s96, s[54:55], 10112
    s_load_dword s96, s[54:55], 10240
    s_load_dword s96, s[54:55], 10368
    s_barrier
    s_barrier
    s_add_u32 s58, s30, 3584
    s_addc_u32 s59, s31, 0
    s_add_u32 s24, s24, 1
    s_add_u32 s50, s24, 0
    s_and_b32 s50, s50, 3
    s_mul_i32 s50, s50, 24576
    s_add_u32 s34, s28, s50
    s_addc_u32 s35, s29, 0
    s_add_u32 s50, s24, 3
    s_and_b32 s50, s50, 3
    s_mul_i32 s50, s50, 24576
    s_add_u32 s36, s28, s50
    s_addc_u32 s37, s29, 0
    s_add_u32 s50, s24, 1
    s_and_b32 s50, s50, 3
    s_mul_i32 s50, s50, 16384
    s_add_u32 s30, s26, s50
    s_addc_u32 s31, s27, 0
    s_add_u32 s54, s54, 458752
    s_addc_u32 s55, s55, 0
    ds_read_b128 v[52:55], v15 offset:0
    ds_read_b128 v[56:59], v15 offset:1024
    ds_read_b128 v[60:63], v15 offset:2048
    ds_read_b128 v[64:67], v15 offset:3072
    v_mov_b32 v44, 0
    v_mov_b32 v45, 0
    v_mov_b32 v46, 0
    v_mov_b32 v47, 0
    s_setprio 1
    global_load_dwordx4 v[68:71], v14, s[58:59] offset:-3584 sc1
    global_load_dwordx4 v[72:75], v14, s[58:59] offset:3584 sc1
    s_branch C5_loop
C5_mre:
    global_load_dwordx4 v[68:71], v14, s[58:59] offset:-3584 sc1
    global_load_dwordx4 v[72:75], v14, s[58:59] offset:3584 sc1
    s_sub_u32 s25, s25, 1
    s_cbranch_scc1 M_end
    s_waitcnt lgkmcnt(0)
    s_branch C5_loop
C5_fin:
    s_setprio 0
    s_waitcnt vmcnt(0)
    ds_read_b128 v[16:19], v6 offset:0
    ds_read_b128 v[20:23], v6 offset:512
    ds_read_b128 v[24:27], v6 offset:1024
    ds_read_b128 v[28:31], v6 offset:1536
    ds_read_b128 v[32:35], v6 offset:2048
    ds_read_b128 v[36:39], v6 offset:2560
    ds_read_b128 v[40:43], v6 offset:3072
    v_mov_b32 v48, 0
    v_mov_b32 v49, 0
    v_mov_b32 v50, 0
    v_mov_b32 v51, 0
    s_waitcnt lgkmcnt(0)
    v_smfmac_f32_16x16x64_f16 v[44:47], v[28:31], v[52:59], v5
    ds_read_b128 v[52:55], v15 offset:4096
    ds_read_b128 v[56:59], v15 offset:5120
    v_smfmac_f32_16x16x64_f16 v[44:47], v[16:19], v[96:103], v5
    v_smfmac_f32_16x16x64_f16 v[48:51], v[28:31], v[60:67], v5
    ds_read_b128 v[60:63], v15 offset:6144
    ds_read_b128 v[64:67], v15 offset:7168
    v_smfmac_f32_16x16x64_f16 v[48:51], v[16:19], v[104:111], v5
    s_waitcnt lgkmcnt(2)
    v_smfmac_f32_16x16x64_f16 v[44:47], v[32:35], v[52:59], v5
    ds_read_b128 v[52:55], v15 offset:8192
    ds_read_b128 v[56:59], v15 offset:9216
    v_smfmac_f32_16x16x64_f16 v[44:47], v[20:23], v[112:119], v5
    s_waitcnt lgkmcnt(2)
    v_smfmac_f32_16x16x64_f16 v[48:51], v[32:35], v[60:67], v5
    ds_read_b128 v[60:63], v15 offset:10240
    ds_read_b128 v[64:67], v15 offset:11264
    v_smfmac_f32_16x16x64_f16 v[48:51], v[20:23], v[120:127], v5
    s_waitcnt lgkmcnt(2)
    v_smfmac_f32_16x16x64_f16 v[44:47], v[36:39], v[52:59], v5
    ds_read_b128 v[52:55], v15 offset:12288
    ds_read_b128 v[56:59], v15 offset:13312
    v_smfmac_f32_16x16x64_f16 v[44:47], v[24:27], v[128:135], v5
    s_waitcnt lgkmcnt(2)
    v_smfmac_f32_16x16x64_f16 v[48:51], v[36:39], v[60:67], v5
    ds_read_b128 v[60:63], v15 offset:14336
    ds_read_b128 v[64:67], v15 offset:15360
    v_smfmac_f32_16x16x64_f16 v[48:51], v[24:27], v[136:143], v5
    s_waitcnt lgkmcnt(2)
    v_smfmac_f32_16x16x64_f16 v[44:47], v[40:43], v[52:59], v5
    s_waitcnt lgkmcnt(0)
    v_smfmac_f32_16x16x64_f16 v[48:51], v[40:43], v[60:67], v5
    s_nop 5
    v_cvt_pk_f16_f32 v16, v44, v45
    v_cvt_pk_f16_f32 v17, v46, v47
    v_cvt_pk_f16_f32 v18, v48, v49
    v_cvt_pk_f16_f32 v19, v50, v51
    ds_write_b128 v12, v[16:19]
    s_waitcnt lgkmcnt(0)
    s_barrier
    s_endpgm
C6_entry:
    s_add_u32 s48, s4, 0x5b54000
    s_addc_u32 s49, s5, 0
    s_add_u32 s50, s24, 0
    s_and_b32 s50, s50, 3
    s_mul_i32 s50, s50, 24576
    s_add_u32 s34, s28, s50
    s_addc_u32 s35, s29, 0
    s_add_u32 s50, s24, 3
    s_and_b32 s50, s50, 3
    s_mul_i32 s50, s50, 24576
    s_add_u32 s36, s28, s50
    s_addc_u32 s37, s29, 0
    s_add_u32 s50, s24, 1
    s_and_b32 s50, s50, 3
    s_mul_i32 s50, s50, 16384
    s_add_u32 s30, s26, s50
    s_addc_u32 s31, s27, 0
    s_add_u32 s50, s24, 3
    s_and_b32 s50, s50, 3
    s_mul_i32 s50, s50, 16384
    s_add_u32 s32, s26, s50
    s_addc_u32 s33, s27, 0
    s_add_u32 s42, s42, 28672
    s_addc_u32 s43, s43, 0
    s_add_u32 s54, s54, 458752
    s_addc_u32 s55, s55, 0
    v_mov_b32 v44, 0
    v_mov_b32 v45, 0
    v_mov_b32 v46, 0
    v_mov_b32 v47, 0
    s_setprio 1
    s_branch C6_top
.p2align 6
C6_loop:
    s_cmp_eq_u32 s24, 63
    s_cbranch_scc1 C6_top
    s_waitcnt vmcnt(0)
C6_got:
C6_top:
    s_cmp_eq_u32 s24, 63
    s_waitcnt lgkmcnt(0)
    s_barrier
    s_cbranch_scc1 C6_fin
    ds_read_b128 v[16:19], v3 offset:0
    ds_read_b128 v[20:23], v3 offset:512
    ds_read_b128 v[24:27], v3 offset:1024
    ds_read_b128 v[28:31], v3 offset:1536
    ds_read_b128 v[32:35], v3 offset:2048
    ds_read_b128 v[36:39], v3 offset:2560
    ds_read_b128 v[40:43], v3 offset:3072
    s_waitcnt lgkmcnt(6)
    v_smfmac_f32_16x16x64_f16 v[44:47], v[16:19], v[144:151], v5
    ds_read_b128 v[16:19], v6 offset:0
    s_waitcnt lgkmcnt(6)
    v_smfmac_f32_16x16x64_f16 v[44:47], v[20:23], v[152:159], v5
    ds_read_b128 v[20:23], v6 offset:512
    s_waitcnt lgkmcnt(6)
    v_smfmac_f32_16x16x64_f16 v[44:47], v[24:27], v[160:167], v5
    ds_read_b128 v[24:27], v6 offset:1024
    s_waitcnt lgkmcnt(6)
    v_smfmac_f32_16x16x64_f16 v[44:47], v[28:31], v[168:175], v5
    ds_read_b128 v[28:31], v6 offset:1536
    s_waitcnt lgkmcnt(6)
    v_smfmac_f32_16x16x64_f16 v[44:47], v[32:35], v[176:183], v5
    ds_read_b128 v[32:35], v6 offset:2048
    s_waitcnt lgkmcnt(6)
    v_smfmac_f32_16x16x64_f16 v[44:47], v[36:39], v[184:191], v5
    ds_read_b128 v[36:39], v6 offset:2560
    s_waitcnt lgkmcnt(6)
    v_smfmac_f32_16x16x64_f16 v[44:47], v[40:43], v[192:199], v5
    ds_read_b128 v[40:43], v6 offset:3072
    s_waitcnt lgkmcnt(6)
    v_smfmac_f32_16x16x64_f16 v[44:47], v[16:19], v[200:207], v5
    s_waitcnt lgkmcnt(5)
    v_smfmac_f32_16x16x64_f16 v[44:47], v[20:23], v[208:215], v5
    s_waitcnt lgkmcnt(4)
    v_smfmac_f32_16x16x64_f16 v[44:47], v[24:27], v[216:223], v5
    s_waitcnt lgkmcnt(3)
    v_smfmac_f32_16x16x64_f16 v[44:47], v[28:31], v[224:231], v5
    s_waitcnt lgkmcnt(2)
    v_smfmac_f32_16x16x64_f16 v[44:47], v[32:35], v[232:239], v5
    s_waitcnt lgkmcnt(1)
    v_smfmac_f32_16x16x64_f16 v[44:47], v[36:39], v[240:247], v5
    s_waitcnt lgkmcnt(0)
    v_smfmac_f32_16x16x64_f16 v[44:47], v[40:43], v[248:255], v5
    s_nop 7
    v_cvt_pk_f16_f32 v44, v44, v46
    v_cvt_pk_f16_f32 v45, v45, v47
    ds_write2_b32 v7, v44, v45 offset0:0 offset1:4
    s_waitcnt lgkmcnt(0)
    s_barrier
    s_setprio 0
    ds_read_b128 v[52:55], v8 offset:0
    ds_read_b128 v[56:59], v8 offset:512
    ds_read_b128 v[60:63], v8 offset:1024
    ds_read_b128 v[64:67], v8 offset:1536
    ds_read_b128 v[48:51], v8 offset:2048
    s_waitcnt lgkmcnt(4)
    v_mfma_f32_16x16x32_f16 v[44:47], v[68:71], v[52:55], 0
    ds_read_b128 v[52:55], v8 offset:2560
    s_waitcnt lgkmcnt(4)
    v_mfma_f32_16x16x32_f16 v[44:47], v[72:75], v[56:59], v[44:47]
    ds_read_b128 v[56:59], v8 offset:3072
    s_waitcnt lgkmcnt(4)
    v_mfma_f32_16x16x32_f16 v[44:47], v[76:79], v[60:63], v[44:47]
    s_waitcnt lgkmcnt(3)
    v_mfma_f32_16x16x32_f16 v[44:47], v[80:83], v[64:67], v[44:47]
    s_waitcnt lgkmcnt(2)
    v_mfma_f32_16x16x32_f16 v[44:47], v[84:87], v[48:51], v[44:47]
    s_waitcnt lgkmcnt(1)
    v_mfma_f32_16x16x32_f16 v[44:47], v[88:91], v[52:55], v[44:47]
    s_waitcnt lgkmcnt(0)
    v_mfma_f32_16x16x32_f16 v[44:47], v[92:95], v[56:59], v[44:47]
    s_mov_b64 exec, s[46:47]
    s_nop 6
    v_cvt_pk_f16_f32 v60, v44, v45
    v_cvt_pk_f16_f32 v61, v46, v47
    global_store_dwordx2 v9, v[60:61], s[34:35]
    s_mov_b64 exec, -1
    s_setprio 0
    s_barrier
    ds_read_b128 v[52:55], v15 offset:0
    ds_read_b128 v[56:59], v15 offset:1024
    v_mov_b32 v44, 0
    v_mov_b32 v45, 0
    v_mov_b32 v46, 0
    v_mov_b32 v47, 0
    v_mov_b32 v48, 0
    v_mov_b32 v49, 0
    v_mov_b32 v50, 0
    v_mov_b32 v51, 0
    ds_read_b128 v[60:63], v15 offset:2048
    ds_read_b128 v[64:67], v15 offset:3072
    v_smfmac_f32_16x16x64_f16 v[44:47], v[16:19], v[96:103], v5
    v_smfmac_f32_16x16x64_f16 v[48:51], v[16:19], v[104:111], v5
    v_smfmac_f32_16x16x64_f16 v[44:47], v[20:23], v[112:119], v5
    s_waitcnt lgkmcnt(2)
    v_smfmac_f32_16x16x64_f16 v[44:47], v[28:31], v[52:59], v5
    ds_read_b128 v[52:55], v15 offset:4096
    ds_read_b128 v[56:59], v15 offset:5120
    v_smfmac_f32_16x16x64_f16 v[48:51], v[20:23], v[120:127], v5
    s_waitcnt lgkmcnt(2)
    v_smfmac_f32_16x16x64_f16 v[48:51], v[28:31], v[60:67], v5
    ds_read_b128 v[60:63], v15 offset:6144
    ds_read_b128 v[64:67], v15 offset:7168
    v_smfmac_f32_16x16x64_f16 v[44:47], v[24:27], v[128:135], v5
    s_waitcnt lgkmcnt(2)
    v_smfmac_f32_16x16x64_f16 v[44:47], v[32:35], v[52:59], v5
    ds_read_b128 v[52:55], v15 offset:8192
    ds_read_b128 v[56:59], v15 offset:9216
    v_smfmac_f32_16x16x64_f16 v[48:51], v[24:27], v[136:143], v5
    s_waitcnt lgkmcnt(2)
    v_smfmac_f32_16x16x64_f16 v[48:51], v[32:35], v[60:67], v5
    ds_read_b128 v[60:63], v15 offset:10240
    ds_read_b128 v[64:67], v15 offset:11264
    s_waitcnt lgkmcnt(2)
    v_smfmac_f32_16x16x64_f16 v[44:47], v[36:39], v[52:59], v5
    ds_read_b128 v[52:55], v15 offset:12288
    ds_read_b128 v[56:59], v15 offset:13312
    s_waitcnt lgkmcnt(2)
    v_smfmac_f32_16x16x64_f16 v[48:51], v[36:39], v[60:67], v5
    ds_read_b128 v[60:63], v15 offset:14336
    ds_read_b128 v[64:67], v15 offset:15360
    s_waitcnt lgkmcnt(2)
    v_smfmac_f32_16x16x64_f16 v[44:47], v[40:43], v[52:59], v5
    s_waitcnt lgkmcnt(0)
    v_smfmac_f32_16x16x64_f16 v[48:51], v[40:43], v[60:67], v5
    s_nop 5
    v_cvt_pk_f16_f32 v16, v44, v45
    v_cvt_pk_f16_f32 v17, v46, v47
    v_cvt_pk_f16_f32 v18, v48, v49
    v_cvt_pk_f16_f32 v19, v50, v51
    ds_write_b128 v12, v[16:19]
    s_waitcnt lgkmcnt(0)
    s_barrier
    global_load_dwordx4 v[68:71], v2, s[42:43] offset:-4096 sc1
    global_load_dwordx4 v[72:75], v2, s[42:43] offset:-3072 sc1
    global_load_dwordx4 v[76:79], v2, s[42:43] offset:-2048 sc1
    global_load_dwordx4 v[80:83], v2, s[42:43] offset:-1024 sc1
    global_load_dwordx4 v[84:87], v2, s[42:43] offset:0 sc1
    global_load_dwordx4 v[88:91], v2, s[42:43] offset:1024 sc1
    global_load_dwordx4 v[92:95], v2, s[42:43] offset:2048 sc1
    v_mov_b32 v48, -1
    v_mov_b32 v49, -1
    global_store_dwordx2 v13, v[48:49], s[32:33]
    s_mov_b64 exec, s[46:47]
    global_store_dwordx2 v9, v[48:49], s[36:37]
    s_mov_b64 exec, -1
    s_barrier
    ds_read_b128 v[16:19], v2 offset:11264
    ds_read_b128 v[20:23], v2 offset:12288
    ds_read_b128 v[24:27], v2 offset:13312
    ds_read_b128 v[28:31], v2 offset:14336
    s_waitcnt lgkmcnt(2)
    v_pk_add_f32 v[16:17], v[16:17], v[20:21]
    v_pk_add_f32 v[18:19], v[18:19], v[22:23]
    s_waitcnt lgkmcnt(1)
    v_pk_add_f32 v[16:17], v[16:17], v[24:25]
    v_pk_add_f32 v[18:19], v[18:19], v[26:27]
    s_waitcnt lgkmcnt(0)
    v_pk_add_f32 v[16:17], v[16:17], v[28:29]
    v_pk_add_f32 v[18:19], v[18:19], v[30:31]
    v_cvt_pk_f16_f32 v16, v16, v17
    v_cvt_pk_f16_f32 v17, v18, v19
    global_store_dwordx2 v13, v[16:17], s[30:31]
    s_barrier
    s_cmp_eq_u32 s24, 62
    s_cselect_b64 exec, -1, 0
    global_store_dwordx2 v13, v[16:17], s[48:49] sc1
    s_mov_b64 exec, -1
    s_add_u32 s58, s30, 3584
    s_addc_u32 s59, s31, 0
    s_add_u32 s24, s24, 1
    s_add_u32 s50, s24, 0
    s_and_b32 s50, s50, 3
    s_mul_i32 s50, s50, 24576
    s_add_u32 s34, s28, s50
    s_addc_u32 s35, s29, 0
    s_add_u32 s50, s24, 3
    s_and_b32 s50, s50, 3
    s_mul_i32 s50, s50, 24576
    s_add_u32 s36, s28, s50
    s_addc_u32 s37, s29, 0
    s_add_u32 s50, s24, 1
    s_and_b32 s50, s50, 3
    s_mul_i32 s50, s50, 16384
    s_add_u32 s30, s26, s50
    s_addc_u32 s31, s27, 0
    s_add_u32 s50, s24, 3
    s_and_b32 s50, s50, 3
    s_mul_i32 s50, s50, 16384
    s_add_u32 s32, s26, s50
    s_addc_u32 s33, s27, 0
    s_add_u32 s42, s42, 28672
    s_addc_u32 s43, s43, 0
    s_add_u32 s54, s54, 458752
    s_addc_u32 s55, s55, 0
    v_mov_b32 v44, 0
    v_mov_b32 v45, 0
    v_mov_b32 v46, 0
    v_mov_b32 v47, 0
    s_setprio 1
    s_branch C6_loop
C6_fin:
    s_setprio 0
    ds_read_b128 v[16:19], v6 offset:0
    ds_read_b128 v[20:23], v6 offset:512
    ds_read_b128 v[24:27], v6 offset:1024
    ds_read_b128 v[28:31], v6 offset:1536
    ds_read_b128 v[32:35], v6 offset:2048
    ds_read_b128 v[36:39], v6 offset:2560
    ds_read_b128 v[40:43], v6 offset:3072
    ds_read_b128 v[52:55], v15 offset:0
    ds_read_b128 v[56:59], v15 offset:1024
    ds_read_b128 v[60:63], v15 offset:2048
    ds_read_b128 v[64:67], v15 offset:3072
    v_mov_b32 v48, 0
    v_mov_b32 v49, 0
    v_mov_b32 v50, 0
    v_mov_b32 v51, 0
    s_waitcnt lgkmcnt(0)
    v_smfmac_f32_16x16x64_f16 v[44:47], v[28:31], v[52:59], v5
    ds_read_b128 v[52:55], v15 offset:4096
    ds_read_b128 v[56:59], v15 offset:5120
    v_smfmac_f32_16x16x64_f16 v[44:47], v[16:19], v[96:103], v5
    v_smfmac_f32_16x16x64_f16 v[48:51], v[28:31], v[60:67], v5
    ds_read_b128 v[60:63], v15 offset:6144
    ds_read_b128 v[64:67], v15 offset:7168
    v_smfmac_f32_16x16x64_f16 v[48:51], v[16:19], v[104:111], v5
    s_waitcnt lgkmcnt(2)
    v_smfmac_f32_16x16x64_f16 v[44:47], v[32:35], v[52:59], v5
    ds_read_b128 v[52:55], v15 offset:8192
    ds_read_b128 v[56:59], v15 offset:9216
    v_smfmac_f32_16x16x64_f16 v[44:47], v[20:23], v[112:119], v5
    s_waitcnt lgkmcnt(2)
    v_smfmac_f32_16x16x64_f16 v[48:51], v[32:35], v[60:67], v5
    ds_read_b128 v[60:63], v15 offset:10240
    ds_read_b128 v[64:67], v15 offset:11264
    v_smfmac_f32_16x16x64_f16 v[48:51], v[20:23], v[120:127], v5
    s_waitcnt lgkmcnt(2)
    v_smfmac_f32_16x16x64_f16 v[44:47], v[36:39], v[52:59], v5
    ds_read_b128 v[52:55], v15 offset:12288
    ds_read_b128 v[56:59], v15 offset:13312
    v_smfmac_f32_16x16x64_f16 v[44:47], v[24:27], v[128:135], v5
    s_waitcnt lgkmcnt(2)
    v_smfmac_f32_16x16x64_f16 v[48:51], v[36:39], v[60:67], v5
    ds_read_b128 v[60:63], v15 offset:14336
    ds_read_b128 v[64:67], v15 offset:15360
    v_smfmac_f32_16x16x64_f16 v[48:51], v[24:27], v[136:143], v5
    s_waitcnt lgkmcnt(2)
    v_smfmac_f32_16x16x64_f16 v[44:47], v[40:43], v[52:59], v5
    s_waitcnt lgkmcnt(0)
    v_smfmac_f32_16x16x64_f16 v[48:51], v[40:43], v[60:67], v5
    s_nop 5
    v_cvt_pk_f16_f32 v16, v44, v45
    v_cvt_pk_f16_f32 v17, v46, v47
    v_cvt_pk_f16_f32 v18, v48, v49
    v_cvt_pk_f16_f32 v19, v50, v51
    ds_write_b128 v12, v[16:19]
    s_waitcnt lgkmcnt(0)
    s_barrier
    s_endpgm
C7_entry:
    s_add_u32 s50, s24, 0
    s_and_b32 s50, s50, 3
    s_mul_i32 s50, s50, 24576
    s_add_u32 s34, s28, s50
    s_addc_u32 s35, s29, 0
    s_add_u32 s50, s24, 3
    s_and_b32 s50, s50, 3
    s_mul_i32 s50, s50, 24576
    s_add_u32 s36, s28, s50
    s_addc_u32 s37, s29, 0
    s_add_u32 s50, s24, 1
    s_and_b32 s50, s50, 3
    s_mul_i32 s50, s50, 16384
    s_add_u32 s30, s26, s50
    s_addc_u32 s31, s27, 0
    s_add_u32 s42, s42, 28672
    s_addc_u32 s43, s43, 0
    s_add_u32 s54, s54, 458752
    s_addc_u32 s55, s55, 0
    v_mov_b32 v44, 0
    v_mov_b32 v45, 0
    v_mov_b32 v46, 0
    v_mov_b32 v47, 0
    v_mov_b32 v48, 0
    v_mov_b32 v49, 0
    v_mov_b32 v50, 0
    v_mov_b32 v51, 0
    s_setprio 1
    s_branch C7_top
.p2align 6
C7_loop:
    s_waitcnt vmcnt(0)
    v_pk_add_f16 v16, v208, v212
    v_pk_add_f16 v17, v209, v213
    v_pk_add_f16 v18, v210, v214
    v_pk_add_f16 v19, v211, v215
    ds_write_b128 v14, v[16:19]
    v_pk_maximum3_f16 v20, v16, v17, v18
    v_pk_maximum3_f16 v20, v20, v19, v19
    v_cmp_u_f16 vcc, v20, v20
    s_cbranch_vccnz C7_mre
C7_got:
C7_top:
    s_cmp_eq_u32 s24, 63
    s_waitcnt lgkmcnt(0)
    s_barrier
    s_cbranch_scc1 C7_fin
    s_setprio 0
    global_load_dword v4, v10, s[54:55] sc1
    ds_read_b128 v[52:55], v2 offset:19456
    ds_read_b128 v[56:59], v2 offset:20480
    ds_read_b128 v[60:63], v2 offset:21504
    ds_read_b128 v[64:67], v2 offset:22528
    s_waitcnt lgkmcnt(0)
    global_store_dwordx4 v2, v[52:55], s[40:41] offset:-2048 sc1
    global_store_dwordx4 v2, v[56:59], s[40:41] offset:-1024 sc1
    global_store_dwordx4 v2, v[60:63], s[40:41] offset:2048 sc1
    global_store_dwordx4 v2, v[64:67], s[40:41] offset:3072 sc1
    ds_read_b128 v[16:19], v6 offset:0
    ds_read_b128 v[20:23], v6 offset:512
    ds_read_b128 v[24:27], v6 offset:1024
    ds_read_b128 v[28:31], v6 offset:1536
    ds_read_b128 v[32:35], v6 offset:2048
    ds_read_b128 v[36:39], v6 offset:2560
    ds_read_b128 v[40:43], v6 offset:3072
    s_barrier
    s_setprio 0
    ds_read_b128 v[224:227], v8 offset:0
    ds_read_b128 v[228:231], v8 offset:512
    ds_read_b128 v[232:235], v8 offset:1024
    ds_read_b128 v[236:239], v8 offset:1536
    ds_read_b128 v[240:243], v8 offset:2048
    ds_read_b128 v[244:247], v8 offset:2560
    ds_read_b128 v[248:251], v8 offset:3072
    s_waitcnt lgkmcnt(6)
    v_mfma_f32_16x16x32_f16 v[252:255], v[68:71], v[224:227], 0
    s_waitcnt lgkmcnt(5)
    v_mfma_f32_16x16x32_f16 v[252:255], v[72:75], v[228:231], v[252:255]
    s_waitcnt lgkmcnt(4)
    v_mfma_f32_16x16x32_f16 v[252:255], v[76:79], v[232:235], v[252:255]
    s_waitcnt lgkmcnt(3)
    v_mfma_f32_16x16x32_f16 v[252:255], v[80:83], v[236:239], v[252:255]
    s_waitcnt lgkmcnt(2)
    v_mfma_f32_16x16x32_f16 v[252:255], v[84:87], v[240:243], v[252:255]
    s_waitcnt lgkmcnt(1)
    v_mfma_f32_16x16x32_f16 v[252:255], v[88:91], v[244:247], v[252:255]
    s_waitcnt lgkmcnt(0)
    v_mfma_f32_16x16x32_f16 v[252:255], v[92:95], v[248:251], v[252:255]
    s_mov_b64 exec, s[46:47]
    s_nop 6
    v_cvt_pk_f16_f32 v232, v252, v253
    v_cvt_pk_f16_f32 v233, v254, v255
    global_store_dwordx2 v9, v[232:233], s[34:35]
    s_mov_b64 exec, -1
    s_setprio 0
    s_barrier
    v_smfmac_f32_16x16x64_f16 v[44:47], v[16:19], v[96:103], v5
    v_smfmac_f32_16x16x64_f16 v[48:51], v[16:19], v[104:111], v5
    v_smfmac_f32_16x16x64_f16 v[44:47], v[20:23], v[112:119], v5
    v_smfmac_f32_16x16x64_f16 v[48:51], v[20:23], v[120:127], v5
    v_smfmac_f32_16x16x64_f16 v[44:47], v[24:27], v[128:135], v5
    v_smfmac_f32_16x16x64_f16 v[48:51], v[24:27], v[136:143], v5
    v_smfmac_f32_16x16x64_f16 v[44:47], v[28:31], v[144:151], v5
    v_smfmac_f32_16x16x64_f16 v[48:51], v[28:31], v[152:159], v5
    v_smfmac_f32_16x16x64_f16 v[44:47], v[32:35], v[160:167], v5
    v_smfmac_f32_16x16x64_f16 v[48:51], v[32:35], v[168:175], v5
    v_smfmac_f32_16x16x64_f16 v[44:47], v[36:39], v[176:183], v5
    v_smfmac_f32_16x16x64_f16 v[48:51], v[36:39], v[184:191], v5
    v_smfmac_f32_16x16x64_f16 v[44:47], v[40:43], v[192:199], v5
    v_smfmac_f32_16x16x64_f16 v[48:51], v[40:43], v[200:207], v5
    s_nop 6
    v_cvt_pk_f16_f32 v16, v44, v45
    v_cvt_pk_f16_f32 v17, v46, v47
    v_cvt_pk_f16_f32 v18, v48, v49
    v_cvt_pk_f16_f32 v19, v50, v51
    ds_write_b128 v12, v[16:19]
    s_waitcnt lgkmcnt(0)
    s_barrier
    global_load_dwordx4 v[68:71], v2, s[42:43] offset:-4096 sc1
    global_load_dwordx4 v[72:75], v2, s[42:43] offset:-3072 sc1
    global_load_dwordx4 v[76:79], v2, s[42:43] offset:-2048 sc1
    global_load_dwordx4 v[80:83], v2, s[42:43] offset:-1024 sc1
    global_load_dwordx4 v[84:87], v2, s[42:43] offset:0 sc1
    global_load_dwordx4 v[88:91], v2, s[42:43] offset:1024 sc1
    global_load_dwordx4 v[92:95], v2, s[42:43] offset:2048 sc1
    v_mov_b32 v48, -1
    v_mov_b32 v49, -1
    s_mov_b64 exec, s[46:47]
    global_store_dwordx2 v9, v[48:49], s[36:37]
    s_mov_b64 exec, -1
    s_load_dword s96, s[54:55], 10496
    s_load_dword s96, s[54:55], 10624
    s_load_dword s96, s[54:55], 10752
    s_load_dword s96, s[54:55], 10880
    s_load_dword s96, s[54:55], 11008
    s_load_dword s96, s[54:55], 11136
    s_load_dword s96, s[54:55], 11264
    s_load_dword s96, s[54:55], 11392
    s_load_dword s96, s[54:55], 11520
    s_load_dword s96, s[54:55], 11648
    s_load_dword s96, s[54:55], 11776
    s_load_dword s96, s[54:55], 11904
    s_load_dword s96, s[54:55], 12032
    s_load_dword s96, s[54:55], 12160
    s_barrier
    s_barrier
    s_add_u32 s58, s30, 3584
    s_addc_u32 s59, s31, 0
    s_add_u32 s24, s24, 1
    s_add_u32 s50, s24, 0
    s_and_b32 s50, s50, 3
    s_mul_i32 s50, s50, 24576
    s_add_u32 s34, s28, s50
    s_addc_u32 s35, s29, 0
    s_add_u32 s50, s24, 3
    s_and_b32 s50, s50, 3
    s_mul_i32 s50, s50, 24576
    s_add_u32 s36, s28, s50
    s_addc_u32 s37, s29, 0
    s_add_u32 s50, s24, 1
    s_and_b32 s50, s50, 3
    s_mul_i32 s50, s50, 16384
    s_add_u32 s30, s26, s50
    s_addc_u32 s31, s27, 0
    s_add_u32 s42, s42, 28672
    s_addc_u32 s43, s43, 0
    s_add_u32 s54, s54, 458752
    s_addc_u32 s55, s55, 0
    s_add_u32 s40, s40, 114688
    s_addc_u32 s41, s41, 0
    s_add_u32 s44, s44, 28672
    s_addc_u32 s45, s45, 0
    v_mov_b32 v44, 0
    v_mov_b32 v45, 0
    v_mov_b32 v46, 0
    v_mov_b32 v47, 0
    v_mov_b32 v48, 0
    v_mov_b32 v49, 0
    v_mov_b32 v50, 0
    v_mov_b32 v51, 0
    s_setprio 1
    global_load_dwordx4 v[208:211], v14, s[58:59] offset:-3584 sc1
    global_load_dwordx4 v[212:215], v14, s[58:59] offset:3584 sc1
    s_branch C7_loop
C7_mre:
    global_load_dwordx4 v[208:211], v14, s[58:59] offset:-3584 sc1
    global_load_dwordx4 v[212:215], v14, s[58:59] offset:3584 sc1
    s_sub_u32 s25, s25, 1
    s_cbranch_scc1 M_end
    s_waitcnt lgkmcnt(0)
    s_branch C7_loop
C7_fin:
    s_setprio 0
    s_waitcnt vmcnt(0)
    ds_read_b128 v[16:19], v6 offset:0
    ds_read_b128 v[20:23], v6 offset:512
    ds_read_b128 v[24:27], v6 offset:1024
    ds_read_b128 v[28:31], v6 offset:1536
    ds_read_b128 v[32:35], v6 offset:2048
    ds_read_b128 v[36:39], v6 offset:2560
    ds_read_b128 v[40:43], v6 offset:3072
    ds_read_b128 v[208:211], v2 offset:19456
    ds_read_b128 v[212:215], v2 offset:20480
    ds_read_b128 v[216:219], v2 offset:21504
    ds_read_b128 v[220:223], v2 offset:22528
    s_waitcnt lgkmcnt(0)
    global_store_dwordx4 v2, v[208:211], s[40:41] offset:-2048 sc1
    global_store_dwordx4 v2, v[212:215], s[40:41] offset:-1024 sc1
    global_store_dwordx4 v2, v[216:219], s[40:41] offset:2048 sc1
    global_store_dwordx4 v2, v[220:223], s[40:41] offset:3072 sc1
    s_add_u32 s40, s40, 114688
    s_addc_u32 s41, s41, 0
    v_smfmac_f32_16x16x64_f16 v[44:47], v[16:19], v[96:103], v5
    v_smfmac_f32_16x16x64_f16 v[48:51], v[16:19], v[104:111], v5
    v_smfmac_f32_16x16x64_f16 v[44:47], v[20:23], v[112:119], v5
    v_smfmac_f32_16x16x64_f16 v[48:51], v[20:23], v[120:127], v5
    v_smfmac_f32_16x16x64_f16 v[44:47], v[24:27], v[128:135], v5
    v_smfmac_f32_16x16x64_f16 v[48:51], v[24:27], v[136:143], v5
    v_smfmac_f32_16x16x64_f16 v[44:47], v[28:31], v[144:151], v5
    v_smfmac_f32_16x16x64_f16 v[48:51], v[28:31], v[152:159], v5
    v_smfmac_f32_16x16x64_f16 v[44:47], v[32:35], v[160:167], v5
    v_smfmac_f32_16x16x64_f16 v[48:51], v[32:35], v[168:175], v5
    v_smfmac_f32_16x16x64_f16 v[44:47], v[36:39], v[176:183], v5
    v_smfmac_f32_16x16x64_f16 v[48:51], v[36:39], v[184:191], v5
    v_smfmac_f32_16x16x64_f16 v[44:47], v[40:43], v[192:199], v5
    v_smfmac_f32_16x16x64_f16 v[48:51], v[40:43], v[200:207], v5
    s_nop 6
    v_cvt_pk_f16_f32 v16, v44, v45
    v_cvt_pk_f16_f32 v17, v46, v47
    v_cvt_pk_f16_f32 v18, v48, v49
    v_cvt_pk_f16_f32 v19, v50, v51
    ds_write_b128 v12, v[16:19]
    s_waitcnt lgkmcnt(0)
    s_barrier
    s_endpgm
CH_hdisp:
    s_cmp_eq_u32 s14, 3
    s_cbranch_scc1 H3_entry
    s_cmp_eq_u32 s14, 4
    s_cbranch_scc1 H4_entry
    s_cmp_eq_u32 s14, 5
    s_cbranch_scc1 H5_entry
    s_cmp_eq_u32 s14, 6
    s_cbranch_scc1 H6_entry
    s_cmp_eq_u32 s14, 7
    s_cbranch_scc1 H7_entry
H0_entry:
    s_add_u32 s50, s24, 0
    s_and_b32 s50, s50, 3
    s_mul_i32 s50, s50, 24576
    s_add_u32 s34, s28, s50
    s_addc_u32 s35, s29, 0
    s_add_u32 s50, s24, 1
    s_and_b32 s50, s50, 3
    s_mul_i32 s50, s50, 16384
    s_add_u32 s30, s26, s50
    s_addc_u32 s31, s27, 0
    v_mov_b32 v84, 0
    v_mov_b32 v85, 0
    v_mov_b32 v86, 0
    v_mov_b32 v87, 0
    s_setprio 1
    s_branch H0_top
.p2align 6
H0_loop:
    s_waitcnt vmcnt(0)
    v_pk_add_f16 v16, v68, v72
    v_pk_add_f16 v17, v69, v73
    v_pk_add_f16 v18, v70, v74
    v_pk_add_f16 v19, v71, v75
    ds_write_b128 v14, v[16:19]
    v_pk_maximum3_f16 v20, v16, v17, v18
    v_pk_maximum3_f16 v20, v20, v19, v19
    v_cmp_u_f16 vcc, v20, v20
    s_cbranch_vccnz H0_mre
H0_got:
H0_top:
    s_cmp_eq_u32 s24, 63
    s_waitcnt lgkmcnt(0)
    s_barrier
    s_cbranch_scc1 H0_fin
    ds_read_b128 v[16:19], v3 offset:0
    ds_read_b128 v[20:23], v3 offset:512
    ds_read_b128 v[24:27], v3 offset:1024
    ds_read_b128 v[28:31], v3 offset:1536
    ds_read_b128 v[32:35], v3 offset:2048
    ds_read_b128 v[36:39], v3 offset:2560
    s_waitcnt lgkmcnt(5)
    v_smfmac_f32_16x16x64_f16 v[84:87], v[16:19], v[144:151], v5
    ds_read_b128 v[40:43], v3 offset:3072
    s_waitcnt lgkmcnt(5)
    v_smfmac_f32_16x16x64_f16 v[84:87], v[20:23], v[152:159], v5
    ds_read_b128 v[16:19], v6 offset:0
    s_waitcnt lgkmcnt(5)
    v_smfmac_f32_16x16x64_f16 v[84:87], v[24:27], v[160:167], v5
    ds_read_b128 v[20:23], v6 offset:512
    s_waitcnt lgkmcnt(5)
    v_smfmac_f32_16x16x64_f16 v[84:87], v[28:31], v[168:175], v5
    ds_read_b128 v[24:27], v6 offset:1024
    s_waitcnt lgkmcnt(5)
    v_smfmac_f32_16x16x64_f16 v[84:87], v[32:35], v[176:183], v5
    ds_read_b128 v[28:31], v6 offset:1536
    s_waitcnt lgkmcnt(5)
    v_smfmac_f32_16x16x64_f16 v[84:87], v[36:39], v[184:191], v5
    ds_read_b128 v[32:35], v6 offset:2048
    s_waitcnt lgkmcnt(5)
    v_smfmac_f32_16x16x64_f16 v[84:87], v[40:43], v[192:199], v5
    ds_read_b128 v[36:39], v6 offset:2560
    s_waitcnt lgkmcnt(5)
    v_smfmac_f32_16x16x64_f16 v[84:87], v[16:19], v[200:207], v5
    ds_read_b128 v[40:43], v6 offset:3072
    s_waitcnt lgkmcnt(5)
    v_smfmac_f32_16x16x64_f16 v[84:87], v[20:23], v[208:215], v5
    s_waitcnt lgkmcnt(4)
    v_smfmac_f32_16x16x64_f16 v[84:87], v[24:27], v[216:223], v5
    s_waitcnt lgkmcnt(3)
    v_smfmac_f32_16x16x64_f16 v[84:87], v[28:31], v[224:231], v5
    s_waitcnt lgkmcnt(2)
    v_smfmac_f32_16x16x64_f16 v[84:87], v[32:35], v[232:239], v5
    s_waitcnt lgkmcnt(1)
    v_smfmac_f32_16x16x64_f16 v[84:87], v[36:39], v[240:247], v5
    s_waitcnt lgkmcnt(0)
    v_smfmac_f32_16x16x64_f16 v[84:87], v[40:43], v[248:255], v5
    s_nop 7
    v_cvt_pk_f16_f32 v84, v84, v86
    v_cvt_pk_f16_f32 v85, v85, v87
    ds_write2_b32 v7, v84, v85 offset0:0 offset1:4
    s_setprio 0
    ds_read2_b64 v[52:55], v4 offset0:0 offset1:32
    s_waitcnt lgkmcnt(0)
    global_store_dwordx4 v13, v[52:55], s[48:49] sc1
    s_waitcnt lgkmcnt(0)
    s_barrier
    s_barrier
    global_load_dword v68, v96, s[56:57] sc1
    s_barrier
    s_add_u32 s58, s30, 3584
    s_addc_u32 s59, s31, 0
    global_load_dwordx4 v[68:71], v14, s[58:59] offset:-3584 sc1
    global_load_dwordx4 v[72:75], v14, s[58:59] offset:3584 sc1
    s_add_u32 s24, s24, 1
    s_add_u32 s50, s24, 0
    s_and_b32 s50, s50, 3
    s_mul_i32 s50, s50, 24576
    s_add_u32 s34, s28, s50
    s_addc_u32 s35, s29, 0
    s_add_u32 s50, s24, 1
    s_and_b32 s50, s50, 3
    s_mul_i32 s50, s50, 16384
    s_add_u32 s30, s26, s50
    s_addc_u32 s31, s27, 0
    s_add_u32 s38, s38, 458752
    s_addc_u32 s39, s39, 0
    s_add_u32 s48, s48, 8192
    s_addc_u32 s49, s49, 0
    s_add_u32 s56, s56, 458752
    s_addc_u32 s57, s57, 0
    v_mov_b32 v84, 0
    v_mov_b32 v85, 0
    v_mov_b32 v86, 0
    v_mov_b32 v87, 0
    s_setprio 1
    s_branch H0_loop
H0_mre:
    global_load_dwordx4 v[68:71], v14, s[58:59] offset:-3584 sc1
    global_load_dwordx4 v[72:75], v14, s[58:59] offset:3584 sc1
    s_sub_u32 s25, s25, 1
    s_cbranch_scc1 M_end
    s_waitcnt lgkmcnt(0)
    s_branch H0_loop
H0_fin:
    s_setprio 0
    s_waitcnt vmcnt(0)
    ds_read2_b64 v[52:55], v4 offset0:0 offset1:32
    s_waitcnt lgkmcnt(0)
    global_store_dwordx4 v13, v[52:55], s[48:49] sc1
    s_endpgm
H3_entry:
    s_add_u32 s50, s24, 0
    s_and_b32 s50, s50, 3
    s_mul_i32 s50, s50, 24576
    s_add_u32 s34, s28, s50
    s_addc_u32 s35, s29, 0
    s_add_u32 s50, s24, 1
    s_and_b32 s50, s50, 3
    s_mul_i32 s50, s50, 16384
    s_add_u32 s30, s26, s50
    s_addc_u32 s31, s27, 0
    v_mov_b32 v84, 0
    v_mov_b32 v85, 0
    v_mov_b32 v86, 0
    v_mov_b32 v87, 0
    s_setprio 1
    s_branch H3_top
.p2align 6
H3_loop:
    s_waitcnt vmcnt(0)
    v_pk_add_f16 v16, v68, v72
    v_pk_add_f16 v17, v69, v73
    v_pk_add_f16 v18, v70, v74
    v_pk_add_f16 v19, v71, v75
    ds_write_b128 v14, v[16:19]
    v_pk_maximum3_f16 v20, v16, v17, v18
    v_pk_maximum3_f16 v20, v20, v19, v19
    v_cmp_u_f16 vcc, v20, v20
    s_cbranch_vccnz H3_mre
H3_got:
H3_top:
    s_cmp_eq_u32 s24, 63
    s_waitcnt lgkmcnt(0)
    s_barrier
    s_cbranch_scc1 H3_fin
    ds_read_b128 v[16:19], v3 offset:0
    ds_read_b128 v[20:23], v3 offset:512
    ds_read_b128 v[24:27], v3 offset:1024
    ds_read_b128 v[28:31], v3 offset:1536
    ds_read_b128 v[32:35], v3 offset:2048
    ds_read_b128 v[36:39], v3 offset:2560
    s_waitcnt lgkmcnt(5)
    v_smfmac_f32_16x16x64_f16 v[84:87], v[16:19], v[144:151], v5
    ds_read_b128 v[40:43], v3 offset:3072
    s_waitcnt lgkmcnt(5)
    v_smfmac_f32_16x16x64_f16 v[84:87], v[20:23], v[152:159], v5
    ds_read_b128 v[16:19], v6 offset:0
    s_waitcnt lgkmcnt(5)
    v_smfmac_f32_16x16x64_f16 v[84:87], v[24:27], v[160:167], v5
    ds_read_b128 v[20:23], v6 offset:512
    s_waitcnt lgkmcnt(5)
    v_smfmac_f32_16x16x64_f16 v[84:87], v[28:31], v[168:175], v5
    ds_read_b128 v[24:27], v6 offset:1024
    s_waitcnt lgkmcnt(5)
    v_smfmac_f32_16x16x64_f16 v[84:87], v[32:35], v[176:183], v5
    ds_read_b128 v[28:31], v6 offset:1536
    s_waitcnt lgkmcnt(5)
    v_smfmac_f32_16x16x64_f16 v[84:87], v[36:39], v[184:191], v5
    ds_read_b128 v[32:35], v6 offset:2048
    s_waitcnt lgkmcnt(5)
    v_smfmac_f32_16x16x64_f16 v[84:87], v[40:43], v[192:199], v5
    ds_read_b128 v[36:39], v6 offset:2560
    s_waitcnt lgkmcnt(5)
    v_smfmac_f32_16x16x64_f16 v[84:87], v[16:19], v[200:207], v5
    ds_read_b128 v[40:43], v6 offset:3072
    s_waitcnt lgkmcnt(5)
    v_smfmac_f32_16x16x64_f16 v[84:87], v[20:23], v[208:215], v5
    s_waitcnt lgkmcnt(4)
    v_smfmac_f32_16x16x64_f16 v[84:87], v[24:27], v[216:223], v5
    s_waitcnt lgkmcnt(3)
    v_smfmac_f32_16x16x64_f16 v[84:87], v[28:31], v[224:231], v5
    s_waitcnt lgkmcnt(2)
    v_smfmac_f32_16x16x64_f16 v[84:87], v[32:35], v[232:239], v5
    s_waitcnt lgkmcnt(1)
    v_smfmac_f32_16x16x64_f16 v[84:87], v[36:39], v[240:247], v5
    s_waitcnt lgkmcnt(0)
    v_smfmac_f32_16x16x64_f16 v[84:87], v[40:43], v[248:255], v5
    s_nop 7
    v_cvt_pk_f16_f32 v84, v84, v86
    v_cvt_pk_f16_f32 v85, v85, v87
    ds_write2_b32 v7, v84, v85 offset0:0 offset1:4
    s_setprio 0
    ds_read2_b64 v[52:55], v4 offset0:0 offset1:32
    s_waitcnt lgkmcnt(0)
    global_store_dwordx4 v13, v[52:55], s[48:49] sc1
    s_waitcnt lgkmcnt(0)
    s_barrier
    s_barrier
    global_load_dword v68, v96, s[56:57] sc1
    s_barrier
    s_add_u32 s58, s30, 3584
    s_addc_u32 s59, s31, 0
    global_load_dwordx4 v[68:71], v14, s[58:59] offset:-3584 sc1
    global_load_dwordx4 v[72:75], v14, s[58:59] offset:3584 sc1
    s_add_u32 s24, s24, 1
    s_add_u32 s50, s24, 0
    s_and_b32 s50, s50, 3
    s_mul_i32 s50, s50, 24576
    s_add_u32 s34, s28, s50
    s_addc_u32 s35, s29, 0
    s_add_u32 s50, s24, 1
    s_and_b32 s50, s50, 3
    s_mul_i32 s50, s50, 16384
    s_add_u32 s30, s26, s50
    s_addc_u32 s31, s27, 0
    s_add_u32 s38, s38, 458752
    s_addc_u32 s39, s39, 0
    s_add_u32 s48, s48, 8192
    s_addc_u32 s49, s49, 0
    s_add_u32 s56, s56, 458752
    s_addc_u32 s57, s57, 0
    v_mov_b32 v84, 0
    v_mov_b32 v85, 0
    v_mov_b32 v86, 0
    v_mov_b32 v87, 0
    s_setprio 1
    s_branch H3_loop
H3_mre:
    global_load_dwordx4 v[68:71], v14, s[58:59] offset:-3584 sc1
    global_load_dwordx4 v[72:75], v14, s[58:59] offset:3584 sc1
    s_sub_u32 s25, s25, 1
    s_cbranch_scc1 M_end
    s_waitcnt lgkmcnt(0)
    s_branch H3_loop
H3_fin:
    s_setprio 0
    s_waitcnt vmcnt(0)
    ds_read2_b64 v[52:55], v4 offset0:0 offset1:32
    s_waitcnt lgkmcnt(0)
    global_store_dwordx4 v13, v[52:55], s[48:49] sc1
    s_endpgm
H4_entry:
    s_add_u32 s50, s24, 1
    s_and_b32 s50, s50, 3
    s_mul_i32 s50, s50, 16384
    s_add_u32 s30, s26, s50
    s_addc_u32 s31, s27, 0
    s_add_u32 s54, s54, 458752
    s_addc_u32 s55, s55, 0
    v_mov_b32 v44, 0
    v_mov_b32 v45, 0
    v_mov_b32 v46, 0
    v_mov_b32 v47, 0
    s_setprio 1
    s_branch H4_top
.p2align 6
H4_loop:
    s_waitcnt vmcnt(0)
    v_pk_add_f16 v16, v68, v72
    v_pk_add_f16 v17, v69, v73
    v_pk_add_f16 v18, v70, v74
    v_pk_add_f16 v19, v71, v75
    ds_write_b128 v14, v[16:19]
    v_pk_maximum3_f16 v20, v16, v17, v18
    v_pk_maximum3_f16 v20, v20, v19, v19
    v_cmp_u_f16 vcc, v20, v20
    s_cbranch_vccnz H4_mre
H4_got:
H4_top:
    s_cmp_eq_u32 s24, 63
    s_waitcnt lgkmcnt(0)
    s_barrier
    s_cbranch_scc1 H4_fin
    ds_read_b128 v[16:19], v3 offset:0
    ds_read_b128 v[20:23], v3 offset:512
    ds_read_b128 v[24:27], v3 offset:1024
    ds_read_b128 v[28:31], v3 offset:1536
    ds_read_b128 v[32:35], v3 offset:2048
    ds_read_b128 v[36:39], v3 offset:2560
    ds_read_b128 v[40:43], v3 offset:3072
    s_waitcnt lgkmcnt(6)
    v_smfmac_f32_16x16x64_f16 v[44:47], v[16:19], v[144:151], v5
    ds_read_b128 v[16:19], v6 offset:0
    s_waitcnt lgkmcnt(6)
    v_smfmac_f32_16x16x64_f16 v[44:47], v[20:23], v[152:159], v5
    ds_read_b128 v[20:23], v6 offset:512
    s_waitcnt lgkmcnt(6)
    v_smfmac_f32_16x16x64_f16 v[44:47], v[24:27], v[160:167], v5
    ds_read_b128 v[24:27], v6 offset:1024
    s_waitcnt lgkmcnt(6)
    v_smfmac_f32_16x16x64_f16 v[44:47], v[28:31], v[168:175], v5
    ds_read_b128 v[28:31], v6 offset:1536
    s_waitcnt lgkmcnt(6)
    v_smfmac_f32_16x16x64_f16 v[44:47], v[32:35], v[176:183], v5
    ds_read_b128 v[32:35], v6 offset:2048
    s_waitcnt lgkmcnt(6)
    v_smfmac_f32_16x16x64_f16 v[44:47], v[36:39], v[184:191], v5
    ds_read_b128 v[36:39], v6 offset:2560
    s_waitcnt lgkmcnt(6)
    v_smfmac_f32_16x16x64_f16 v[44:47], v[40:43], v[192:199], v5
    ds_read_b128 v[40:43], v6 offset:3072
    s_waitcnt lgkmcnt(6)
    v_smfmac_f32_16x16x64_f16 v[44:47], v[16:19], v[200:207], v5
    s_waitcnt lgkmcnt(5)
    v_smfmac_f32_16x16x64_f16 v[44:47], v[20:23], v[208:215], v5
    s_waitcnt lgkmcnt(4)
    v_smfmac_f32_16x16x64_f16 v[44:47], v[24:27], v[216:223], v5
    s_waitcnt lgkmcnt(3)
    v_smfmac_f32_16x16x64_f16 v[44:47], v[28:31], v[224:231], v5
    s_waitcnt lgkmcnt(2)
    v_smfmac_f32_16x16x64_f16 v[44:47], v[32:35], v[232:239], v5
    s_waitcnt lgkmcnt(1)
    v_smfmac_f32_16x16x64_f16 v[44:47], v[36:39], v[240:247], v5
    s_waitcnt lgkmcnt(0)
    v_smfmac_f32_16x16x64_f16 v[44:47], v[40:43], v[248:255], v5
    s_nop 7
    v_cvt_pk_f16_f32 v44, v44, v46
    v_cvt_pk_f16_f32 v45, v45, v47
    ds_write2_b32 v7, v44, v45 offset0:0 offset1:4
H4_uc:
    v_xor_b32 v52, s19, v52
    v_bitop3_b32 v52, v52, v53, s19 bitop3:0xf6
    v_bitop3_b32 v52, v52, v54, s19 bitop3:0xf6
    v_bitop3_b32 v52, v52, v55, s19 bitop3:0xf6
    v_bitop3_b32 v52, v52, v56, s19 bitop3:0xf6
    v_bitop3_b32 v52, v52, v57, s19 bitop3:0xf6
    v_bitop3_b32 v52, v52, v58, s19 bitop3:0xf6
    v_bitop3_b32 v52, v52, v59, s19 bitop3:0xf6
    v_cmp_ne_u32 vcc, 0, v52
    s_cbranch_vccnz H4_ure
    s_waitcnt lgkmcnt(0)
    s_barrier
    s_setprio 0
    s_barrier
    global_load_dword v68, v96, s[56:57] sc1
    s_add_u32 s50, s24, 4
    s_min_u32 s50, s50, 63
    s_lshl_b32 s50, s50, 11
    s_add_u32 s50, s52, s50
    s_addc_u32 s51, s53, 0
    global_load_dwordx4 v[52:55], v60, s[50:51] offset:0 sc1
    global_load_dwordx4 v[56:59], v60, s[50:51] offset:1024 sc1
    s_barrier
    s_add_u32 s58, s30, 3584
    s_addc_u32 s59, s31, 0
    global_load_dwordx4 v[68:71], v14, s[58:59] offset:-3584 sc1
    global_load_dwordx4 v[72:75], v14, s[58:59] offset:3584 sc1
    s_add_u32 s24, s24, 1
    s_add_u32 s50, s24, 1
    s_and_b32 s50, s50, 3
    s_mul_i32 s50, s50, 16384
    s_add_u32 s30, s26, s50
    s_addc_u32 s31, s27, 0
    s_add_u32 s54, s54, 458752
    s_addc_u32 s55, s55, 0
    s_add_u32 s56, s56, 458752
    s_addc_u32 s57, s57, 0
    v_mov_b32 v44, 0
    v_mov_b32 v45, 0
    v_mov_b32 v46, 0
    v_mov_b32 v47, 0
    s_setprio 1
    s_branch H4_loop
H4_mre:
    global_load_dwordx4 v[68:71], v14, s[58:59] offset:-3584 sc1
    global_load_dwordx4 v[72:75], v14, s[58:59] offset:3584 sc1
    s_sub_u32 s25, s25, 1
    s_cbranch_scc1 M_end
    s_waitcnt lgkmcnt(0)
    s_branch H4_loop
H4_ure:
    s_add_u32 s50, s24, 3
    s_min_u32 s50, s50, 63
    s_lshl_b32 s50, s50, 11
    s_add_u32 s50, s52, s50
    s_addc_u32 s51, s53, 0
    global_load_dwordx4 v[52:55], v60, s[50:51] offset:0 sc1
    global_load_dwordx4 v[56:59], v60, s[50:51] offset:1024 sc1
    s_sub_u32 s25, s25, 1
    s_cbranch_scc1 M_end
    s_waitcnt vmcnt(0)
    s_branch H4_uc
H4_fin:
    s_setprio 0
    s_waitcnt vmcnt(0)
    s_endpgm
H5_entry:
    s_add_u32 s50, s24, 0
    s_and_b32 s50, s50, 3
    s_mul_i32 s50, s50, 24576
    s_add_u32 s34, s28, s50
    s_addc_u32 s35, s29, 0
    s_add_u32 s50, s24, 3
    s_and_b32 s50, s50, 3
    s_mul_i32 s50, s50, 24576
    s_add_u32 s36, s28, s50
    s_addc_u32 s37, s29, 0
    s_add_u32 s50, s24, 1
    s_and_b32 s50, s50, 3
    s_mul_i32 s50, s50, 16384
    s_add_u32 s30, s26, s50
    s_addc_u32 s31, s27, 0
    s_add_u32 s54, s54, 458752
    s_addc_u32 s55, s55, 0
    v_mov_b32 v44, 0
    v_mov_b32 v45, 0
    v_mov_b32 v46, 0
    v_mov_b32 v47, 0
    s_setprio 1
    s_branch H5_top
.p2align 6
H5_loop:
    s_waitcnt vmcnt(0)
    v_pk_add_f16 v16, v68, v72
    v_pk_add_f16 v17, v69, v73
    v_pk_add_f16 v18, v70, v74
    v_pk_add_f16 v19, v71, v75
    ds_write_b128 v14, v[16:19]
    v_pk_maximum3_f16 v20, v16, v17, v18
    v_pk_maximum3_f16 v20, v20, v19, v19
    v_cmp_u_f16 vcc, v20, v20
    s_cbranch_vccnz H5_mre
H5_got:
H5_top:
    s_cmp_eq_u32 s24, 63
    s_waitcnt lgkmcnt(0)
    s_barrier
    s_cbranch_scc1 H5_fin
    ds_read_b128 v[16:19], v3 offset:0
    ds_read_b128 v[20:23], v3 offset:512
    ds_read_b128 v[24:27], v3 offset:1024
    ds_read_b128 v[28:31], v3 offset:1536
    ds_read_b128 v[32:35], v3 offset:2048
    ds_read_b128 v[36:39], v3 offset:2560
    ds_read_b128 v[40:43], v3 offset:3072
    s_waitcnt lgkmcnt(6)
    v_smfmac_f32_16x16x64_f16 v[44:47], v[16:19], v[144:151], v5
    ds_read_b128 v[16:19], v6 offset:0
    s_waitcnt lgkmcnt(6)
    v_smfmac_f32_16x16x64_f16 v[44:47], v[20:23], v[152:159], v5
    ds_read_b128 v[20:23], v6 offset:512
    s_waitcnt lgkmcnt(6)
    v_smfmac_f32_16x16x64_f16 v[44:47], v[24:27], v[160:167], v5
    ds_read_b128 v[24:27], v6 offset:1024
    s_waitcnt lgkmcnt(6)
    v_smfmac_f32_16x16x64_f16 v[44:47], v[28:31], v[168:175], v5
    ds_read_b128 v[28:31], v6 offset:1536
    s_waitcnt lgkmcnt(6)
    v_smfmac_f32_16x16x64_f16 v[44:47], v[32:35], v[176:183], v5
    ds_read_b128 v[32:35], v6 offset:2048
    s_waitcnt lgkmcnt(6)
    v_smfmac_f32_16x16x64_f16 v[44:47], v[36:39], v[184:191], v5
    ds_read_b128 v[36:39], v6 offset:2560
    s_waitcnt lgkmcnt(6)
    v_smfmac_f32_16x16x64_f16 v[44:47], v[40:43], v[192:199], v5
    ds_read_b128 v[40:43], v6 offset:3072
    s_waitcnt lgkmcnt(6)
    v_smfmac_f32_16x16x64_f16 v[44:47], v[16:19], v[200:207], v5
    s_waitcnt lgkmcnt(5)
    v_smfmac_f32_16x16x64_f16 v[44:47], v[20:23], v[208:215], v5
    s_waitcnt lgkmcnt(4)
    v_smfmac_f32_16x16x64_f16 v[44:47], v[24:27], v[216:223], v5
    s_waitcnt lgkmcnt(3)
    v_smfmac_f32_16x16x64_f16 v[44:47], v[28:31], v[224:231], v5
    s_waitcnt lgkmcnt(2)
    v_smfmac_f32_16x16x64_f16 v[44:47], v[32:35], v[232:239], v5
    s_waitcnt lgkmcnt(1)
    v_smfmac_f32_16x16x64_f16 v[44:47], v[36:39], v[240:247], v5
    s_waitcnt lgkmcnt(0)
    v_smfmac_f32_16x16x64_f16 v[44:47], v[40:43], v[248:255], v5
    s_nop 7
    v_cvt_pk_f16_f32 v44, v44, v46
    v_cvt_pk_f16_f32 v45, v45, v47
    ds_write2_b32 v7, v44, v45 offset0:0 offset1:4
    s_waitcnt lgkmcnt(0)
    s_waitcnt vmcnt(0)
    s_barrier
    s_setprio 0
    ds_read2_b64 v[68:71], v8 offset0:0 offset1:16
    ds_read2_b64 v[72:75], v8 offset0:64 offset1:80
    ds_read2_b64 v[76:79], v8 offset0:128 offset1:144
    ds_read2_b64 v[80:83], v8 offset0:192 offset1:208
    ds_read2_b64 v[84:87], v10 offset0:0 offset1:16
    ds_read2_b64 v[88:91], v10 offset0:64 offset1:80
    ds_read2_b64 v[92:95], v10 offset0:128 offset1:144
    s_waitcnt lgkmcnt(6)
    v_mfma_f32_16x16x32_f16 v[44:47], v[16:19], v[68:71], 0
    s_waitcnt lgkmcnt(5)
    v_mfma_f32_16x16x32_f16 v[44:47], v[20:23], v[72:75], v[44:47]
    s_waitcnt lgkmcnt(4)
    v_mfma_f32_16x16x32_f16 v[44:47], v[24:27], v[76:79], v[44:47]
    s_waitcnt lgkmcnt(3)
    v_mfma_f32_16x16x32_f16 v[44:47], v[28:31], v[80:83], v[44:47]
    s_waitcnt lgkmcnt(2)
    v_mfma_f32_16x16x32_f16 v[44:47], v[32:35], v[84:87], v[44:47]
    s_waitcnt lgkmcnt(1)
    v_mfma_f32_16x16x32_f16 v[44:47], v[36:39], v[88:91], v[44:47]
    s_waitcnt lgkmcnt(0)
    v_mfma_f32_16x16x32_f16 v[44:47], v[40:43], v[92:95], v[44:47]
    s_mov_b64 exec, s[46:47]
    v_mov_b32 v78, -1
    s_nop 5
    v_cvt_pk_f16_f32 v76, v44, v45
    global_store_dword v9, v76, s[34:35]
    global_store_dword v9, v78, s[36:37]
    s_mov_b64 exec, -1
    s_setprio 0
    s_barrier
    global_load_dword v68, v11, s[26:27] sc1
    global_load_dword v69, v11, s[26:27] sc1
H5_fl:
    s_sub_u32 s25, s25, 1
    s_cbranch_scc1 M_end
    global_load_dword v70, v11, s[26:27] sc1
    s_waitcnt vmcnt(2)
    v_cmp_gt_i32 vcc, s24, v68
    s_cbranch_vccz H5_fd
    global_load_dword v68, v11, s[26:27] sc1
    s_waitcnt vmcnt(2)
    v_cmp_gt_i32 vcc, s24, v69
    s_cbranch_vccz H5_fd
    global_load_dword v69, v11, s[26:27] sc1
    s_waitcnt vmcnt(2)
    v_cmp_gt_i32 vcc, s24, v70
    s_cbranch_vccnz H5_fl
H5_fd:
    s_barrier
    s_add_u32 s58, s30, 3584
    s_addc_u32 s59, s31, 0
    global_load_dwordx4 v[68:71], v14, s[58:59] offset:-3584 sc1
    global_load_dwordx4 v[72:75], v14, s[58:59] offset:3584 sc1
    s_add_u32 s24, s24, 1
    s_add_u32 s50, s24, 0
    s_and_b32 s50, s50, 3
    s_mul_i32 s50, s50, 24576
    s_add_u32 s34, s28, s50
    s_addc_u32 s35, s29, 0
    s_add_u32 s50, s24, 3
    s_and_b32 s50, s50, 3
    s_mul_i32 s50, s50, 24576
    s_add_u32 s36, s28, s50
    s_addc_u32 s37, s29, 0
    s_add_u32 s50, s24, 1
    s_and_b32 s50, s50, 3
    s_mul_i32 s50, s50, 16384
    s_add_u32 s30, s26, s50
    s_addc_u32 s31, s27, 0
    s_add_u32 s54, s54, 458752
    s_addc_u32 s55, s55, 0
    v_mov_b32 v44, 0
    v_mov_b32 v45, 0
    v_mov_b32 v46, 0
    v_mov_b32 v47, 0
    s_setprio 1
    s_branch H5_loop
H5_mre:
    global_load_dwordx4 v[68:71], v14, s[58:59] offset:-3584 sc1
    global_load_dwordx4 v[72:75], v14, s[58:59] offset:3584 sc1
    s_sub_u32 s25, s25, 1
    s_cbranch_scc1 M_end
    s_waitcnt lgkmcnt(0)
    s_branch H5_loop
H5_fin:
    s_setprio 0
    s_waitcnt vmcnt(0)
    s_endpgm
H6_entry:
    s_add_u32 s50, s24, 0
    s_and_b32 s50, s50, 3
    s_mul_i32 s50, s50, 24576
    s_add_u32 s34, s28, s50
    s_addc_u32 s35, s29, 0
    s_add_u32 s50, s24, 3
    s_and_b32 s50, s50, 3
    s_mul_i32 s50, s50, 24576
    s_add_u32 s36, s28, s50
    s_addc_u32 s37, s29, 0
    s_add_u32 s50, s24, 1
    s_and_b32 s50, s50, 3
    s_mul_i32 s50, s50, 16384
    s_add_u32 s30, s26, s50
    s_addc_u32 s31, s27, 0
    s_add_u32 s50, s24, 3
    s_and_b32 s50, s50, 3
    s_mul_i32 s50, s50, 16384
    s_add_u32 s32, s26, s50
    s_addc_u32 s33, s27, 0
    s_add_u32 s42, s42, 28672
    s_addc_u32 s43, s43, 0
    s_add_u32 s54, s54, 458752
    s_addc_u32 s55, s55, 0
    v_mov_b32 v44, 0
    v_mov_b32 v45, 0
    v_mov_b32 v46, 0
    v_mov_b32 v47, 0
    s_setprio 1
    s_branch H6_top
.p2align 6
H6_loop:
    s_cmp_eq_u32 s24, 63
    s_cbranch_scc1 H6_top
    s_waitcnt vmcnt(0)
H6_got:
H6_top:
    s_cmp_eq_u32 s24, 63
    s_waitcnt lgkmcnt(0)
    s_barrier
    s_cbranch_scc1 H6_fin
    ds_read_b128 v[16:19], v3 offset:0
    ds_read_b128 v[20:23], v3 offset:512
    ds_read_b128 v[24:27], v3 offset:1024
    ds_read_b128 v[28:31], v3 offset:1536
    ds_read_b128 v[32:35], v3 offset:2048
    ds_read_b128 v[36:39], v3 offset:2560
    ds_read_b128 v[40:43], v3 offset:3072
    s_waitcnt lgkmcnt(6)
    v_smfmac_f32_16x16x64_f16 v[44:47], v[16:19], v[144:151], v5
    ds_read_b128 v[16:19], v6 offset:0
    s_waitcnt lgkmcnt(6)
    v_smfmac_f32_16x16x64_f16 v[44:47], v[20:23], v[152:159], v5
    ds_read_b128 v[20:23], v6 offset:512
    s_waitcnt lgkmcnt(6)
    v_smfmac_f32_16x16x64_f16 v[44:47], v[24:27], v[160:167], v5
    ds_read_b128 v[24:27], v6 offset:1024
    s_waitcnt lgkmcnt(6)
    v_smfmac_f32_16x16x64_f16 v[44:47], v[28:31], v[168:175], v5
    ds_read_b128 v[28:31], v6 offset:1536
    s_waitcnt lgkmcnt(6)
    v_smfmac_f32_16x16x64_f16 v[44:47], v[32:35], v[176:183], v5
    ds_read_b128 v[32:35], v6 offset:2048
    s_waitcnt lgkmcnt(6)
    v_smfmac_f32_16x16x64_f16 v[44:47], v[36:39], v[184:191], v5
    ds_read_b128 v[36:39], v6 offset:2560
    s_waitcnt lgkmcnt(6)
    v_smfmac_f32_16x16x64_f16 v[44:47], v[40:43], v[192:199], v5
    ds_read_b128 v[40:43], v6 offset:3072
    s_waitcnt lgkmcnt(6)
    v_smfmac_f32_16x16x64_f16 v[44:47], v[16:19], v[200:207], v5
    s_waitcnt lgkmcnt(5)
    v_smfmac_f32_16x16x64_f16 v[44:47], v[20:23], v[208:215], v5
    s_waitcnt lgkmcnt(4)
    v_smfmac_f32_16x16x64_f16 v[44:47], v[24:27], v[216:223], v5
    s_waitcnt lgkmcnt(3)
    v_smfmac_f32_16x16x64_f16 v[44:47], v[28:31], v[224:231], v5
    s_waitcnt lgkmcnt(2)
    v_smfmac_f32_16x16x64_f16 v[44:47], v[32:35], v[232:239], v5
    s_waitcnt lgkmcnt(1)
    v_smfmac_f32_16x16x64_f16 v[44:47], v[36:39], v[240:247], v5
    s_waitcnt lgkmcnt(0)
    v_smfmac_f32_16x16x64_f16 v[44:47], v[40:43], v[248:255], v5
    s_nop 7
    v_cvt_pk_f16_f32 v44, v44, v46
    v_cvt_pk_f16_f32 v45, v45, v47
    ds_write2_b32 v7, v44, v45 offset0:0 offset1:4
    s_waitcnt lgkmcnt(0)
    s_barrier
    s_setprio 0
    ds_read_b128 v[52:55], v8 offset:0
    ds_read_b128 v[56:59], v8 offset:512
    ds_read_b128 v[60:63], v8 offset:1024
    ds_read_b128 v[64:67], v8 offset:1536
    ds_read_b128 v[48:51], v8 offset:2048
    s_waitcnt lgkmcnt(4)
    v_mfma_f32_16x16x32_f16 v[44:47], v[68:71], v[52:55], 0
    ds_read_b128 v[52:55], v8 offset:2560
    s_waitcnt lgkmcnt(4)
    v_mfma_f32_16x16x32_f16 v[44:47], v[72:75], v[56:59], v[44:47]
    ds_read_b128 v[56:59], v8 offset:3072
    s_waitcnt lgkmcnt(4)
    v_mfma_f32_16x16x32_f16 v[44:47], v[76:79], v[60:63], v[44:47]
    s_waitcnt lgkmcnt(3)
    v_mfma_f32_16x16x32_f16 v[44:47], v[80:83], v[64:67], v[44:47]
    s_waitcnt lgkmcnt(2)
    v_mfma_f32_16x16x32_f16 v[44:47], v[84:87], v[48:51], v[44:47]
    s_waitcnt lgkmcnt(1)
    v_mfma_f32_16x16x32_f16 v[44:47], v[88:91], v[52:55], v[44:47]
    s_waitcnt lgkmcnt(0)
    v_mfma_f32_16x16x32_f16 v[44:47], v[92:95], v[56:59], v[44:47]
    s_mov_b64 exec, s[46:47]
    v_mov_b32 v62, -1
    v_mov_b32 v63, -1
    s_nop 4
    v_cvt_pk_f16_f32 v60, v44, v45
    v_cvt_pk_f16_f32 v61, v46, v47
    global_store_dwordx2 v9, v[60:61], s[34:35]
    global_store_dwordx2 v9, v[62:63], s[36:37]
    s_mov_b64 exec, -1
    s_setprio 0
    s_barrier
    global_load_dwordx4 v[68:71], v2, s[42:43] offset:-4096 sc1
    global_load_dwordx4 v[72:75], v2, s[42:43] offset:-3072 sc1
    global_load_dwordx4 v[76:79], v2, s[42:43] offset:-2048 sc1
    global_load_dwordx4 v[80:83], v2, s[42:43] offset:-1024 sc1
    global_load_dwordx4 v[84:87], v2, s[42:43] offset:0 sc1
    global_load_dwordx4 v[88:91], v2, s[42:43] offset:1024 sc1
    global_load_dwordx4 v[92:95], v2, s[42:43] offset:2048 sc1
    s_barrier
    s_add_u32 s58, s30, 3584
    s_addc_u32 s59, s31, 0
    s_add_u32 s24, s24, 1
    s_add_u32 s50, s24, 0
    s_and_b32 s50, s50, 3
    s_mul_i32 s50, s50, 24576
    s_add_u32 s34, s28, s50
    s_addc_u32 s35, s29, 0
    s_add_u32 s50, s24, 3
    s_and_b32 s50, s50, 3
    s_mul_i32 s50, s50, 24576
    s_add_u32 s36, s28, s50
    s_addc_u32 s37, s29, 0
    s_add_u32 s50, s24, 1
    s_and_b32 s50, s50, 3
    s_mul_i32 s50, s50, 16384
    s_add_u32 s30, s26, s50
    s_addc_u32 s31, s27, 0
    s_add_u32 s50, s24, 3
    s_and_b32 s50, s50, 3
    s_mul_i32 s50, s50, 16384
    s_add_u32 s32, s26, s50
    s_addc_u32 s33, s27, 0
    s_add_u32 s42, s42, 28672
    s_addc_u32 s43, s43, 0
    s_add_u32 s54, s54, 458752
    s_addc_u32 s55, s55, 0
    v_mov_b32 v44, 0
    v_mov_b32 v45, 0
    v_mov_b32 v46, 0
    v_mov_b32 v47, 0
    s_setprio 1
    s_branch H6_loop
H6_fin:
    s_setprio 0
    s_endpgm
H7_entry:
    s_add_u32 s50, s24, 0
    s_and_b32 s50, s50, 3
    s_mul_i32 s50, s50, 24576
    s_add_u32 s34, s28, s50
    s_addc_u32 s35, s29, 0
    s_add_u32 s50, s24, 3
    s_and_b32 s50, s50, 3
    s_mul_i32 s50, s50, 24576
    s_add_u32 s36, s28, s50
    s_addc_u32 s37, s29, 0
    s_add_u32 s50, s24, 1
    s_and_b32 s50, s50, 3
    s_mul_i32 s50, s50, 16384
    s_add_u32 s30, s26, s50
    s_addc_u32 s31, s27, 0
    s_add_u32 s42, s42, 28672
    s_addc_u32 s43, s43, 0
    s_add_u32 s54, s54, 458752
    s_addc_u32 s55, s55, 0
    s_setprio 1
    s_branch H7_top
.p2align 6
H7_loop:
    s_waitcnt vmcnt(0)
    v_pk_add_f16 v16, v208, v212
    v_pk_add_f16 v17, v209, v213
    v_pk_add_f16 v18, v210, v214
    v_pk_add_f16 v19, v211, v215
    ds_write_b128 v14, v[16:19]
    v_pk_maximum3_f16 v20, v16, v17, v18
    v_pk_maximum3_f16 v20, v20, v19, v19
    v_cmp_u_f16 vcc, v20, v20
    s_cbranch_vccnz H7_mre
H7_got:
H7_top:
    s_cmp_eq_u32 s24, 63
    s_waitcnt lgkmcnt(0)
    s_barrier
    s_cbranch_scc1 H7_fin
    global_load_dword v124, v10, s[44:45] sc1
    s_barrier
    s_setprio 0
    ds_read_b128 v[224:227], v8 offset:0
    ds_read_b128 v[228:231], v8 offset:512
    ds_read_b128 v[232:235], v8 offset:1024
    ds_read_b128 v[236:239], v8 offset:1536
    ds_read_b128 v[240:243], v8 offset:2048
    ds_read_b128 v[244:247], v8 offset:2560
    ds_read_b128 v[248:251], v8 offset:3072
    s_waitcnt lgkmcnt(6)
    v_mfma_f32_16x16x32_f16 v[252:255], v[68:71], v[224:227], 0
    s_waitcnt lgkmcnt(5)
    v_mfma_f32_16x16x32_f16 v[252:255], v[72:75], v[228:231], v[252:255]
    s_waitcnt lgkmcnt(4)
    v_mfma_f32_16x16x32_f16 v[252:255], v[76:79], v[232:235], v[252:255]
    s_waitcnt lgkmcnt(3)
    v_mfma_f32_16x16x32_f16 v[252:255], v[80:83], v[236:239], v[252:255]
    s_waitcnt lgkmcnt(2)
    v_mfma_f32_16x16x32_f16 v[252:255], v[84:87], v[240:243], v[252:255]
    s_waitcnt lgkmcnt(1)
    v_mfma_f32_16x16x32_f16 v[252:255], v[88:91], v[244:247], v[252:255]
    s_waitcnt lgkmcnt(0)
    v_mfma_f32_16x16x32_f16 v[252:255], v[92:95], v[248:251], v[252:255]
    s_mov_b64 exec, s[46:47]
    v_mov_b32 v234, -1
    v_mov_b32 v235, -1
    s_nop 4
    v_cvt_pk_f16_f32 v232, v252, v253
    v_cvt_pk_f16_f32 v233, v254, v255
    global_store_dwordx2 v9, v[232:233], s[34:35]
    global_store_dwordx2 v9, v[234:235], s[36:37]
    s_mov_b64 exec, -1
    s_setprio 0
    s_barrier
    global_load_dwordx4 v[68:71], v2, s[42:43] offset:-4096 sc1
    global_load_dwordx4 v[72:75], v2, s[42:43] offset:-3072 sc1
    global_load_dwordx4 v[76:79], v2, s[42:43] offset:-2048 sc1
    global_load_dwordx4 v[80:83], v2, s[42:43] offset:-1024 sc1
    global_load_dwordx4 v[84:87], v2, s[42:43] offset:0 sc1
    global_load_dwordx4 v[88:91], v2, s[42:43] offset:1024 sc1
    global_load_dwordx4 v[92:95], v2, s[42:43] offset:2048 sc1
    s_barrier
    s_add_u32 s58, s30, 3584
    s_addc_u32 s59, s31, 0
    global_load_dwordx4 v[208:211], v14, s[58:59] offset:-3584 sc1
    global_load_dwordx4 v[212:215], v14, s[58:59] offset:3584 sc1
    s_add_u32 s24, s24, 1
    s_add_u32 s50, s24, 0
    s_and_b32 s50, s50, 3
    s_mul_i32 s50, s50, 24576
    s_add_u32 s34, s28, s50
    s_addc_u32 s35, s29, 0
    s_add_u32 s50, s24, 3
    s_and_b32 s50, s50, 3
    s_mul_i32 s50, s50, 24576
    s_add_u32 s36, s28, s50
    s_addc_u32 s37, s29, 0
    s_add_u32 s50, s24, 1
    s_and_b32 s50, s50, 3
    s_mul_i32 s50, s50, 16384
    s_add_u32 s30, s26, s50
    s_addc_u32 s31, s27, 0
    s_add_u32 s42, s42, 28672
    s_addc_u32 s43, s43, 0
    s_add_u32 s54, s54, 458752
    s_addc_u32 s55, s55, 0
    s_add_u32 s40, s40, 114688
    s_addc_u32 s41, s41, 0
    s_add_u32 s44, s44, 28672
    s_addc_u32 s45, s45, 0
    s_setprio 1
    s_branch H7_loop
H7_mre:
    global_load_dwordx4 v[208:211], v14, s[58:59] offset:-3584 sc1
    global_load_dwordx4 v[212:215], v14, s[58:59] offset:3584 sc1
    s_sub_u32 s25, s25, 1
    s_cbranch_scc1 M_end
    s_waitcnt lgkmcnt(0)
    s_branch H7_loop
H7_fin:
    s_setprio 0
    s_waitcnt vmcnt(0)
    s_endpgm
CH_mixed:
    s_cmp_eq_u32 s23, 0
    s_cbranch_scc1 XCH_hdisp
    s_cmp_eq_u32 s14, 3
    s_cbranch_scc1 XC3_entry
    s_cmp_eq_u32 s14, 4
    s_cbranch_scc1 XC4_entry
    s_cmp_eq_u32 s14, 5
    s_cbranch_scc1 XC5_entry
    s_cmp_eq_u32 s14, 6
    s_cbranch_scc1 XC6_entry
    s_cmp_eq_u32 s14, 7
    s_cbranch_scc1 XC7_entry
XC0_entry:
    s_add_u32 s50, s24, 0
    s_and_b32 s50, s50, 3
    s_mul_i32 s50, s50, 24576
    s_add_u32 s34, s28, s50
    s_addc_u32 s35, s29, 0
    s_add_u32 s50, s24, 1
    s_and_b32 s50, s50, 3
    s_mul_i32 s50, s50, 16384
    s_add_u32 s30, s26, s50
    s_addc_u32 s31, s27, 0
    ds_read_b128 v[52:55], v15 offset:0
    ds_read_b128 v[56:59], v15 offset:1024
    ds_read_b128 v[60:63], v15 offset:2048
    ds_read_b128 v[64:67], v15 offset:3072
    v_mov_b32 v84, 0
    v_mov_b32 v85, 0
    v_mov_b32 v86, 0
    v_mov_b32 v87, 0
    v_mov_b32 v44, 0
    v_mov_b32 v45, 0
    v_mov_b32 v46, 0
    v_mov_b32 v47, 0
    v_mov_b32 v48, 0
    v_mov_b32 v49, 0
    v_mov_b32 v50, 0
    v_mov_b32 v51, 0
    s_setprio 1
    s_branch XC0_top
.p2align 6
XC0_loop:
    s_waitcnt vmcnt(0)
    v_pk_add_f16 v16, v68, v72
    v_pk_add_f16 v17, v69, v73
    v_pk_add_f16 v18, v70, v74
    v_pk_add_f16 v19, v71, v75
    ds_write_b128 v14, v[16:19]
    v_pk_maximum3_f16 v20, v16, v17, v18
    v_pk_maximum3_f16 v20, v20, v19, v19
    v_cmp_u_f16 vcc, v20, v20
    s_cbranch_vccnz XC0_mre
XC0_got:
XC0_top:
    s_cmp_eq_u32 s24, 63
    s_waitcnt lgkmcnt(0)
    s_barrier
    s_cbranch_scc1 XC0_fin
    ds_read_b128 v[16:19], v3 offset:0
    ds_read_b128 v[20:23], v3 offset:512
    ds_read_b128 v[24:27], v3 offset:1024
    ds_read_b128 v[28:31], v3 offset:1536
    ds_read_b128 v[32:35], v3 offset:2048
    ds_read_b128 v[36:39], v3 offset:2560
    s_waitcnt lgkmcnt(5)
    v_smfmac_f32_16x16x64_f16 v[84:87], v[16:19], v[144:151], v5
    ds_read_b128 v[40:43], v3 offset:3072
    s_waitcnt lgkmcnt(5)
    v_smfmac_f32_16x16x64_f16 v[84:87], v[20:23], v[152:159], v5
    ds_read_b128 v[16:19], v6 offset:0
    s_waitcnt lgkmcnt(5)
    v_smfmac_f32_16x16x64_f16 v[84:87], v[24:27], v[160:167], v5
    ds_read_b128 v[20:23], v6 offset:512
    s_waitcnt lgkmcnt(5)
    v_smfmac_f32_16x16x64_f16 v[84:87], v[28:31], v[168:175], v5
    ds_read_b128 v[24:27], v6 offset:1024
    s_waitcnt lgkmcnt(5)
    v_smfmac_f32_16x16x64_f16 v[84:87], v[32:35], v[176:183], v5
    ds_read_b128 v[28:31], v6 offset:1536
    s_waitcnt lgkmcnt(5)
    v_smfmac_f32_16x16x64_f16 v[84:87], v[36:39], v[184:191], v5
    ds_read_b128 v[32:35], v6 offset:2048
    s_waitcnt lgkmcnt(5)
    v_smfmac_f32_16x16x64_f16 v[84:87], v[40:43], v[192:199], v5
    ds_read_b128 v[36:39], v6 offset:2560
    s_waitcnt lgkmcnt(5)
    v_smfmac_f32_16x16x64_f16 v[84:87], v[16:19], v[200:207], v5
    ds_read_b128 v[40:43], v6 offset:3072
    s_waitcnt lgkmcnt(5)
    v_smfmac_f32_16x16x64_f16 v[84:87], v[20:23], v[208:215], v5
    s_waitcnt lgkmcnt(4)
    v_smfmac_f32_16x16x64_f16 v[84:87], v[24:27], v[216:223], v5
    s_waitcnt lgkmcnt(3)
    v_smfmac_f32_16x16x64_f16 v[84:87], v[28:31], v[224:231], v5
    s_waitcnt lgkmcnt(2)
    v_smfmac_f32_16x16x64_f16 v[84:87], v[32:35], v[232:239], v5
    s_waitcnt lgkmcnt(1)
    v_smfmac_f32_16x16x64_f16 v[84:87], v[36:39], v[240:247], v5
    s_waitcnt lgkmcnt(0)
    v_smfmac_f32_16x16x64_f16 v[84:87], v[40:43], v[248:255], v5
    global_load_dwordx4 v[68:71], v13, s[38:39] offset:0 sc1
    global_load_dwordx4 v[72:75], v13, s[38:39] offset:1024 sc1
    s_nop 5
    v_cvt_pk_f16_f32 v84, v84, v86
    v_cvt_pk_f16_f32 v85, v85, v87
    ds_write2_b32 v7, v84, v85 offset0:0 offset1:4
    s_setprio 0
    global_load_dwordx4 v[76:79], v13, s[38:39] offset:2048 sc1
    global_load_dwordx4 v[80:83], v13, s[38:39] offset:3072 sc1
    v_smfmac_f32_16x16x64_f16 v[44:47], v[28:31], v[52:59], v5
    ds_read_b128 v[52:55], v15 offset:4096
    ds_read_b128 v[56:59], v15 offset:5120
    v_smfmac_f32_16x16x64_f16 v[44:47], v[16:19], v[96:103], v5
    v_smfmac_f32_16x16x64_f16 v[48:51], v[28:31], v[60:67], v5
    ds_read_b128 v[60:63], v15 offset:6144
    ds_read_b128 v[64:67], v15 offset:7168
    v_smfmac_f32_16x16x64_f16 v[48:51], v[16:19], v[104:111], v5
    s_waitcnt lgkmcnt(4)
    s_barrier
    s_waitcnt lgkmcnt(2)
    v_smfmac_f32_16x16x64_f16 v[44:47], v[32:35], v[52:59], v5
    ds_read_b128 v[52:55], v15 offset:8192
    ds_read_b128 v[56:59], v15 offset:9216
    v_smfmac_f32_16x16x64_f16 v[44:47], v[20:23], v[112:119], v5
    s_waitcnt lgkmcnt(2)
    v_smfmac_f32_16x16x64_f16 v[48:51], v[32:35], v[60:67], v5
    ds_read_b128 v[60:63], v15 offset:10240
    ds_read_b128 v[64:67], v15 offset:11264
    v_smfmac_f32_16x16x64_f16 v[48:51], v[20:23], v[120:127], v5
    s_barrier
    s_waitcnt lgkmcnt(2)
    v_smfmac_f32_16x16x64_f16 v[44:47], v[36:39], v[52:59], v5
    ds_read_b128 v[52:55], v15 offset:12288
    ds_read_b128 v[56:59], v15 offset:13312
    v_smfmac_f32_16x16x64_f16 v[44:47], v[24:27], v[128:135], v5
    s_waitcnt lgkmcnt(2)
    v_smfmac_f32_16x16x64_f16 v[48:51], v[36:39], v[60:67], v5
    ds_read_b128 v[60:63], v15 offset:14336
    ds_read_b128 v[64:67], v15 offset:15360
    v_smfmac_f32_16x16x64_f16 v[48:51], v[24:27], v[136:143], v5
    s_waitcnt lgkmcnt(2)
    v_smfmac_f32_16x16x64_f16 v[44:47], v[40:43], v[52:59], v5
    s_waitcnt lgkmcnt(0)
    v_smfmac_f32_16x16x64_f16 v[48:51], v[40:43], v[60:67], v5
    v_mov_b32 v52, 0x3c003c00
    v_mov_b32 v53, 0x3c003c00
    v_mov_b32 v54, 0x3c003c00
    v_mov_b32 v55, 0x3c003c00
    v_mov_b32 v56, 0x3c003c00
    v_mov_b32 v57, 0x3c003c00
    v_mov_b32 v58, 0x3c003c00
    v_mov_b32 v59, 0x3c003c00
    v_mov_b32 v60, 0
    v_mov_b32 v61, 0
    v_mov_b32 v62, 0
    v_mov_b32 v63, 0
    v_cvt_pk_f16_f32 v16, v44, v45
    v_cvt_pk_f16_f32 v17, v46, v47
    v_cvt_pk_f16_f32 v18, v48, v49
    v_cvt_pk_f16_f32 v19, v50, v51
    global_load_dwordx4 v[84:87], v10, s[34:35] sc1
    global_load_dwordx4 v[88:91], v10, s[34:35] offset:1024 sc1
    global_load_dword v92, v11, s[34:35] sc1
    global_load_dword v93, v11, s[34:35] offset:256 sc1
    v_mov_b32 v20, 0
    v_mov_b32 v21, 0
    v_mov_b32 v33, 0
    v_mov_b32 v44, 0
    v_mov_b32 v45, 0
    v_mov_b32 v46, 0
    v_mov_b32 v47, 0
    v_mov_b32 v48, 0
    v_mov_b32 v49, 0
    v_mov_b32 v50, 0
    v_mov_b32 v51, 0
XC0_sp:
    s_waitcnt vmcnt(0)
    v_pk_add_f16 v28, v84, v88
    v_pk_add_f16 v29, v85, v89
    v_pk_add_f16 v30, v86, v90
    v_pk_add_f16 v31, v87, v91
    v_pk_add_f16 v32, v92, v93
    v_pk_maximum3_f16 v34, v28, v29, v30
    v_pk_maximum3_f16 v34, v34, v31, v32
    v_pk_maximum3_f16 v34, v34, v34, v34 op_sel:[0,1,0] op_sel_hi:[1,0,1]
    v_mov_b32 v35, v34
    v_cmp_u_f16 vcc, v34, v34
    s_nop 0
    v_permlane32_swap_b32 v34, v35
    v_pk_max_f16 v34, v34, v35
    v_mov_b32 v35, v34
    s_cbranch_vccnz XC0_gre
XC0_sok:
    s_nop 0
    v_permlane16_swap_b32 v34, v35
    v_pk_max_f16 v34, v34, v35
    v_pk_add_f16 v32, v32, v34 neg_lo:[0,1] neg_hi:[0,1]
    v_pk_add_f16 v28, v28, v34 neg_lo:[0,1] neg_hi:[0,1]
    v_pk_add_f16 v29, v29, v34 neg_lo:[0,1] neg_hi:[0,1]
    v_pk_add_f16 v30, v30, v34 neg_lo:[0,1] neg_hi:[0,1]
    v_pk_add_f16 v31, v31, v34 neg_lo:[0,1] neg_hi:[0,1]
    v_exp_f16_sdwa v32, v32 dst_sel:WORD_0 dst_unused:UNUSED_PRESERVE src0_sel:WORD_0
    v_exp_f16_sdwa v28, v28 dst_sel:WORD_0 dst_unused:UNUSED_PRESERVE src0_sel:WORD_0
    s_barrier
    ds_read_b128 v[24:27], v12
    v_exp_f16_sdwa v32, v32 dst_sel:WORD_1 dst_unused:UNUSED_PRESERVE src0_sel:WORD_1
    v_exp_f16_sdwa v29, v29 dst_sel:WORD_0 dst_unused:UNUSED_PRESERVE src0_sel:WORD_0
    v_exp_f16_sdwa v28, v28 dst_sel:WORD_1 dst_unused:UNUSED_PRESERVE src0_sel:WORD_1
    v_smfmac_f32_16x16x32_f16 v[60:63], v[32:33], v[52:55], v5
    v_exp_f16_sdwa v30, v30 dst_sel:WORD_0 dst_unused:UNUSED_PRESERVE src0_sel:WORD_0
    v_exp_f16_sdwa v29, v29 dst_sel:WORD_1 dst_unused:UNUSED_PRESERVE src0_sel:WORD_1
    v_exp_f16_sdwa v31, v31 dst_sel:WORD_0 dst_unused:UNUSED_PRESERVE src0_sel:WORD_0
    v_exp_f16_sdwa v30, v30 dst_sel:WORD_1 dst_unused:UNUSED_PRESERVE src0_sel:WORD_1
    v_exp_f16_sdwa v31, v31 dst_sel:WORD_1 dst_unused:UNUSED_PRESERVE src0_sel:WORD_1
    s_nop 1
    v_smfmac_f32_16x16x64_f16 v[60:63], v[28:31], v[52:59], v5
    v_smfmac_f32_16x16x64_f16 v[44:47], v[28:31], v[68:75], v5
    v_smfmac_f32_16x16x64_f16 v[48:51], v[28:31], v[76:83], v5
    s_waitcnt lgkmcnt(0)
    v_pk_add_f16 v16, v16, v24
    v_pk_add_f16 v17, v17, v25
    v_pk_add_f16 v18, v18, v26
    v_pk_add_f16 v19, v19, v27
    s_nop 1
    v_smfmac_f32_16x16x32_f16 v[44:47], v[32:33], v[16:19], v5
    v_smfmac_f32_16x16x32_f16 v[48:51], v[32:33], v[18:21], v5
    v_rcp_f32 v36, v60
    v_rcp_f32 v37, v61
    v_rcp_f32 v38, v62
    v_rcp_f32 v39, v63
    s_nop 2
    v_pk_mul_f32 v[44:45], v[44:45], v[36:37]
    v_pk_fma_f32 v[44:45], v[46:47], v[38:39], v[44:45]
    ds_write2_b32 v9, v44, v45 offset0:0 offset1:8
    v_pk_mul_f32 v[48:49], v[48:49], v[36:37]
    v_pk_fma_f32 v[48:49], v[50:51], v[38:39], v[48:49]
    ds_write2_b32 v9, v48, v49 offset0:128 offset1:136
    ds_write_b64 v8, v[16:17] offset:0
    ds_write_b64 v8, v[18:19] offset:2048
    s_waitcnt lgkmcnt(2)
    s_barrier
    s_barrier
    s_add_u32 s58, s30, 3584
    s_addc_u32 s59, s31, 0
    s_add_u32 s24, s24, 1
    s_add_u32 s50, s24, 0
    s_and_b32 s50, s50, 3
    s_mul_i32 s50, s50, 24576
    s_add_u32 s34, s28, s50
    s_addc_u32 s35, s29, 0
    s_add_u32 s50, s24, 1
    s_and_b32 s50, s50, 3
    s_mul_i32 s50, s50, 16384
    s_add_u32 s30, s26, s50
    s_addc_u32 s31, s27, 0
    s_add_u32 s38, s38, 458752
    s_addc_u32 s39, s39, 0
    s_add_u32 s48, s48, 8192
    s_addc_u32 s49, s49, 0
    s_add_u32 s56, s56, 458752
    s_addc_u32 s57, s57, 0
    s_waitcnt vmcnt(0)
    ds_read_b128 v[52:55], v15 offset:0
    ds_read_b128 v[56:59], v15 offset:1024
    ds_read_b128 v[60:63], v15 offset:2048
    ds_read_b128 v[64:67], v15 offset:3072
    v_mov_b32 v84, 0
    v_mov_b32 v85, 0
    v_mov_b32 v86, 0
    v_mov_b32 v87, 0
    v_mov_b32 v44, 0
    v_mov_b32 v45, 0
    v_mov_b32 v46, 0
    v_mov_b32 v47, 0
    v_mov_b32 v48, 0
    v_mov_b32 v49, 0
    v_mov_b32 v50, 0
    v_mov_b32 v51, 0
    s_setprio 1
    global_load_dwordx4 v[68:71], v14, s[58:59] offset:-3584 sc1
    global_load_dwordx4 v[72:75], v14, s[58:59] offset:3584 sc1
    s_branch XC0_loop
XC0_mre:
    global_load_dwordx4 v[68:71], v14, s[58:59] offset:-3584 sc1
    global_load_dwordx4 v[72:75], v14, s[58:59] offset:3584 sc1
    s_sub_u32 s25, s25, 1
    s_cbranch_scc1 M_end
    s_waitcnt lgkmcnt(0)
    s_branch XC0_loop
XC0_gre:
    global_load_dwordx4 v[84:87], v10, s[34:35] sc1
    global_load_dwordx4 v[88:91], v10, s[34:35] offset:1024 sc1
    global_load_dword v92, v11, s[34:35] sc1
    global_load_dword v93, v11, s[34:35] offset:256 sc1
    s_sub_u32 s25, s25, 1
    s_cbranch_scc1 M_end
    s_branch XC0_sp
XC0_fin:
    s_setprio 0
    s_waitcnt vmcnt(0)
    ds_read_b128 v[16:19], v6 offset:0
    ds_read_b128 v[20:23], v6 offset:512
    ds_read_b128 v[24:27], v6 offset:1024
    ds_read_b128 v[28:31], v6 offset:1536
    ds_read_b128 v[32:35], v6 offset:2048
    ds_read_b128 v[36:39], v6 offset:2560
    ds_read_b128 v[40:43], v6 offset:3072
    s_add_u32 s40, s40, 7320576
    s_addc_u32 s41, s41, 0
    s_waitcnt lgkmcnt(0)
    v_smfmac_f32_16x16x64_f16 v[44:47], v[28:31], v[52:59], v5
    ds_read_b128 v[52:55], v15 offset:4096
    ds_read_b128 v[56:59], v15 offset:5120
    v_smfmac_f32_16x16x64_f16 v[44:47], v[16:19], v[96:103], v5
    v_smfmac_f32_16x16x64_f16 v[48:51], v[28:31], v[60:67], v5
    ds_read_b128 v[60:63], v15 offset:6144
    ds_read_b128 v[64:67], v15 offset:7168
    v_smfmac_f32_16x16x64_f16 v[48:51], v[16:19], v[104:111], v5
    s_waitcnt lgkmcnt(2)
    v_smfmac_f32_16x16x64_f16 v[44:47], v[32:35], v[52:59], v5
    ds_read_b128 v[52:55], v15 offset:8192
    ds_read_b128 v[56:59], v15 offset:9216
    v_smfmac_f32_16x16x64_f16 v[44:47], v[20:23], v[112:119], v5
    s_waitcnt lgkmcnt(2)
    v_smfmac_f32_16x16x64_f16 v[48:51], v[32:35], v[60:67], v5
    ds_read_b128 v[60:63], v15 offset:10240
    ds_read_b128 v[64:67], v15 offset:11264
    v_smfmac_f32_16x16x64_f16 v[48:51], v[20:23], v[120:127], v5
    s_waitcnt lgkmcnt(2)
    v_smfmac_f32_16x16x64_f16 v[44:47], v[36:39], v[52:59], v5
    ds_read_b128 v[52:55], v15 offset:12288
    ds_read_b128 v[56:59], v15 offset:13312
    v_smfmac_f32_16x16x64_f16 v[44:47], v[24:27], v[128:135], v5
    s_waitcnt lgkmcnt(2)
    v_smfmac_f32_16x16x64_f16 v[48:51], v[36:39], v[60:67], v5
    ds_read_b128 v[60:63], v15 offset:14336
    ds_read_b128 v[64:67], v15 offset:15360
    v_smfmac_f32_16x16x64_f16 v[48:51], v[24:27], v[136:143], v5
    s_waitcnt lgkmcnt(2)
    v_smfmac_f32_16x16x64_f16 v[44:47], v[40:43], v[52:59], v5
    s_waitcnt lgkmcnt(0)
    v_smfmac_f32_16x16x64_f16 v[48:51], v[40:43], v[60:67], v5
    s_nop 5
    v_cvt_pk_f16_f32 v16, v44, v45
    v_cvt_pk_f16_f32 v17, v46, v47
    v_cvt_pk_f16_f32 v18, v48, v49
    v_cvt_pk_f16_f32 v19, v50, v51
    s_barrier
    ds_read_b128 v[24:27], v12
    s_waitcnt lgkmcnt(0)
    v_pk_add_f16 v16, v16, v24
    v_pk_add_f16 v17, v17, v25
    v_pk_add_f16 v18, v18, v26
    v_pk_add_f16 v19, v19, v27
    global_store_dwordx2 v8, v[16:17], s[40:41] offset:-2048 sc1
    global_store_dwordx2 v8, v[18:19], s[40:41] offset:2048 sc1
    s_endpgm
XC3_entry:
    s_add_u32 s50, s24, 0
    s_and_b32 s50, s50, 3
    s_mul_i32 s50, s50, 24576
    s_add_u32 s34, s28, s50
    s_addc_u32 s35, s29, 0
    s_add_u32 s50, s24, 1
    s_and_b32 s50, s50, 3
    s_mul_i32 s50, s50, 16384
    s_add_u32 s30, s26, s50
    s_addc_u32 s31, s27, 0
    ds_read_b128 v[52:55], v15 offset:0
    ds_read_b128 v[56:59], v15 offset:1024
    ds_read_b128 v[60:63], v15 offset:2048
    ds_read_b128 v[64:67], v15 offset:3072
    v_mov_b32 v84, 0
    v_mov_b32 v85, 0
    v_mov_b32 v86, 0
    v_mov_b32 v87, 0
    v_mov_b32 v44, 0
    v_mov_b32 v45, 0
    v_mov_b32 v46, 0
    v_mov_b32 v47, 0
    v_mov_b32 v48, 0
    v_mov_b32 v49, 0
    v_mov_b32 v50, 0
    v_mov_b32 v51, 0
    s_setprio 1
    s_branch XC3_top
.p2align 6
XC3_loop:
    s_waitcnt vmcnt(0)
    v_pk_add_f16 v16, v68, v72
    v_pk_add_f16 v17, v69, v73
    v_pk_add_f16 v18, v70, v74
    v_pk_add_f16 v19, v71, v75
    ds_write_b128 v14, v[16:19]
    v_pk_maximum3_f16 v20, v16, v17, v18
    v_pk_maximum3_f16 v20, v20, v19, v19
    v_cmp_u_f16 vcc, v20, v20
    s_cbranch_vccnz XC3_mre
XC3_got:
XC3_top:
    s_cmp_eq_u32 s24, 63
    s_waitcnt lgkmcnt(0)
    s_barrier
    s_cbranch_scc1 XC3_fin
    ds_read_b128 v[16:19], v3 offset:0
    ds_read_b128 v[20:23], v3 offset:512
    ds_read_b128 v[24:27], v3 offset:1024
    ds_read_b128 v[28:31], v3 offset:1536
    ds_read_b128 v[32:35], v3 offset:2048
    ds_read_b128 v[36:39], v3 offset:2560
    s_waitcnt lgkmcnt(5)
    v_smfmac_f32_16x16x64_f16 v[84:87], v[16:19], v[144:151], v5
    ds_read_b128 v[40:43], v3 offset:3072
    s_waitcnt lgkmcnt(5)
    v_smfmac_f32_16x16x64_f16 v[84:87], v[20:23], v[152:159], v5
    ds_read_b128 v[16:19], v6 offset:0
    s_waitcnt lgkmcnt(5)
    v_smfmac_f32_16x16x64_f16 v[84:87], v[24:27], v[160:167], v5
    ds_read_b128 v[20:23], v6 offset:512
    s_waitcnt lgkmcnt(5)
    v_smfmac_f32_16x16x64_f16 v[84:87], v[28:31], v[168:175], v5
    ds_read_b128 v[24:27], v6 offset:1024
    s_waitcnt lgkmcnt(5)
    v_smfmac_f32_16x16x64_f16 v[84:87], v[32:35], v[176:183], v5
    ds_read_b128 v[28:31], v6 offset:1536
    s_waitcnt lgkmcnt(5)
    v_smfmac_f32_16x16x64_f16 v[84:87], v[36:39], v[184:191], v5
    ds_read_b128 v[32:35], v6 offset:2048
    s_waitcnt lgkmcnt(5)
    v_smfmac_f32_16x16x64_f16 v[84:87], v[40:43], v[192:199], v5
    ds_read_b128 v[36:39], v6 offset:2560
    s_waitcnt lgkmcnt(5)
    v_smfmac_f32_16x16x64_f16 v[84:87], v[16:19], v[200:207], v5
    ds_read_b128 v[40:43], v6 offset:3072
    s_waitcnt lgkmcnt(5)
    v_smfmac_f32_16x16x64_f16 v[84:87], v[20:23], v[208:215], v5
    s_waitcnt lgkmcnt(4)
    v_smfmac_f32_16x16x64_f16 v[84:87], v[24:27], v[216:223], v5
    s_waitcnt lgkmcnt(3)
    v_smfmac_f32_16x16x64_f16 v[84:87], v[28:31], v[224:231], v5
    s_waitcnt lgkmcnt(2)
    v_smfmac_f32_16x16x64_f16 v[84:87], v[32:35], v[232:239], v5
    s_waitcnt lgkmcnt(1)
    v_smfmac_f32_16x16x64_f16 v[84:87], v[36:39], v[240:247], v5
    s_waitcnt lgkmcnt(0)
    v_smfmac_f32_16x16x64_f16 v[84:87], v[40:43], v[248:255], v5
    global_load_dwordx4 v[68:71], v13, s[38:39] offset:0 sc1
    global_load_dwordx4 v[72:75], v13, s[38:39] offset:1024 sc1
    s_nop 5
    v_cvt_pk_f16_f32 v84, v84, v86
    v_cvt_pk_f16_f32 v85, v85, v87
    ds_write2_b32 v7, v84, v85 offset0:0 offset1:4
    s_setprio 0
    global_load_dwordx4 v[76:79], v13, s[38:39] offset:2048 sc1
    global_load_dwordx4 v[80:83], v13, s[38:39] offset:3072 sc1
    v_smfmac_f32_16x16x64_f16 v[44:47], v[28:31], v[52:59], v5
    ds_read_b128 v[52:55], v15 offset:4096
    ds_read_b128 v[56:59], v15 offset:5120
    v_smfmac_f32_16x16x64_f16 v[44:47], v[16:19], v[96:103], v5
    v_smfmac_f32_16x16x64_f16 v[48:51], v[28:31], v[60:67], v5
    ds_read_b128 v[60:63], v15 offset:6144
    ds_read_b128 v[64:67], v15 offset:7168
    v_smfmac_f32_16x16x64_f16 v[48:51], v[16:19], v[104:111], v5
    s_waitcnt lgkmcnt(4)
    s_barrier
    s_waitcnt lgkmcnt(2)
    v_smfmac_f32_16x16x64_f16 v[44:47], v[32:35], v[52:59], v5
    ds_read_b128 v[52:55], v15 offset:8192
    ds_read_b128 v[56:59], v15 offset:9216
    v_smfmac_f32_16x16x64_f16 v[44:47], v[20:23], v[112:119], v5
    s_waitcnt lgkmcnt(2)
    v_smfmac_f32_16x16x64_f16 v[48:51], v[32:35], v[60:67], v5
    ds_read_b128 v[60:63], v15 offset:10240
    ds_read_b128 v[64:67], v15 offset:11264
    v_smfmac_f32_16x16x64_f16 v[48:51], v[20:23], v[120:127], v5
    s_barrier
    s_waitcnt lgkmcnt(2)
    v_smfmac_f32_16x16x64_f16 v[44:47], v[36:39], v[52:59], v5
    ds_read_b128 v[52:55], v15 offset:12288
    ds_read_b128 v[56:59], v15 offset:13312
    v_smfmac_f32_16x16x64_f16 v[44:47], v[24:27], v[128:135], v5
    s_waitcnt lgkmcnt(2)
    v_smfmac_f32_16x16x64_f16 v[48:51], v[36:39], v[60:67], v5
    ds_read_b128 v[60:63], v15 offset:14336
    ds_read_b128 v[64:67], v15 offset:15360
    v_smfmac_f32_16x16x64_f16 v[48:51], v[24:27], v[136:143], v5
    s_waitcnt lgkmcnt(2)
    v_smfmac_f32_16x16x64_f16 v[44:47], v[40:43], v[52:59], v5
    s_waitcnt lgkmcnt(0)
    v_smfmac_f32_16x16x64_f16 v[48:51], v[40:43], v[60:67], v5
    v_mov_b32 v52, 0x3c003c00
    v_mov_b32 v53, 0x3c003c00
    v_mov_b32 v54, 0x3c003c00
    v_mov_b32 v55, 0x3c003c00
    v_mov_b32 v56, 0x3c003c00
    v_mov_b32 v57, 0x3c003c00
    v_mov_b32 v58, 0x3c003c00
    v_mov_b32 v59, 0x3c003c00
    v_mov_b32 v60, 0
    v_mov_b32 v61, 0
    v_mov_b32 v62, 0
    v_mov_b32 v63, 0
    v_cvt_pk_f16_f32 v16, v44, v45
    v_cvt_pk_f16_f32 v17, v46, v47
    v_cvt_pk_f16_f32 v18, v48, v49
    v_cvt_pk_f16_f32 v19, v50, v51
    global_load_dwordx4 v[84:87], v10, s[34:35] sc1
    global_load_dwordx4 v[88:91], v10, s[34:35] offset:1024 sc1
    global_load_dword v92, v11, s[34:35] sc1
    global_load_dword v93, v11, s[34:35] offset:256 sc1
    v_mov_b32 v20, 0
    v_mov_b32 v21, 0
    v_mov_b32 v33, 0
    v_mov_b32 v44, 0
    v_mov_b32 v45, 0
    v_mov_b32 v46, 0
    v_mov_b32 v47, 0
    v_mov_b32 v48, 0
    v_mov_b32 v49, 0
    v_mov_b32 v50, 0
    v_mov_b32 v51, 0
    v_mov_b32 v36, s24
XC3_sp:
    s_waitcnt vmcnt(0)
    v_pk_add_f16 v28, v84, v88
    v_pk_add_f16 v29, v85, v89
    v_pk_add_f16 v30, v86, v90
    v_pk_add_f16 v31, v87, v91
    v_pk_add_f16 v32, v92, v93
    v_pk_maximum3_f16 v34, v28, v29, v30
    v_pk_maximum3_f16 v34, v34, v31, v32
    v_pk_maximum3_f16 v34, v34, v34, v34 op_sel:[0,1,0] op_sel_hi:[1,0,1]
    v_mov_b32 v35, v34
    v_cmp_u_f16 vcc, v34, v34
    s_nop 0
    v_permlane32_swap_b32 v34, v35
    v_pk_max_f16 v34, v34, v35
    v_mov_b32 v35, v34
    s_cbranch_vccnz XC3_gre
XC3_sok:
    s_nop 0
    v_permlane16_swap_b32 v34, v35
    v_pk_max_f16 v34, v34, v35
    v_pk_add_f16 v32, v32, v34 neg_lo:[0,1] neg_hi:[0,1]
    v_pk_add_f16 v28, v28, v34 neg_lo:[0,1] neg_hi:[0,1]
    v_pk_add_f16 v29, v29, v34 neg_lo:[0,1] neg_hi:[0,1]
    v_pk_add_f16 v30, v30, v34 neg_lo:[0,1] neg_hi:[0,1]
    v_pk_add_f16 v31, v31, v34 neg_lo:[0,1] neg_hi:[0,1]
    v_exp_f16_sdwa v32, v32 dst_sel:WORD_0 dst_unused:UNUSED_PRESERVE src0_sel:WORD_0
    v_exp_f16_sdwa v28, v28 dst_sel:WORD_0 dst_unused:UNUSED_PRESERVE src0_sel:WORD_0
    s_barrier
    ds_read_b128 v[24:27], v12
    v_exp_f16_sdwa v32, v32 dst_sel:WORD_1 dst_unused:UNUSED_PRESERVE src0_sel:WORD_1
    v_exp_f16_sdwa v29, v29 dst_sel:WORD_0 dst_unused:UNUSED_PRESERVE src0_sel:WORD_0
    v_exp_f16_sdwa v28, v28 dst_sel:WORD_1 dst_unused:UNUSED_PRESERVE src0_sel:WORD_1
    v_smfmac_f32_16x16x32_f16 v[60:63], v[32:33], v[52:55], v5
    v_exp_f16_sdwa v30, v30 dst_sel:WORD_0 dst_unused:UNUSED_PRESERVE src0_sel:WORD_0
    v_exp_f16_sdwa v29, v29 dst_sel:WORD_1 dst_unused:UNUSED_PRESERVE src0_sel:WORD_1
    v_exp_f16_sdwa v31, v31 dst_sel:WORD_0 dst_unused:UNUSED_PRESERVE src0_sel:WORD_0
    global_store_dword v4, v36, s[26:27] sc1
    v_exp_f16_sdwa v30, v30 dst_sel:WORD_1 dst_unused:UNUSED_PRESERVE src0_sel:WORD_1
    v_exp_f16_sdwa v31, v31 dst_sel:WORD_1 dst_unused:UNUSED_PRESERVE src0_sel:WORD_1
    s_nop 1
    v_smfmac_f32_16x16x64_f16 v[60:63], v[28:31], v[52:59], v5
    v_smfmac_f32_16x16x64_f16 v[44:47], v[28:31], v[68:75], v5
    v_smfmac_f32_16x16x64_f16 v[48:51], v[28:31], v[76:83], v5
    s_waitcnt lgkmcnt(0)
    v_pk_add_f16 v16, v16, v24
    v_pk_add_f16 v17, v17, v25
    v_pk_add_f16 v18, v18, v26
    v_pk_add_f16 v19, v19, v27
    s_nop 1
    v_smfmac_f32_16x16x32_f16 v[44:47], v[32:33], v[16:19], v5
    v_smfmac_f32_16x16x32_f16 v[48:51], v[32:33], v[18:21], v5
    v_rcp_f32 v36, v60
    v_rcp_f32 v37, v61
    v_rcp_f32 v38, v62
    v_rcp_f32 v39, v63
    s_nop 2
    v_pk_mul_f32 v[44:45], v[44:45], v[36:37]
    v_pk_fma_f32 v[44:45], v[46:47], v[38:39], v[44:45]
    ds_write2_b32 v9, v44, v45 offset0:0 offset1:8
    v_pk_mul_f32 v[48:49], v[48:49], v[36:37]
    v_pk_fma_f32 v[48:49], v[50:51], v[38:39], v[48:49]
    ds_write2_b32 v9, v48, v49 offset0:128 offset1:136
    ds_write_b64 v8, v[16:17] offset:0
    ds_write_b64 v8, v[18:19] offset:2048
    s_waitcnt lgkmcnt(2)
    s_barrier
    s_barrier
    s_add_u32 s58, s30, 3584
    s_addc_u32 s59, s31, 0
    s_add_u32 s24, s24, 1
    s_add_u32 s50, s24, 0
    s_and_b32 s50, s50, 3
    s_mul_i32 s50, s50, 24576
    s_add_u32 s34, s28, s50
    s_addc_u32 s35, s29, 0
    s_add_u32 s50, s24, 1
    s_and_b32 s50, s50, 3
    s_mul_i32 s50, s50, 16384
    s_add_u32 s30, s26, s50
    s_addc_u32 s31, s27, 0
    s_add_u32 s38, s38, 458752
    s_addc_u32 s39, s39, 0
    s_add_u32 s48, s48, 8192
    s_addc_u32 s49, s49, 0
    s_add_u32 s56, s56, 458752
    s_addc_u32 s57, s57, 0
    s_waitcnt vmcnt(0)
    ds_read_b128 v[52:55], v15 offset:0
    ds_read_b128 v[56:59], v15 offset:1024
    ds_read_b128 v[60:63], v15 offset:2048
    ds_read_b128 v[64:67], v15 offset:3072
    v_mov_b32 v84, 0
    v_mov_b32 v85, 0
    v_mov_b32 v86, 0
    v_mov_b32 v87, 0
    v_mov_b32 v44, 0
    v_mov_b32 v45, 0
    v_mov_b32 v46, 0
    v_mov_b32 v47, 0
    v_mov_b32 v48, 0
    v_mov_b32 v49, 0
    v_mov_b32 v50, 0
    v_mov_b32 v51, 0
    s_setprio 1
    global_load_dwordx4 v[68:71], v14, s[58:59] offset:-3584 sc1
    global_load_dwordx4 v[72:75], v14, s[58:59] offset:3584 sc1
    s_branch XC3_loop
XC3_mre:
    global_load_dwordx4 v[68:71], v14, s[58:59] offset:-3584 sc1
    global_load_dwordx4 v[72:75], v14, s[58:59] offset:3584 sc1
    s_sub_u32 s25, s25, 1
    s_cbranch_scc1 M_end
    s_waitcnt lgkmcnt(0)
    s_branch XC3_loop
XC3_gre:
    global_load_dwordx4 v[84:87], v10, s[34:35] sc1
    global_load_dwordx4 v[88:91], v10, s[34:35] offset:1024 sc1
    global_load_dword v92, v11, s[34:35] sc1
    global_load_dword v93, v11, s[34:35] offset:256 sc1
    s_sub_u32 s25, s25, 1
    s_cbranch_scc1 M_end
    s_branch XC3_sp
XC3_fin:
    s_setprio 0
    s_waitcnt vmcnt(0)
    ds_read_b128 v[16:19], v6 offset:0
    ds_read_b128 v[20:23], v6 offset:512
    ds_read_b128 v[24:27], v6 offset:1024
    ds_read_b128 v[28:31], v6 offset:1536
    ds_read_b128 v[32:35], v6 offset:2048
    ds_read_b128 v[36:39], v6 offset:2560
    ds_read_b128 v[40:43], v6 offset:3072
    s_add_u32 s40, s40, 7320576
    s_addc_u32 s41, s41, 0
    s_waitcnt lgkmcnt(0)
    v_smfmac_f32_16x16x64_f16 v[44:47], v[28:31], v[52:59], v5
    ds_read_b128 v[52:55], v15 offset:4096
    ds_read_b128 v[56:59], v15 offset:5120
    v_smfmac_f32_16x16x64_f16 v[44:47], v[16:19], v[96:103], v5
    v_smfmac_f32_16x16x64_f16 v[48:51], v[28:31], v[60:67], v5
    ds_read_b128 v[60:63], v15 offset:6144
    ds_read_b128 v[64:67], v15 offset:7168
    v_smfmac_f32_16x16x64_f16 v[48:51], v[16:19], v[104:111], v5
    s_waitcnt lgkmcnt(2)
    v_smfmac_f32_16x16x64_f16 v[44:47], v[32:35], v[52:59], v5
    ds_read_b128 v[52:55], v15 offset:8192
    ds_read_b128 v[56:59], v15 offset:9216
    v_smfmac_f32_16x16x64_f16 v[44:47], v[20:23], v[112:119], v5
    s_waitcnt lgkmcnt(2)
    v_smfmac_f32_16x16x64_f16 v[48:51], v[32:35], v[60:67], v5
    ds_read_b128 v[60:63], v15 offset:10240
    ds_read_b128 v[64:67], v15 offset:11264
    v_smfmac_f32_16x16x64_f16 v[48:51], v[20:23], v[120:127], v5
    s_waitcnt lgkmcnt(2)
    v_smfmac_f32_16x16x64_f16 v[44:47], v[36:39], v[52:59], v5
    ds_read_b128 v[52:55], v15 offset:12288
    ds_read_b128 v[56:59], v15 offset:13312
    v_smfmac_f32_16x16x64_f16 v[44:47], v[24:27], v[128:135], v5
    s_waitcnt lgkmcnt(2)
    v_smfmac_f32_16x16x64_f16 v[48:51], v[36:39], v[60:67], v5
    ds_read_b128 v[60:63], v15 offset:14336
    ds_read_b128 v[64:67], v15 offset:15360
    v_smfmac_f32_16x16x64_f16 v[48:51], v[24:27], v[136:143], v5
    s_waitcnt lgkmcnt(2)
    v_smfmac_f32_16x16x64_f16 v[44:47], v[40:43], v[52:59], v5
    s_waitcnt lgkmcnt(0)
    v_smfmac_f32_16x16x64_f16 v[48:51], v[40:43], v[60:67], v5
    s_nop 5
    v_cvt_pk_f16_f32 v16, v44, v45
    v_cvt_pk_f16_f32 v17, v46, v47
    v_cvt_pk_f16_f32 v18, v48, v49
    v_cvt_pk_f16_f32 v19, v50, v51
    s_barrier
    ds_read_b128 v[24:27], v12
    s_waitcnt lgkmcnt(0)
    v_pk_add_f16 v16, v16, v24
    v_pk_add_f16 v17, v17, v25
    v_pk_add_f16 v18, v18, v26
    v_pk_add_f16 v19, v19, v27
    global_store_dwordx2 v8, v[16:17], s[40:41] offset:-2048 sc1
    global_store_dwordx2 v8, v[18:19], s[40:41] offset:2048 sc1
    s_endpgm
XC4_entry:
    s_add_u32 s50, s24, 1
    s_and_b32 s50, s50, 3
    s_mul_i32 s50, s50, 16384
    s_add_u32 s30, s26, s50
    s_addc_u32 s31, s27, 0
    s_add_u32 s54, s54, 458752
    s_addc_u32 s55, s55, 0
    ds_read_b128 v[52:55], v15 offset:0
    ds_read_b128 v[56:59], v15 offset:1024
    ds_read_b128 v[60:63], v15 offset:2048
    ds_read_b128 v[64:67], v15 offset:3072
    v_mov_b32 v44, 0
    v_mov_b32 v45, 0
    v_mov_b32 v46, 0
    v_mov_b32 v47, 0
    s_setprio 1
    s_branch XC4_top
.p2align 6
XC4_loop:
    s_waitcnt vmcnt(0)
    v_pk_add_f16 v16, v68, v72
    v_pk_add_f16 v17, v69, v73
    v_pk_add_f16 v18, v70, v74
    v_pk_add_f16 v19, v71, v75
    ds_write_b128 v14, v[16:19]
    v_pk_maximum3_f16 v20, v16, v17, v18
    v_pk_maximum3_f16 v20, v20, v19, v19
    v_cmp_u_f16 vcc, v20, v20
    s_cbranch_vccnz XC4_mre
XC4_got:
XC4_top:
    s_cmp_eq_u32 s24, 63
    s_waitcnt lgkmcnt(0)
    s_barrier
    s_cbranch_scc1 XC4_fin
    ds_read_b128 v[16:19], v3 offset:0
    ds_read_b128 v[20:23], v3 offset:512
    ds_read_b128 v[24:27], v3 offset:1024
    ds_read_b128 v[28:31], v3 offset:1536
    ds_read_b128 v[32:35], v3 offset:2048
    ds_read_b128 v[36:39], v3 offset:2560
    ds_read_b128 v[40:43], v3 offset:3072
    s_waitcnt lgkmcnt(6)
    v_smfmac_f32_16x16x64_f16 v[44:47], v[16:19], v[144:151], v5
    ds_read_b128 v[16:19], v6 offset:0
    s_waitcnt lgkmcnt(6)
    v_smfmac_f32_16x16x64_f16 v[44:47], v[20:23], v[152:159], v5
    ds_read_b128 v[20:23], v6 offset:512
    s_waitcnt lgkmcnt(6)
    v_smfmac_f32_16x16x64_f16 v[44:47], v[24:27], v[160:167], v5
    ds_read_b128 v[24:27], v6 offset:1024
    s_waitcnt lgkmcnt(6)
    v_smfmac_f32_16x16x64_f16 v[44:47], v[28:31], v[168:175], v5
    ds_read_b128 v[28:31], v6 offset:1536
    s_waitcnt lgkmcnt(6)
    v_smfmac_f32_16x16x64_f16 v[44:47], v[32:35], v[176:183], v5
    ds_read_b128 v[32:35], v6 offset:2048
    s_waitcnt lgkmcnt(6)
    v_smfmac_f32_16x16x64_f16 v[44:47], v[36:39], v[184:191], v5
    ds_read_b128 v[36:39], v6 offset:2560
    s_waitcnt lgkmcnt(6)
    v_smfmac_f32_16x16x64_f16 v[44:47], v[40:43], v[192:199], v5
    ds_read_b128 v[40:43], v6 offset:3072
    s_waitcnt lgkmcnt(6)
    v_smfmac_f32_16x16x64_f16 v[44:47], v[16:19], v[200:207], v5
    s_waitcnt lgkmcnt(5)
    v_smfmac_f32_16x16x64_f16 v[44:47], v[20:23], v[208:215], v5
    s_waitcnt lgkmcnt(4)
    v_smfmac_f32_16x16x64_f16 v[44:47], v[24:27], v[216:223], v5
    s_waitcnt lgkmcnt(3)
    v_smfmac_f32_16x16x64_f16 v[44:47], v[28:31], v[224:231], v5
    s_waitcnt lgkmcnt(2)
    v_smfmac_f32_16x16x64_f16 v[44:47], v[32:35], v[232:239], v5
    s_waitcnt lgkmcnt(1)
    v_smfmac_f32_16x16x64_f16 v[44:47], v[36:39], v[240:247], v5
    s_waitcnt lgkmcnt(0)
    v_smfmac_f32_16x16x64_f16 v[44:47], v[40:43], v[248:255], v5
    s_nop 7
    v_cvt_pk_f16_f32 v44, v44, v46
    v_cvt_pk_f16_f32 v45, v45, v47
    ds_write2_b32 v7, v44, v45 offset0:0 offset1:4
    s_waitcnt lgkmcnt(0)
    s_barrier
    s_setprio 0
    v_mov_b32 v44, 0
    v_mov_b32 v45, 0
    v_mov_b32 v46, 0
    v_mov_b32 v47, 0
    v_mov_b32 v48, 0
    v_mov_b32 v49, 0
    v_mov_b32 v50, 0
    v_mov_b32 v51, 0
    v_smfmac_f32_16x16x64_f16 v[44:47], v[28:31], v[52:59], v5
    ds_read_b128 v[52:55], v15 offset:4096
    ds_read_b128 v[56:59], v15 offset:5120
    v_smfmac_f32_16x16x64_f16 v[44:47], v[16:19], v[96:103], v5
    v_smfmac_f32_16x16x64_f16 v[48:51], v[28:31], v[60:67], v5
    ds_read_b128 v[60:63], v15 offset:6144
    ds_read_b128 v[64:67], v15 offset:7168
    v_smfmac_f32_16x16x64_f16 v[48:51], v[16:19], v[104:111], v5
    s_waitcnt lgkmcnt(2)
    v_smfmac_f32_16x16x64_f16 v[44:47], v[32:35], v[52:59], v5
    ds_read_b128 v[52:55], v15 offset:8192
    ds_read_b128 v[56:59], v15 offset:9216
    v_smfmac_f32_16x16x64_f16 v[44:47], v[20:23], v[112:119], v5
    s_waitcnt lgkmcnt(2)
    v_smfmac_f32_16x16x64_f16 v[48:51], v[32:35], v[60:67], v5
    ds_read_b128 v[60:63], v15 offset:10240
    ds_read_b128 v[64:67], v15 offset:11264
    v_smfmac_f32_16x16x64_f16 v[48:51], v[20:23], v[120:127], v5
    s_barrier
    s_waitcnt lgkmcnt(2)
    v_smfmac_f32_16x16x64_f16 v[44:47], v[36:39], v[52:59], v5
    ds_read_b128 v[52:55], v15 offset:12288
    ds_read_b128 v[56:59], v15 offset:13312
    v_smfmac_f32_16x16x64_f16 v[44:47], v[24:27], v[128:135], v5
    s_waitcnt lgkmcnt(2)
    v_smfmac_f32_16x16x64_f16 v[48:51], v[36:39], v[60:67], v5
    ds_read_b128 v[60:63], v15 offset:14336
    ds_read_b128 v[64:67], v15 offset:15360
    v_smfmac_f32_16x16x64_f16 v[48:51], v[24:27], v[136:143], v5
    s_waitcnt lgkmcnt(2)
    v_smfmac_f32_16x16x64_f16 v[44:47], v[40:43], v[52:59], v5
    s_waitcnt lgkmcnt(0)
    v_smfmac_f32_16x16x64_f16 v[48:51], v[40:43], v[60:67], v5
    s_nop 5
    v_cvt_pk_f16_f32 v16, v44, v45
    v_cvt_pk_f16_f32 v17, v46, v47
    v_cvt_pk_f16_f32 v18, v48, v49
    v_cvt_pk_f16_f32 v19, v50, v51
    ds_write_b128 v12, v[16:19]
    s_waitcnt lgkmcnt(0)
    s_load_dword s96, s[54:55], 6912
    s_load_dword s96, s[54:55], 7040
    s_load_dword s96, s[54:55], 7168
    s_load_dword s96, s[54:55], 7296
    s_load_dword s96, s[54:55], 7424
    s_load_dword s96, s[54:55], 7552
    s_load_dword s96, s[54:55], 7680
    s_load_dword s96, s[54:55], 7808
    s_load_dword s96, s[54:55], 7936
    s_load_dword s96, s[54:55], 8064
    s_load_dword s96, s[54:55], 8192
    s_load_dword s96, s[54:55], 8320
    s_load_dword s96, s[54:55], 8448
    s_load_dword s96, s[54:55], 8576
    s_barrier
    s_barrier
    s_barrier
    s_add_u32 s58, s30, 3584
    s_addc_u32 s59, s31, 0
    s_add_u32 s24, s24, 1
    s_add_u32 s50, s24, 1
    s_and_b32 s50, s50, 3
    s_mul_i32 s50, s50, 16384
    s_add_u32 s30, s26, s50
    s_addc_u32 s31, s27, 0
    s_add_u32 s54, s54, 458752
    s_addc_u32 s55, s55, 0
    s_add_u32 s56, s56, 458752
    s_addc_u32 s57, s57, 0
    ds_read_b128 v[52:55], v15 offset:0
    ds_read_b128 v[56:59], v15 offset:1024
    ds_read_b128 v[60:63], v15 offset:2048
    ds_read_b128 v[64:67], v15 offset:3072
    v_mov_b32 v44, 0
    v_mov_b32 v45, 0
    v_mov_b32 v46, 0
    v_mov_b32 v47, 0
    s_setprio 1
    global_load_dwordx4 v[68:71], v14, s[58:59] offset:-3584 sc1
    global_load_dwordx4 v[72:75], v14, s[58:59] offset:3584 sc1
    s_branch XC4_loop
XC4_mre:
    global_load_dwordx4 v[68:71], v14, s[58:59] offset:-3584 sc1
    global_load_dwordx4 v[72:75], v14, s[58:59] offset:3584 sc1
    s_sub_u32 s25, s25, 1
    s_cbranch_scc1 M_end
    s_waitcnt lgkmcnt(0)
    s_branch XC4_loop
XC4_fin:
    s_setprio 0
    s_waitcnt vmcnt(0)
    ds_read_b128 v[16:19], v6 offset:0
    ds_read_b128 v[20:23], v6 offset:512
    ds_read_b128 v[24:27], v6 offset:1024
    ds_read_b128 v[28:31], v6 offset:1536
    ds_read_b128 v[32:35], v6 offset:2048
    ds_read_b128 v[36:39], v6 offset:2560
    ds_read_b128 v[40:43], v6 offset:3072
    v_mov_b32 v48, 0
    v_mov_b32 v49, 0
    v_mov_b32 v50, 0
    v_mov_b32 v51, 0
    s_waitcnt lgkmcnt(0)
    v_smfmac_f32_16x16x64_f16 v[44:47], v[28:31], v[52:59], v5
    ds_read_b128 v[52:55], v15 offset:4096
    ds_read_b128 v[56:59], v15 offset:5120
    v_smfmac_f32_16x16x64_f16 v[44:47], v[16:19], v[96:103], v5
    v_smfmac_f32_16x16x64_f16 v[48:51], v[28:31], v[60:67], v5
    ds_read_b128 v[60:63], v15 offset:6144
    ds_read_b128 v[64:67], v15 offset:7168
    v_smfmac_f32_16x16x64_f16 v[48:51], v[16:19], v[104:111], v5
    s_waitcnt lgkmcnt(2)
    v_smfmac_f32_16x16x64_f16 v[44:47], v[32:35], v[52:59], v5
    ds_read_b128 v[52:55], v15 offset:8192
    ds_read_b128 v[56:59], v15 offset:9216
    v_smfmac_f32_16x16x64_f16 v[44:47], v[20:23], v[112:119], v5
    s_waitcnt lgkmcnt(2)
    v_smfmac_f32_16x16x64_f16 v[48:51], v[32:35], v[60:67], v5
    ds_read_b128 v[60:63], v15 offset:10240
    ds_read_b128 v[64:67], v15 offset:11264
    v_smfmac_f32_16x16x64_f16 v[48:51], v[20:23], v[120:127], v5
    s_waitcnt lgkmcnt(2)
    v_smfmac_f32_16x16x64_f16 v[44:47], v[36:39], v[52:59], v5
    ds_read_b128 v[52:55], v15 offset:12288
    ds_read_b128 v[56:59], v15 offset:13312
    v_smfmac_f32_16x16x64_f16 v[44:47], v[24:27], v[128:135], v5
    s_waitcnt lgkmcnt(2)
    v_smfmac_f32_16x16x64_f16 v[48:51], v[36:39], v[60:67], v5
    ds_read_b128 v[60:63], v15 offset:14336
    ds_read_b128 v[64:67], v15 offset:15360
    v_smfmac_f32_16x16x64_f16 v[48:51], v[24:27], v[136:143], v5
    s_waitcnt lgkmcnt(2)
    v_smfmac_f32_16x16x64_f16 v[44:47], v[40:43], v[52:59], v5
    s_waitcnt lgkmcnt(0)
    v_smfmac_f32_16x16x64_f16 v[48:51], v[40:43], v[60:67], v5
    s_nop 5
    v_cvt_pk_f16_f32 v16, v44, v45
    v_cvt_pk_f16_f32 v17, v46, v47
    v_cvt_pk_f16_f32 v18, v48, v49
    v_cvt_pk_f16_f32 v19, v50, v51
    ds_write_b128 v12, v[16:19]
    s_waitcnt lgkmcnt(0)
    s_barrier
    s_endpgm
XC5_entry:
    s_add_u32 s50, s24, 0
    s_and_b32 s50, s50, 3
    s_mul_i32 s50, s50, 24576
    s_add_u32 s34, s28, s50
    s_addc_u32 s35, s29, 0
    s_add_u32 s50, s24, 3
    s_and_b32 s50, s50, 3
    s_mul_i32 s50, s50, 24576
    s_add_u32 s36, s28, s50
    s_addc_u32 s37, s29, 0
    s_add_u32 s50, s24, 1
    s_and_b32 s50, s50, 3
    s_mul_i32 s50, s50, 16384
    s_add_u32 s30, s26, s50
    s_addc_u32 s31, s27, 0
    s_add_u32 s54, s54, 458752
    s_addc_u32 s55, s55, 0
    ds_read_b128 v[52:55], v15 offset:0
    ds_read_b128 v[56:59], v15 offset:1024
    ds_read_b128 v[60:63], v15 offset:2048
    ds_read_b128 v[64:67], v15 offset:3072
    v_mov_b32 v44, 0
    v_mov_b32 v45, 0
    v_mov_b32 v46, 0
    v_mov_b32 v47, 0
    s_setprio 1
    s_branch XC5_top
.p2align 6
XC5_loop:
    s_waitcnt vmcnt(0)
    v_pk_add_f16 v16, v68, v72
    v_pk_add_f16 v17, v69, v73
    v_pk_add_f16 v18, v70, v74
    v_pk_add_f16 v19, v71, v75
    ds_write_b128 v14, v[16:19]
    v_pk_maximum3_f16 v20, v16, v17, v18
    v_pk_maximum3_f16 v20, v20, v19, v19
    v_cmp_u_f16 vcc, v20, v20
    s_cbranch_vccnz XC5_mre
XC5_got:
XC5_top:
    s_cmp_eq_u32 s24, 63
    s_waitcnt lgkmcnt(0)
    s_barrier
    s_cbranch_scc1 XC5_fin
    ds_read_b128 v[16:19], v3 offset:0
    ds_read_b128 v[20:23], v3 offset:512
    ds_read_b128 v[24:27], v3 offset:1024
    ds_read_b128 v[28:31], v3 offset:1536
    ds_read_b128 v[32:35], v3 offset:2048
    ds_read_b128 v[36:39], v3 offset:2560
    ds_read_b128 v[40:43], v3 offset:3072
    s_waitcnt lgkmcnt(6)
    v_smfmac_f32_16x16x64_f16 v[44:47], v[16:19], v[144:151], v5
    ds_read_b128 v[16:19], v6 offset:0
    s_waitcnt lgkmcnt(6)
    v_smfmac_f32_16x16x64_f16 v[44:47], v[20:23], v[152:159], v5
    ds_read_b128 v[20:23], v6 offset:512
    s_waitcnt lgkmcnt(6)
    v_smfmac_f32_16x16x64_f16 v[44:47], v[24:27], v[160:167], v5
    ds_read_b128 v[24:27], v6 offset:1024
    s_waitcnt lgkmcnt(6)
    v_smfmac_f32_16x16x64_f16 v[44:47], v[28:31], v[168:175], v5
    ds_read_b128 v[28:31], v6 offset:1536
    s_waitcnt lgkmcnt(6)
    v_smfmac_f32_16x16x64_f16 v[44:47], v[32:35], v[176:183], v5
    ds_read_b128 v[32:35], v6 offset:2048
    s_waitcnt lgkmcnt(6)
    v_smfmac_f32_16x16x64_f16 v[44:47], v[36:39], v[184:191], v5
    ds_read_b128 v[36:39], v6 offset:2560
    s_waitcnt lgkmcnt(6)
    v_smfmac_f32_16x16x64_f16 v[44:47], v[40:43], v[192:199], v5
    ds_read_b128 v[40:43], v6 offset:3072
    s_waitcnt lgkmcnt(6)
    v_smfmac_f32_16x16x64_f16 v[44:47], v[16:19], v[200:207], v5
    s_waitcnt lgkmcnt(5)
    v_smfmac_f32_16x16x64_f16 v[44:47], v[20:23], v[208:215], v5
    s_waitcnt lgkmcnt(4)
    v_smfmac_f32_16x16x64_f16 v[44:47], v[24:27], v[216:223], v5
    s_waitcnt lgkmcnt(3)
    v_smfmac_f32_16x16x64_f16 v[44:47], v[28:31], v[224:231], v5
    s_waitcnt lgkmcnt(2)
    v_smfmac_f32_16x16x64_f16 v[44:47], v[32:35], v[232:239], v5
    s_waitcnt lgkmcnt(1)
    v_smfmac_f32_16x16x64_f16 v[44:47], v[36:39], v[240:247], v5
    s_waitcnt lgkmcnt(0)
    v_smfmac_f32_16x16x64_f16 v[44:47], v[40:43], v[248:255], v5
    s_nop 7
    v_cvt_pk_f16_f32 v44, v44, v46
    v_cvt_pk_f16_f32 v45, v45, v47
    ds_write2_b32 v7, v44, v45 offset0:0 offset1:4
    s_waitcnt lgkmcnt(0)
    s_waitcnt vmcnt(0)
    s_barrier
    s_setprio 0
    ds_read2_b64 v[68:71], v8 offset0:0 offset1:16
    ds_read2_b64 v[72:75], v8 offset0:64 offset1:80
    ds_read2_b64 v[76:79], v8 offset0:128 offset1:144
    ds_read2_b64 v[80:83], v8 offset0:192 offset1:208
    ds_read2_b64 v[84:87], v10 offset0:0 offset1:16
    ds_read2_b64 v[88:91], v10 offset0:64 offset1:80
    ds_read2_b64 v[92:95], v10 offset0:128 offset1:144
    s_waitcnt lgkmcnt(6)
    v_mfma_f32_16x16x32_f16 v[44:47], v[16:19], v[68:71], 0
    s_waitcnt lgkmcnt(5)
    v_mfma_f32_16x16x32_f16 v[44:47], v[20:23], v[72:75], v[44:47]
    s_waitcnt lgkmcnt(4)
    v_mfma_f32_16x16x32_f16 v[44:47], v[24:27], v[76:79], v[44:47]
    s_waitcnt lgkmcnt(3)
    v_mfma_f32_16x16x32_f16 v[44:47], v[28:31], v[80:83], v[44:47]
    s_waitcnt lgkmcnt(2)
    v_mfma_f32_16x16x32_f16 v[44:47], v[32:35], v[84:87], v[44:47]
    s_waitcnt lgkmcnt(1)
    v_mfma_f32_16x16x32_f16 v[44:47], v[36:39], v[88:91], v[44:47]
    s_waitcnt lgkmcnt(0)
    v_mfma_f32_16x16x32_f16 v[44:47], v[40:43], v[92:95], v[44:47]
    s_mov_b64 exec, s[46:47]
    s_nop 6
    v_cvt_pk_f16_f32 v76, v44, v45
    global_store_dword v9, v76, s[34:35] sc1
    s_mov_b64 exec, -1
    s_setprio 0
    s_barrier
    v_mov_b32 v44, 0
    v_mov_b32 v45, 0
    v_mov_b32 v46, 0
    v_mov_b32 v47, 0
    v_mov_b32 v48, 0
    v_mov_b32 v49, 0
    v_mov_b32 v50, 0
    v_mov_b32 v51, 0
    v_smfmac_f32_16x16x64_f16 v[44:47], v[28:31], v[52:59], v5
    ds_read_b128 v[52:55], v15 offset:4096
    ds_read_b128 v[56:59], v15 offset:5120
    v_smfmac_f32_16x16x64_f16 v[44:47], v[16:19], v[96:103], v5
    v_smfmac_f32_16x16x64_f16 v[48:51], v[28:31], v[60:67], v5
    ds_read_b128 v[60:63], v15 offset:6144
    ds_read_b128 v[64:67], v15 offset:7168
    v_smfmac_f32_16x16x64_f16 v[48:51], v[16:19], v[104:111], v5
    s_waitcnt lgkmcnt(2)
    v_smfmac_f32_16x16x64_f16 v[44:47], v[32:35], v[52:59], v5
    ds_read_b128 v[52:55], v15 offset:8192
    ds_read_b128 v[56:59], v15 offset:9216
    v_smfmac_f32_16x16x64_f16 v[44:47], v[20:23], v[112:119], v5
    s_waitcnt lgkmcnt(2)
    v_smfmac_f32_16x16x64_f16 v[48:51], v[32:35], v[60:67], v5
    ds_read_b128 v[60:63], v15 offset:10240
    ds_read_b128 v[64:67], v15 offset:11264
    v_smfmac_f32_16x16x64_f16 v[48:51], v[20:23], v[120:127], v5
    s_waitcnt lgkmcnt(2)
    v_smfmac_f32_16x16x64_f16 v[44:47], v[36:39], v[52:59], v5
    ds_read_b128 v[52:55], v15 offset:12288
    ds_read_b128 v[56:59], v15 offset:13312
    v_smfmac_f32_16x16x64_f16 v[44:47], v[24:27], v[128:135], v5
    s_waitcnt lgkmcnt(2)
    v_smfmac_f32_16x16x64_f16 v[48:51], v[36:39], v[60:67], v5
    ds_read_b128 v[60:63], v15 offset:14336
    ds_read_b128 v[64:67], v15 offset:15360
    v_smfmac_f32_16x16x64_f16 v[48:51], v[24:27], v[136:143], v5
    s_waitcnt lgkmcnt(2)
    v_smfmac_f32_16x16x64_f16 v[44:47], v[40:43], v[52:59], v5
    s_waitcnt lgkmcnt(0)
    v_smfmac_f32_16x16x64_f16 v[48:51], v[40:43], v[60:67], v5
    s_nop 5
    v_cvt_pk_f16_f32 v16, v44, v45
    v_cvt_pk_f16_f32 v17, v46, v47
    v_cvt_pk_f16_f32 v18, v48, v49
    v_cvt_pk_f16_f32 v19, v50, v51
    ds_write_b128 v12, v[16:19]
    s_waitcnt lgkmcnt(0)
    s_barrier
    v_mov_b32 v48, -1
    v_mov_b32 v49, -1
    s_mov_b64 exec, s[46:47]
    global_store_dword v9, v48, s[36:37] sc1
    s_mov_b64 exec, -1
    s_load_dword s96, s[54:55], 8704
    s_load_dword s96, s[54:55], 8832
    s_load_dword s96, s[54:55], 8960
    s_load_dword s96, s[54:55], 9088
    s_load_dword s96, s[54:55], 9216
    s_load_dword s96, s[54:55], 9344
    s_load_dword s96, s[54:55], 9472
    s_load_dword s96, s[54:55], 9600
    s_load_dword s96, s[54:55], 9728
    s_load_dword s96, s[54:55], 9856
    s_load_dword s96, s[54:55], 9984
    s_load_dword s96, s[54:55], 10112
    s_load_dword s96, s[54:55], 10240
    s_load_dword s96, s[54:55], 10368
    s_barrier
    s_barrier
    s_add_u32 s58, s30, 3584
    s_addc_u32 s59, s31, 0
    s_add_u32 s24, s24, 1
    s_add_u32 s50, s24, 0
    s_and_b32 s50, s50, 3
    s_mul_i32 s50, s50, 24576
    s_add_u32 s34, s28, s50
    s_addc_u32 s35, s29, 0
    s_add_u32 s50, s24, 3
    s_and_b32 s50, s50, 3
    s_mul_i32 s50, s50, 24576
    s_add_u32 s36, s28, s50
    s_addc_u32 s37, s29, 0
    s_add_u32 s50, s24, 1
    s_and_b32 s50, s50, 3
    s_mul_i32 s50, s50, 16384
    s_add_u32 s30, s26, s50
    s_addc_u32 s31, s27, 0
    s_add_u32 s54, s54, 458752
    s_addc_u32 s55, s55, 0
    ds_read_b128 v[52:55], v15 offset:0
    ds_read_b128 v[56:59], v15 offset:1024
    ds_read_b128 v[60:63], v15 offset:2048
    ds_read_b128 v[64:67], v15 offset:3072
    v_mov_b32 v44, 0
    v_mov_b32 v45, 0
    v_mov_b32 v46, 0
    v_mov_b32 v47, 0
    s_setprio 1
    global_load_dwordx4 v[68:71], v14, s[58:59] offset:-3584 sc1
    global_load_dwordx4 v[72:75], v14, s[58:59] offset:3584 sc1
    s_branch XC5_loop
XC5_mre:
    global_load_dwordx4 v[68:71], v14, s[58:59] offset:-3584 sc1
    global_load_dwordx4 v[72:75], v14, s[58:59] offset:3584 sc1
    s_sub_u32 s25, s25, 1
    s_cbranch_scc1 M_end
    s_waitcnt lgkmcnt(0)
    s_branch XC5_loop
XC5_fin:
    s_setprio 0
    s_waitcnt vmcnt(0)
    ds_read_b128 v[16:19], v6 offset:0
    ds_read_b128 v[20:23], v6 offset:512
    ds_read_b128 v[24:27], v6 offset:1024
    ds_read_b128 v[28:31], v6 offset:1536
    ds_read_b128 v[32:35], v6 offset:2048
    ds_read_b128 v[36:39], v6 offset:2560
    ds_read_b128 v[40:43], v6 offset:3072
    v_mov_b32 v48, 0
    v_mov_b32 v49, 0
    v_mov_b32 v50, 0
    v_mov_b32 v51, 0
    s_waitcnt lgkmcnt(0)
    v_smfmac_f32_16x16x64_f16 v[44:47], v[28:31], v[52:59], v5
    ds_read_b128 v[52:55], v15 offset:4096
    ds_read_b128 v[56:59], v15 offset:5120
    v_smfmac_f32_16x16x64_f16 v[44:47], v[16:19], v[96:103], v5
    v_smfmac_f32_16x16x64_f16 v[48:51], v[28:31], v[60:67], v5
    ds_read_b128 v[60:63], v15 offset:6144
    ds_read_b128 v[64:67], v15 offset:7168
    v_smfmac_f32_16x16x64_f16 v[48:51], v[16:19], v[104:111], v5
    s_waitcnt lgkmcnt(2)
    v_smfmac_f32_16x16x64_f16 v[44:47], v[32:35], v[52:59], v5
    ds_read_b128 v[52:55], v15 offset:8192
    ds_read_b128 v[56:59], v15 offset:9216
    v_smfmac_f32_16x16x64_f16 v[44:47], v[20:23], v[112:119], v5
    s_waitcnt lgkmcnt(2)
    v_smfmac_f32_16x16x64_f16 v[48:51], v[32:35], v[60:67], v5
    ds_read_b128 v[60:63], v15 offset:10240
    ds_read_b128 v[64:67], v15 offset:11264
    v_smfmac_f32_16x16x64_f16 v[48:51], v[20:23], v[120:127], v5
    s_waitcnt lgkmcnt(2)
    v_smfmac_f32_16x16x64_f16 v[44:47], v[36:39], v[52:59], v5
    ds_read_b128 v[52:55], v15 offset:12288
    ds_read_b128 v[56:59], v15 offset:13312
    v_smfmac_f32_16x16x64_f16 v[44:47], v[24:27], v[128:135], v5
    s_waitcnt lgkmcnt(2)
    v_smfmac_f32_16x16x64_f16 v[48:51], v[36:39], v[60:67], v5
    ds_read_b128 v[60:63], v15 offset:14336
    ds_read_b128 v[64:67], v15 offset:15360
    v_smfmac_f32_16x16x64_f16 v[48:51], v[24:27], v[136:143], v5
    s_waitcnt lgkmcnt(2)
    v_smfmac_f32_16x16x64_f16 v[44:47], v[40:43], v[52:59], v5
    s_waitcnt lgkmcnt(0)
    v_smfmac_f32_16x16x64_f16 v[48:51], v[40:43], v[60:67], v5
    s_nop 5
    v_cvt_pk_f16_f32 v16, v44, v45
    v_cvt_pk_f16_f32 v17, v46, v47
    v_cvt_pk_f16_f32 v18, v48, v49
    v_cvt_pk_f16_f32 v19, v50, v51
    ds_write_b128 v12, v[16:19]
    s_waitcnt lgkmcnt(0)
    s_barrier
    s_endpgm
XC6_entry:
    s_add_u32 s48, s4, 0x5b54000
    s_addc_u32 s49, s5, 0
    s_add_u32 s50, s24, 0
    s_and_b32 s50, s50, 3
    s_mul_i32 s50, s50, 24576
    s_add_u32 s34, s28, s50
    s_addc_u32 s35, s29, 0
    s_add_u32 s50, s24, 3
    s_and_b32 s50, s50, 3
    s_mul_i32 s50, s50, 24576
    s_add_u32 s36, s28, s50
    s_addc_u32 s37, s29, 0
    s_add_u32 s50, s24, 1
    s_and_b32 s50, s50, 3
    s_mul_i32 s50, s50, 16384
    s_add_u32 s30, s26, s50
    s_addc_u32 s31, s27, 0
    s_add_u32 s50, s24, 3
    s_and_b32 s50, s50, 3
    s_mul_i32 s50, s50, 16384
    s_add_u32 s32, s26, s50
    s_addc_u32 s33, s27, 0
    s_add_u32 s42, s42, 28672
    s_addc_u32 s43, s43, 0
    s_add_u32 s54, s54, 458752
    s_addc_u32 s55, s55, 0
    v_mov_b32 v44, 0
    v_mov_b32 v45, 0
    v_mov_b32 v46, 0
    v_mov_b32 v47, 0
    s_setprio 1
    s_branch XC6_top
.p2align 6
XC6_loop:
    s_cmp_eq_u32 s24, 63
    s_cbranch_scc1 XC6_top
    s_waitcnt vmcnt(0)
XC6_got:
XC6_top:
    s_cmp_eq_u32 s24, 63
    s_waitcnt lgkmcnt(0)
    s_barrier
    s_cbranch_scc1 XC6_fin
    ds_read_b128 v[16:19], v3 offset:0
    ds_read_b128 v[20:23], v3 offset:512
    ds_read_b128 v[24:27], v3 offset:1024
    ds_read_b128 v[28:31], v3 offset:1536
    ds_read_b128 v[32:35], v3 offset:2048
    ds_read_b128 v[36:39], v3 offset:2560
    ds_read_b128 v[40:43], v3 offset:3072
    s_waitcnt lgkmcnt(6)
    v_smfmac_f32_16x16x64_f16 v[44:47], v[16:19], v[144:151], v5
    ds_read_b128 v[16:19], v6 offset:0
    s_waitcnt lgkmcnt(6)
    v_smfmac_f32_16x16x64_f16 v[44:47], v[20:23], v[152:159], v5
    ds_read_b128 v[20:23], v6 offset:512
    s_waitcnt lgkmcnt(6)
    v_smfmac_f32_16x16x64_f16 v[44:47], v[24:27], v[160:167], v5
    ds_read_b128 v[24:27], v6 offset:1024
    s_waitcnt lgkmcnt(6)
    v_smfmac_f32_16x16x64_f16 v[44:47], v[28:31], v[168:175], v5
    ds_read_b128 v[28:31], v6 offset:1536
    s_waitcnt lgkmcnt(6)
    v_smfmac_f32_16x16x64_f16 v[44:47], v[32:35], v[176:183], v5
    ds_read_b128 v[32:35], v6 offset:2048
    s_waitcnt lgkmcnt(6)
    v_smfmac_f32_16x16x64_f16 v[44:47], v[36:39], v[184:191], v5
    ds_read_b128 v[36:39], v6 offset:2560
    s_waitcnt lgkmcnt(6)
    v_smfmac_f32_16x16x64_f16 v[44:47], v[40:43], v[192:199], v5
    ds_read_b128 v[40:43], v6 offset:3072
    s_waitcnt lgkmcnt(6)
    v_smfmac_f32_16x16x64_f16 v[44:47], v[16:19], v[200:207], v5
    s_waitcnt lgkmcnt(5)
    v_smfmac_f32_16x16x64_f16 v[44:47], v[20:23], v[208:215], v5
    s_waitcnt lgkmcnt(4)
    v_smfmac_f32_16x16x64_f16 v[44:47], v[24:27], v[216:223], v5
    s_waitcnt lgkmcnt(3)
    v_smfmac_f32_16x16x64_f16 v[44:47], v[28:31], v[224:231], v5
    s_waitcnt lgkmcnt(2)
    v_smfmac_f32_16x16x64_f16 v[44:47], v[32:35], v[232:239], v5
    s_waitcnt lgkmcnt(1)
    v_smfmac_f32_16x16x64_f16 v[44:47], v[36:39], v[240:247], v5
    s_waitcnt lgkmcnt(0)
    v_smfmac_f32_16x16x64_f16 v[44:47], v[40:43], v[248:255], v5
    s_nop 7
    v_cvt_pk_f16_f32 v44, v44, v46
    v_cvt_pk_f16_f32 v45, v45, v47
    ds_write2_b32 v7, v44, v45 offset0:0 offset1:4
    s_waitcnt lgkmcnt(0)
    s_barrier
    s_setprio 0
    ds_read_b128 v[52:55], v8 offset:0
    ds_read_b128 v[56:59], v8 offset:512
    ds_read_b128 v[60:63], v8 offset:1024
    ds_read_b128 v[64:67], v8 offset:1536
    ds_read_b128 v[48:51], v8 offset:2048
    s_waitcnt lgkmcnt(4)
    v_mfma_f32_16x16x32_f16 v[44:47], v[68:71], v[52:55], 0
    ds_read_b128 v[52:55], v8 offset:2560
    s_waitcnt lgkmcnt(4)
    v_mfma_f32_16x16x32_f16 v[44:47], v[72:75], v[56:59], v[44:47]
    ds_read_b128 v[56:59], v8 offset:3072
    s_waitcnt lgkmcnt(4)
    v_mfma_f32_16x16x32_f16 v[44:47], v[76:79], v[60:63], v[44:47]
    s_waitcnt lgkmcnt(3)
    v_mfma_f32_16x16x32_f16 v[44:47], v[80:83], v[64:67], v[44:47]
    s_waitcnt lgkmcnt(2)
    v_mfma_f32_16x16x32_f16 v[44:47], v[84:87], v[48:51], v[44:47]
    s_waitcnt lgkmcnt(1)
    v_mfma_f32_16x16x32_f16 v[44:47], v[88:91], v[52:55], v[44:47]
    s_waitcnt lgkmcnt(0)
    v_mfma_f32_16x16x32_f16 v[44:47], v[92:95], v[56:59], v[44:47]
    s_mov_b64 exec, s[46:47]
    s_nop 6
    v_cvt_pk_f16_f32 v60, v44, v45
    v_cvt_pk_f16_f32 v61, v46, v47
    global_store_dwordx2 v9, v[60:61], s[34:35] sc1
    s_mov_b64 exec, -1
    s_setprio 0
    s_barrier
    ds_read_b128 v[52:55], v15 offset:0
    ds_read_b128 v[56:59], v15 offset:1024
    v_mov_b32 v44, 0
    v_mov_b32 v45, 0
    v_mov_b32 v46, 0
    v_mov_b32 v47, 0
    v_mov_b32 v48, 0
    v_mov_b32 v49, 0
    v_mov_b32 v50, 0
    v_mov_b32 v51, 0
    ds_read_b128 v[60:63], v15 offset:2048
    ds_read_b128 v[64:67], v15 offset:3072
    v_smfmac_f32_16x16x64_f16 v[44:47], v[16:19], v[96:103], v5
    v_smfmac_f32_16x16x64_f16 v[48:51], v[16:19], v[104:111], v5
    v_smfmac_f32_16x16x64_f16 v[44:47], v[20:23], v[112:119], v5
    s_waitcnt lgkmcnt(2)
    v_smfmac_f32_16x16x64_f16 v[44:47], v[28:31], v[52:59], v5
    ds_read_b128 v[52:55], v15 offset:4096
    ds_read_b128 v[56:59], v15 offset:5120
    v_smfmac_f32_16x16x64_f16 v[48:51], v[20:23], v[120:127], v5
    s_waitcnt lgkmcnt(2)
    v_smfmac_f32_16x16x64_f16 v[48:51], v[28:31], v[60:67], v5
    ds_read_b128 v[60:63], v15 offset:6144
    ds_read_b128 v[64:67], v15 offset:7168
    v_smfmac_f32_16x16x64_f16 v[44:47], v[24:27], v[128:135], v5
    s_waitcnt lgkmcnt(2)
    v_smfmac_f32_16x16x64_f16 v[44:47], v[32:35], v[52:59], v5
    ds_read_b128 v[52:55], v15 offset:8192
    ds_read_b128 v[56:59], v15 offset:9216
    v_smfmac_f32_16x16x64_f16 v[48:51], v[24:27], v[136:143], v5
    s_waitcnt lgkmcnt(2)
    v_smfmac_f32_16x16x64_f16 v[48:51], v[32:35], v[60:67], v5
    ds_read_b128 v[60:63], v15 offset:10240
    ds_read_b128 v[64:67], v15 offset:11264
    s_waitcnt lgkmcnt(2)
    v_smfmac_f32_16x16x64_f16 v[44:47], v[36:39], v[52:59], v5
    ds_read_b128 v[52:55], v15 offset:12288
    ds_read_b128 v[56:59], v15 offset:13312
    s_waitcnt lgkmcnt(2)
    v_smfmac_f32_16x16x64_f16 v[48:51], v[36:39], v[60:67], v5
    ds_read_b128 v[60:63], v15 offset:14336
    ds_read_b128 v[64:67], v15 offset:15360
    s_waitcnt lgkmcnt(2)
    v_smfmac_f32_16x16x64_f16 v[44:47], v[40:43], v[52:59], v5
    s_waitcnt lgkmcnt(0)
    v_smfmac_f32_16x16x64_f16 v[48:51], v[40:43], v[60:67], v5
    s_nop 5
    v_cvt_pk_f16_f32 v16, v44, v45
    v_cvt_pk_f16_f32 v17, v46, v47
    v_cvt_pk_f16_f32 v18, v48, v49
    v_cvt_pk_f16_f32 v19, v50, v51
    ds_write_b128 v12, v[16:19]
    s_waitcnt lgkmcnt(0)
    s_barrier
    global_load_dwordx4 v[68:71], v2, s[42:43] offset:-4096 sc1
    global_load_dwordx4 v[72:75], v2, s[42:43] offset:-3072 sc1
    global_load_dwordx4 v[76:79], v2, s[42:43] offset:-2048 sc1
    global_load_dwordx4 v[80:83], v2, s[42:43] offset:-1024 sc1
    global_load_dwordx4 v[84:87], v2, s[42:43] offset:0 sc1
    global_load_dwordx4 v[88:91], v2, s[42:43] offset:1024 sc1
    global_load_dwordx4 v[92:95], v2, s[42:43] offset:2048 sc1
    v_mov_b32 v48, -1
    v_mov_b32 v49, -1
    global_store_dwordx2 v13, v[48:49], s[32:33] sc1
    s_mov_b64 exec, s[46:47]
    global_store_dwordx2 v9, v[48:49], s[36:37] sc1
    s_mov_b64 exec, -1
    s_barrier
    ds_read_b128 v[16:19], v2 offset:11264
    ds_read_b128 v[20:23], v2 offset:12288
    ds_read_b128 v[24:27], v2 offset:13312
    ds_read_b128 v[28:31], v2 offset:14336
    s_waitcnt lgkmcnt(2)
    v_pk_add_f32 v[16:17], v[16:17], v[20:21]
    v_pk_add_f32 v[18:19], v[18:19], v[22:23]
    s_waitcnt lgkmcnt(1)
    v_pk_add_f32 v[16:17], v[16:17], v[24:25]
    v_pk_add_f32 v[18:19], v[18:19], v[26:27]
    s_waitcnt lgkmcnt(0)
    v_pk_add_f32 v[16:17], v[16:17], v[28:29]
    v_pk_add_f32 v[18:19], v[18:19], v[30:31]
    v_cvt_pk_f16_f32 v16, v16, v17
    v_cvt_pk_f16_f32 v17, v18, v19
    global_store_dwordx2 v13, v[16:17], s[30:31] sc1
    s_barrier
    s_cmp_eq_u32 s24, 62
    s_cselect_b64 exec, -1, 0
    global_store_dwordx2 v13, v[16:17], s[48:49] sc1
    s_mov_b64 exec, -1
    s_add_u32 s58, s30, 3584
    s_addc_u32 s59, s31, 0
    s_add_u32 s24, s24, 1
    s_add_u32 s50, s24, 0
    s_and_b32 s50, s50, 3
    s_mul_i32 s50, s50, 24576
    s_add_u32 s34, s28, s50
    s_addc_u32 s35, s29, 0
    s_add_u32 s50, s24, 3
    s_and_b32 s50, s50, 3
    s_mul_i32 s50, s50, 24576
    s_add_u32 s36, s28, s50
    s_addc_u32 s37, s29, 0
    s_add_u32 s50, s24, 1
    s_and_b32 s50, s50, 3
    s_mul_i32 s50, s50, 16384
    s_add_u32 s30, s26, s50
    s_addc_u32 s31, s27, 0
    s_add_u32 s50, s24, 3
    s_and_b32 s50, s50, 3
    s_mul_i32 s50, s50, 16384
    s_add_u32 s32, s26, s50
    s_addc_u32 s33, s27, 0
    s_add_u32 s42, s42, 28672
    s_addc_u32 s43, s43, 0
    s_add_u32 s54, s54, 458752
    s_addc_u32 s55, s55, 0
    v_mov_b32 v44, 0
    v_mov_b32 v45, 0
    v_mov_b32 v46, 0
    v_mov_b32 v47, 0
    s_setprio 1
    s_branch XC6_loop
XC6_fin:
    s_setprio 0
    ds_read_b128 v[16:19], v6 offset:0
    ds_read_b128 v[20:23], v6 offset:512
    ds_read_b128 v[24:27], v6 offset:1024
    ds_read_b128 v[28:31], v6 offset:1536
    ds_read_b128 v[32:35], v6 offset:2048
    ds_read_b128 v[36:39], v6 offset:2560
    ds_read_b128 v[40:43], v6 offset:3072
    ds_read_b128 v[52:55], v15 offset:0
    ds_read_b128 v[56:59], v15 offset:1024
    ds_read_b128 v[60:63], v15 offset:2048
    ds_read_b128 v[64:67], v15 offset:3072
    v_mov_b32 v48, 0
    v_mov_b32 v49, 0
    v_mov_b32 v50, 0
    v_mov_b32 v51, 0
    s_waitcnt lgkmcnt(0)
    v_smfmac_f32_16x16x64_f16 v[44:47], v[28:31], v[52:59], v5
    ds_read_b128 v[52:55], v15 offset:4096
    ds_read_b128 v[56:59], v15 offset:5120
    v_smfmac_f32_16x16x64_f16 v[44:47], v[16:19], v[96:103], v5
    v_smfmac_f32_16x16x64_f16 v[48:51], v[28:31], v[60:67], v5
    ds_read_b128 v[60:63], v15 offset:6144
    ds_read_b128 v[64:67], v15 offset:7168
    v_smfmac_f32_16x16x64_f16 v[48:51], v[16:19], v[104:111], v5
    s_waitcnt lgkmcnt(2)
    v_smfmac_f32_16x16x64_f16 v[44:47], v[32:35], v[52:59], v5
    ds_read_b128 v[52:55], v15 offset:8192
    ds_read_b128 v[56:59], v15 offset:9216
    v_smfmac_f32_16x16x64_f16 v[44:47], v[20:23], v[112:119], v5
    s_waitcnt lgkmcnt(2)
    v_smfmac_f32_16x16x64_f16 v[48:51], v[32:35], v[60:67], v5
    ds_read_b128 v[60:63], v15 offset:10240
    ds_read_b128 v[64:67], v15 offset:11264
    v_smfmac_f32_16x16x64_f16 v[48:51], v[20:23], v[120:127], v5
    s_waitcnt lgkmcnt(2)
    v_smfmac_f32_16x16x64_f16 v[44:47], v[36:39], v[52:59], v5
    ds_read_b128 v[52:55], v15 offset:12288
    ds_read_b128 v[56:59], v15 offset:13312
    v_smfmac_f32_16x16x64_f16 v[44:47], v[24:27], v[128:135], v5
    s_waitcnt lgkmcnt(2)
    v_smfmac_f32_16x16x64_f16 v[48:51], v[36:39], v[60:67], v5
    ds_read_b128 v[60:63], v15 offset:14336
    ds_read_b128 v[64:67], v15 offset:15360
    v_smfmac_f32_16x16x64_f16 v[48:51], v[24:27], v[136:143], v5
    s_waitcnt lgkmcnt(2)
    v_smfmac_f32_16x16x64_f16 v[44:47], v[40:43], v[52:59], v5
    s_waitcnt lgkmcnt(0)
    v_smfmac_f32_16x16x64_f16 v[48:51], v[40:43], v[60:67], v5
    s_nop 5
    v_cvt_pk_f16_f32 v16, v44, v45
    v_cvt_pk_f16_f32 v17, v46, v47
    v_cvt_pk_f16_f32 v18, v48, v49
    v_cvt_pk_f16_f32 v19, v50, v51
    ds_write_b128 v12, v[16:19]
    s_waitcnt lgkmcnt(0)
    s_barrier
    s_endpgm
XC7_entry:
    s_add_u32 s50, s24, 0
    s_and_b32 s50, s50, 3
    s_mul_i32 s50, s50, 24576
    s_add_u32 s34, s28, s50
    s_addc_u32 s35, s29, 0
    s_add_u32 s50, s24, 3
    s_and_b32 s50, s50, 3
    s_mul_i32 s50, s50, 24576
    s_add_u32 s36, s28, s50
    s_addc_u32 s37, s29, 0
    s_add_u32 s50, s24, 1
    s_and_b32 s50, s50, 3
    s_mul_i32 s50, s50, 16384
    s_add_u32 s30, s26, s50
    s_addc_u32 s31, s27, 0
    s_add_u32 s42, s42, 28672
    s_addc_u32 s43, s43, 0
    s_add_u32 s54, s54, 458752
    s_addc_u32 s55, s55, 0
    v_mov_b32 v44, 0
    v_mov_b32 v45, 0
    v_mov_b32 v46, 0
    v_mov_b32 v47, 0
    v_mov_b32 v48, 0
    v_mov_b32 v49, 0
    v_mov_b32 v50, 0
    v_mov_b32 v51, 0
    s_setprio 1
    s_branch XC7_top
.p2align 6
XC7_loop:
    s_waitcnt vmcnt(0)
    v_pk_add_f16 v16, v208, v212
    v_pk_add_f16 v17, v209, v213
    v_pk_add_f16 v18, v210, v214
    v_pk_add_f16 v19, v211, v215
    ds_write_b128 v14, v[16:19]
    v_pk_maximum3_f16 v20, v16, v17, v18
    v_pk_maximum3_f16 v20, v20, v19, v19
    v_cmp_u_f16 vcc, v20, v20
    s_cbranch_vccnz XC7_mre
XC7_got:
XC7_top:
    s_cmp_eq_u32 s24, 63
    s_waitcnt lgkmcnt(0)
    s_barrier
    s_cbranch_scc1 XC7_fin
    s_setprio 0
    global_load_dword v4, v10, s[54:55] sc1
    ds_read_b128 v[52:55], v2 offset:19456
    ds_read_b128 v[56:59], v2 offset:20480
    ds_read_b128 v[60:63], v2 offset:21504
    ds_read_b128 v[64:67], v2 offset:22528
    s_waitcnt lgkmcnt(0)
    global_store_dwordx4 v2, v[52:55], s[40:41] offset:-2048 sc1
    global_store_dwordx4 v2, v[56:59], s[40:41] offset:-1024 sc1
    global_store_dwordx4 v2, v[60:63], s[40:41] offset:2048 sc1
    global_store_dwordx4 v2, v[64:67], s[40:41] offset:3072 sc1
    ds_read_b128 v[16:19], v6 offset:0
    ds_read_b128 v[20:23], v6 offset:512
    ds_read_b128 v[24:27], v6 offset:1024
    ds_read_b128 v[28:31], v6 offset:1536
    ds_read_b128 v[32:35], v6 offset:2048
    ds_read_b128 v[36:39], v6 offset:2560
    ds_read_b128 v[40:43], v6 offset:3072
    s_barrier
    s_setprio 0
    ds_read_b128 v[224:227], v8 offset:0
    ds_read_b128 v[228:231], v8 offset:512
    ds_read_b128 v[232:235], v8 offset:1024
    ds_read_b128 v[236:239], v8 offset:1536
    ds_read_b128 v[240:243], v8 offset:2048
    ds_read_b128 v[244:247], v8 offset:2560
    ds_read_b128 v[248:251], v8 offset:3072
    s_waitcnt lgkmcnt(6)
    v_mfma_f32_16x16x32_f16 v[252:255], v[68:71], v[224:227], 0
    s_waitcnt lgkmcnt(5)
    v_mfma_f32_16x16x32_f16 v[252:255], v[72:75], v[228:231], v[252:255]
    s_waitcnt lgkmcnt(4)
    v_mfma_f32_16x16x32_f16 v[252:255], v[76:79], v[232:235], v[252:255]
    s_waitcnt lgkmcnt(3)
    v_mfma_f32_16x16x32_f16 v[252:255], v[80:83], v[236:239], v[252:255]
    s_waitcnt lgkmcnt(2)
    v_mfma_f32_16x16x32_f16 v[252:255], v[84:87], v[240:243], v[252:255]
    s_waitcnt lgkmcnt(1)
    v_mfma_f32_16x16x32_f16 v[252:255], v[88:91], v[244:247], v[252:255]
    s_waitcnt lgkmcnt(0)
    v_mfma_f32_16x16x32_f16 v[252:255], v[92:95], v[248:251], v[252:255]
    s_mov_b64 exec, s[46:47]
    s_nop 6
    v_cvt_pk_f16_f32 v232, v252, v253
    v_cvt_pk_f16_f32 v233, v254, v255
    global_store_dwordx2 v9, v[232:233], s[34:35] sc1
    s_mov_b64 exec, -1
    s_setprio 0
    s_barrier
    v_smfmac_f32_16x16x64_f16 v[44:47], v[16:19], v[96:103], v5
    v_smfmac_f32_16x16x64_f16 v[48:51], v[16:19], v[104:111], v5
    v_smfmac_f32_16x16x64_f16 v[44:47], v[20:23], v[112:119], v5
    v_smfmac_f32_16x16x64_f16 v[48:51], v[20:23], v[120:127], v5
    v_smfmac_f32_16x16x64_f16 v[44:47], v[24:27], v[128:135], v5
    v_smfmac_f32_16x16x64_f16 v[48:51], v[24:27], v[136:143], v5
    v_smfmac_f32_16x16x64_f16 v[44:47], v[28:31], v[144:151], v5
    v_smfmac_f32_16x16x64_f16 v[48:51], v[28:31], v[152:159], v5
    v_smfmac_f32_16x16x64_f16 v[44:47], v[32:35], v[160:167], v5
    v_smfmac_f32_16x16x64_f16 v[48:51], v[32:35], v[168:175], v5
    v_smfmac_f32_16x16x64_f16 v[44:47], v[36:39], v[176:183], v5
    v_smfmac_f32_16x16x64_f16 v[48:51], v[36:39], v[184:191], v5
    v_smfmac_f32_16x16x64_f16 v[44:47], v[40:43], v[192:199], v5
    v_smfmac_f32_16x16x64_f16 v[48:51], v[40:43], v[200:207], v5
    s_nop 6
    v_cvt_pk_f16_f32 v16, v44, v45
    v_cvt_pk_f16_f32 v17, v46, v47
    v_cvt_pk_f16_f32 v18, v48, v49
    v_cvt_pk_f16_f32 v19, v50, v51
    ds_write_b128 v12, v[16:19]
    s_waitcnt lgkmcnt(0)
    s_barrier
    global_load_dwordx4 v[68:71], v2, s[42:43] offset:-4096 sc1
    global_load_dwordx4 v[72:75], v2, s[42:43] offset:-3072 sc1
    global_load_dwordx4 v[76:79], v2, s[42:43] offset:-2048 sc1
    global_load_dwordx4 v[80:83], v2, s[42:43] offset:-1024 sc1
    global_load_dwordx4 v[84:87], v2, s[42:43] offset:0 sc1
    global_load_dwordx4 v[88:91], v2, s[42:43] offset:1024 sc1
    global_load_dwordx4 v[92:95], v2, s[42:43] offset:2048 sc1
    v_mov_b32 v48, -1
    v_mov_b32 v49, -1
    s_mov_b64 exec, s[46:47]
    global_store_dwordx2 v9, v[48:49], s[36:37] sc1
    s_mov_b64 exec, -1
    s_load_dword s96, s[54:55], 10496
    s_load_dword s96, s[54:55], 10624
    s_load_dword s96, s[54:55], 10752
    s_load_dword s96, s[54:55], 10880
    s_load_dword s96, s[54:55], 11008
    s_load_dword s96, s[54:55], 11136
    s_load_dword s96, s[54:55], 11264
    s_load_dword s96, s[54:55], 11392
    s_load_dword s96, s[54:55], 11520
    s_load_dword s96, s[54:55], 11648
    s_load_dword s96, s[54:55], 11776
    s_load_dword s96, s[54:55], 11904
    s_load_dword s96, s[54:55], 12032
    s_load_dword s96, s[54:55], 12160
    s_barrier
    s_barrier
    s_add_u32 s58, s30, 3584
    s_addc_u32 s59, s31, 0
    s_add_u32 s24, s24, 1
    s_add_u32 s50, s24, 0
    s_and_b32 s50, s50, 3
    s_mul_i32 s50, s50, 24576
    s_add_u32 s34, s28, s50
    s_addc_u32 s35, s29, 0
    s_add_u32 s50, s24, 3
    s_and_b32 s50, s50, 3
    s_mul_i32 s50, s50, 24576
    s_add_u32 s36, s28, s50
    s_addc_u32 s37, s29, 0
    s_add_u32 s50, s24, 1
    s_and_b32 s50, s50, 3
    s_mul_i32 s50, s50, 16384
    s_add_u32 s30, s26, s50
    s_addc_u32 s31, s27, 0
    s_add_u32 s42, s42, 28672
    s_addc_u32 s43, s43, 0
    s_add_u32 s54, s54, 458752
    s_addc_u32 s55, s55, 0
    s_add_u32 s40, s40, 114688
    s_addc_u32 s41, s41, 0
    s_add_u32 s44, s44, 28672
    s_addc_u32 s45, s45, 0
    v_mov_b32 v44, 0
    v_mov_b32 v45, 0
    v_mov_b32 v46, 0
    v_mov_b32 v47, 0
    v_mov_b32 v48, 0
    v_mov_b32 v49, 0
    v_mov_b32 v50, 0
    v_mov_b32 v51, 0
    s_setprio 1
    global_load_dwordx4 v[208:211], v14, s[58:59] offset:-3584 sc1
    global_load_dwordx4 v[212:215], v14, s[58:59] offset:3584 sc1
    s_branch XC7_loop
XC7_mre:
    global_load_dwordx4 v[208:211], v14, s[58:59] offset:-3584 sc1
    global_load_dwordx4 v[212:215], v14, s[58:59] offset:3584 sc1
    s_sub_u32 s25, s25, 1
    s_cbranch_scc1 M_end
    s_waitcnt lgkmcnt(0)
    s_branch XC7_loop
XC7_fin:
    s_setprio 0
    s_waitcnt vmcnt(0)
    ds_read_b128 v[16:19], v6 offset:0
    ds_read_b128 v[20:23], v6 offset:512
    ds_read_b128 v[24:27], v6 offset:1024
    ds_read_b128 v[28:31], v6 offset:1536
    ds_read_b128 v[32:35], v6 offset:2048
    ds_read_b128 v[36:39], v6 offset:2560
    ds_read_b128 v[40:43], v6 offset:3072
    ds_read_b128 v[208:211], v2 offset:19456
    ds_read_b128 v[212:215], v2 offset:20480
    ds_read_b128 v[216:219], v2 offset:21504
    ds_read_b128 v[220:223], v2 offset:22528
    s_waitcnt lgkmcnt(0)
    global_store_dwordx4 v2, v[208:211], s[40:41] offset:-2048 sc1
    global_store_dwordx4 v2, v[212:215], s[40:41] offset:-1024 sc1
    global_store_dwordx4 v2, v[216:219], s[40:41] offset:2048 sc1
    global_store_dwordx4 v2, v[220:223], s[40:41] offset:3072 sc1
    s_add_u32 s40, s40, 114688
    s_addc_u32 s41, s41, 0
    v_smfmac_f32_16x16x64_f16 v[44:47], v[16:19], v[96:103], v5
    v_smfmac_f32_16x16x64_f16 v[48:51], v[16:19], v[104:111], v5
    v_smfmac_f32_16x16x64_f16 v[44:47], v[20:23], v[112:119], v5
    v_smfmac_f32_16x16x64_f16 v[48:51], v[20:23], v[120:127], v5
    v_smfmac_f32_16x16x64_f16 v[44:47], v[24:27], v[128:135], v5
    v_smfmac_f32_16x16x64_f16 v[48:51], v[24:27], v[136:143], v5
    v_smfmac_f32_16x16x64_f16 v[44:47], v[28:31], v[144:151], v5
    v_smfmac_f32_16x16x64_f16 v[48:51], v[28:31], v[152:159], v5
    v_smfmac_f32_16x16x64_f16 v[44:47], v[32:35], v[160:167], v5
    v_smfmac_f32_16x16x64_f16 v[48:51], v[32:35], v[168:175], v5
    v_smfmac_f32_16x16x64_f16 v[44:47], v[36:39], v[176:183], v5
    v_smfmac_f32_16x16x64_f16 v[48:51], v[36:39], v[184:191], v5
    v_smfmac_f32_16x16x64_f16 v[44:47], v[40:43], v[192:199], v5
    v_smfmac_f32_16x16x64_f16 v[48:51], v[40:43], v[200:207], v5
    s_nop 6
    v_cvt_pk_f16_f32 v16, v44, v45
    v_cvt_pk_f16_f32 v17, v46, v47
    v_cvt_pk_f16_f32 v18, v48, v49
    v_cvt_pk_f16_f32 v19, v50, v51
    ds_write_b128 v12, v[16:19]
    s_waitcnt lgkmcnt(0)
    s_barrier
    s_endpgm
XCH_hdisp:
    s_cmp_eq_u32 s14, 3
    s_cbranch_scc1 XH3_entry
    s_cmp_eq_u32 s14, 4
    s_cbranch_scc1 XH4_entry
    s_cmp_eq_u32 s14, 5
    s_cbranch_scc1 XH5_entry
    s_cmp_eq_u32 s14, 6
    s_cbranch_scc1 XH6_entry
    s_cmp_eq_u32 s14, 7
    s_cbranch_scc1 XH7_entry
XH0_entry:
    s_add_u32 s50, s24, 0
    s_and_b32 s50, s50, 3
    s_mul_i32 s50, s50, 24576
    s_add_u32 s34, s28, s50
    s_addc_u32 s35, s29, 0
    s_add_u32 s50, s24, 1
    s_and_b32 s50, s50, 3
    s_mul_i32 s50, s50, 16384
    s_add_u32 s30, s26, s50
    s_addc_u32 s31, s27, 0
    v_mov_b32 v84, 0
    v_mov_b32 v85, 0
    v_mov_b32 v86, 0
    v_mov_b32 v87, 0
    s_setprio 1
    s_branch XH0_top
.p2align 6
XH0_loop:
    s_waitcnt vmcnt(0)
    v_pk_add_f16 v16, v68, v72
    v_pk_add_f16 v17, v69, v73
    v_pk_add_f16 v18, v70, v74
    v_pk_add_f16 v19, v71, v75
    ds_write_b128 v14, v[16:19]
    v_pk_maximum3_f16 v20, v16, v17, v18
    v_pk_maximum3_f16 v20, v20, v19, v19
    v_cmp_u_f16 vcc, v20, v20
    s_cbranch_vccnz XH0_mre
XH0_got:
XH0_top:
    s_cmp_eq_u32 s24, 63
    s_waitcnt lgkmcnt(0)
    s_barrier
    s_cbranch_scc1 XH0_fin
    ds_read_b128 v[16:19], v3 offset:0
    ds_read_b128 v[20:23], v3 offset:512
    ds_read_b128 v[24:27], v3 offset:1024
    ds_read_b128 v[28:31], v3 offset:1536
    ds_read_b128 v[32:35], v3 offset:2048
    ds_read_b128 v[36:39], v3 offset:2560
    s_waitcnt lgkmcnt(5)
    v_smfmac_f32_16x16x64_f16 v[84:87], v[16:19], v[144:151], v5
    ds_read_b128 v[40:43], v3 offset:3072
    s_waitcnt lgkmcnt(5)
    v_smfmac_f32_16x16x64_f16 v[84:87], v[20:23], v[152:159], v5
    ds_read_b128 v[16:19], v6 offset:0
    s_waitcnt lgkmcnt(5)
    v_smfmac_f32_16x16x64_f16 v[84:87], v[24:27], v[160:167], v5
    ds_read_b128 v[20:23], v6 offset:512
    s_waitcnt lgkmcnt(5)
    v_smfmac_f32_16x16x64_f16 v[84:87], v[28:31], v[168:175], v5
    ds_read_b128 v[24:27], v6 offset:1024
    s_waitcnt lgkmcnt(5)
    v_smfmac_f32_16x16x64_f16 v[84:87], v[32:35], v[176:183], v5
    ds_read_b128 v[28:31], v6 offset:1536
    s_waitcnt lgkmcnt(5)
    v_smfmac_f32_16x16x64_f16 v[84:87], v[36:39], v[184:191], v5
    ds_read_b128 v[32:35], v6 offset:2048
    s_waitcnt lgkmcnt(5)
    v_smfmac_f32_16x16x64_f16 v[84:87], v[40:43], v[192:199], v5
    ds_read_b128 v[36:39], v6 offset:2560
    s_waitcnt lgkmcnt(5)
    v_smfmac_f32_16x16x64_f16 v[84:87], v[16:19], v[200:207], v5
    ds_read_b128 v[40:43], v6 offset:3072
    s_waitcnt lgkmcnt(5)
    v_smfmac_f32_16x16x64_f16 v[84:87], v[20:23], v[208:215], v5
    s_waitcnt lgkmcnt(4)
    v_smfmac_f32_16x16x64_f16 v[84:87], v[24:27], v[216:223], v5
    s_waitcnt lgkmcnt(3)
    v_smfmac_f32_16x16x64_f16 v[84:87], v[28:31], v[224:231], v5
    s_waitcnt lgkmcnt(2)
    v_smfmac_f32_16x16x64_f16 v[84:87], v[32:35], v[232:239], v5
    s_waitcnt lgkmcnt(1)
    v_smfmac_f32_16x16x64_f16 v[84:87], v[36:39], v[240:247], v5
    s_waitcnt lgkmcnt(0)
    v_smfmac_f32_16x16x64_f16 v[84:87], v[40:43], v[248:255], v5
    s_nop 7
    v_cvt_pk_f16_f32 v84, v84, v86
    v_cvt_pk_f16_f32 v85, v85, v87
    ds_write2_b32 v7, v84, v85 offset0:0 offset1:4
    s_setprio 0
    ds_read2_b64 v[52:55], v4 offset0:0 offset1:32
    s_waitcnt lgkmcnt(0)
    global_store_dwordx4 v13, v[52:55], s[48:49] sc1
    s_waitcnt lgkmcnt(0)
    s_barrier
    s_barrier
    global_load_dword v68, v96, s[56:57] sc1
    s_barrier
    s_add_u32 s58, s30, 3584
    s_addc_u32 s59, s31, 0
    global_load_dwordx4 v[68:71], v14, s[58:59] offset:-3584 sc1
    global_load_dwordx4 v[72:75], v14, s[58:59] offset:3584 sc1
    s_add_u32 s24, s24, 1
    s_add_u32 s50, s24, 0
    s_and_b32 s50, s50, 3
    s_mul_i32 s50, s50, 24576
    s_add_u32 s34, s28, s50
    s_addc_u32 s35, s29, 0
    s_add_u32 s50, s24, 1
    s_and_b32 s50, s50, 3
    s_mul_i32 s50, s50, 16384
    s_add_u32 s30, s26, s50
    s_addc_u32 s31, s27, 0
    s_add_u32 s38, s38, 458752
    s_addc_u32 s39, s39, 0
    s_add_u32 s48, s48, 8192
    s_addc_u32 s49, s49, 0
    s_add_u32 s56, s56, 458752
    s_addc_u32 s57, s57, 0
    v_mov_b32 v84, 0
    v_mov_b32 v85, 0
    v_mov_b32 v86, 0
    v_mov_b32 v87, 0
    s_setprio 1
    s_branch XH0_loop
XH0_mre:
    global_load_dwordx4 v[68:71], v14, s[58:59] offset:-3584 sc1
    global_load_dwordx4 v[72:75], v14, s[58:59] offset:3584 sc1
    s_sub_u32 s25, s25, 1
    s_cbranch_scc1 M_end
    s_waitcnt lgkmcnt(0)
    s_branch XH0_loop
XH0_fin:
    s_setprio 0
    s_waitcnt vmcnt(0)
    ds_read2_b64 v[52:55], v4 offset0:0 offset1:32
    s_waitcnt lgkmcnt(0)
    global_store_dwordx4 v13, v[52:55], s[48:49] sc1
    s_endpgm
XH3_entry:
    s_add_u32 s50, s24, 0
    s_and_b32 s50, s50, 3
    s_mul_i32 s50, s50, 24576
    s_add_u32 s34, s28, s50
    s_addc_u32 s35, s29, 0
    s_add_u32 s50, s24, 1
    s_and_b32 s50, s50, 3
    s_mul_i32 s50, s50, 16384
    s_add_u32 s30, s26, s50
    s_addc_u32 s31, s27, 0
    v_mov_b32 v84, 0
    v_mov_b32 v85, 0
    v_mov_b32 v86, 0
    v_mov_b32 v87, 0
    s_setprio 1
    s_branch XH3_top
.p2align 6
XH3_loop:
    s_waitcnt vmcnt(0)
    v_pk_add_f16 v16, v68, v72
    v_pk_add_f16 v17, v69, v73
    v_pk_add_f16 v18, v70, v74
    v_pk_add_f16 v19, v71, v75
    ds_write_b128 v14, v[16:19]
    v_pk_maximum3_f16 v20, v16, v17, v18
    v_pk_maximum3_f16 v20, v20, v19, v19
    v_cmp_u_f16 vcc, v20, v20
    s_cbranch_vccnz XH3_mre
XH3_got:
XH3_top:
    s_cmp_eq_u32 s24, 63
    s_waitcnt lgkmcnt(0)
    s_barrier
    s_cbranch_scc1 XH3_fin
    ds_read_b128 v[16:19], v3 offset:0
    ds_read_b128 v[20:23], v3 offset:512
    ds_read_b128 v[24:27], v3 offset:1024
    ds_read_b128 v[28:31], v3 offset:1536
    ds_read_b128 v[32:35], v3 offset:2048
    ds_read_b128 v[36:39], v3 offset:2560
    s_waitcnt lgkmcnt(5)
    v_smfmac_f32_16x16x64_f16 v[84:87], v[16:19], v[144:151], v5
    ds_read_b128 v[40:43], v3 offset:3072
    s_waitcnt lgkmcnt(5)
    v_smfmac_f32_16x16x64_f16 v[84:87], v[20:23], v[152:159], v5
    ds_read_b128 v[16:19], v6 offset:0
    s_waitcnt lgkmcnt(5)
    v_smfmac_f32_16x16x64_f16 v[84:87], v[24:27], v[160:167], v5
    ds_read_b128 v[20:23], v6 offset:512
    s_waitcnt lgkmcnt(5)
    v_smfmac_f32_16x16x64_f16 v[84:87], v[28:31], v[168:175], v5
    ds_read_b128 v[24:27], v6 offset:1024
    s_waitcnt lgkmcnt(5)
    v_smfmac_f32_16x16x64_f16 v[84:87], v[32:35], v[176:183], v5
    ds_read_b128 v[28:31], v6 offset:1536
    s_waitcnt lgkmcnt(5)
    v_smfmac_f32_16x16x64_f16 v[84:87], v[36:39], v[184:191], v5
    ds_read_b128 v[32:35], v6 offset:2048
    s_waitcnt lgkmcnt(5)
    v_smfmac_f32_16x16x64_f16 v[84:87], v[40:43], v[192:199], v5
    ds_read_b128 v[36:39], v6 offset:2560
    s_waitcnt lgkmcnt(5)
    v_smfmac_f32_16x16x64_f16 v[84:87], v[16:19], v[200:207], v5
    ds_read_b128 v[40:43], v6 offset:3072
    s_waitcnt lgkmcnt(5)
    v_smfmac_f32_16x16x64_f16 v[84:87], v[20:23], v[208:215], v5
    s_waitcnt lgkmcnt(4)
    v_smfmac_f32_16x16x64_f16 v[84:87], v[24:27], v[216:223], v5
    s_waitcnt lgkmcnt(3)
    v_smfmac_f32_16x16x64_f16 v[84:87], v[28:31], v[224:231], v5
    s_waitcnt lgkmcnt(2)
    v_smfmac_f32_16x16x64_f16 v[84:87], v[32:35], v[232:239], v5
    s_waitcnt lgkmcnt(1)
    v_smfmac_f32_16x16x64_f16 v[84:87], v[36:39], v[240:247], v5
    s_waitcnt lgkmcnt(0)
    v_smfmac_f32_16x16x64_f16 v[84:87], v[40:43], v[248:255], v5
    s_nop 7
    v_cvt_pk_f16_f32 v84, v84, v86
    v_cvt_pk_f16_f32 v85, v85, v87
    ds_write2_b32 v7, v84, v85 offset0:0 offset1:4
    s_setprio 0
    ds_read2_b64 v[52:55], v4 offset0:0 offset1:32
    s_waitcnt lgkmcnt(0)
    global_store_dwordx4 v13, v[52:55], s[48:49] sc1
    s_waitcnt lgkmcnt(0)
    s_barrier
    s_barrier
    global_load_dword v68, v96, s[56:57] sc1
    s_barrier
    s_add_u32 s58, s30, 3584
    s_addc_u32 s59, s31, 0
    global_load_dwordx4 v[68:71], v14, s[58:59] offset:-3584 sc1
    global_load_dwordx4 v[72:75], v14, s[58:59] offset:3584 sc1
    s_add_u32 s24, s24, 1
    s_add_u32 s50, s24, 0
    s_and_b32 s50, s50, 3
    s_mul_i32 s50, s50, 24576
    s_add_u32 s34, s28, s50
    s_addc_u32 s35, s29, 0
    s_add_u32 s50, s24, 1
    s_and_b32 s50, s50, 3
    s_mul_i32 s50, s50, 16384
    s_add_u32 s30, s26, s50
    s_addc_u32 s31, s27, 0
    s_add_u32 s38, s38, 458752
    s_addc_u32 s39, s39, 0
    s_add_u32 s48, s48, 8192
    s_addc_u32 s49, s49, 0
    s_add_u32 s56, s56, 458752
    s_addc_u32 s57, s57, 0
    v_mov_b32 v84, 0
    v_mov_b32 v85, 0
    v_mov_b32 v86, 0
    v_mov_b32 v87, 0
    s_setprio 1
    s_branch XH3_loop
XH3_mre:
    global_load_dwordx4 v[68:71], v14, s[58:59] offset:-3584 sc1
    global_load_dwordx4 v[72:75], v14, s[58:59] offset:3584 sc1
    s_sub_u32 s25, s25, 1
    s_cbranch_scc1 M_end
    s_waitcnt lgkmcnt(0)
    s_branch XH3_loop
XH3_fin:
    s_setprio 0
    s_waitcnt vmcnt(0)
    ds_read2_b64 v[52:55], v4 offset0:0 offset1:32
    s_waitcnt lgkmcnt(0)
    global_store_dwordx4 v13, v[52:55], s[48:49] sc1
    s_endpgm
XH4_entry:
    s_add_u32 s50, s24, 1
    s_and_b32 s50, s50, 3
    s_mul_i32 s50, s50, 16384
    s_add_u32 s30, s26, s50
    s_addc_u32 s31, s27, 0
    s_add_u32 s54, s54, 458752
    s_addc_u32 s55, s55, 0
    v_mov_b32 v44, 0
    v_mov_b32 v45, 0
    v_mov_b32 v46, 0
    v_mov_b32 v47, 0
    s_setprio 1
    s_branch XH4_top
.p2align 6
XH4_loop:
    s_waitcnt vmcnt(0)
    v_pk_add_f16 v16, v68, v72
    v_pk_add_f16 v17, v69, v73
    v_pk_add_f16 v18, v70, v74
    v_pk_add_f16 v19, v71, v75
    ds_write_b128 v14, v[16:19]
    v_pk_maximum3_f16 v20, v16, v17, v18
    v_pk_maximum3_f16 v20, v20, v19, v19
    v_cmp_u_f16 vcc, v20, v20
    s_cbranch_vccnz XH4_mre
XH4_got:
XH4_top:
    s_cmp_eq_u32 s24, 63
    s_waitcnt lgkmcnt(0)
    s_barrier
    s_cbranch_scc1 XH4_fin
    ds_read_b128 v[16:19], v3 offset:0
    ds_read_b128 v[20:23], v3 offset:512
    ds_read_b128 v[24:27], v3 offset:1024
    ds_read_b128 v[28:31], v3 offset:1536
    ds_read_b128 v[32:35], v3 offset:2048
    ds_read_b128 v[36:39], v3 offset:2560
    ds_read_b128 v[40:43], v3 offset:3072
    s_waitcnt lgkmcnt(6)
    v_smfmac_f32_16x16x64_f16 v[44:47], v[16:19], v[144:151], v5
    ds_read_b128 v[16:19], v6 offset:0
    s_waitcnt lgkmcnt(6)
    v_smfmac_f32_16x16x64_f16 v[44:47], v[20:23], v[152:159], v5
    ds_read_b128 v[20:23], v6 offset:512
    s_waitcnt lgkmcnt(6)
    v_smfmac_f32_16x16x64_f16 v[44:47], v[24:27], v[160:167], v5
    ds_read_b128 v[24:27], v6 offset:1024
    s_waitcnt lgkmcnt(6)
    v_smfmac_f32_16x16x64_f16 v[44:47], v[28:31], v[168:175], v5
    ds_read_b128 v[28:31], v6 offset:1536
    s_waitcnt lgkmcnt(6)
    v_smfmac_f32_16x16x64_f16 v[44:47], v[32:35], v[176:183], v5
    ds_read_b128 v[32:35], v6 offset:2048
    s_waitcnt lgkmcnt(6)
    v_smfmac_f32_16x16x64_f16 v[44:47], v[36:39], v[184:191], v5
    ds_read_b128 v[36:39], v6 offset:2560
    s_waitcnt lgkmcnt(6)
    v_smfmac_f32_16x16x64_f16 v[44:47], v[40:43], v[192:199], v5
    ds_read_b128 v[40:43], v6 offset:3072
    s_waitcnt lgkmcnt(6)
    v_smfmac_f32_16x16x64_f16 v[44:47], v[16:19], v[200:207], v5
    s_waitcnt lgkmcnt(5)
    v_smfmac_f32_16x16x64_f16 v[44:47], v[20:23], v[208:215], v5
    s_waitcnt lgkmcnt(4)
    v_smfmac_f32_16x16x64_f16 v[44:47], v[24:27], v[216:223], v5
    s_waitcnt lgkmcnt(3)
    v_smfmac_f32_16x16x64_f16 v[44:47], v[28:31], v[224:231], v5
    s_waitcnt lgkmcnt(2)
    v_smfmac_f32_16x16x64_f16 v[44:47], v[32:35], v[232:239], v5
    s_waitcnt lgkmcnt(1)
    v_smfmac_f32_16x16x64_f16 v[44:47], v[36:39], v[240:247], v5
    s_waitcnt lgkmcnt(0)
    v_smfmac_f32_16x16x64_f16 v[44:47], v[40:43], v[248:255], v5
    s_nop 7
    v_cvt_pk_f16_f32 v44, v44, v46
    v_cvt_pk_f16_f32 v45, v45, v47
    ds_write2_b32 v7, v44, v45 offset0:0 offset1:4
XH4_uc:
    v_xor_b32 v52, s19, v52
    v_bitop3_b32 v52, v52, v53, s19 bitop3:0xf6
    v_bitop3_b32 v52, v52, v54, s19 bitop3:0xf6
    v_bitop3_b32 v52, v52, v55, s19 bitop3:0xf6
    v_bitop3_b32 v52, v52, v56, s19 bitop3:0xf6
    v_bitop3_b32 v52, v52, v57, s19 bitop3:0xf6
    v_bitop3_b32 v52, v52, v58, s19 bitop3:0xf6
    v_bitop3_b32 v52, v52, v59, s19 bitop3:0xf6
    v_cmp_ne_u32 vcc, 0, v52
    s_cbranch_vccnz XH4_ure
    s_waitcnt lgkmcnt(0)
    s_barrier
    s_setprio 0
    s_barrier
    global_load_dword v68, v96, s[56:57] sc1
    s_add_u32 s50, s24, 4
    s_min_u32 s50, s50, 63
    s_lshl_b32 s50, s50, 11
    s_add_u32 s50, s52, s50
    s_addc_u32 s51, s53, 0
    global_load_dwordx4 v[52:55], v60, s[50:51] offset:0 sc1
    global_load_dwordx4 v[56:59], v60, s[50:51] offset:1024 sc1
    s_barrier
    s_add_u32 s58, s30, 3584
    s_addc_u32 s59, s31, 0
    global_load_dwordx4 v[68:71], v14, s[58:59] offset:-3584 sc1
    global_load_dwordx4 v[72:75], v14, s[58:59] offset:3584 sc1
    s_add_u32 s24, s24, 1
    s_add_u32 s50, s24, 1
    s_and_b32 s50, s50, 3
    s_mul_i32 s50, s50, 16384
    s_add_u32 s30, s26, s50
    s_addc_u32 s31, s27, 0
    s_add_u32 s54, s54, 458752
    s_addc_u32 s55, s55, 0
    s_add_u32 s56, s56, 458752
    s_addc_u32 s57, s57, 0
    v_mov_b32 v44, 0
    v_mov_b32 v45, 0
    v_mov_b32 v46, 0
    v_mov_b32 v47, 0
    s_setprio 1
    s_branch XH4_loop
XH4_mre:
    global_load_dwordx4 v[68:71], v14, s[58:59] offset:-3584 sc1
    global_load_dwordx4 v[72:75], v14, s[58:59] offset:3584 sc1
    s_sub_u32 s25, s25, 1
    s_cbranch_scc1 M_end
    s_waitcnt lgkmcnt(0)
    s_branch XH4_loop
XH4_ure:
    s_add_u32 s50, s24, 3
    s_min_u32 s50, s50, 63
    s_lshl_b32 s50, s50, 11
    s_add_u32 s50, s52, s50
    s_addc_u32 s51, s53, 0
    global_load_dwordx4 v[52:55], v60, s[50:51] offset:0 sc1
    global_load_dwordx4 v[56:59], v60, s[50:51] offset:1024 sc1
    s_sub_u32 s25, s25, 1
    s_cbranch_scc1 M_end
    s_waitcnt vmcnt(0)
    s_branch XH4_uc
XH4_fin:
    s_setprio 0
    s_waitcnt vmcnt(0)
    s_endpgm
XH5_entry:
    s_add_u32 s50, s24, 0
    s_and_b32 s50, s50, 3
    s_mul_i32 s50, s50, 24576
    s_add_u32 s34, s28, s50
    s_addc_u32 s35, s29, 0
    s_add_u32 s50, s24, 3
    s_and_b32 s50, s50, 3
    s_mul_i32 s50, s50, 24576
    s_add_u32 s36, s28, s50
    s_addc_u32 s37, s29, 0
    s_add_u32 s50, s24, 1
    s_and_b32 s50, s50, 3
    s_mul_i32 s50, s50, 16384
    s_add_u32 s30, s26, s50
    s_addc_u32 s31, s27, 0
    s_add_u32 s54, s54, 458752
    s_addc_u32 s55, s55, 0
    v_mov_b32 v44, 0
    v_mov_b32 v45, 0
    v_mov_b32 v46, 0
    v_mov_b32 v47, 0
    s_setprio 1
    s_branch XH5_top
.p2align 6
XH5_loop:
    s_waitcnt vmcnt(0)
    v_pk_add_f16 v16, v68, v72
    v_pk_add_f16 v17, v69, v73
    v_pk_add_f16 v18, v70, v74
    v_pk_add_f16 v19, v71, v75
    ds_write_b128 v14, v[16:19]
    v_pk_maximum3_f16 v20, v16, v17, v18
    v_pk_maximum3_f16 v20, v20, v19, v19
    v_cmp_u_f16 vcc, v20, v20
    s_cbranch_vccnz XH5_mre
XH5_got:
XH5_top:
    s_cmp_eq_u32 s24, 63
    s_waitcnt lgkmcnt(0)
    s_barrier
    s_cbranch_scc1 XH5_fin
    ds_read_b128 v[16:19], v3 offset:0
    ds_read_b128 v[20:23], v3 offset:512
    ds_read_b128 v[24:27], v3 offset:1024
    ds_read_b128 v[28:31], v3 offset:1536
    ds_read_b128 v[32:35], v3 offset:2048
    ds_read_b128 v[36:39], v3 offset:2560
    ds_read_b128 v[40:43], v3 offset:3072
    s_waitcnt lgkmcnt(6)
    v_smfmac_f32_16x16x64_f16 v[44:47], v[16:19], v[144:151], v5
    ds_read_b128 v[16:19], v6 offset:0
    s_waitcnt lgkmcnt(6)
    v_smfmac_f32_16x16x64_f16 v[44:47], v[20:23], v[152:159], v5
    ds_read_b128 v[20:23], v6 offset:512
    s_waitcnt lgkmcnt(6)
    v_smfmac_f32_16x16x64_f16 v[44:47], v[24:27], v[160:167], v5
    ds_read_b128 v[24:27], v6 offset:1024
    s_waitcnt lgkmcnt(6)
    v_smfmac_f32_16x16x64_f16 v[44:47], v[28:31], v[168:175], v5
    ds_read_b128 v[28:31], v6 offset:1536
    s_waitcnt lgkmcnt(6)
    v_smfmac_f32_16x16x64_f16 v[44:47], v[32:35], v[176:183], v5
    ds_read_b128 v[32:35], v6 offset:2048
    s_waitcnt lgkmcnt(6)
    v_smfmac_f32_16x16x64_f16 v[44:47], v[36:39], v[184:191], v5
    ds_read_b128 v[36:39], v6 offset:2560
    s_waitcnt lgkmcnt(6)
    v_smfmac_f32_16x16x64_f16 v[44:47], v[40:43], v[192:199], v5
    ds_read_b128 v[40:43], v6 offset:3072
    s_waitcnt lgkmcnt(6)
    v_smfmac_f32_16x16x64_f16 v[44:47], v[16:19], v[200:207], v5
    s_waitcnt lgkmcnt(5)
    v_smfmac_f32_16x16x64_f16 v[44:47], v[20:23], v[208:215], v5
    s_waitcnt lgkmcnt(4)
    v_smfmac_f32_16x16x64_f16 v[44:47], v[24:27], v[216:223], v5
    s_waitcnt lgkmcnt(3)
    v_smfmac_f32_16x16x64_f16 v[44:47], v[28:31], v[224:231], v5
    s_waitcnt lgkmcnt(2)
    v_smfmac_f32_16x16x64_f16 v[44:47], v[32:35], v[232:239], v5
    s_waitcnt lgkmcnt(1)
    v_smfmac_f32_16x16x64_f16 v[44:47], v[36:39], v[240:247], v5
    s_waitcnt lgkmcnt(0)
    v_smfmac_f32_16x16x64_f16 v[44:47], v[40:43], v[248:255], v5
    s_nop 7
    v_cvt_pk_f16_f32 v44, v44, v46
    v_cvt_pk_f16_f32 v45, v45, v47
    ds_write2_b32 v7, v44, v45 offset0:0 offset1:4
    s_waitcnt lgkmcnt(0)
    s_waitcnt vmcnt(0)
    s_barrier
    s_setprio 0
    ds_read2_b64 v[68:71], v8 offset0:0 offset1:16
    ds_read2_b64 v[72:75], v8 offset0:64 offset1:80
    ds_read2_b64 v[76:79], v8 offset0:128 offset1:144
    ds_read2_b64 v[80:83], v8 offset0:192 offset1:208
    ds_read2_b64 v[84:87], v10 offset0:0 offset1:16
    ds_read2_b64 v[88:91], v10 offset0:64 offset1:80
    ds_read2_b64 v[92:95], v10 offset0:128 offset1:144
    s_waitcnt lgkmcnt(6)
    v_mfma_f32_16x16x32_f16 v[44:47], v[16:19], v[68:71], 0
    s_waitcnt lgkmcnt(5)
    v_mfma_f32_16x16x32_f16 v[44:47], v[20:23], v[72:75], v[44:47]
    s_waitcnt lgkmcnt(4)
    v_mfma_f32_16x16x32_f16 v[44:47], v[24:27], v[76:79], v[44:47]
    s_waitcnt lgkmcnt(3)
    v_mfma_f32_16x16x32_f16 v[44:47], v[28:31], v[80:83], v[44:47]
    s_waitcnt lgkmcnt(2)
    v_mfma_f32_16x16x32_f16 v[44:47], v[32:35], v[84:87], v[44:47]
    s_waitcnt lgkmcnt(1)
    v_mfma_f32_16x16x32_f16 v[44:47], v[36:39], v[88:91], v[44:47]
    s_waitcnt lgkmcnt(0)
    v_mfma_f32_16x16x32_f16 v[44:47], v[40:43], v[92:95], v[44:47]
    s_mov_b64 exec, s[46:47]
    v_mov_b32 v78, -1
    s_nop 5
    v_cvt_pk_f16_f32 v76, v44, v45
    global_store_dword v9, v76, s[34:35] sc1
    global_store_dword v9, v78, s[36:37] sc1
    s_mov_b64 exec, -1
    s_setprio 0
    s_barrier
    global_load_dword v68, v11, s[26:27] sc1
    global_load_dword v69, v11, s[26:27] sc1
XH5_fl:
    s_sub_u32 s25, s25, 1
    s_cbranch_scc1 M_end
    global_load_dword v70, v11, s[26:27] sc1
    s_waitcnt vmcnt(2)
    v_cmp_gt_i32 vcc, s24, v68
    s_cbranch_vccz XH5_fd
    global_load_dword v68, v11, s[26:27] sc1
    s_waitcnt vmcnt(2)
    v_cmp_gt_i32 vcc, s24, v69
    s_cbranch_vccz XH5_fd
    global_load_dword v69, v11, s[26:27] sc1
    s_waitcnt vmcnt(2)
    v_cmp_gt_i32 vcc, s24, v70
    s_cbranch_vccnz XH5_fl
XH5_fd:
    s_barrier
    s_add_u32 s58, s30, 3584
    s_addc_u32 s59, s31, 0
    global_load_dwordx4 v[68:71], v14, s[58:59] offset:-3584 sc1
    global_load_dwordx4 v[72:75], v14, s[58:59] offset:3584 sc1
    s_add_u32 s24, s24, 1
    s_add_u32 s50, s24, 0
    s_and_b32 s50, s50, 3
    s_mul_i32 s50, s50, 24576
    s_add_u32 s34, s28, s50
    s_addc_u32 s35, s29, 0
    s_add_u32 s50, s24, 3
    s_and_b32 s50, s50, 3
    s_mul_i32 s50, s50, 24576
    s_add_u32 s36, s28, s50
    s_addc_u32 s37, s29, 0
    s_add_u32 s50, s24, 1
    s_and_b32 s50, s50, 3
    s_mul_i32 s50, s50, 16384
    s_add_u32 s30, s26, s50
    s_addc_u32 s31, s27, 0
    s_add_u32 s54, s54, 458752
    s_addc_u32 s55, s55, 0
    v_mov_b32 v44, 0
    v_mov_b32 v45, 0
    v_mov_b32 v46, 0
    v_mov_b32 v47, 0
    s_setprio 1
    s_branch XH5_loop
XH5_mre:
    global_load_dwordx4 v[68:71], v14, s[58:59] offset:-3584 sc1
    global_load_dwordx4 v[72:75], v14, s[58:59] offset:3584 sc1
    s_sub_u32 s25, s25, 1
    s_cbranch_scc1 M_end
    s_waitcnt lgkmcnt(0)
    s_branch XH5_loop
XH5_fin:
    s_setprio 0
    s_waitcnt vmcnt(0)
    s_endpgm
XH6_entry:
    s_add_u32 s50, s24, 0
    s_and_b32 s50, s50, 3
    s_mul_i32 s50, s50, 24576
    s_add_u32 s34, s28, s50
    s_addc_u32 s35, s29, 0
    s_add_u32 s50, s24, 3
    s_and_b32 s50, s50, 3
    s_mul_i32 s50, s50, 24576
    s_add_u32 s36, s28, s50
    s_addc_u32 s37, s29, 0
    s_add_u32 s50, s24, 1
    s_and_b32 s50, s50, 3
    s_mul_i32 s50, s50, 16384
    s_add_u32 s30, s26, s50
    s_addc_u32 s31, s27, 0
    s_add_u32 s50, s24, 3
    s_and_b32 s50, s50, 3
    s_mul_i32 s50, s50, 16384
    s_add_u32 s32, s26, s50
    s_addc_u32 s33, s27, 0
    s_add_u32 s42, s42, 28672
    s_addc_u32 s43, s43, 0
    s_add_u32 s54, s54, 458752
    s_addc_u32 s55, s55, 0
    v_mov_b32 v44, 0
    v_mov_b32 v45, 0
    v_mov_b32 v46, 0
    v_mov_b32 v47, 0
    s_setprio 1
    s_branch XH6_top
.p2align 6
XH6_loop:
    s_cmp_eq_u32 s24, 63
    s_cbranch_scc1 XH6_top
    s_waitcnt vmcnt(0)
XH6_got:
XH6_top:
    s_cmp_eq_u32 s24, 63
    s_waitcnt lgkmcnt(0)
    s_barrier
    s_cbranch_scc1 XH6_fin
    ds_read_b128 v[16:19], v3 offset:0
    ds_read_b128 v[20:23], v3 offset:512
    ds_read_b128 v[24:27], v3 offset:1024
    ds_read_b128 v[28:31], v3 offset:1536
    ds_read_b128 v[32:35], v3 offset:2048
    ds_read_b128 v[36:39], v3 offset:2560
    ds_read_b128 v[40:43], v3 offset:3072
    s_waitcnt lgkmcnt(6)
    v_smfmac_f32_16x16x64_f16 v[44:47], v[16:19], v[144:151], v5
    ds_read_b128 v[16:19], v6 offset:0
    s_waitcnt lgkmcnt(6)
    v_smfmac_f32_16x16x64_f16 v[44:47], v[20:23], v[152:159], v5
    ds_read_b128 v[20:23], v6 offset:512
    s_waitcnt lgkmcnt(6)
    v_smfmac_f32_16x16x64_f16 v[44:47], v[24:27], v[160:167], v5
    ds_read_b128 v[24:27], v6 offset:1024
    s_waitcnt lgkmcnt(6)
    v_smfmac_f32_16x16x64_f16 v[44:47], v[28:31], v[168:175], v5
    ds_read_b128 v[28:31], v6 offset:1536
    s_waitcnt lgkmcnt(6)
    v_smfmac_f32_16x16x64_f16 v[44:47], v[32:35], v[176:183], v5
    ds_read_b128 v[32:35], v6 offset:2048
    s_waitcnt lgkmcnt(6)
    v_smfmac_f32_16x16x64_f16 v[44:47], v[36:39], v[184:191], v5
    ds_read_b128 v[36:39], v6 offset:2560
    s_waitcnt lgkmcnt(6)
    v_smfmac_f32_16x16x64_f16 v[44:47], v[40:43], v[192:199], v5
    ds_read_b128 v[40:43], v6 offset:3072
    s_waitcnt lgkmcnt(6)
    v_smfmac_f32_16x16x64_f16 v[44:47], v[16:19], v[200:207], v5
    s_waitcnt lgkmcnt(5)
    v_smfmac_f32_16x16x64_f16 v[44:47], v[20:23], v[208:215], v5
    s_waitcnt lgkmcnt(4)
    v_smfmac_f32_16x16x64_f16 v[44:47], v[24:27], v[216:223], v5
    s_waitcnt lgkmcnt(3)
    v_smfmac_f32_16x16x64_f16 v[44:47], v[28:31], v[224:231], v5
    s_waitcnt lgkmcnt(2)
    v_smfmac_f32_16x16x64_f16 v[44:47], v[32:35], v[232:239], v5
    s_waitcnt lgkmcnt(1)
    v_smfmac_f32_16x16x64_f16 v[44:47], v[36:39], v[240:247], v5
    s_waitcnt lgkmcnt(0)
    v_smfmac_f32_16x16x64_f16 v[44:47], v[40:43], v[248:255], v5
    s_nop 7
    v_cvt_pk_f16_f32 v44, v44, v46
    v_cvt_pk_f16_f32 v45, v45, v47
    ds_write2_b32 v7, v44, v45 offset0:0 offset1:4
    s_waitcnt lgkmcnt(0)
    s_barrier
    s_setprio 0
    ds_read_b128 v[52:55], v8 offset:0
    ds_read_b128 v[56:59], v8 offset:512
    ds_read_b128 v[60:63], v8 offset:1024
    ds_read_b128 v[64:67], v8 offset:1536
    ds_read_b128 v[48:51], v8 offset:2048
    s_waitcnt lgkmcnt(4)
    v_mfma_f32_16x16x32_f16 v[44:47], v[68:71], v[52:55], 0
    ds_read_b128 v[52:55], v8 offset:2560
    s_waitcnt lgkmcnt(4)
    v_mfma_f32_16x16x32_f16 v[44:47], v[72:75], v[56:59], v[44:47]
    ds_read_b128 v[56:59], v8 offset:3072
    s_waitcnt lgkmcnt(4)
    v_mfma_f32_16x16x32_f16 v[44:47], v[76:79], v[60:63], v[44:47]
    s_waitcnt lgkmcnt(3)
    v_mfma_f32_16x16x32_f16 v[44:47], v[80:83], v[64:67], v[44:47]
    s_waitcnt lgkmcnt(2)
    v_mfma_f32_16x16x32_f16 v[44:47], v[84:87], v[48:51], v[44:47]
    s_waitcnt lgkmcnt(1)
    v_mfma_f32_16x16x32_f16 v[44:47], v[88:91], v[52:55], v[44:47]
    s_waitcnt lgkmcnt(0)
    v_mfma_f32_16x16x32_f16 v[44:47], v[92:95], v[56:59], v[44:47]
    s_mov_b64 exec, s[46:47]
    v_mov_b32 v62, -1
    v_mov_b32 v63, -1
    s_nop 4
    v_cvt_pk_f16_f32 v60, v44, v45
    v_cvt_pk_f16_f32 v61, v46, v47
    global_store_dwordx2 v9, v[60:61], s[34:35] sc1
    global_store_dwordx2 v9, v[62:63], s[36:37] sc1
    s_mov_b64 exec, -1
    s_setprio 0
    s_barrier
    global_load_dwordx4 v[68:71], v2, s[42:43] offset:-4096 sc1
    global_load_dwordx4 v[72:75], v2, s[42:43] offset:-3072 sc1
    global_load_dwordx4 v[76:79], v2, s[42:43] offset:-2048 sc1
    global_load_dwordx4 v[80:83], v2, s[42:43] offset:-1024 sc1
    global_load_dwordx4 v[84:87], v2, s[42:43] offset:0 sc1
    global_load_dwordx4 v[88:91], v2, s[42:43] offset:1024 sc1
    global_load_dwordx4 v[92:95], v2, s[42:43] offset:2048 sc1
    s_barrier
    s_add_u32 s58, s30, 3584
    s_addc_u32 s59, s31, 0
    s_add_u32 s24, s24, 1
    s_add_u32 s50, s24, 0
    s_and_b32 s50, s50, 3
    s_mul_i32 s50, s50, 24576
    s_add_u32 s34, s28, s50
    s_addc_u32 s35, s29, 0
    s_add_u32 s50, s24, 3
    s_and_b32 s50, s50, 3
    s_mul_i32 s50, s50, 24576
    s_add_u32 s36, s28, s50
    s_addc_u32 s37, s29, 0
    s_add_u32 s50, s24, 1
    s_and_b32 s50, s50, 3
    s_mul_i32 s50, s50, 16384
    s_add_u32 s30, s26, s50
    s_addc_u32 s31, s27, 0
    s_add_u32 s50, s24, 3
    s_and_b32 s50, s50, 3
    s_mul_i32 s50, s50, 16384
    s_add_u32 s32, s26, s50
    s_addc_u32 s33, s27, 0
    s_add_u32 s42, s42, 28672
    s_addc_u32 s43, s43, 0
    s_add_u32 s54, s54, 458752
    s_addc_u32 s55, s55, 0
    v_mov_b32 v44, 0
    v_mov_b32 v45, 0
    v_mov_b32 v46, 0
    v_mov_b32 v47, 0
    s_setprio 1
    s_branch XH6_loop
XH6_fin:
    s_setprio 0
    s_endpgm
XH7_entry:
    s_add_u32 s50, s24, 0
    s_and_b32 s50, s50, 3
    s_mul_i32 s50, s50, 24576
    s_add_u32 s34, s28, s50
    s_addc_u32 s35, s29, 0
    s_add_u32 s50, s24, 3
    s_and_b32 s50, s50, 3
    s_mul_i32 s50, s50, 24576
    s_add_u32 s36, s28, s50
    s_addc_u32 s37, s29, 0
    s_add_u32 s50, s24, 1
    s_and_b32 s50, s50, 3
    s_mul_i32 s50, s50, 16384
    s_add_u32 s30, s26, s50
    s_addc_u32 s31, s27, 0
    s_add_u32 s42, s42, 28672
    s_addc_u32 s43, s43, 0
    s_add_u32 s54, s54, 458752
    s_addc_u32 s55, s55, 0
    s_setprio 1
    s_branch XH7_top
.p2align 6
XH7_loop:
    s_waitcnt vmcnt(0)
    v_pk_add_f16 v16, v208, v212
    v_pk_add_f16 v17, v209, v213
    v_pk_add_f16 v18, v210, v214
    v_pk_add_f16 v19, v211, v215
    ds_write_b128 v14, v[16:19]
    v_pk_maximum3_f16 v20, v16, v17, v18
    v_pk_maximum3_f16 v20, v20, v19, v19
    v_cmp_u_f16 vcc, v20, v20
    s_cbranch_vccnz XH7_mre
XH7_got:
XH7_top:
    s_cmp_eq_u32 s24, 63
    s_waitcnt lgkmcnt(0)
    s_barrier
    s_cbranch_scc1 XH7_fin
    global_load_dword v124, v10, s[44:45] sc1
    s_barrier
    s_setprio 0
    ds_read_b128 v[224:227], v8 offset:0
    ds_read_b128 v[228:231], v8 offset:512
    ds_read_b128 v[232:235], v8 offset:1024
    ds_read_b128 v[236:239], v8 offset:1536
    ds_read_b128 v[240:243], v8 offset:2048
    ds_read_b128 v[244:247], v8 offset:2560
    ds_read_b128 v[248:251], v8 offset:3072
    s_waitcnt lgkmcnt(6)
    v_mfma_f32_16x16x32_f16 v[252:255], v[68:71], v[224:227], 0
    s_waitcnt lgkmcnt(5)
    v_mfma_f32_16x16x32_f16 v[252:255], v[72:75], v[228:231], v[252:255]
    s_waitcnt lgkmcnt(4)
    v_mfma_f32_16x16x32_f16 v[252:255], v[76:79], v[232:235], v[252:255]
    s_waitcnt lgkmcnt(3)
    v_mfma_f32_16x16x32_f16 v[252:255], v[80:83], v[236:239], v[252:255]
    s_waitcnt lgkmcnt(2)
    v_mfma_f32_16x16x32_f16 v[252:255], v[84:87], v[240:243], v[252:255]
    s_waitcnt lgkmcnt(1)
    v_mfma_f32_16x16x32_f16 v[252:255], v[88:91], v[244:247], v[252:255]
    s_waitcnt lgkmcnt(0)
    v_mfma_f32_16x16x32_f16 v[252:255], v[92:95], v[248:251], v[252:255]
    s_mov_b64 exec, s[46:47]
    v_mov_b32 v234, -1
    v_mov_b32 v235, -1
    s_nop 4
    v_cvt_pk_f16_f32 v232, v252, v253
    v_cvt_pk_f16_f32 v233, v254, v255
    global_store_dwordx2 v9, v[232:233], s[34:35] sc1
    global_store_dwordx2 v9, v[234:235], s[36:37] sc1
    s_mov_b64 exec, -1
    s_setprio 0
    s_barrier
    global_load_dwordx4 v[68:71], v2, s[42:43] offset:-4096 sc1
    global_load_dwordx4 v[72:75], v2, s[42:43] offset:-3072 sc1
    global_load_dwordx4 v[76:79], v2, s[42:43] offset:-2048 sc1
    global_load_dwordx4 v[80:83], v2, s[42:43] offset:-1024 sc1
    global_load_dwordx4 v[84:87], v2, s[42:43] offset:0 sc1
    global_load_dwordx4 v[88:91], v2, s[42:43] offset:1024 sc1
    global_load_dwordx4 v[92:95], v2, s[42:43] offset:2048 sc1
    s_barrier
    s_add_u32 s58, s30, 3584
    s_addc_u32 s59, s31, 0
    global_load_dwordx4 v[208:211], v14, s[58:59] offset:-3584 sc1
    global_load_dwordx4 v[212:215], v14, s[58:59] offset:3584 sc1
    s_add_u32 s24, s24, 1
    s_add_u32 s50, s24, 0
    s_and_b32 s50, s50, 3
    s_mul_i32 s50, s50, 24576
    s_add_u32 s34, s28, s50
    s_addc_u32 s35, s29, 0
    s_add_u32 s50, s24, 3
    s_and_b32 s50, s50, 3
    s_mul_i32 s50, s50, 24576
    s_add_u32 s36, s28, s50
    s_addc_u32 s37, s29, 0
    s_add_u32 s50, s24, 1
    s_and_b32 s50, s50, 3
    s_mul_i32 s50, s50, 16384
    s_add_u32 s30, s26, s50
    s_addc_u32 s31, s27, 0
    s_add_u32 s42, s42, 28672
    s_addc_u32 s43, s43, 0
    s_add_u32 s54, s54, 458752
    s_addc_u32 s55, s55, 0
    s_add_u32 s40, s40, 114688
    s_addc_u32 s41, s41, 0
    s_add_u32 s44, s44, 28672
    s_addc_u32 s45, s45, 0
    s_setprio 1
    s_branch XH7_loop
XH7_mre:
    global_load_dwordx4 v[208:211], v14, s[58:59] offset:-3584 sc1
    global_load_dwordx4 v[212:215], v14, s[58:59] offset:3584 sc1
    s_sub_u32 s25, s25, 1
    s_cbranch_scc1 M_end
    s_waitcnt lgkmcnt(0)
    s_branch XH7_loop
XH7_fin:
    s_setprio 0
    s_waitcnt vmcnt(0)
    s_endpgm
CH_fin:
    s_waitcnt vmcnt(0)
    s_endpgm
M_chk:
    s_barrier
    s_cmp_lg_u32 s14, 7
    s_cbranch_scc1 M_n1
    v_mov_b32 v101, 4
    global_load_dword v100, v101, s[10:11] sc1
    s_waitcnt vmcnt(0)
    s_mov_b32 s18, 0x100000
    s_branch NP_8a
NP_8:
    v_mov_b32 v101, 4
    global_load_dword v100, v101, s[10:11] sc1
    s_sub_u32 s18, s18, 1
    s_cbranch_scc1 M_end
    s_waitcnt vmcnt(0)
NP_8a:
    v_readfirstlane_b32 s19, v100
    s_cmp_eq_u32 s19, 0
    s_cbranch_scc1 NP_8
    v_mov_b32 v101, 161840
    ds_write_b32 v101, v100
M_n1:
    s_cmp_lg_u32 s14, 0
    s_cbranch_scc1 M_c1
    v_lshlrev_b32 v6, 5, v1
    v_mov_b32 v7, 1
    v_mov_b32 v8, 64
    v_lshlrev_b32 v9, 2, v1
    v_add_u32 v9, 161792, v9
    s_mov_b64 exec, 0xff
    global_load_dword v8, v6, s[10:11] sc1
    s_waitcnt vmcnt(0)
    v_cmp_gt_u32 vcc, 32, v8
    s_and_b32 exec_lo, vcc_lo, 0xfe
    s_cbranch_scc0 M_c1x
    global_atomic_add v8, v6, v7, s[10:11] sc0 sc1
    s_waitcnt vmcnt(0)
M_c1x:
    s_mov_b32 exec_lo, 0xff
    ds_write_b32 v9, v8
    s_mov_b64 exec, -1
M_c1:
    s_waitcnt lgkmcnt(0)
    s_barrier
    v_and_b32 v6, 7, v1
    v_lshlrev_b32 v6, 2, v6
    v_add_u32 v6, 161792, v6
    ds_read_b32 v0, v6
    ds_read_b32 v9, v6 offset:64
    s_mov_b32 s18, 0x1000000
NG_9:
    v_mov_b32 v8, 161840
    ds_read_b32 v8, v8
    s_sub_u32 s18, s18, 1
    s_cbranch_scc1 M_end
    s_waitcnt lgkmcnt(0)
    v_readfirstlane_b32 s19, v8
    s_cmp_eq_u32 s19, 0
    s_cbranch_scc1 NG_9
    v_cmp_gt_u32 vcc, 32, v0
    s_mov_b32 s16, vcc_lo
    s_and_b32 s101, vcc_lo, 0xfe
    s_cbranch_scc1 M_cl
M_uph:
    v_mov_b32 v0, v9
    s_mov_b32 s17, -1
M_u:
    s_cmp_lg_u32 s101, 0
    s_cbranch_scc1 M_u0
    s_add_u32 s17, s17, 1
    s_cmp_eq_u32 s17, 7
    s_cbranch_scc1 M_u1
    v_readlane_b32 s101, v0, s17
    s_branch M_u
M_u0:
    s_ff1_i32_b32 s21, s101
    s_bitset0_b32 s101, s21
    s_lshl_b32 s20, s17, 5
    s_add_u32 s20, s20, s21
    s_mul_i32 s33, s20, 2341
    s_lshr_b32 s33, s33, 16
    s_mul_i32 s34, s33, 28
    s_sub_u32 s34, s20, s34
    s_mul_i32 s28, s14, 14336
    s_add_u32 s28, s28, 0x1000
    s_add_u32 s28, s4, s28
    s_addc_u32 s29, s5, 0
    v_add_u32 v13, 8192, v2
    s_mov_b32 s25, 0x400000
    s_and_b32 s22, s20, 31
    s_lshl_b32 s22, s22, 7
    s_add_u32 s22, s22, s14
    s_lshl_b32 s22, s22, 2
    s_add_u32 s22, s22, 0x5b91000
    v_mov_b32 v9, s22
    s_cmp_eq_u32 s14, 7
    s_cbranch_scc1 U_a
U_x:
    global_load_dword v10, v9, s[4:5] sc1
    s_sub_u32 s25, s25, 1
    s_cbranch_scc1 M_end
    s_waitcnt vmcnt(0)
    v_cmp_ne_u32 vcc, s19, v10
    s_cbranch_vccnz U_x
    global_load_dwordx4 v[128:131], v2, s[28:29] offset:-4096 sc1
    global_load_dwordx4 v[132:135], v2, s[28:29] offset:-3072 sc1
    global_load_dwordx4 v[136:139], v2, s[28:29] offset:-2048 sc1
    global_load_dwordx4 v[140:143], v2, s[28:29] offset:-1024 sc1
    global_load_dwordx4 v[144:147], v2, s[28:29] offset:0 sc1
    global_load_dwordx4 v[148:151], v2, s[28:29] offset:1024 sc1
    global_load_dwordx4 v[152:155], v2, s[28:29] offset:2048 sc1
    global_load_dwordx4 v[156:159], v2, s[28:29] offset:3072 sc1
    global_load_dwordx4 v[160:163], v13, s[28:29] offset:-4096 sc1
    global_load_dwordx4 v[164:167], v13, s[28:29] offset:-3072 sc1
    global_load_dwordx4 v[168:171], v13, s[28:29] offset:-2048 sc1
    global_load_dwordx4 v[172:175], v13, s[28:29] offset:-1024 sc1
    global_load_dwordx4 v[176:179], v13, s[28:29] offset:0 sc1
    global_load_dwordx4 v[180:183], v13, s[28:29] offset:1024 sc1
    s_add_u32 s28, s28, 114688
    s_addc_u32 s29, s29, 0
    s_cmp_lg_u32 s14, 7
    s_cbranch_scc1 U_b
    v_mov_b32 v8, 0
    s_branch U_c
U_a:
    s_mul_i32 s23, s33, 14
    s_lshr_b32 s22, s34, 2
    s_add_u32 s23, s23, s22
    s_lshl_b32 s23, s23, 6
    s_add_u32 s23, s23, 0x5b8c000
    v_and_b32 v8, 1, v3
    v_mul_u32_u24 v8, 448, v8
    v_lshl_add_u32 v8, v4, 2, v8
    v_add_u32 v8, s23, v8
U_w:
    global_load_dword v12, v8, s[4:5] sc1
    s_sub_u32 s25, s25, 1
    s_cbranch_scc1 M_end
    s_waitcnt vmcnt(0)
    v_cmp_eq_u32 vcc, s19, v12
    s_or_b32 vcc_lo, vcc_lo, 0x80808080
    s_cmp_eq_u32 vcc_lo, -1
    s_cbranch_scc0 U_w
    s_barrier
    s_branch U_x
U_b:
    s_barrier
    s_lshl_b32 s21, s14, 12
    v_add_u32 v8, s21, v2
    s_mul_i32 s26, s20, 28672
    s_add_u32 s26, s26, 0x1c0000
    s_add_u32 s26, s4, s26
    s_addc_u32 s27, s5, 0
    global_load_dwordx4 v[184:187], v8, s[26:27] offset:0 sc1
    global_load_dwordx4 v[188:191], v8, s[26:27] offset:1024 sc1
    global_load_dwordx4 v[192:195], v8, s[26:27] offset:2048 sc1
    global_load_dwordx4 v[196:199], v8, s[26:27] offset:3072 sc1
U_c:
    v_mov_b32 v9, v13
    s_lshr_b32 s22, s14, 1
    s_and_b32 s23, s14, 1
    s_mul_i32 s35, s22, 14
    s_lshr_b32 s32, s34, 1
    s_add_u32 s35, s35, s32
    s_lshl_b32 s35, s35, 3
    s_add_u32 s35, s35, s33
    s_lshl_b32 s35, s35, 1
    s_and_b32 s34, s34, 1
    s_add_u32 s35, s35, s34
    s_lshl_b32 s35, s35, 1
    s_add_u32 s35, s35, s23
    s_lshl_b32 s35, s35, 10
    s_add_u32 s35, s35, 0x1110000
    s_add_u32 s30, s4, s35
    s_addc_u32 s31, s5, 0
    s_lshl_b32 s36, s20, 1
    s_add_u32 s36, s36, s23
    s_lshl_b32 s36, s36, 8
    s_mul_i32 s32, s22, 114688
    s_add_u32 s32, s32, s36
    s_add_u32 s32, s32, 0x542c000
    s_add_u32 s32, s4, s32
    s_addc_u32 s33, s5, 0
    s_min_u32 s36, s36, 7936
    s_lshl_b32 s34, s22, 13
    s_add_u32 s34, s34, s36
    s_add_u32 s34, s34, 0x5390000
    s_add_u32 s34, s4, s34
    s_addc_u32 s35, s5, 0
    s_lshl_b32 s36, s14, 10
    s_lshl_b32 s37, s20, 2
    s_add_u32 s36, s36, s37
    s_add_u32 s36, s36, 0x5b6c000
    s_add_u32 s36, s4, s36
    s_addc_u32 s37, s5, 0
    v_mov_b32 v12, -1
    v_mov_b32 v13, -1
    v_mov_b32 v14, -1
    v_mov_b32 v15, -1
    v_mov_b32 v10, 0
    s_mov_b32 s24, 0
    v_mov_b32 v11, s19
    s_cmp_eq_u32 s14, 7
    s_cbranch_scc1 U_d
    s_waitcnt vmcnt(3)
    ds_write_b128 v8, v[184:187] offset:0
    s_waitcnt vmcnt(2)
    ds_write_b128 v8, v[188:191] offset:1024
    s_waitcnt vmcnt(1)
    ds_write_b128 v8, v[192:195] offset:2048
    s_waitcnt vmcnt(0)
    ds_write_b128 v8, v[196:199] offset:3072
    s_waitcnt lgkmcnt(0)
U_d:
    s_barrier
    ds_read_b128 v[16:19], v2 offset:0
    ds_read_b128 v[20:23], v2 offset:1024
    ds_read_b128 v[24:27], v2 offset:2048
    ds_read_b128 v[28:31], v2 offset:3072
    ds_read_b128 v[32:35], v2 offset:4096
    ds_read_b128 v[36:39], v2 offset:5120
    ds_read_b128 v[40:43], v2 offset:6144
    ds_read_b128 v[44:47], v2 offset:7168
    ds_read_b128 v[48:51], v2 offset:8192
    ds_read_b128 v[52:55], v2 offset:9216
    ds_read_b128 v[56:59], v2 offset:10240
    ds_read_b128 v[60:63], v2 offset:11264
    ds_read_b128 v[64:67], v2 offset:12288
    ds_read_b128 v[68:71], v2 offset:13312
    ds_read_b128 v[72:75], v2 offset:14336
    ds_read_b128 v[76:79], v2 offset:15360
    ds_read_b128 v[80:83], v2 offset:16384
    ds_read_b128 v[84:87], v2 offset:17408
    ds_read_b128 v[88:91], v2 offset:18432
    ds_read_b128 v[92:95], v2 offset:19456
    ds_read_b128 v[96:99], v2 offset:20480
    ds_read_b128 v[100:103], v2 offset:21504
    ds_read_b128 v[104:107], v2 offset:22528
    ds_read_b128 v[108:111], v2 offset:23552
    ds_read_b128 v[112:115], v2 offset:24576
    ds_read_b128 v[116:119], v2 offset:25600
    ds_read_b128 v[120:123], v2 offset:26624
    ds_read_b128 v[124:127], v2 offset:27648
    s_cmp_lg_u32 s14, 7
    s_cbranch_scc1 U_e
    s_waitcnt vmcnt(0)
U_e:
    s_waitcnt lgkmcnt(0)
UT_10:
    s_cmp_eq_u32 s24, 0
    s_cbranch_scc1 UTs_11
    global_load_dwordx4 v[184:187], v2, s[28:29] offset:-4096 sc1
    global_load_dwordx4 v[188:191], v2, s[28:29] offset:-3072 sc1
    global_load_dwordx4 v[192:195], v2, s[28:29] offset:-2048 sc1
    global_load_dwordx4 v[196:199], v2, s[28:29] offset:-1024 sc1
    global_load_dwordx4 v[200:203], v2, s[28:29] offset:0 sc1
    global_load_dwordx4 v[204:207], v2, s[28:29] offset:1024 sc1
    global_load_dwordx4 v[208:211], v2, s[28:29] offset:2048 sc1
    global_load_dwordx4 v[212:215], v2, s[28:29] offset:3072 sc1
    global_load_dwordx4 v[216:219], v9, s[28:29] offset:-4096 sc1
    global_load_dwordx4 v[220:223], v9, s[28:29] offset:-3072 sc1
    global_load_dwordx4 v[224:227], v9, s[28:29] offset:-2048 sc1
    global_load_dwordx4 v[228:231], v9, s[28:29] offset:-1024 sc1
    global_load_dwordx4 v[232:235], v9, s[28:29] offset:0 sc1
    global_load_dwordx4 v[236:239], v9, s[28:29] offset:1024 sc1
    s_add_u32 s28, s28, 114688
    s_addc_u32 s29, s29, 0
UTs_11:
    v_mfma_f32_16x16x32_f16 v[240:243], v[128:131], v[16:19], 0
    v_mfma_f32_16x16x32_f16 v[244:247], v[128:131], v[72:75], 0
    v_mfma_f32_16x16x32_f16 v[240:243], v[132:135], v[20:23], v[240:243]
    v_mfma_f32_16x16x32_f16 v[244:247], v[132:135], v[76:79], v[244:247]
    v_mfma_f32_16x16x32_f16 v[240:243], v[136:139], v[24:27], v[240:243]
    v_mfma_f32_16x16x32_f16 v[244:247], v[136:139], v[80:83], v[244:247]
    v_mfma_f32_16x16x32_f16 v[240:243], v[140:143], v[28:31], v[240:243]
    v_mfma_f32_16x16x32_f16 v[244:247], v[140:143], v[84:87], v[244:247]
    v_mfma_f32_16x16x32_f16 v[240:243], v[144:147], v[32:35], v[240:243]
    v_mfma_f32_16x16x32_f16 v[244:247], v[144:147], v[88:91], v[244:247]
    v_mfma_f32_16x16x32_f16 v[240:243], v[148:151], v[36:39], v[240:243]
    v_mfma_f32_16x16x32_f16 v[244:247], v[148:151], v[92:95], v[244:247]
    v_mfma_f32_16x16x32_f16 v[240:243], v[152:155], v[40:43], v[240:243]
    v_mfma_f32_16x16x32_f16 v[244:247], v[152:155], v[96:99], v[244:247]
    v_mfma_f32_16x16x32_f16 v[240:243], v[156:159], v[44:47], v[240:243]
    v_mfma_f32_16x16x32_f16 v[244:247], v[156:159], v[100:103], v[244:247]
    v_mfma_f32_16x16x32_f16 v[240:243], v[160:163], v[48:51], v[240:243]
    v_mfma_f32_16x16x32_f16 v[244:247], v[160:163], v[104:107], v[244:247]
    v_mfma_f32_16x16x32_f16 v[240:243], v[164:167], v[52:55], v[240:243]
    v_mfma_f32_16x16x32_f16 v[244:247], v[164:167], v[108:111], v[244:247]
    v_mfma_f32_16x16x32_f16 v[240:243], v[168:171], v[56:59], v[240:243]
    v_mfma_f32_16x16x32_f16 v[244:247], v[168:171], v[112:115], v[244:247]
    v_mfma_f32_16x16x32_f16 v[240:243], v[172:175], v[60:63], v[240:243]
    v_mfma_f32_16x16x32_f16 v[244:247], v[172:175], v[116:119], v[244:247]
    v_mfma_f32_16x16x32_f16 v[240:243], v[176:179], v[64:67], v[240:243]
    v_mfma_f32_16x16x32_f16 v[244:247], v[176:179], v[120:123], v[244:247]
    v_mfma_f32_16x16x32_f16 v[240:243], v[180:183], v[68:71], v[240:243]
    v_mfma_f32_16x16x32_f16 v[244:247], v[180:183], v[124:127], v[244:247]
    s_mov_b64 exec, 0xffff
    global_store_dwordx4 v2, v[12:15], s[32:33] sc1
    s_cmp_ge_u32 s20, 14
    s_cbranch_scc1 UTm_12
    global_store_dwordx4 v2, v[12:15], s[34:35] sc1
UTm_12:
    s_mov_b64 exec, -1
    s_nop 1
    v_cvt_pk_f16_f32 v248, v240, v241
    v_cvt_pk_f16_f32 v250, v242, v243
    v_cvt_pk_f16_f32 v249, v244, v245
    v_cvt_pk_f16_f32 v251, v246, v247
    global_store_dwordx4 v2, v[248:251], s[30:31] sc1
    s_add_u32 s30, s30, 1835008
    s_addc_u32 s31, s31, 0
    s_add_u32 s32, s32, 458752
    s_addc_u32 s33, s33, 0
    s_add_u32 s34, s34, 32768
    s_addc_u32 s35, s35, 0
    s_waitcnt vmcnt(0)
    s_mov_b64 exec, 1
    global_store_dword v10, v11, s[36:37] sc1
    s_mov_b64 exec, -1
    s_add_u32 s36, s36, 8192
    s_addc_u32 s37, s37, 0
    s_cmp_lg_u32 s24, 0
    s_cbranch_scc1 UTs_13
    s_and_b32 s22, s20, 31
    s_lshl_b32 s22, s22, 9
    s_add_u32 s22, s22, 0x5b91000
    v_lshlrev_b32 v185, 3, v1
    v_add_u32 v185, s22, v185
    s_mov_b32 s25, 0x400000
UW_14:
    global_load_dwordx2 v[186:187], v185, s[4:5] sc1
    s_sub_u32 s25, s25, 1
    s_cbranch_scc1 M_end
    s_waitcnt vmcnt(0)
    v_xor_b32 v186, s19, v186
    v_bitop3_b32 v186, v186, v187, s19 bitop3:0xf6
    v_cmp_ne_u32 vcc, 0, v186
    s_cbranch_vccnz UW_14
    global_load_dwordx4 v[184:187], v2, s[28:29] offset:-4096 sc1
    global_load_dwordx4 v[188:191], v2, s[28:29] offset:-3072 sc1
    global_load_dwordx4 v[192:195], v2, s[28:29] offset:-2048 sc1
    global_load_dwordx4 v[196:199], v2, s[28:29] offset:-1024 sc1
    global_load_dwordx4 v[200:203], v2, s[28:29] offset:0 sc1
    global_load_dwordx4 v[204:207], v2, s[28:29] offset:1024 sc1
    global_load_dwordx4 v[208:211], v2, s[28:29] offset:2048 sc1
    global_load_dwordx4 v[212:215], v2, s[28:29] offset:3072 sc1
    global_load_dwordx4 v[216:219], v9, s[28:29] offset:-4096 sc1
    global_load_dwordx4 v[220:223], v9, s[28:29] offset:-3072 sc1
    global_load_dwordx4 v[224:227], v9, s[28:29] offset:-2048 sc1
    global_load_dwordx4 v[228:231], v9, s[28:29] offset:-1024 sc1
    global_load_dwordx4 v[232:235], v9, s[28:29] offset:0 sc1
    global_load_dwordx4 v[236:239], v9, s[28:29] offset:1024 sc1
    s_add_u32 s28, s28, 114688
    s_addc_u32 s29, s29, 0
    s_waitcnt vmcnt(0)
UTs_13:
    s_cmp_eq_u32 s24, 7
    s_cbranch_scc1 UTs_15
    global_load_dwordx4 v[128:131], v2, s[28:29] offset:-4096 sc1
    global_load_dwordx4 v[132:135], v2, s[28:29] offset:-3072 sc1
    global_load_dwordx4 v[136:139], v2, s[28:29] offset:-2048 sc1
    global_load_dwordx4 v[140:143], v2, s[28:29] offset:-1024 sc1
    global_load_dwordx4 v[144:147], v2, s[28:29] offset:0 sc1
    global_load_dwordx4 v[148:151], v2, s[28:29] offset:1024 sc1
    global_load_dwordx4 v[152:155], v2, s[28:29] offset:2048 sc1
    global_load_dwordx4 v[156:159], v2, s[28:29] offset:3072 sc1
    global_load_dwordx4 v[160:163], v9, s[28:29] offset:-4096 sc1
    global_load_dwordx4 v[164:167], v9, s[28:29] offset:-3072 sc1
    global_load_dwordx4 v[168:171], v9, s[28:29] offset:-2048 sc1
    global_load_dwordx4 v[172:175], v9, s[28:29] offset:-1024 sc1
    global_load_dwordx4 v[176:179], v9, s[28:29] offset:0 sc1
    global_load_dwordx4 v[180:183], v9, s[28:29] offset:1024 sc1
    s_add_u32 s28, s28, 114688
    s_addc_u32 s29, s29, 0
UTs_15:
    v_mfma_f32_16x16x32_f16 v[240:243], v[184:187], v[16:19], 0
    v_mfma_f32_16x16x32_f16 v[244:247], v[184:187], v[72:75], 0
    v_mfma_f32_16x16x32_f16 v[240:243], v[188:191], v[20:23], v[240:243]
    v_mfma_f32_16x16x32_f16 v[244:247], v[188:191], v[76:79], v[244:247]
    v_mfma_f32_16x16x32_f16 v[240:243], v[192:195], v[24:27], v[240:243]
    v_mfma_f32_16x16x32_f16 v[244:247], v[192:195], v[80:83], v[244:247]
    v_mfma_f32_16x16x32_f16 v[240:243], v[196:199], v[28:31], v[240:243]
    v_mfma_f32_16x16x32_f16 v[244:247], v[196:199], v[84:87], v[244:247]
    v_mfma_f32_16x16x32_f16 v[240:243], v[200:203], v[32:35], v[240:243]
    v_mfma_f32_16x16x32_f16 v[244:247], v[200:203], v[88:91], v[244:247]
    v_mfma_f32_16x16x32_f16 v[240:243], v[204:207], v[36:39], v[240:243]
    v_mfma_f32_16x16x32_f16 v[244:247], v[204:207], v[92:95], v[244:247]
    v_mfma_f32_16x16x32_f16 v[240:243], v[208:211], v[40:43], v[240:243]
    v_mfma_f32_16x16x32_f16 v[244:247], v[208:211], v[96:99], v[244:247]
    v_mfma_f32_16x16x32_f16 v[240:243], v[212:215], v[44:47], v[240:243]
    v_mfma_f32_16x16x32_f16 v[244:247], v[212:215], v[100:103], v[244:247]
    v_mfma_f32_16x16x32_f16 v[240:243], v[216:219], v[48:51], v[240:243]
    v_mfma_f32_16x16x32_f16 v[244:247], v[216:219], v[104:107], v[244:247]
    v_mfma_f32_16x16x32_f16 v[240:243], v[220:223], v[52:55], v[240:243]
    v_mfma_f32_16x16x32_f16 v[244:247], v[220:223], v[108:111], v[244:247]
    v_mfma_f32_16x16x32_f16 v[240:243], v[224:227], v[56:59], v[240:243]
    v_mfma_f32_16x16x32_f16 v[244:247], v[224:227], v[112:115], v[244:247]
    v_mfma_f32_16x16x32_f16 v[240:243], v[228:231], v[60:63], v[240:243]
    v_mfma_f32_16x16x32_f16 v[244:247], v[228:231], v[116:119], v[244:247]
    v_mfma_f32_16x16x32_f16 v[240:243], v[232:235], v[64:67], v[240:243]
    v_mfma_f32_16x16x32_f16 v[244:247], v[232:235], v[120:123], v[244:247]
    v_mfma_f32_16x16x32_f16 v[240:243], v[236:239], v[68:71], v[240:243]
    v_mfma_f32_16x16x32_f16 v[244:247], v[236:239], v[124:127], v[244:247]
    s_mov_b64 exec, 0xffff
    global_store_dwordx4 v2, v[12:15], s[32:33] sc1
    s_cmp_ge_u32 s20, 14
    s_cbranch_scc1 UTm_16
    global_store_dwordx4 v2, v[12:15], s[34:35] sc1
UTm_16:
    s_mov_b64 exec, -1
    s_nop 1
    v_cvt_pk_f16_f32 v248, v240, v241
    v_cvt_pk_f16_f32 v250, v242, v243
    v_cvt_pk_f16_f32 v249, v244, v245
    v_cvt_pk_f16_f32 v251, v246, v247
    global_store_dwordx4 v2, v[248:251], s[30:31] sc1
    s_add_u32 s30, s30, 1835008
    s_addc_u32 s31, s31, 0
    s_add_u32 s32, s32, 458752
    s_addc_u32 s33, s33, 0
    s_add_u32 s34, s34, 32768
    s_addc_u32 s35, s35, 0
    s_waitcnt vmcnt(0)
    s_mov_b64 exec, 1
    global_store_dword v10, v11, s[36:37] sc1
    s_mov_b64 exec, -1
    s_add_u32 s36, s36, 8192
    s_addc_u32 s37, s37, 0
    s_add_u32 s24, s24, 1
    s_cmp_lt_u32 s24, 8
    s_cbranch_scc1 UT_10
    s_mov_b32 s26, 1
    s_barrier
    s_branch M_ab2
M_u1:
    s_mov_b32 s21, 0
    s_mov_b32 s17, 1
    s_bitcmp1_b32 s16, 0
    s_cbranch_scc1 M_tk
M_acq:
    s_mov_b32 s25, 0x400000
    s_cmp_lg_u32 s14, 0
    s_cbranch_scc1 M_next
    s_mov_b32 s21, 44
    v_mov_b32 v8, s21
WC_17:
    global_load_dword v9, v8, s[10:11] sc1
    s_sub_u32 s25, s25, 1
    s_cbranch_scc1 M_end
    s_waitcnt vmcnt(0)
    v_cmp_gt_u32 vcc, 224, v9
    s_cbranch_vccnz WC_17
    buffer_inv sc1
M_next:
    s_barrier
    s_cmp_lg_u32 s14, 0
    s_cbranch_scc1 M_q1
    v_mov_b32 v6, 12
    v_mov_b32 v7, 1
    s_mov_b64 exec, 1
    global_atomic_add v8, v6, v7, s[10:11] sc0 sc1
    v_mov_b32 v6, 161792
    s_waitcnt vmcnt(0)
    ds_write_b32 v6, v8
    s_mov_b64 exec, -1
    s_waitcnt lgkmcnt(0)
M_q1:
    s_barrier
    v_mov_b32 v6, 161792
    ds_read_b32 v8, v6
    s_waitcnt lgkmcnt(0)
    v_readfirstlane_b32 s15, v8
    s_mov_b32 s25, 0x400000
    s_cmp_lt_u32 s15, 224
    s_cbranch_scc0 M_d2
    s_mul_i32 s20, s15, 2341
    s_lshr_b32 s20, s20, 16
    s_mul_i32 s21, s20, 28
    s_sub_u32 s21, s15, s21
    s_lshl_b32 s22, s20, 3
    s_add_u32 s22, s22, s14
    s_lshl_b32 s23, s14, 12
    v_add_u32 v8, s23, v2
    s_mov_b32 s24, 8
    s_mov_b32 s25, 0
    s_barrier
    s_cmp_ge_u32 s24, 18
    s_cbranch_scc1 G1s_18
    s_cmp_eq_u32 s14, 7
    s_cbranch_scc1 G1s_18
    s_lshl_b32 s26, s21, 3
    s_add_u32 s26, s26, s24
    s_add_u32 s27, s26, 216
    s_cmp_ge_u32 s24, 8
    s_cselect_b32 s26, s27, s26
    s_lshl_b32 s27, s21, 1
    s_add_u32 s27, s27, s24
    s_add_u32 s27, s27, 432
    s_cmp_ge_u32 s24, 16
    s_cselect_b32 s26, s27, s26
    s_mul_i32 s26, s26, 28672
    s_add_u32 s26, s26, 0x1c0000
    s_add_u32 s26, s4, s26
    s_addc_u32 s27, s5, 0
    s_add_u32 m0, s25, s23
    s_nop 0
    global_load_lds_dwordx4 v8, s[26:27] offset:0
    global_load_lds_dwordx4 v8, s[26:27] offset:1024
    global_load_lds_dwordx4 v8, s[26:27] offset:2048
    global_load_lds_dwordx4 v8, s[26:27] offset:3072
G1s_18:
    s_add_u32 s24, s24, 1
    s_add_u32 s25, s25, 28672
    s_cmp_eq_u32 s25, 86016
    s_cselect_b32 s25, 0, s25
    s_cmp_ge_u32 s24, 18
    s_cbranch_scc1 G1s_19
    s_cmp_eq_u32 s14, 7
    s_cbranch_scc1 G1s_19
    s_lshl_b32 s26, s21, 3
    s_add_u32 s26, s26, s24
    s_add_u32 s27, s26, 216
    s_cmp_ge_u32 s24, 8
    s_cselect_b32 s26, s27, s26
    s_lshl_b32 s27, s21, 1
    s_add_u32 s27, s27, s24
    s_add_u32 s27, s27, 432
    s_cmp_ge_u32 s24, 16
    s_cselect_b32 s26, s27, s26
    s_mul_i32 s26, s26, 28672
    s_add_u32 s26, s26, 0x1c0000
    s_add_u32 s26, s4, s26
    s_addc_u32 s27, s5, 0
    s_add_u32 m0, s25, s23
    s_nop 0
    global_load_lds_dwordx4 v8, s[26:27] offset:0
    global_load_lds_dwordx4 v8, s[26:27] offset:1024
    global_load_lds_dwordx4 v8, s[26:27] offset:2048
    global_load_lds_dwordx4 v8, s[26:27] offset:3072
G1s_19:
    s_add_u32 s24, s24, 1
    s_add_u32 s25, s25, 28672
    s_cmp_eq_u32 s25, 86016
    s_cselect_b32 s25, 0, s25
    s_mul_i32 s28, s22, 28672
    s_add_u32 s28, s28, 0x1000
    s_add_u32 s28, s4, s28
    s_addc_u32 s29, s5, 0
    global_load_dwordx4 v[16:19], v2, s[28:29] offset:-4096
    global_load_dwordx4 v[20:23], v2, s[28:29] offset:-3072
    global_load_dwordx4 v[24:27], v2, s[28:29] offset:-2048
    global_load_dwordx4 v[28:31], v2, s[28:29] offset:-1024
    global_load_dwordx4 v[32:35], v2, s[28:29] offset:0
    global_load_dwordx4 v[36:39], v2, s[28:29] offset:1024
    global_load_dwordx4 v[40:43], v2, s[28:29] offset:2048
    global_load_dwordx4 v[44:47], v2, s[28:29] offset:3072
    s_add_u32 s28, s28, 8192
    s_addc_u32 s29, s29, 0
    global_load_dwordx4 v[48:51], v2, s[28:29] offset:-4096
    global_load_dwordx4 v[52:55], v2, s[28:29] offset:-3072
    global_load_dwordx4 v[56:59], v2, s[28:29] offset:-2048
    global_load_dwordx4 v[60:63], v2, s[28:29] offset:-1024
    global_load_dwordx4 v[64:67], v2, s[28:29] offset:0
    global_load_dwordx4 v[68:71], v2, s[28:29] offset:1024
    global_load_dwordx4 v[72:75], v2, s[28:29] offset:2048
    global_load_dwordx4 v[76:79], v2, s[28:29] offset:3072
    s_add_u32 s28, s28, 8192
    s_addc_u32 s29, s29, 0
    global_load_dwordx4 v[80:83], v2, s[28:29] offset:-4096
    global_load_dwordx4 v[84:87], v2, s[28:29] offset:-3072
    global_load_dwordx4 v[88:91], v2, s[28:29] offset:-2048
    global_load_dwordx4 v[92:95], v2, s[28:29] offset:-1024
    global_load_dwordx4 v[96:99], v2, s[28:29] offset:0
    global_load_dwordx4 v[100:103], v2, s[28:29] offset:1024
    global_load_dwordx4 v[104:107], v2, s[28:29] offset:2048
    global_load_dwordx4 v[108:111], v2, s[28:29] offset:3072
    s_add_u32 s28, s28, 8192
    s_addc_u32 s29, s29, 0
    global_load_dwordx4 v[112:115], v2, s[28:29] offset:-4096
    global_load_dwordx4 v[116:119], v2, s[28:29] offset:-3072
    global_load_dwordx4 v[120:123], v2, s[28:29] offset:-2048
    global_load_dwordx4 v[124:127], v2, s[28:29] offset:-1024
    s_waitcnt vmcnt(0)
    s_mov_b32 s30, 8
    s_mov_b32 s31, 0
    v_add_u32 v9, 1024, v2
    v_add_u32 v10, 14336, v2
    v_add_u32 v11, 57344, v2
G1Q_20:
    s_waitcnt vmcnt(8)
    s_barrier
    s_cmp_ge_u32 s24, 18
    s_cbranch_scc1 G1s_21
    s_cmp_eq_u32 s14, 7
    s_cbranch_scc1 G1s_21
    s_lshl_b32 s26, s21, 3
    s_add_u32 s26, s26, s24
    s_add_u32 s27, s26, 216
    s_cmp_ge_u32 s24, 8
    s_cselect_b32 s26, s27, s26
    s_lshl_b32 s27, s21, 1
    s_add_u32 s27, s27, s24
    s_add_u32 s27, s27, 432
    s_cmp_ge_u32 s24, 16
    s_cselect_b32 s26, s27, s26
    s_mul_i32 s26, s26, 28672
    s_add_u32 s26, s26, 0x1c0000
    s_add_u32 s26, s4, s26
    s_addc_u32 s27, s5, 0
    s_add_u32 m0, s25, s23
    s_nop 0
    global_load_lds_dwordx4 v8, s[26:27] offset:0
    global_load_lds_dwordx4 v8, s[26:27] offset:1024
    global_load_lds_dwordx4 v8, s[26:27] offset:2048
    global_load_lds_dwordx4 v8, s[26:27] offset:3072
G1s_21:
    s_add_u32 s24, s24, 1
    s_add_u32 s25, s25, 28672
    s_cmp_eq_u32 s25, 86016
    s_cselect_b32 s25, 0, s25
    v_add_u32 v12, s31, v2
    v_mov_b32 v160, 0
    v_mov_b32 v161, 0
    v_mov_b32 v162, 0
    v_mov_b32 v163, 0
    v_mov_b32 v164, 0
    v_mov_b32 v165, 0
    v_mov_b32 v166, 0
    v_mov_b32 v167, 0
    v_mov_b32 v168, 0
    v_mov_b32 v169, 0
    v_mov_b32 v170, 0
    v_mov_b32 v171, 0
    v_mov_b32 v172, 0
    v_mov_b32 v173, 0
    v_mov_b32 v174, 0
    v_mov_b32 v175, 0
    ds_read_b128 v[128:131], v12 offset:0
    ds_read_b128 v[132:135], v12 offset:14336
    ds_read_b128 v[136:139], v12 offset:1024
    ds_read_b128 v[140:143], v12 offset:15360
    s_lshl_b32 s32, s21, 3
    s_add_u32 s32, s32, s30
    s_sub_u32 s32, s32, 8
    s_mul_i32 s33, s32, 4682
    s_lshr_b32 s33, s33, 16
    s_mul_i32 s34, s33, 14
    s_sub_u32 s34, s32, s34
    s_lshl_b32 s35, s22, 4
    s_add_u32 s35, s35, s33
    s_mul_i32 s35, s35, 28
    s_add_u32 s35, s35, s34
    s_lshl_b32 s35, s35, 10
    s_add_u32 s35, s35, 0x2d10000
    s_add_u32 s36, s4, s35
    s_addc_u32 s37, s5, 0
    ds_read_b128 v[144:147], v12 offset:2048
    ds_read_b128 v[148:151], v12 offset:16384
    s_waitcnt lgkmcnt(4)
    v_mfma_f32_16x16x32_f16 v[160:163], v[128:131], v[16:19], v[160:163]
    v_mfma_f32_16x16x32_f16 v[168:171], v[128:131], v[72:75], v[168:171]
    v_mfma_f32_16x16x32_f16 v[164:167], v[132:135], v[16:19], v[164:167]
    v_mfma_f32_16x16x32_f16 v[172:175], v[132:135], v[72:75], v[172:175]
    ds_read_b128 v[128:131], v12 offset:3072
    ds_read_b128 v[132:135], v12 offset:17408
    s_waitcnt lgkmcnt(4)
    v_mfma_f32_16x16x32_f16 v[160:163], v[136:139], v[20:23], v[160:163]
    v_mfma_f32_16x16x32_f16 v[168:171], v[136:139], v[76:79], v[168:171]
    v_mfma_f32_16x16x32_f16 v[164:167], v[140:143], v[20:23], v[164:167]
    v_mfma_f32_16x16x32_f16 v[172:175], v[140:143], v[76:79], v[172:175]
    ds_read_b128 v[136:139], v12 offset:4096
    ds_read_b128 v[140:143], v12 offset:18432
    s_waitcnt lgkmcnt(4)
    v_mfma_f32_16x16x32_f16 v[160:163], v[144:147], v[24:27], v[160:163]
    v_mfma_f32_16x16x32_f16 v[168:171], v[144:147], v[80:83], v[168:171]
    v_mfma_f32_16x16x32_f16 v[164:167], v[148:151], v[24:27], v[164:167]
    v_mfma_f32_16x16x32_f16 v[172:175], v[148:151], v[80:83], v[172:175]
    ds_read_b128 v[144:147], v12 offset:5120
    ds_read_b128 v[148:151], v12 offset:19456
    s_waitcnt lgkmcnt(4)
    v_mfma_f32_16x16x32_f16 v[160:163], v[128:131], v[28:31], v[160:163]
    v_mfma_f32_16x16x32_f16 v[168:171], v[128:131], v[84:87], v[168:171]
    v_mfma_f32_16x16x32_f16 v[164:167], v[132:135], v[28:31], v[164:167]
    v_mfma_f32_16x16x32_f16 v[172:175], v[132:135], v[84:87], v[172:175]
    ds_read_b128 v[128:131], v12 offset:6144
    ds_read_b128 v[132:135], v12 offset:20480
    s_waitcnt lgkmcnt(4)
    v_mfma_f32_16x16x32_f16 v[160:163], v[136:139], v[32:35], v[160:163]
    v_mfma_f32_16x16x32_f16 v[168:171], v[136:139], v[88:91], v[168:171]
    v_mfma_f32_16x16x32_f16 v[164:167], v[140:143], v[32:35], v[164:167]
    v_mfma_f32_16x16x32_f16 v[172:175], v[140:143], v[88:91], v[172:175]
    ds_read_b128 v[136:139], v12 offset:7168
    ds_read_b128 v[140:143], v12 offset:21504
    s_waitcnt lgkmcnt(4)
    v_mfma_f32_16x16x32_f16 v[160:163], v[144:147], v[36:39], v[160:163]
    v_mfma_f32_16x16x32_f16 v[168:171], v[144:147], v[92:95], v[168:171]
    v_mfma_f32_16x16x32_f16 v[164:167], v[148:151], v[36:39], v[164:167]
    v_mfma_f32_16x16x32_f16 v[172:175], v[148:151], v[92:95], v[172:175]
    ds_read_b128 v[144:147], v12 offset:8192
    ds_read_b128 v[148:151], v12 offset:22528
    s_waitcnt lgkmcnt(4)
    v_mfma_f32_16x16x32_f16 v[160:163], v[128:131], v[40:43], v[160:163]
    v_mfma_f32_16x16x32_f16 v[168:171], v[128:131], v[96:99], v[168:171]
    v_mfma_f32_16x16x32_f16 v[164:167], v[132:135], v[40:43], v[164:167]
    v_mfma_f32_16x16x32_f16 v[172:175], v[132:135], v[96:99], v[172:175]
    ds_read_b128 v[128:131], v12 offset:9216
    ds_read_b128 v[132:135], v12 offset:23552
    s_waitcnt lgkmcnt(4)
    v_mfma_f32_16x16x32_f16 v[160:163], v[136:139], v[44:47], v[160:163]
    v_mfma_f32_16x16x32_f16 v[168:171], v[136:139], v[100:103], v[168:171]
    v_mfma_f32_16x16x32_f16 v[164:167], v[140:143], v[44:47], v[164:167]
    v_mfma_f32_16x16x32_f16 v[172:175], v[140:143], v[100:103], v[172:175]
    ds_read_b128 v[136:139], v12 offset:10240
    ds_read_b128 v[140:143], v12 offset:24576
    s_waitcnt lgkmcnt(4)
    v_mfma_f32_16x16x32_f16 v[160:163], v[144:147], v[48:51], v[160:163]
    v_mfma_f32_16x16x32_f16 v[168:171], v[144:147], v[104:107], v[168:171]
    v_mfma_f32_16x16x32_f16 v[164:167], v[148:151], v[48:51], v[164:167]
    v_mfma_f32_16x16x32_f16 v[172:175], v[148:151], v[104:107], v[172:175]
    ds_read_b128 v[144:147], v12 offset:11264
    ds_read_b128 v[148:151], v12 offset:25600
    s_waitcnt lgkmcnt(4)
    v_mfma_f32_16x16x32_f16 v[160:163], v[128:131], v[52:55], v[160:163]
    v_mfma_f32_16x16x32_f16 v[168:171], v[128:131], v[108:111], v[168:171]
    v_mfma_f32_16x16x32_f16 v[164:167], v[132:135], v[52:55], v[164:167]
    v_mfma_f32_16x16x32_f16 v[172:175], v[132:135], v[108:111], v[172:175]
    ds_read_b128 v[128:131], v12 offset:12288
    ds_read_b128 v[132:135], v12 offset:26624
    s_waitcnt lgkmcnt(4)
    v_mfma_f32_16x16x32_f16 v[160:163], v[136:139], v[56:59], v[160:163]
    v_mfma_f32_16x16x32_f16 v[168:171], v[136:139], v[112:115], v[168:171]
    v_mfma_f32_16x16x32_f16 v[164:167], v[140:143], v[56:59], v[164:167]
    v_mfma_f32_16x16x32_f16 v[172:175], v[140:143], v[112:115], v[172:175]
    ds_read_b128 v[136:139], v12 offset:13312
    ds_read_b128 v[140:143], v12 offset:27648
    s_waitcnt lgkmcnt(4)
    v_mfma_f32_16x16x32_f16 v[160:163], v[144:147], v[60:63], v[160:163]
    v_mfma_f32_16x16x32_f16 v[168:171], v[144:147], v[116:119], v[168:171]
    v_mfma_f32_16x16x32_f16 v[164:167], v[148:151], v[60:63], v[164:167]
    v_mfma_f32_16x16x32_f16 v[172:175], v[148:151], v[116:119], v[172:175]
    s_waitcnt lgkmcnt(2)
    v_mfma_f32_16x16x32_f16 v[160:163], v[128:131], v[64:67], v[160:163]
    v_mfma_f32_16x16x32_f16 v[168:171], v[128:131], v[120:123], v[168:171]
    v_mfma_f32_16x16x32_f16 v[164:167], v[132:135], v[64:67], v[164:167]
    v_mfma_f32_16x16x32_f16 v[172:175], v[132:135], v[120:123], v[172:175]
    s_waitcnt lgkmcnt(0)
    v_mfma_f32_16x16x32_f16 v[160:163], v[136:139], v[68:71], v[160:163]
    v_mfma_f32_16x16x32_f16 v[168:171], v[136:139], v[124:127], v[168:171]
    v_mfma_f32_16x16x32_f16 v[164:167], v[140:143], v[68:71], v[164:167]
    v_mfma_f32_16x16x32_f16 v[172:175], v[140:143], v[124:127], v[172:175]
    s_add_u32 s30, s30, 1
    s_add_u32 s31, s31, 28672
    s_cmp_eq_u32 s31, 86016
    s_cselect_b32 s31, 0, s31
    s_nop 2
    v_cvt_pk_f16_f32 v192, v160, v164
    v_cvt_pk_f16_f32 v193, v161, v165
    v_cvt_pk_f16_f32 v194, v162, v166
    v_cvt_pk_f16_f32 v195, v163, v167
    global_store_dwordx4 v2, v[192:195], s[36:37] sc1
    v_cvt_pk_f16_f32 v196, v168, v172
    v_cvt_pk_f16_f32 v197, v169, v173
    v_cvt_pk_f16_f32 v198, v170, v174
    v_cvt_pk_f16_f32 v199, v171, v175
    global_store_dwordx4 v10, v[196:199], s[36:37] sc1
    s_cmp_lt_u32 s30, 16
    s_cbranch_scc1 G1Q_20
G1H_22:
    s_waitcnt vmcnt(4)
    s_barrier
    s_cmp_ge_u32 s24, 18
    s_cbranch_scc1 G1s_23
    s_cmp_eq_u32 s14, 7
    s_cbranch_scc1 G1s_23
    s_lshl_b32 s26, s21, 3
    s_add_u32 s26, s26, s24
    s_add_u32 s27, s26, 216
    s_cmp_ge_u32 s24, 8
    s_cselect_b32 s26, s27, s26
    s_lshl_b32 s27, s21, 1
    s_add_u32 s27, s27, s24
    s_add_u32 s27, s27, 432
    s_cmp_ge_u32 s24, 16
    s_cselect_b32 s26, s27, s26
    s_mul_i32 s26, s26, 28672
    s_add_u32 s26, s26, 0x1c0000
    s_add_u32 s26, s4, s26
    s_addc_u32 s27, s5, 0
    s_add_u32 m0, s25, s23
    s_nop 0
    global_load_lds_dwordx4 v8, s[26:27] offset:0
    global_load_lds_dwordx4 v8, s[26:27] offset:1024
    global_load_lds_dwordx4 v8, s[26:27] offset:2048
    global_load_lds_dwordx4 v8, s[26:27] offset:3072
G1s_23:
    s_add_u32 s24, s24, 1
    s_add_u32 s25, s25, 28672
    s_cmp_eq_u32 s25, 86016
    s_cselect_b32 s25, 0, s25
    v_add_u32 v12, s31, v2
    v_mov_b32 v160, 0
    v_mov_b32 v161, 0
    v_mov_b32 v162, 0
    v_mov_b32 v163, 0
    v_mov_b32 v164, 0
    v_mov_b32 v165, 0
    v_mov_b32 v166, 0
    v_mov_b32 v167, 0
    v_mov_b32 v168, 0
    v_mov_b32 v169, 0
    v_mov_b32 v170, 0
    v_mov_b32 v171, 0
    v_mov_b32 v172, 0
    v_mov_b32 v173, 0
    v_mov_b32 v174, 0
    v_mov_b32 v175, 0
    ds_read_b128 v[128:131], v12 offset:0
    ds_read_b128 v[132:135], v12 offset:14336
    ds_read_b128 v[136:139], v12 offset:1024
    ds_read_b128 v[140:143], v12 offset:15360
    s_mul_i32 s35, s22, 112
    s_lshl_b32 s32, s21, 1
    s_add_u32 s35, s35, s32
    s_add_u32 s35, s35, s30
    s_sub_u32 s35, s35, 16
    s_lshl_b32 s35, s35, 10
    s_add_u32 s35, s35, 0x4910000
    s_add_u32 s36, s4, s35
    s_addc_u32 s37, s5, 0
    ds_read_b128 v[144:147], v12 offset:2048
    ds_read_b128 v[148:151], v12 offset:16384
    s_waitcnt lgkmcnt(4)
    v_mfma_f32_16x16x32_f16 v[160:163], v[128:131], v[16:19], v[160:163]
    v_mfma_f32_16x16x32_f16 v[168:171], v[128:131], v[72:75], v[168:171]
    v_mfma_f32_16x16x32_f16 v[164:167], v[132:135], v[16:19], v[164:167]
    v_mfma_f32_16x16x32_f16 v[172:175], v[132:135], v[72:75], v[172:175]
    ds_read_b128 v[128:131], v12 offset:3072
    ds_read_b128 v[132:135], v12 offset:17408
    s_waitcnt lgkmcnt(4)
    v_mfma_f32_16x16x32_f16 v[160:163], v[136:139], v[20:23], v[160:163]
    v_mfma_f32_16x16x32_f16 v[168:171], v[136:139], v[76:79], v[168:171]
    v_mfma_f32_16x16x32_f16 v[164:167], v[140:143], v[20:23], v[164:167]
    v_mfma_f32_16x16x32_f16 v[172:175], v[140:143], v[76:79], v[172:175]
    ds_read_b128 v[136:139], v12 offset:4096
    ds_read_b128 v[140:143], v12 offset:18432
    s_waitcnt lgkmcnt(4)
    v_mfma_f32_16x16x32_f16 v[160:163], v[144:147], v[24:27], v[160:163]
    v_mfma_f32_16x16x32_f16 v[168:171], v[144:147], v[80:83], v[168:171]
    v_mfma_f32_16x16x32_f16 v[164:167], v[148:151], v[24:27], v[164:167]
    v_mfma_f32_16x16x32_f16 v[172:175], v[148:151], v[80:83], v[172:175]
    ds_read_b128 v[144:147], v12 offset:5120
    ds_read_b128 v[148:151], v12 offset:19456
    s_waitcnt lgkmcnt(4)
    v_mfma_f32_16x16x32_f16 v[160:163], v[128:131], v[28:31], v[160:163]
    v_mfma_f32_16x16x32_f16 v[168:171], v[128:131], v[84:87], v[168:171]
    v_mfma_f32_16x16x32_f16 v[164:167], v[132:135], v[28:31], v[164:167]
    v_mfma_f32_16x16x32_f16 v[172:175], v[132:135], v[84:87], v[172:175]
    ds_read_b128 v[128:131], v12 offset:6144
    ds_read_b128 v[132:135], v12 offset:20480
    s_waitcnt lgkmcnt(4)
    v_mfma_f32_16x16x32_f16 v[160:163], v[136:139], v[32:35], v[160:163]
    v_mfma_f32_16x16x32_f16 v[168:171], v[136:139], v[88:91], v[168:171]
    v_mfma_f32_16x16x32_f16 v[164:167], v[140:143], v[32:35], v[164:167]
    v_mfma_f32_16x16x32_f16 v[172:175], v[140:143], v[88:91], v[172:175]
    ds_read_b128 v[136:139], v12 offset:7168
    ds_read_b128 v[140:143], v12 offset:21504
    s_waitcnt lgkmcnt(4)
    v_mfma_f32_16x16x32_f16 v[160:163], v[144:147], v[36:39], v[160:163]
    v_mfma_f32_16x16x32_f16 v[168:171], v[144:147], v[92:95], v[168:171]
    v_mfma_f32_16x16x32_f16 v[164:167], v[148:151], v[36:39], v[164:167]
    v_mfma_f32_16x16x32_f16 v[172:175], v[148:151], v[92:95], v[172:175]
    ds_read_b128 v[144:147], v12 offset:8192
    ds_read_b128 v[148:151], v12 offset:22528
    s_waitcnt lgkmcnt(4)
    v_mfma_f32_16x16x32_f16 v[160:163], v[128:131], v[40:43], v[160:163]
    v_mfma_f32_16x16x32_f16 v[168:171], v[128:131], v[96:99], v[168:171]
    v_mfma_f32_16x16x32_f16 v[164:167], v[132:135], v[40:43], v[164:167]
    v_mfma_f32_16x16x32_f16 v[172:175], v[132:135], v[96:99], v[172:175]
    ds_read_b128 v[128:131], v12 offset:9216
    ds_read_b128 v[132:135], v12 offset:23552
    s_waitcnt lgkmcnt(4)
    v_mfma_f32_16x16x32_f16 v[160:163], v[136:139], v[44:47], v[160:163]
    v_mfma_f32_16x16x32_f16 v[168:171], v[136:139], v[100:103], v[168:171]
    v_mfma_f32_16x16x32_f16 v[164:167], v[140:143], v[44:47], v[164:167]
    v_mfma_f32_16x16x32_f16 v[172:175], v[140:143], v[100:103], v[172:175]
    ds_read_b128 v[136:139], v12 offset:10240
    ds_read_b128 v[140:143], v12 offset:24576
    s_waitcnt lgkmcnt(4)
    v_mfma_f32_16x16x32_f16 v[160:163], v[144:147], v[48:51], v[160:163]
    v_mfma_f32_16x16x32_f16 v[168:171], v[144:147], v[104:107], v[168:171]
    v_mfma_f32_16x16x32_f16 v[164:167], v[148:151], v[48:51], v[164:167]
    v_mfma_f32_16x16x32_f16 v[172:175], v[148:151], v[104:107], v[172:175]
    ds_read_b128 v[144:147], v12 offset:11264
    ds_read_b128 v[148:151], v12 offset:25600
    s_waitcnt lgkmcnt(4)
    v_mfma_f32_16x16x32_f16 v[160:163], v[128:131], v[52:55], v[160:163]
    v_mfma_f32_16x16x32_f16 v[168:171], v[128:131], v[108:111], v[168:171]
    v_mfma_f32_16x16x32_f16 v[164:167], v[132:135], v[52:55], v[164:167]
    v_mfma_f32_16x16x32_f16 v[172:175], v[132:135], v[108:111], v[172:175]
    ds_read_b128 v[128:131], v12 offset:12288
    ds_read_b128 v[132:135], v12 offset:26624
    s_waitcnt lgkmcnt(4)
    v_mfma_f32_16x16x32_f16 v[160:163], v[136:139], v[56:59], v[160:163]
    v_mfma_f32_16x16x32_f16 v[168:171], v[136:139], v[112:115], v[168:171]
    v_mfma_f32_16x16x32_f16 v[164:167], v[140:143], v[56:59], v[164:167]
    v_mfma_f32_16x16x32_f16 v[172:175], v[140:143], v[112:115], v[172:175]
    ds_read_b128 v[136:139], v12 offset:13312
    ds_read_b128 v[140:143], v12 offset:27648
    s_waitcnt lgkmcnt(4)
    v_mfma_f32_16x16x32_f16 v[160:163], v[144:147], v[60:63], v[160:163]
    v_mfma_f32_16x16x32_f16 v[168:171], v[144:147], v[116:119], v[168:171]
    v_mfma_f32_16x16x32_f16 v[164:167], v[148:151], v[60:63], v[164:167]
    v_mfma_f32_16x16x32_f16 v[172:175], v[148:151], v[116:119], v[172:175]
    s_waitcnt lgkmcnt(2)
    v_mfma_f32_16x16x32_f16 v[160:163], v[128:131], v[64:67], v[160:163]
    v_mfma_f32_16x16x32_f16 v[168:171], v[128:131], v[120:123], v[168:171]
    v_mfma_f32_16x16x32_f16 v[164:167], v[132:135], v[64:67], v[164:167]
    v_mfma_f32_16x16x32_f16 v[172:175], v[132:135], v[120:123], v[172:175]
    s_waitcnt lgkmcnt(0)
    v_mfma_f32_16x16x32_f16 v[160:163], v[136:139], v[68:71], v[160:163]
    v_mfma_f32_16x16x32_f16 v[168:171], v[136:139], v[124:127], v[168:171]
    v_mfma_f32_16x16x32_f16 v[164:167], v[140:143], v[68:71], v[164:167]
    v_mfma_f32_16x16x32_f16 v[172:175], v[140:143], v[124:127], v[172:175]
    s_add_u32 s30, s30, 1
    s_add_u32 s31, s31, 28672
    s_cmp_eq_u32 s31, 86016
    s_cselect_b32 s31, 0, s31
    s_nop 0
    v_max_f32 v160, 0, v160
    v_max_f32 v161, 0, v161
    v_max_f32 v162, 0, v162
    v_max_f32 v163, 0, v163
    v_cvt_pk_f16_f32 v192, v160, v161
    v_cvt_pk_f16_f32 v193, v162, v163
    v_max_f32 v164, 0, v164
    v_max_f32 v165, 0, v165
    v_max_f32 v166, 0, v166
    v_max_f32 v167, 0, v167
    v_cvt_pk_f16_f32 v194, v164, v165
    v_cvt_pk_f16_f32 v195, v166, v167
    global_store_dwordx4 v2, v[192:195], s[36:37] sc1
    v_max_f32 v168, 0, v168
    v_max_f32 v169, 0, v169
    v_max_f32 v170, 0, v170
    v_max_f32 v171, 0, v171
    v_cvt_pk_f16_f32 v196, v168, v169
    v_cvt_pk_f16_f32 v197, v170, v171
    v_max_f32 v172, 0, v172
    v_max_f32 v173, 0, v173
    v_max_f32 v174, 0, v174
    v_max_f32 v175, 0, v175
    v_cvt_pk_f16_f32 v198, v172, v173
    v_cvt_pk_f16_f32 v199, v174, v175
    global_store_dwordx4 v11, v[196:199], s[36:37] sc1
    s_cmp_lt_u32 s30, 18
    s_cbranch_scc1 G1H_22
    s_lshl_b32 s38, s20, 5
    s_add_u32 s38, s38, 8
    s_waitcnt vmcnt(0)
    s_barrier
    s_cmp_lg_u32 s14, 0
    s_cbranch_scc1 SG_24
    v_mov_b32 v6, s38
    v_mov_b32 v7, 1
    s_mov_b64 s[90:91], exec
    s_mov_b64 exec, 1
    global_atomic_add v6, v7, s[10:11] sc1
    s_mov_b64 exec, s[90:91]
SG_24:
    s_branch M_next
M_d2:
    s_sub_u32 s20, s15, 224
    s_cmp_lt_u32 s20, 224
    s_cbranch_scc0 M_d3
    s_cmp_lg_u32 s14, 0
    s_cbranch_scc1 M_d2w
    s_mul_i32 s21, s20, 2341
    s_lshr_b32 s21, s21, 16
    s_lshl_b32 s21, s21, 5
    s_add_u32 s21, s21, 8
    v_mov_b32 v8, s21
WC_25:
    global_load_dword v9, v8, s[10:11] sc1
    s_sub_u32 s25, s25, 1
    s_cbranch_scc1 M_end
    s_waitcnt vmcnt(0)
    v_cmp_gt_u32 vcc, 28, v9
    s_cbranch_vccnz WC_25
M_d2w:
    s_barrier
    s_mul_i32 s21, s20, 293
    s_lshr_b32 s21, s21, 11
    s_mul_i32 s22, s21, 7
    s_sub_u32 s22, s20, s22
    s_mul_i32 s23, s14, 7168
    s_add_u32 s23, s23, 4096
    s_mul_i32 s24, s21, 229376
    s_add_u32 s24, s24, s23
    s_add_u32 s24, s24, 0x4910000
    s_add_u32 s24, s4, s24
    s_addc_u32 s25, s5, 0
    s_mul_i32 s26, s22, 229376
    s_add_u32 s26, s26, s23
    s_add_u32 s26, s26, 0xf88000
    s_add_u32 s26, s4, s26
    s_addc_u32 s27, s5, 0
    v_add_u32 v8, 57344, v2
    v_add_u32 v9, 114688, v2
    v_add_u32 v10, 172032, v2
    global_load_dwordx4 v[128:131], v2, s[24:25] offset:-4096 sc1
    global_load_dwordx4 v[144:147], v2, s[26:27] offset:-4096
    global_load_dwordx4 v[132:135], v8, s[24:25] offset:-4096 sc1
    global_load_dwordx4 v[148:151], v8, s[26:27] offset:-4096
    global_load_dwordx4 v[136:139], v9, s[24:25] offset:-4096 sc1
    global_load_dwordx4 v[152:155], v9, s[26:27] offset:-4096
    global_load_dwordx4 v[140:143], v10, s[24:25] offset:-4096 sc1
    global_load_dwordx4 v[156:159], v10, s[26:27] offset:-4096
    global_load_dwordx4 v[160:163], v2, s[24:25] offset:-3072 sc1
    global_load_dwordx4 v[176:179], v2, s[26:27] offset:-3072
    global_load_dwordx4 v[164:167], v8, s[24:25] offset:-3072 sc1
    global_load_dwordx4 v[180:183], v8, s[26:27] offset:-3072
    global_load_dwordx4 v[168:171], v9, s[24:25] offset:-3072 sc1
    global_load_dwordx4 v[184:187], v9, s[26:27] offset:-3072
    global_load_dwordx4 v[172:175], v10, s[24:25] offset:-3072 sc1
    global_load_dwordx4 v[188:191], v10, s[26:27] offset:-3072
    global_load_dwordx4 v[192:195], v2, s[24:25] offset:-2048 sc1
    global_load_dwordx4 v[208:211], v2, s[26:27] offset:-2048
    global_load_dwordx4 v[196:199], v8, s[24:25] offset:-2048 sc1
    global_load_dwordx4 v[212:215], v8, s[26:27] offset:-2048
    global_load_dwordx4 v[200:203], v9, s[24:25] offset:-2048 sc1
    global_load_dwordx4 v[216:219], v9, s[26:27] offset:-2048
    global_load_dwordx4 v[204:207], v10, s[24:25] offset:-2048 sc1
    global_load_dwordx4 v[220:223], v10, s[26:27] offset:-2048
    global_load_dwordx4 v[224:227], v2, s[24:25] offset:-1024 sc1
    global_load_dwordx4 v[240:243], v2, s[26:27] offset:-1024
    global_load_dwordx4 v[228:231], v8, s[24:25] offset:-1024 sc1
    global_load_dwordx4 v[244:247], v8, s[26:27] offset:-1024
    global_load_dwordx4 v[232:235], v9, s[24:25] offset:-1024 sc1
    global_load_dwordx4 v[248:251], v9, s[26:27] offset:-1024
    global_load_dwordx4 v[236:239], v10, s[24:25] offset:-1024 sc1
    global_load_dwordx4 v[252:255], v10, s[26:27] offset:-1024
    s_lshr_b32 s28, s14, 1
    s_lshl_b32 s29, s21, 2
    s_add_u32 s28, s28, s29
    s_and_b32 s29, s14, 1
    s_lshl_b32 s30, s22, 1
    s_add_u32 s29, s29, s30
    s_mul_i32 s30, s28, 14336
    s_lshl_b32 s31, s29, 6
    s_add_u32 s30, s30, s31
    s_add_u32 s30, s6, s30
    s_addc_u32 s31, s7, 0
    v_mul_u32_u24 v11, 896, v4
    v_lshl_add_u32 v11, v3, 4, v11
    global_load_dwordx4 v[12:15], v11, s[30:31]
    s_lshr_b32 s32, s28, 1
    s_mul_i32 s32, s32, 28
    s_lshl_b32 s33, s29, 1
    s_add_u32 s32, s32, s33
    s_lshl_b32 s32, s32, 1
    s_and_b32 s33, s28, 1
    s_add_u32 s32, s32, s33
    s_lshl_b32 s32, s32, 10
    s_add_u32 s32, s32, 0x5010000
    s_add_u32 s32, s4, s32
    s_addc_u32 s33, s5, 0
    s_waitcnt vmcnt(25)
    v_mfma_f32_16x16x32_f16 v[64:67], v[144:147], v[128:131], 0
    v_mfma_f32_16x16x32_f16 v[68:71], v[148:151], v[128:131], 0
    v_mfma_f32_16x16x32_f16 v[72:75], v[152:155], v[128:131], 0
    v_mfma_f32_16x16x32_f16 v[76:79], v[156:159], v[128:131], 0
    v_mfma_f32_16x16x32_f16 v[80:83], v[144:147], v[132:135], 0
    v_mfma_f32_16x16x32_f16 v[84:87], v[148:151], v[132:135], 0
    v_mfma_f32_16x16x32_f16 v[88:91], v[152:155], v[132:135], 0
    v_mfma_f32_16x16x32_f16 v[92:95], v[156:159], v[132:135], 0
    v_mfma_f32_16x16x32_f16 v[96:99], v[144:147], v[136:139], 0
    v_mfma_f32_16x16x32_f16 v[100:103], v[148:151], v[136:139], 0
    v_mfma_f32_16x16x32_f16 v[104:107], v[152:155], v[136:139], 0
    v_mfma_f32_16x16x32_f16 v[108:111], v[156:159], v[136:139], 0
    v_mfma_f32_16x16x32_f16 v[112:115], v[144:147], v[140:143], 0
    v_mfma_f32_16x16x32_f16 v[116:119], v[148:151], v[140:143], 0
    v_mfma_f32_16x16x32_f16 v[120:123], v[152:155], v[140:143], 0
    v_mfma_f32_16x16x32_f16 v[124:127], v[156:159], v[140:143], 0
    global_load_dwordx4 v[128:131], v2, s[24:25] offset:0 sc1
    global_load_dwordx4 v[144:147], v2, s[26:27] offset:0
    global_load_dwordx4 v[132:135], v8, s[24:25] offset:0 sc1
    global_load_dwordx4 v[148:151], v8, s[26:27] offset:0
    global_load_dwordx4 v[136:139], v9, s[24:25] offset:0 sc1
    global_load_dwordx4 v[152:155], v9, s[26:27] offset:0
    global_load_dwordx4 v[140:143], v10, s[24:25] offset:0 sc1
    global_load_dwordx4 v[156:159], v10, s[26:27] offset:0
    s_waitcnt vmcnt(25)
    v_mfma_f32_16x16x32_f16 v[64:67], v[176:179], v[160:163], v[64:67]
    v_mfma_f32_16x16x32_f16 v[68:71], v[180:183], v[160:163], v[68:71]
    v_mfma_f32_16x16x32_f16 v[72:75], v[184:187], v[160:163], v[72:75]
    v_mfma_f32_16x16x32_f16 v[76:79], v[188:191], v[160:163], v[76:79]
    v_mfma_f32_16x16x32_f16 v[80:83], v[176:179], v[164:167], v[80:83]
    v_mfma_f32_16x16x32_f16 v[84:87], v[180:183], v[164:167], v[84:87]
    v_mfma_f32_16x16x32_f16 v[88:91], v[184:187], v[164:167], v[88:91]
    v_mfma_f32_16x16x32_f16 v[92:95], v[188:191], v[164:167], v[92:95]
    v_mfma_f32_16x16x32_f16 v[96:99], v[176:179], v[168:171], v[96:99]
    v_mfma_f32_16x16x32_f16 v[100:103], v[180:183], v[168:171], v[100:103]
    v_mfma_f32_16x16x32_f16 v[104:107], v[184:187], v[168:171], v[104:107]
    v_mfma_f32_16x16x32_f16 v[108:111], v[188:191], v[168:171], v[108:111]
    v_mfma_f32_16x16x32_f16 v[112:115], v[176:179], v[172:175], v[112:115]
    v_mfma_f32_16x16x32_f16 v[116:119], v[180:183], v[172:175], v[116:119]
    v_mfma_f32_16x16x32_f16 v[120:123], v[184:187], v[172:175], v[120:123]
    v_mfma_f32_16x16x32_f16 v[124:127], v[188:191], v[172:175], v[124:127]
    global_load_dwordx4 v[160:163], v2, s[24:25] offset:1024 sc1
    global_load_dwordx4 v[176:179], v2, s[26:27] offset:1024
    global_load_dwordx4 v[164:167], v8, s[24:25] offset:1024 sc1
    global_load_dwordx4 v[180:183], v8, s[26:27] offset:1024
    global_load_dwordx4 v[168:171], v9, s[24:25] offset:1024 sc1
    global_load_dwordx4 v[184:187], v9, s[26:27] offset:1024
    global_load_dwordx4 v[172:175], v10, s[24:25] offset:1024 sc1
    global_load_dwordx4 v[188:191], v10, s[26:27] offset:1024
    s_waitcnt vmcnt(25)
    v_mfma_f32_16x16x32_f16 v[64:67], v[208:211], v[192:195], v[64:67]
    v_mfma_f32_16x16x32_f16 v[68:71], v[212:215], v[192:195], v[68:71]
    v_mfma_f32_16x16x32_f16 v[72:75], v[216:219], v[192:195], v[72:75]
    v_mfma_f32_16x16x32_f16 v[76:79], v[220:223], v[192:195], v[76:79]
    v_mfma_f32_16x16x32_f16 v[80:83], v[208:211], v[196:199], v[80:83]
    v_mfma_f32_16x16x32_f16 v[84:87], v[212:215], v[196:199], v[84:87]
    v_mfma_f32_16x16x32_f16 v[88:91], v[216:219], v[196:199], v[88:91]
    v_mfma_f32_16x16x32_f16 v[92:95], v[220:223], v[196:199], v[92:95]
    v_mfma_f32_16x16x32_f16 v[96:99], v[208:211], v[200:203], v[96:99]
    v_mfma_f32_16x16x32_f16 v[100:103], v[212:215], v[200:203], v[100:103]
    v_mfma_f32_16x16x32_f16 v[104:107], v[216:219], v[200:203], v[104:107]
    v_mfma_f32_16x16x32_f16 v[108:111], v[220:223], v[200:203], v[108:111]
    v_mfma_f32_16x16x32_f16 v[112:115], v[208:211], v[204:207], v[112:115]
    v_mfma_f32_16x16x32_f16 v[116:119], v[212:215], v[204:207], v[116:119]
    v_mfma_f32_16x16x32_f16 v[120:123], v[216:219], v[204:207], v[120:123]
    v_mfma_f32_16x16x32_f16 v[124:127], v[220:223], v[204:207], v[124:127]
    global_load_dwordx4 v[192:195], v2, s[24:25] offset:2048 sc1
    global_load_dwordx4 v[208:211], v2, s[26:27] offset:2048
    global_load_dwordx4 v[196:199], v8, s[24:25] offset:2048 sc1
    global_load_dwordx4 v[212:215], v8, s[26:27] offset:2048
    global_load_dwordx4 v[200:203], v9, s[24:25] offset:2048 sc1
    global_load_dwordx4 v[216:219], v9, s[26:27] offset:2048
    global_load_dwordx4 v[204:207], v10, s[24:25] offset:2048 sc1
    global_load_dwordx4 v[220:223], v10, s[26:27] offset:2048
    s_waitcnt vmcnt(25)
    v_mfma_f32_16x16x32_f16 v[64:67], v[240:243], v[224:227], v[64:67]
    v_mfma_f32_16x16x32_f16 v[68:71], v[244:247], v[224:227], v[68:71]
    v_mfma_f32_16x16x32_f16 v[72:75], v[248:251], v[224:227], v[72:75]
    v_mfma_f32_16x16x32_f16 v[76:79], v[252:255], v[224:227], v[76:79]
    v_mfma_f32_16x16x32_f16 v[80:83], v[240:243], v[228:231], v[80:83]
    v_mfma_f32_16x16x32_f16 v[84:87], v[244:247], v[228:231], v[84:87]
    v_mfma_f32_16x16x32_f16 v[88:91], v[248:251], v[228:231], v[88:91]
    v_mfma_f32_16x16x32_f16 v[92:95], v[252:255], v[228:231], v[92:95]
    v_mfma_f32_16x16x32_f16 v[96:99], v[240:243], v[232:235], v[96:99]
    v_mfma_f32_16x16x32_f16 v[100:103], v[244:247], v[232:235], v[100:103]
    v_mfma_f32_16x16x32_f16 v[104:107], v[248:251], v[232:235], v[104:107]
    v_mfma_f32_16x16x32_f16 v[108:111], v[252:255], v[232:235], v[108:111]
    v_mfma_f32_16x16x32_f16 v[112:115], v[240:243], v[236:239], v[112:115]
    v_mfma_f32_16x16x32_f16 v[116:119], v[244:247], v[236:239], v[116:119]
    v_mfma_f32_16x16x32_f16 v[120:123], v[248:251], v[236:239], v[120:123]
    v_mfma_f32_16x16x32_f16 v[124:127], v[252:255], v[236:239], v[124:127]
    s_waitcnt vmcnt(16)
    v_mfma_f32_16x16x32_f16 v[64:67], v[144:147], v[128:131], v[64:67]
    v_mfma_f32_16x16x32_f16 v[68:71], v[148:151], v[128:131], v[68:71]
    v_mfma_f32_16x16x32_f16 v[72:75], v[152:155], v[128:131], v[72:75]
    v_mfma_f32_16x16x32_f16 v[76:79], v[156:159], v[128:131], v[76:79]
    v_mfma_f32_16x16x32_f16 v[80:83], v[144:147], v[132:135], v[80:83]
    v_mfma_f32_16x16x32_f16 v[84:87], v[148:151], v[132:135], v[84:87]
    v_mfma_f32_16x16x32_f16 v[88:91], v[152:155], v[132:135], v[88:91]
    v_mfma_f32_16x16x32_f16 v[92:95], v[156:159], v[132:135], v[92:95]
    v_mfma_f32_16x16x32_f16 v[96:99], v[144:147], v[136:139], v[96:99]
    v_mfma_f32_16x16x32_f16 v[100:103], v[148:151], v[136:139], v[100:103]
    v_mfma_f32_16x16x32_f16 v[104:107], v[152:155], v[136:139], v[104:107]
    v_mfma_f32_16x16x32_f16 v[108:111], v[156:159], v[136:139], v[108:111]
    v_mfma_f32_16x16x32_f16 v[112:115], v[144:147], v[140:143], v[112:115]
    v_mfma_f32_16x16x32_f16 v[116:119], v[148:151], v[140:143], v[116:119]
    v_mfma_f32_16x16x32_f16 v[120:123], v[152:155], v[140:143], v[120:123]
    v_mfma_f32_16x16x32_f16 v[124:127], v[156:159], v[140:143], v[124:127]
    s_waitcnt vmcnt(8)
    v_mfma_f32_16x16x32_f16 v[64:67], v[176:179], v[160:163], v[64:67]
    v_mfma_f32_16x16x32_f16 v[68:71], v[180:183], v[160:163], v[68:71]
    v_mfma_f32_16x16x32_f16 v[72:75], v[184:187], v[160:163], v[72:75]
    v_mfma_f32_16x16x32_f16 v[76:79], v[188:191], v[160:163], v[76:79]
    v_mfma_f32_16x16x32_f16 v[80:83], v[176:179], v[164:167], v[80:83]
    v_mfma_f32_16x16x32_f16 v[84:87], v[180:183], v[164:167], v[84:87]
    v_mfma_f32_16x16x32_f16 v[88:91], v[184:187], v[164:167], v[88:91]
    v_mfma_f32_16x16x32_f16 v[92:95], v[188:191], v[164:167], v[92:95]
    v_mfma_f32_16x16x32_f16 v[96:99], v[176:179], v[168:171], v[96:99]
    v_mfma_f32_16x16x32_f16 v[100:103], v[180:183], v[168:171], v[100:103]
    v_mfma_f32_16x16x32_f16 v[104:107], v[184:187], v[168:171], v[104:107]
    v_mfma_f32_16x16x32_f16 v[108:111], v[188:191], v[168:171], v[108:111]
    v_mfma_f32_16x16x32_f16 v[112:115], v[176:179], v[172:175], v[112:115]
    v_mfma_f32_16x16x32_f16 v[116:119], v[180:183], v[172:175], v[116:119]
    v_mfma_f32_16x16x32_f16 v[120:123], v[184:187], v[172:175], v[120:123]
    v_mfma_f32_16x16x32_f16 v[124:127], v[188:191], v[172:175], v[124:127]
    s_waitcnt vmcnt(0)
    v_mfma_f32_16x16x32_f16 v[64:67], v[208:211], v[192:195], v[64:67]
    v_mfma_f32_16x16x32_f16 v[68:71], v[212:215], v[192:195], v[68:71]
    v_mfma_f32_16x16x32_f16 v[72:75], v[216:219], v[192:195], v[72:75]
    v_mfma_f32_16x16x32_f16 v[76:79], v[220:223], v[192:195], v[76:79]
    v_mfma_f32_16x16x32_f16 v[80:83], v[208:211], v[196:199], v[80:83]
    v_mfma_f32_16x16x32_f16 v[84:87], v[212:215], v[196:199], v[84:87]
    v_mfma_f32_16x16x32_f16 v[88:91], v[216:219], v[196:199], v[88:91]
    v_mfma_f32_16x16x32_f16 v[92:95], v[220:223], v[196:199], v[92:95]
    v_mfma_f32_16x16x32_f16 v[96:99], v[208:211], v[200:203], v[96:99]
    v_mfma_f32_16x16x32_f16 v[100:103], v[212:215], v[200:203], v[100:103]
    v_mfma_f32_16x16x32_f16 v[104:107], v[216:219], v[200:203], v[104:107]
    v_mfma_f32_16x16x32_f16 v[108:111], v[220:223], v[200:203], v[108:111]
    v_mfma_f32_16x16x32_f16 v[112:115], v[208:211], v[204:207], v[112:115]
    v_mfma_f32_16x16x32_f16 v[116:119], v[212:215], v[204:207], v[116:119]
    v_mfma_f32_16x16x32_f16 v[120:123], v[216:219], v[204:207], v[120:123]
    v_mfma_f32_16x16x32_f16 v[124:127], v[220:223], v[204:207], v[124:127]
    s_barrier
    s_lshl_b32 s34, s14, 14
    v_add_u32 v8, s34, v2
    ds_write_b128 v8, v[64:67] offset:0
    ds_write_b128 v8, v[68:71] offset:1024
    ds_write_b128 v8, v[72:75] offset:2048
    ds_write_b128 v8, v[76:79] offset:3072
    ds_write_b128 v8, v[80:83] offset:4096
    ds_write_b128 v8, v[84:87] offset:5120
    ds_write_b128 v8, v[88:91] offset:6144
    ds_write_b128 v8, v[92:95] offset:7168
    ds_write_b128 v8, v[96:99] offset:8192
    ds_write_b128 v8, v[100:103] offset:9216
    ds_write_b128 v8, v[104:107] offset:10240
    ds_write_b128 v8, v[108:111] offset:11264
    ds_write_b128 v8, v[112:115] offset:12288
    ds_write_b128 v8, v[116:119] offset:13312
    ds_write_b128 v8, v[120:123] offset:14336
    ds_write_b128 v8, v[124:127] offset:15360
    s_lshl_b32 s34, s14, 11
    v_add_u32 v8, s34, v2
    v_add_u32 v9, 0x10000, v8
    s_waitcnt lgkmcnt(0)
    s_barrier
    ds_read_b128 v[128:131], v8 offset:0
    ds_read_b128 v[132:135], v8 offset:1024
    ds_read_b128 v[136:139], v8 offset:16384
    ds_read_b128 v[140:143], v8 offset:17408
    ds_read_b128 v[144:147], v8 offset:32768
    ds_read_b128 v[148:151], v8 offset:33792
    ds_read_b128 v[152:155], v8 offset:49152
    ds_read_b128 v[156:159], v8 offset:50176
    ds_read_b128 v[160:163], v9 offset:0
    ds_read_b128 v[164:167], v9 offset:1024
    ds_read_b128 v[168:171], v9 offset:16384
    ds_read_b128 v[172:175], v9 offset:17408
    ds_read_b128 v[176:179], v9 offset:32768
    ds_read_b128 v[180:183], v9 offset:33792
    ds_read_b128 v[184:187], v9 offset:49152
    ds_read_b128 v[188:191], v9 offset:50176
    v_lshlrev_b32 v64, 16, v12
    v_and_b32 v65, 0xffff0000, v12
    v_lshlrev_b32 v66, 16, v13
    v_and_b32 v67, 0xffff0000, v13
    v_lshlrev_b32 v68, 16, v14
    v_and_b32 v69, 0xffff0000, v14
    v_lshlrev_b32 v70, 16, v15
    v_and_b32 v71, 0xffff0000, v15
    s_waitcnt lgkmcnt(14)
    v_pk_add_f32 v[64:65], v[64:65], v[128:129]
    v_pk_add_f32 v[66:67], v[66:67], v[130:131]
    v_pk_add_f32 v[68:69], v[68:69], v[132:133]
    v_pk_add_f32 v[70:71], v[70:71], v[134:135]
    s_waitcnt lgkmcnt(12)
    v_pk_add_f32 v[64:65], v[64:65], v[136:137]
    v_pk_add_f32 v[66:67], v[66:67], v[138:139]
    v_pk_add_f32 v[68:69], v[68:69], v[140:141]
    v_pk_add_f32 v[70:71], v[70:71], v[142:143]
    s_waitcnt lgkmcnt(10)
    v_pk_add_f32 v[64:65], v[64:65], v[144:145]
    v_pk_add_f32 v[66:67], v[66:67], v[146:147]
    v_pk_add_f32 v[68:69], v[68:69], v[148:149]
    v_pk_add_f32 v[70:71], v[70:71], v[150:151]
    s_waitcnt lgkmcnt(8)
    v_pk_add_f32 v[64:65], v[64:65], v[152:153]
    v_pk_add_f32 v[66:67], v[66:67], v[154:155]
    v_pk_add_f32 v[68:69], v[68:69], v[156:157]
    v_pk_add_f32 v[70:71], v[70:71], v[158:159]
    s_waitcnt lgkmcnt(6)
    v_pk_add_f32 v[64:65], v[64:65], v[160:161]
    v_pk_add_f32 v[66:67], v[66:67], v[162:163]
    v_pk_add_f32 v[68:69], v[68:69], v[164:165]
    v_pk_add_f32 v[70:71], v[70:71], v[166:167]
    s_waitcnt lgkmcnt(4)
    v_pk_add_f32 v[64:65], v[64:65], v[168:169]
    v_pk_add_f32 v[66:67], v[66:67], v[170:171]
    v_pk_add_f32 v[68:69], v[68:69], v[172:173]
    v_pk_add_f32 v[70:71], v[70:71], v[174:175]
    s_waitcnt lgkmcnt(2)
    v_pk_add_f32 v[64:65], v[64:65], v[176:177]
    v_pk_add_f32 v[66:67], v[66:67], v[178:179]
    v_pk_add_f32 v[68:69], v[68:69], v[180:181]
    v_pk_add_f32 v[70:71], v[70:71], v[182:183]
    s_waitcnt lgkmcnt(0)
    v_pk_add_f32 v[64:65], v[64:65], v[184:185]
    v_pk_add_f32 v[66:67], v[66:67], v[186:187]
    v_pk_add_f32 v[68:69], v[68:69], v[188:189]
    v_pk_add_f32 v[70:71], v[70:71], v[190:191]
    global_store_dwordx4 v2, v[64:67], s[32:33] sc1
    global_store_dwordx4 v2, v[68:71], s[32:33] offset:2048 sc1
    s_and_b32 s39, s21, 3
    s_lshr_b32 s38, s21, 2
    s_lshl_b32 s38, s38, 3
    s_add_u32 s38, s38, s39
    s_lshl_b32 s38, s38, 2
    s_add_u32 s38, s38, 16
    s_waitcnt vmcnt(0)
    s_barrier
    s_cmp_lg_u32 s14, 0
    s_cbranch_scc1 SG_26
    v_mov_b32 v6, s38
    v_mov_b32 v7, 1
    s_mov_b64 s[90:91], exec
    s_mov_b64 exec, 1
    global_atomic_add v6, v7, s[10:11] sc1
    s_mov_b64 exec, s[90:91]
SG_26:
    s_branch M_next
M_d3:
    s_sub_u32 s20, s20, 224
    s_cmp_lt_u32 s20, 272
    s_cbranch_scc0 M_end
    s_cmp_ge_u32 s20, 240
    s_cbranch_scc1 M_d4
    s_lshr_b32 s21, s20, 2
    s_bfe_u32 s22, s20, 0x10001
    s_and_b32 s23, s20, 1
    s_mov_b32 s25, 0x400000
    s_min_u32 s24, s14, 6
    s_mul_i32 s23, s23, 7
    s_add_u32 s23, s23, s24
    s_lshl_b32 s23, s23, 1
    s_mul_i32 s26, s21, 28672
    s_add_u32 s26, s26, 0x0
    s_add_u32 s26, s4, s26
    s_addc_u32 s27, s5, 0
    s_lshl_b32 s28, s21, 4
    s_lshl_b32 s29, s14, 1
    s_add_u32 s28, s28, s29
    s_lshl_b32 s28, s28, 1
    s_add_u32 s28, s28, s22
    s_mul_i32 s28, s28, 14336
    s_add_u32 s28, s28, 0x2d11000
    s_add_u32 s28, s4, s28
    s_addc_u32 s29, s5, 0
    s_mul_i32 s30, s21, 28
    s_add_u32 s30, s30, s23
    s_lshr_b32 s32, s30, 1
    s_lshl_b32 s32, s32, 15
    s_and_b32 s31, s30, 1
    s_lshl_b32 s33, s31, 11
    s_add_u32 s32, s32, s33
    s_add_u32 s32, s32, 0x1111000
    s_add_u32 s32, s4, s32
    s_addc_u32 s33, s5, 0
    s_lshl_b32 s34, s30, 1
    s_add_u32 s34, s34, s22
    s_lshl_b32 s34, s34, 10
    s_add_u32 s34, s34, 0x5010000
    s_add_u32 s34, s4, s34
    s_addc_u32 s35, s5, 0
    s_lshl_b32 s36, s30, 12
    s_add_u32 s36, s36, 0x542d000
    s_add_u32 s36, s4, s36
    s_addc_u32 s37, s5, 0
    s_lshl_b32 s38, s21, 13
    s_lshl_b32 s39, s24, 10
    s_add_u32 s38, s38, s39
    s_add_u32 s38, s38, 0x5390000
    s_add_u32 s39, s39, 28672
    v_add_u32 v14, s39, v2
    s_add_u32 s38, s4, s38
    s_addc_u32 s39, s5, 0
    s_add_u32 s52, s21, 2
    s_min_u32 s52, s52, 63
    s_lshl_b32 s52, s52, 13
    s_add_u32 s52, s52, 0x5390000
    s_add_u32 s52, s4, s52
    s_addc_u32 s53, s5, 0
    s_lshl_b32 s48, s21, 1
    s_add_u32 s48, s48, s22
    s_mul_i32 s48, s48, 14336
    s_lshr_b32 s49, s23, 1
    s_lshl_b32 s49, s49, 6
    s_add_u32 s48, s48, s49
    s_lshl_b32 s49, s31, 3
    s_add_u32 s48, s48, s49
    s_add_u32 s48, s8, s48
    s_addc_u32 s49, s9, 0
    v_mul_u32_u24 v15, 896, v4
    v_lshl_add_u32 v15, v3, 4, v15
    v_add_u32 v5, 8192, v2
    v_add_u32 v6, 16384, v2
    v_add_u32 v7, 24576, v2
    v_lshrrev_b32 v12, 2, v4
    v_lshlrev_b32 v12, 1, v12
    v_and_b32 v13, 1, v4
    v_add_u32 v12, v12, v13
    v_lshlrev_b32 v12, 4, v12
    v_lshl_add_u32 v12, v3, 7, v12
    v_add_u32 v12, 28672, v12
    v_lshlrev_b32 v13, 2, v3
    v_sub_u32 v13, v4, v13
    v_cmp_le_i32 s[40:41], 0, v13
    v_cmp_le_i32 s[42:43], 1, v13
    v_cmp_le_i32 s[44:45], 2, v13
    v_cmp_le_i32 s[46:47], 3, v13
    s_cmp_lg_u32 s14, 3
    s_cbranch_scc1 M2_fg
    s_mul_i32 s50, s21, 373
    s_lshr_b32 s50, s50, 10
    s_add_u32 s50, s50, 34
    s_lshl_b32 s50, s50, 13
    s_add_u32 s50, s50, 0x5390000
    s_add_u32 s50, s4, s50
    s_addc_u32 s51, s5, 0
    v_mov_b32 v8, 128
M2_fgl:
    global_load_dword v9, v8, s[50:51] sc1
    s_sub_u32 s25, s25, 1
    s_cbranch_scc1 M_end
    s_waitcnt vmcnt(0)
    v_cmp_eq_u32 vcc, -1, v9
    s_cbranch_vccnz M2_fgl
    v_mov_b32 v8, 12
    global_load_dword v9, v8, s[10:11] sc1
    v_mov_b32 v8, 161836
    s_waitcnt vmcnt(0)
    ds_write_b32 v8, v9
    s_waitcnt lgkmcnt(0)
M2_fg:
    s_cmp_gt_u32 s14, 2
    s_cbranch_scc1 M2_fw
    s_cmp_eq_u32 s14, 2
    s_cbranch_scc1 M2_fw2
    s_lshl_b32 s50, s21, 1
    s_add_u32 s50, s50, s14
    s_lshl_b32 s50, s50, 10
    s_add_u32 s50, s50, 0x5b6c000
    s_add_u32 s50, s4, s50
    s_addc_u32 s51, s5, 0
    v_min_u32 v20, 55, v1
    v_lshlrev_b32 v20, 4, v20
WU_30:
    global_load_dwordx4 v[16:19], v20, s[50:51] sc1
    s_sub_u32 s25, s25, 1
    s_cbranch_scc1 M_end
    s_waitcnt vmcnt(0)
    v_xor_b32 v16, s19, v16
    v_bitop3_b32 v16, v16, v17, s19 bitop3:0xf6
    v_bitop3_b32 v16, v16, v18, s19 bitop3:0xf6
    v_bitop3_b32 v16, v16, v19, s19 bitop3:0xf6
    v_cmp_ne_u32 vcc, 0, v16
    s_cbranch_vccnz WU_30
    s_branch M2_fw
M2_fw2:
    s_lshr_b32 s50, s21, 1
    s_and_b32 s51, s50, 3
    s_lshr_b32 s50, s50, 2
    s_lshl_b32 s50, s50, 3
    s_add_u32 s50, s50, s51
    s_lshl_b32 s50, s50, 2
    s_add_u32 s50, s50, 16
    v_mov_b32 v8, s50
WC_31:
    global_load_dword v9, v8, s[10:11] sc1
    s_sub_u32 s25, s25, 1
    s_cbranch_scc1 M_end
    s_waitcnt vmcnt(0)
    v_cmp_gt_u32 vcc, 7, v9
    s_cbranch_vccnz WC_31
M2_fw:
    s_barrier
    v_mov_b32 v8, 161836
    ds_read_b32 v9, v8
    s_waitcnt lgkmcnt(0)
    v_readfirstlane_b32 s55, v9
    s_cmp_eq_u32 s22, 1
    s_cbranch_scc1 Ft1_33
    s_mul_i32 s50, s24, 2048
    v_add_u32 v8, s50, v2
    s_add_u32 m0, s50, 0
    s_nop 0
    global_load_lds_dwordx4 v8, s[26:27] offset:0
    global_load_lds_dwordx4 v8, s[26:27] offset:1024
    global_load_dwordx4 v[16:19], v2, s[28:29] offset:-4096 sc1 nt
    global_load_dwordx4 v[20:23], v2, s[28:29] offset:-3072 sc1 nt
    global_load_dwordx4 v[24:27], v2, s[28:29] offset:-2048 sc1 nt
    global_load_dwordx4 v[28:31], v2, s[28:29] offset:-1024 sc1 nt
    global_load_dwordx4 v[32:35], v2, s[28:29] offset:0 sc1 nt
    global_load_dwordx4 v[36:39], v2, s[28:29] offset:1024 sc1 nt
    global_load_dwordx4 v[40:43], v2, s[28:29] offset:2048 sc1 nt
    global_load_dwordx4 v[44:47], v2, s[28:29] offset:3072 sc1 nt
    global_load_dwordx4 v[48:51], v5, s[28:29] offset:-4096 sc1 nt
    global_load_dwordx4 v[52:55], v5, s[28:29] offset:-3072 sc1 nt
    global_load_dwordx4 v[56:59], v5, s[28:29] offset:-2048 sc1 nt
    global_load_dwordx4 v[60:63], v5, s[28:29] offset:-1024 sc1 nt
    global_load_dwordx4 v[64:67], v5, s[28:29] offset:0 sc1 nt
    global_load_dwordx4 v[68:71], v5, s[28:29] offset:1024 sc1 nt
    s_add_u32 s28, s28, 28672
    s_addc_u32 s29, s29, 0
    global_load_dwordx4 v[72:75], v2, s[28:29] offset:-4096 sc1 nt
    global_load_dwordx4 v[76:79], v2, s[28:29] offset:-3072 sc1 nt
    global_load_dwordx4 v[80:83], v2, s[28:29] offset:-2048 sc1 nt
    global_load_dwordx4 v[84:87], v2, s[28:29] offset:-1024 sc1 nt
    global_load_dwordx4 v[88:91], v2, s[28:29] offset:0 sc1 nt
    global_load_dwordx4 v[92:95], v2, s[28:29] offset:1024 sc1 nt
    global_load_dwordx4 v[96:99], v2, s[28:29] offset:2048 sc1 nt
    global_load_dwordx4 v[100:103], v2, s[28:29] offset:3072 sc1 nt
    global_load_dwordx4 v[104:107], v5, s[28:29] offset:-4096 sc1 nt
    global_load_dwordx4 v[108:111], v5, s[28:29] offset:-3072 sc1 nt
    global_load_dwordx4 v[112:115], v5, s[28:29] offset:-2048 sc1 nt
    global_load_dwordx4 v[116:119], v5, s[28:29] offset:-1024 sc1 nt
    global_load_dwordx4 v[120:123], v5, s[28:29] offset:0 sc1 nt
    global_load_dwordx4 v[124:127], v5, s[28:29] offset:1024 sc1 nt
    global_load_dwordx4 v[176:179], v2, s[32:33] offset:-4096 sc1
    global_load_dwordx4 v[180:183], v2, s[32:33] offset:-2048 sc1
    global_load_dwordx4 v[184:187], v2, s[32:33] offset:0 sc1
    global_load_dwordx4 v[188:191], v2, s[32:33] offset:2048 sc1
    global_load_dwordx4 v[192:195], v5, s[32:33] offset:-4096 sc1
    global_load_dwordx4 v[196:199], v5, s[32:33] offset:-2048 sc1
    global_load_dwordx4 v[200:203], v5, s[32:33] offset:0 sc1
    global_load_dwordx4 v[204:207], v5, s[32:33] offset:2048 sc1
    global_load_dwordx4 v[208:211], v6, s[32:33] offset:-4096 sc1
    global_load_dwordx4 v[212:215], v6, s[32:33] offset:-2048 sc1
    global_load_dwordx4 v[216:219], v6, s[32:33] offset:0 sc1
    global_load_dwordx4 v[220:223], v6, s[32:33] offset:2048 sc1
    global_load_dwordx4 v[224:227], v7, s[32:33] offset:-4096 sc1
    global_load_dwordx4 v[228:231], v7, s[32:33] offset:-2048 sc1
    global_load_dwordx4 v[232:235], v7, s[32:33] offset:0 sc1
    global_load_dwordx4 v[236:239], v7, s[32:33] offset:2048 sc1
    global_load_dwordx4 v[248:251], v2, s[34:35] offset:0 sc1 nt
    global_load_dwordx4 v[252:255], v2, s[34:35] offset:2048 sc1 nt
    s_waitcnt vmcnt(46)
    s_barrier
    ds_read_b128 v[152:155], v2 offset:0
    ds_read_b128 v[156:159], v2 offset:1024
    ds_read_b128 v[160:163], v2 offset:2048
    ds_read_b128 v[164:167], v2 offset:3072
    ds_read_b128 v[168:171], v2 offset:4096
    s_waitcnt vmcnt(18)
    ds_read_b128 v[172:175], v2 offset:5120
    s_waitcnt lgkmcnt(5)
    v_mfma_f32_16x16x32_f16 v[128:131], v[152:155], v[16:19], 0
    v_mfma_f32_16x16x32_f16 v[136:139], v[152:155], v[72:75], 0
    ds_read_b128 v[152:155], v2 offset:6144
    s_waitcnt lgkmcnt(5)
    v_mfma_f32_16x16x32_f16 v[128:131], v[156:159], v[20:23], v[128:131]
    v_mfma_f32_16x16x32_f16 v[136:139], v[156:159], v[76:79], v[136:139]
    ds_read_b128 v[156:159], v2 offset:7168
    s_waitcnt lgkmcnt(5)
    v_mfma_f32_16x16x32_f16 v[128:131], v[160:163], v[24:27], v[128:131]
    v_mfma_f32_16x16x32_f16 v[136:139], v[160:163], v[80:83], v[136:139]
    ds_read_b128 v[160:163], v2 offset:8192
    s_waitcnt lgkmcnt(5)
    v_mfma_f32_16x16x32_f16 v[128:131], v[164:167], v[28:31], v[128:131]
    v_mfma_f32_16x16x32_f16 v[136:139], v[164:167], v[84:87], v[136:139]
    ds_read_b128 v[164:167], v2 offset:9216
    s_waitcnt lgkmcnt(5)
    v_mfma_f32_16x16x32_f16 v[128:131], v[168:171], v[32:35], v[128:131]
    v_mfma_f32_16x16x32_f16 v[136:139], v[168:171], v[88:91], v[136:139]
    ds_read_b128 v[168:171], v2 offset:10240
    s_waitcnt lgkmcnt(5)
    v_mfma_f32_16x16x32_f16 v[128:131], v[172:175], v[36:39], v[128:131]
    v_mfma_f32_16x16x32_f16 v[136:139], v[172:175], v[92:95], v[136:139]
    ds_read_b128 v[172:175], v2 offset:11264
    s_waitcnt lgkmcnt(5)
    v_mfma_f32_16x16x32_f16 v[128:131], v[152:155], v[40:43], v[128:131]
    v_mfma_f32_16x16x32_f16 v[136:139], v[152:155], v[96:99], v[136:139]
    ds_read_b128 v[152:155], v2 offset:12288
    s_waitcnt lgkmcnt(5)
    v_mfma_f32_16x16x32_f16 v[128:131], v[156:159], v[44:47], v[128:131]
    v_mfma_f32_16x16x32_f16 v[136:139], v[156:159], v[100:103], v[136:139]
    ds_read_b128 v[156:159], v2 offset:13312
    s_waitcnt lgkmcnt(5)
    v_mfma_f32_16x16x32_f16 v[128:131], v[160:163], v[48:51], v[128:131]
    v_mfma_f32_16x16x32_f16 v[136:139], v[160:163], v[104:107], v[136:139]
    s_waitcnt lgkmcnt(4)
    v_mfma_f32_16x16x32_f16 v[128:131], v[164:167], v[52:55], v[128:131]
    v_mfma_f32_16x16x32_f16 v[136:139], v[164:167], v[108:111], v[136:139]
    s_waitcnt lgkmcnt(3)
    v_mfma_f32_16x16x32_f16 v[128:131], v[168:171], v[56:59], v[128:131]
    v_mfma_f32_16x16x32_f16 v[136:139], v[168:171], v[112:115], v[136:139]
    s_waitcnt lgkmcnt(2)
    v_mfma_f32_16x16x32_f16 v[128:131], v[172:175], v[60:63], v[128:131]
    v_mfma_f32_16x16x32_f16 v[136:139], v[172:175], v[116:119], v[136:139]
    s_waitcnt lgkmcnt(1)
    v_mfma_f32_16x16x32_f16 v[128:131], v[152:155], v[64:67], v[128:131]
    v_mfma_f32_16x16x32_f16 v[136:139], v[152:155], v[120:123], v[136:139]
    s_waitcnt lgkmcnt(0)
    v_mfma_f32_16x16x32_f16 v[128:131], v[156:159], v[68:71], v[128:131]
    v_mfma_f32_16x16x32_f16 v[136:139], v[156:159], v[124:127], v[136:139]
    v_mov_b32 v8, 0xff800000
    s_nop 5
    v_cndmask_b32 v128, v8, v128, s[40:41]
    v_cndmask_b32 v129, v8, v129, s[42:43]
    v_cndmask_b32 v130, v8, v130, s[44:45]
    v_cndmask_b32 v131, v8, v131, s[46:47]
    v_cndmask_b32 v136, v8, v136, s[40:41]
    v_cndmask_b32 v137, v8, v137, s[42:43]
    v_cndmask_b32 v138, v8, v138, s[44:45]
    v_cndmask_b32 v139, v8, v139, s[46:47]
    v_max_f32 v13, v128, v129
    v_max_f32 v0, v136, v137
    v_max3_f32 v13, v13, v130, v131
    v_max3_f32 v0, v0, v138, v139
    s_cmp_ge_u32 s21, 63
    s_cbranch_scc1 Fmp_34
    s_cmp_lg_u32 s14, 7
    s_cbranch_scc1 Fgb_36
    v_mov_b32 v8, 0
Fg_35:
    global_load_dword v9, v8, s[52:53] sc1
    s_sub_u32 s25, s25, 1
    s_cbranch_scc1 M_end
    s_waitcnt vmcnt(0)
    v_cmp_eq_u32 vcc, -1, v9
    s_cbranch_vccnz Fg_35
Fgb_36:
    s_barrier
Fmp_34:
    global_load_dwordx4 v[8:11], v2, s[38:39] sc1
    s_sub_u32 s25, s25, 1
    s_cbranch_scc1 M_end
    s_waitcnt vmcnt(0)
    v_pk_maximum3_f16 v152, v8, v9, v10
    v_pk_maximum3_f16 v152, v152, v11, v11
    v_cmp_u_f16 vcc, v152, v152
    s_cbranch_vccnz Fmp_34
    ds_write_b128 v14, v[8:11]
Fd_27:
    s_waitcnt lgkmcnt(0)
    s_barrier
    ds_read_b128 v[152:155], v12 offset:0
    ds_read_b128 v[156:159], v12 offset:512
    ds_read_b128 v[160:163], v12 offset:1024
    ds_read_b128 v[164:167], v12 offset:1536
    ds_read_b128 v[168:171], v12 offset:2048
    ds_read_b128 v[172:175], v12 offset:2560
    s_waitcnt lgkmcnt(5)
    v_mfma_f32_16x16x32_f16 v[144:147], v[152:155], v[16:19], 0
    v_mfma_f32_16x16x32_f16 v[148:151], v[152:155], v[72:75], 0
    ds_read_b128 v[152:155], v12 offset:3072
    s_waitcnt lgkmcnt(5)
    v_mfma_f32_16x16x32_f16 v[144:147], v[156:159], v[20:23], v[144:147]
    v_mfma_f32_16x16x32_f16 v[148:151], v[156:159], v[76:79], v[148:151]
    ds_read_b128 v[156:159], v12 offset:3584
    s_waitcnt lgkmcnt(5)
    v_mfma_f32_16x16x32_f16 v[144:147], v[160:163], v[24:27], v[144:147]
    v_mfma_f32_16x16x32_f16 v[148:151], v[160:163], v[80:83], v[148:151]
    ds_read_b128 v[160:163], v12 offset:4096
    s_waitcnt lgkmcnt(5)
    v_mfma_f32_16x16x32_f16 v[144:147], v[164:167], v[28:31], v[144:147]
    v_mfma_f32_16x16x32_f16 v[148:151], v[164:167], v[84:87], v[148:151]
    ds_read_b128 v[164:167], v12 offset:4608
    s_waitcnt lgkmcnt(5)
    v_mfma_f32_16x16x32_f16 v[144:147], v[168:171], v[32:35], v[144:147]
    v_mfma_f32_16x16x32_f16 v[148:151], v[168:171], v[88:91], v[148:151]
    ds_read_b128 v[168:171], v12 offset:5120
    s_waitcnt lgkmcnt(5)
    v_mfma_f32_16x16x32_f16 v[144:147], v[172:175], v[36:39], v[144:147]
    v_mfma_f32_16x16x32_f16 v[148:151], v[172:175], v[92:95], v[148:151]
    ds_read_b128 v[172:175], v12 offset:5632
    s_waitcnt lgkmcnt(5)
    v_mfma_f32_16x16x32_f16 v[144:147], v[152:155], v[40:43], v[144:147]
    v_mfma_f32_16x16x32_f16 v[148:151], v[152:155], v[96:99], v[148:151]
    ds_read_b128 v[152:155], v12 offset:6144
    s_waitcnt lgkmcnt(5)
    v_mfma_f32_16x16x32_f16 v[144:147], v[156:159], v[44:47], v[144:147]
    v_mfma_f32_16x16x32_f16 v[148:151], v[156:159], v[100:103], v[148:151]
    ds_read_b128 v[156:159], v12 offset:6656
    s_waitcnt lgkmcnt(5)
    v_mfma_f32_16x16x32_f16 v[144:147], v[160:163], v[48:51], v[144:147]
    v_mfma_f32_16x16x32_f16 v[148:151], v[160:163], v[104:107], v[148:151]
    s_waitcnt lgkmcnt(4)
    v_mfma_f32_16x16x32_f16 v[144:147], v[164:167], v[52:55], v[144:147]
    v_mfma_f32_16x16x32_f16 v[148:151], v[164:167], v[108:111], v[148:151]
    s_waitcnt lgkmcnt(3)
    v_mfma_f32_16x16x32_f16 v[144:147], v[168:171], v[56:59], v[144:147]
    v_mfma_f32_16x16x32_f16 v[148:151], v[168:171], v[112:115], v[148:151]
    s_waitcnt lgkmcnt(2)
    v_mfma_f32_16x16x32_f16 v[144:147], v[172:175], v[60:63], v[144:147]
    v_mfma_f32_16x16x32_f16 v[148:151], v[172:175], v[116:119], v[148:151]
    s_waitcnt lgkmcnt(1)
    v_mfma_f32_16x16x32_f16 v[144:147], v[152:155], v[64:67], v[144:147]
    v_mfma_f32_16x16x32_f16 v[148:151], v[152:155], v[120:123], v[148:151]
    s_waitcnt lgkmcnt(0)
    v_mfma_f32_16x16x32_f16 v[144:147], v[156:159], v[68:71], v[144:147]
    v_mfma_f32_16x16x32_f16 v[148:151], v[156:159], v[124:127], v[148:151]
    global_load_dwordx4 v[72:75], v2, s[36:37] offset:-4096 sc1
    global_load_dwordx4 v[76:79], v2, s[36:37] offset:-3072 sc1
    global_load_dwordx4 v[80:83], v2, s[36:37] offset:-2048 sc1
    global_load_dwordx4 v[84:87], v2, s[36:37] offset:-1024 sc1
    global_load_dwordx4 v[88:91], v2, s[36:37] offset:0 sc1
    global_load_dwordx4 v[92:95], v2, s[36:37] offset:1024 sc1
    global_load_dwordx4 v[96:99], v2, s[36:37] offset:2048 sc1
    global_load_dwordx4 v[100:103], v2, s[36:37] offset:3072 sc1
    s_lshl_b32 s50, s14, 11
    s_add_u32 s50, s50, 36864
    v_add_u32 v8, s50, v2
    s_lshr_b32 s50, s14, 1
    s_lshl_b32 s50, s50, 10
    s_and_b32 s51, s14, 1
    s_lshl_b32 s51, s51, 3
    s_add_u32 s50, s50, s51
    s_add_u32 s50, s50, 53248
    v_add_u32 v9, s50, v2
    v_max3_f32 v152, v13, v144, v145
    v_max3_f32 v153, v0, v148, v149
    v_mov_b32 v154, v152
    v_mov_b32 v155, v153
    s_nop 0
    v_permlane32_swap_b32 v152, v154
    v_permlane32_swap_b32 v153, v155
    v_max_f32 v152, v152, v154
    v_max_f32 v153, v153, v155
    v_mov_b32 v154, v152
    v_mov_b32 v155, v153
    s_nop 0
    v_permlane16_swap_b32 v152, v154
    v_permlane16_swap_b32 v153, v155
    v_max_f32 v152, v152, v154
    v_max_f32 v153, v153, v155
    v_sub_f32 v128, v128, v152
    v_sub_f32 v136, v136, v153
    v_sub_f32 v129, v129, v152
    v_sub_f32 v137, v137, v153
    v_sub_f32 v130, v130, v152
    v_sub_f32 v138, v138, v153
    v_sub_f32 v131, v131, v152
    v_sub_f32 v139, v139, v153
    v_sub_f32 v144, v144, v152
    v_sub_f32 v148, v148, v153
    v_sub_f32 v145, v145, v152
    v_sub_f32 v149, v149, v153
    v_exp_f32 v128, v128
    v_exp_f32 v136, v136
    v_exp_f32 v129, v129
    v_exp_f32 v137, v137
    v_exp_f32 v130, v130
    v_exp_f32 v138, v138
    v_exp_f32 v131, v131
    v_exp_f32 v139, v139
    v_exp_f32 v144, v144
    v_exp_f32 v148, v148
    v_exp_f32 v145, v145
    v_exp_f32 v149, v149
    v_add_f32 v152, v128, v129
    v_add_f32 v153, v136, v137
    v_add_f32 v152, v152, v130
    v_add_f32 v153, v153, v138
    v_add_f32 v152, v152, v131
    v_add_f32 v153, v153, v139
    v_add_f32 v152, v152, v144
    v_add_f32 v153, v153, v148
    v_add_f32 v152, v152, v145
    v_add_f32 v153, v153, v149
    v_mov_b32 v154, v152
    v_mov_b32 v155, v153
    s_nop 0
    v_permlane32_swap_b32 v152, v154
    v_permlane32_swap_b32 v153, v155
    v_add_f32 v152, v152, v154
    v_add_f32 v153, v153, v155
    v_mov_b32 v154, v152
    v_mov_b32 v155, v153
    s_nop 0
    v_permlane16_swap_b32 v152, v154
    v_permlane16_swap_b32 v153, v155
    v_add_f32 v152, v152, v154
    v_add_f32 v153, v153, v155
    v_rcp_f32 v152, v152
    v_rcp_f32 v153, v153
    v_mul_f32 v128, v128, v152
    v_mul_f32 v136, v136, v153
    v_mul_f32 v129, v129, v152
    v_mul_f32 v137, v137, v153
    v_mul_f32 v130, v130, v152
    v_mul_f32 v138, v138, v153
    v_mul_f32 v131, v131, v152
    v_mul_f32 v139, v139, v153
    v_mul_f32 v144, v144, v152
    v_mul_f32 v148, v148, v153
    v_mul_f32 v145, v145, v152
    v_mul_f32 v149, v149, v153
    v_cvt_pk_f16_f32 v156, v128, v129
    v_cvt_pk_f16_f32 v158, v130, v131
    v_cvt_pk_f16_f32 v157, v136, v137
    v_cvt_pk_f16_f32 v159, v138, v139
    ds_write_b128 v8, v[156:159] offset:0
    v_cvt_pk_f16_f32 v164, v144, v145
    v_cvt_pk_f16_f32 v165, v148, v149
    ds_write_b64 v9, v[164:165]
    s_waitcnt lgkmcnt(0)
    s_barrier
    s_cmp_eq_u32 s14, 7
    s_cbranch_scc1 Fend_32
    ds_read_b128 v[152:155], v2 offset:53248
    ds_read_b128 v[156:159], v2 offset:54272
    ds_read_b128 v[160:163], v2 offset:55296
    ds_read_b128 v[164:167], v2 offset:56320
    ds_read_b128 v[104:107], v2 offset:36864
    ds_read_b128 v[108:111], v2 offset:38912
    ds_read_b128 v[112:115], v2 offset:40960
    ds_read_b128 v[116:119], v2 offset:43008
    ds_read_b128 v[120:123], v2 offset:45056
    ds_read_b128 v[124:127], v2 offset:47104
    s_waitcnt lgkmcnt(5)
    v_mfma_f32_16x16x32_f16 v[248:251], v[176:179], v[104:107], v[248:251]
    v_mfma_f32_16x16x32_f16 v[252:255], v[180:183], v[104:107], v[252:255]
    ds_read_b128 v[104:107], v2 offset:49152
    s_waitcnt lgkmcnt(5)
    v_mfma_f32_16x16x32_f16 v[248:251], v[184:187], v[108:111], v[248:251]
    v_mfma_f32_16x16x32_f16 v[252:255], v[188:191], v[108:111], v[252:255]
    ds_read_b128 v[108:111], v2 offset:51200
    s_waitcnt lgkmcnt(5)
    v_mfma_f32_16x16x32_f16 v[248:251], v[192:195], v[112:115], v[248:251]
    v_mfma_f32_16x16x32_f16 v[252:255], v[196:199], v[112:115], v[252:255]
    s_waitcnt lgkmcnt(4)
    v_mfma_f32_16x16x32_f16 v[248:251], v[200:203], v[116:119], v[248:251]
    v_mfma_f32_16x16x32_f16 v[252:255], v[204:207], v[116:119], v[252:255]
    s_waitcnt lgkmcnt(3)
    v_mfma_f32_16x16x32_f16 v[248:251], v[208:211], v[120:123], v[248:251]
    v_mfma_f32_16x16x32_f16 v[252:255], v[212:215], v[120:123], v[252:255]
    s_waitcnt lgkmcnt(2)
    v_mfma_f32_16x16x32_f16 v[248:251], v[216:219], v[124:127], v[248:251]
    v_mfma_f32_16x16x32_f16 v[252:255], v[220:223], v[124:127], v[252:255]
    s_waitcnt lgkmcnt(1)
    v_mfma_f32_16x16x32_f16 v[248:251], v[224:227], v[104:107], v[248:251]
    v_mfma_f32_16x16x32_f16 v[252:255], v[228:231], v[104:107], v[252:255]
    s_waitcnt lgkmcnt(0)
    v_mfma_f32_16x16x32_f16 v[248:251], v[232:235], v[108:111], v[248:251]
    v_mfma_f32_16x16x32_f16 v[252:255], v[236:239], v[108:111], v[252:255]
Ftb_38:
    s_waitcnt vmcnt(0)
    v_mfma_f32_16x16x32_f16 v[128:131], v[72:75], v[152:155], v[248:251]
    v_mfma_f32_16x16x32_f16 v[132:135], v[88:91], v[152:155], v[252:255]
    v_mfma_f32_16x16x32_f16 v[128:131], v[76:79], v[156:159], v[128:131]
    v_mfma_f32_16x16x32_f16 v[132:135], v[92:95], v[156:159], v[132:135]
    v_mfma_f32_16x16x32_f16 v[128:131], v[80:83], v[160:163], v[128:131]
    v_mfma_f32_16x16x32_f16 v[132:135], v[96:99], v[160:163], v[132:135]
    v_mfma_f32_16x16x32_f16 v[128:131], v[84:87], v[164:167], v[128:131]
    v_mfma_f32_16x16x32_f16 v[132:135], v[100:103], v[164:167], v[132:135]
    s_nop 6
    v_pk_add_f32 v[8:9], v[128:129], v[130:131]
    v_pk_add_f32 v[10:11], v[132:133], v[134:135]
    v_pk_add_f32 v[8:9], v[8:9], v[10:11]
    v_cmp_u_f32 vcc, v8, v9
    v_cvt_pk_bf16_f32 v8, v128, v129
    v_cvt_pk_bf16_f32 v9, v130, v131
    v_cvt_pk_bf16_f32 v10, v132, v133
    v_cvt_pk_bf16_f32 v11, v134, v135
    s_cbranch_vccnz Ftr_39
Fts_40:
    global_store_dwordx4 v15, v[8:11], s[48:49]
    s_cmp_lt_u32 s55, 0x2d0
    s_cbranch_scc1 Fend_32
    s_endpgm
Ftr_39:
    global_load_dwordx4 v[72:75], v2, s[36:37] offset:-4096 sc1
    global_load_dwordx4 v[76:79], v2, s[36:37] offset:-3072 sc1
    global_load_dwordx4 v[80:83], v2, s[36:37] offset:-2048 sc1
    global_load_dwordx4 v[84:87], v2, s[36:37] offset:-1024 sc1
    global_load_dwordx4 v[88:91], v2, s[36:37] offset:0 sc1
    global_load_dwordx4 v[92:95], v2, s[36:37] offset:1024 sc1
    global_load_dwordx4 v[96:99], v2, s[36:37] offset:2048 sc1
    global_load_dwordx4 v[100:103], v2, s[36:37] offset:3072 sc1
    s_sub_u32 s25, s25, 1
    s_cbranch_scc0 Ftb_38
    s_branch M_end
Ft1_33:
    s_mul_i32 s50, s24, 4096
    v_add_u32 v8, s50, v2
    s_add_u32 m0, s50, 0
    s_nop 0
    global_load_lds_dwordx4 v8, s[26:27] offset:0
    global_load_lds_dwordx4 v8, s[26:27] offset:1024
    global_load_lds_dwordx4 v8, s[26:27] offset:2048
    global_load_lds_dwordx4 v8, s[26:27] offset:3072
    global_load_dwordx4 v[16:19], v2, s[28:29] offset:-4096 sc1 nt
    global_load_dwordx4 v[20:23], v2, s[28:29] offset:-3072 sc1 nt
    global_load_dwordx4 v[24:27], v2, s[28:29] offset:-2048 sc1 nt
    global_load_dwordx4 v[28:31], v2, s[28:29] offset:-1024 sc1 nt
    global_load_dwordx4 v[32:35], v2, s[28:29] offset:0 sc1 nt
    global_load_dwordx4 v[36:39], v2, s[28:29] offset:1024 sc1 nt
    global_load_dwordx4 v[40:43], v2, s[28:29] offset:2048 sc1 nt
    global_load_dwordx4 v[44:47], v2, s[28:29] offset:3072 sc1 nt
    global_load_dwordx4 v[48:51], v5, s[28:29] offset:-4096 sc1 nt
    global_load_dwordx4 v[52:55], v5, s[28:29] offset:-3072 sc1 nt
    global_load_dwordx4 v[56:59], v5, s[28:29] offset:-2048 sc1 nt
    global_load_dwordx4 v[60:63], v5, s[28:29] offset:-1024 sc1 nt
    global_load_dwordx4 v[64:67], v5, s[28:29] offset:0 sc1 nt
    global_load_dwordx4 v[68:71], v5, s[28:29] offset:1024 sc1 nt
    s_add_u32 s28, s28, 28672
    s_addc_u32 s29, s29, 0
    global_load_dwordx4 v[72:75], v2, s[28:29] offset:-4096 sc1 nt
    global_load_dwordx4 v[76:79], v2, s[28:29] offset:-3072 sc1 nt
    global_load_dwordx4 v[80:83], v2, s[28:29] offset:-2048 sc1 nt
    global_load_dwordx4 v[84:87], v2, s[28:29] offset:-1024 sc1 nt
    global_load_dwordx4 v[88:91], v2, s[28:29] offset:0 sc1 nt
    global_load_dwordx4 v[92:95], v2, s[28:29] offset:1024 sc1 nt
    global_load_dwordx4 v[96:99], v2, s[28:29] offset:2048 sc1 nt
    global_load_dwordx4 v[100:103], v2, s[28:29] offset:3072 sc1 nt
    global_load_dwordx4 v[104:107], v5, s[28:29] offset:-4096 sc1 nt
    global_load_dwordx4 v[108:111], v5, s[28:29] offset:-3072 sc1 nt
    global_load_dwordx4 v[112:115], v5, s[28:29] offset:-2048 sc1 nt
    global_load_dwordx4 v[116:119], v5, s[28:29] offset:-1024 sc1 nt
    global_load_dwordx4 v[120:123], v5, s[28:29] offset:0 sc1 nt
    global_load_dwordx4 v[124:127], v5, s[28:29] offset:1024 sc1 nt
    global_load_dwordx4 v[176:179], v2, s[32:33] offset:-4096 sc1
    global_load_dwordx4 v[180:183], v2, s[32:33] offset:-2048 sc1
    global_load_dwordx4 v[184:187], v2, s[32:33] offset:-3072 sc1
    global_load_dwordx4 v[188:191], v2, s[32:33] offset:-1024 sc1
    global_load_dwordx4 v[192:195], v2, s[32:33] offset:0 sc1
    global_load_dwordx4 v[196:199], v2, s[32:33] offset:2048 sc1
    global_load_dwordx4 v[200:203], v2, s[32:33] offset:1024 sc1
    global_load_dwordx4 v[204:207], v2, s[32:33] offset:3072 sc1
    global_load_dwordx4 v[208:211], v5, s[32:33] offset:-4096 sc1
    global_load_dwordx4 v[212:215], v5, s[32:33] offset:-2048 sc1
    global_load_dwordx4 v[216:219], v5, s[32:33] offset:-3072 sc1
    global_load_dwordx4 v[220:223], v5, s[32:33] offset:-1024 sc1
    global_load_dwordx4 v[224:227], v5, s[32:33] offset:0 sc1
    global_load_dwordx4 v[228:231], v5, s[32:33] offset:2048 sc1
    global_load_dwordx4 v[232:235], v5, s[32:33] offset:1024 sc1
    global_load_dwordx4 v[236:239], v5, s[32:33] offset:3072 sc1
    global_load_dwordx4 v[240:243], v6, s[32:33] offset:-4096 sc1
    global_load_dwordx4 v[244:247], v6, s[32:33] offset:-2048 sc1
    global_load_dwordx4 v[248:251], v2, s[34:35] offset:0 sc1 nt
    global_load_dwordx4 v[252:255], v2, s[34:35] offset:2048 sc1 nt
    s_waitcnt vmcnt(48)
    s_barrier
    ds_read_b128 v[152:155], v2 offset:0
    ds_read_b128 v[156:159], v2 offset:14336
    ds_read_b128 v[160:163], v2 offset:1024
    ds_read_b128 v[164:167], v2 offset:15360
    ds_read_b128 v[168:171], v2 offset:2048
    s_waitcnt vmcnt(20)
    ds_read_b128 v[172:175], v2 offset:16384
    s_waitcnt lgkmcnt(5)
    v_mfma_f32_16x16x32_f16 v[128:131], v[152:155], v[16:19], 0
    v_mfma_f32_16x16x32_f16 v[136:139], v[152:155], v[72:75], 0
    ds_read_b128 v[152:155], v2 offset:3072
    s_waitcnt lgkmcnt(5)
    v_mfma_f32_16x16x32_f16 v[132:135], v[156:159], v[16:19], 0
    v_mfma_f32_16x16x32_f16 v[140:143], v[156:159], v[72:75], 0
    ds_read_b128 v[156:159], v2 offset:17408
    s_waitcnt lgkmcnt(5)
    v_mfma_f32_16x16x32_f16 v[128:131], v[160:163], v[20:23], v[128:131]
    v_mfma_f32_16x16x32_f16 v[136:139], v[160:163], v[76:79], v[136:139]
    ds_read_b128 v[160:163], v2 offset:4096
    s_waitcnt lgkmcnt(5)
    v_mfma_f32_16x16x32_f16 v[132:135], v[164:167], v[20:23], v[132:135]
    v_mfma_f32_16x16x32_f16 v[140:143], v[164:167], v[76:79], v[140:143]
    ds_read_b128 v[164:167], v2 offset:18432
    s_waitcnt lgkmcnt(5)
    v_mfma_f32_16x16x32_f16 v[128:131], v[168:171], v[24:27], v[128:131]
    v_mfma_f32_16x16x32_f16 v[136:139], v[168:171], v[80:83], v[136:139]
    ds_read_b128 v[168:171], v2 offset:5120
    s_waitcnt lgkmcnt(5)
    v_mfma_f32_16x16x32_f16 v[132:135], v[172:175], v[24:27], v[132:135]
    v_mfma_f32_16x16x32_f16 v[140:143], v[172:175], v[80:83], v[140:143]
    ds_read_b128 v[172:175], v2 offset:19456
    s_waitcnt lgkmcnt(5)
    v_mfma_f32_16x16x32_f16 v[128:131], v[152:155], v[28:31], v[128:131]
    v_mfma_f32_16x16x32_f16 v[136:139], v[152:155], v[84:87], v[136:139]
    ds_read_b128 v[152:155], v2 offset:6144
    s_waitcnt lgkmcnt(5)
    v_mfma_f32_16x16x32_f16 v[132:135], v[156:159], v[28:31], v[132:135]
    v_mfma_f32_16x16x32_f16 v[140:143], v[156:159], v[84:87], v[140:143]
    ds_read_b128 v[156:159], v2 offset:20480
    s_waitcnt lgkmcnt(5)
    v_mfma_f32_16x16x32_f16 v[128:131], v[160:163], v[32:35], v[128:131]
    v_mfma_f32_16x16x32_f16 v[136:139], v[160:163], v[88:91], v[136:139]
    ds_read_b128 v[160:163], v2 offset:7168
    s_waitcnt lgkmcnt(5)
    v_mfma_f32_16x16x32_f16 v[132:135], v[164:167], v[32:35], v[132:135]
    v_mfma_f32_16x16x32_f16 v[140:143], v[164:167], v[88:91], v[140:143]
    ds_read_b128 v[164:167], v2 offset:21504
    s_waitcnt lgkmcnt(5)
    v_mfma_f32_16x16x32_f16 v[128:131], v[168:171], v[36:39], v[128:131]
    v_mfma_f32_16x16x32_f16 v[136:139], v[168:171], v[92:95], v[136:139]
    ds_read_b128 v[168:171], v2 offset:8192
    s_waitcnt lgkmcnt(5)
    v_mfma_f32_16x16x32_f16 v[132:135], v[172:175], v[36:39], v[132:135]
    v_mfma_f32_16x16x32_f16 v[140:143], v[172:175], v[92:95], v[140:143]
    ds_read_b128 v[172:175], v2 offset:22528
    s_waitcnt lgkmcnt(5)
    v_mfma_f32_16x16x32_f16 v[128:131], v[152:155], v[40:43], v[128:131]
    v_mfma_f32_16x16x32_f16 v[136:139], v[152:155], v[96:99], v[136:139]
    ds_read_b128 v[152:155], v2 offset:9216
    s_waitcnt lgkmcnt(5)
    v_mfma_f32_16x16x32_f16 v[132:135], v[156:159], v[40:43], v[132:135]
    v_mfma_f32_16x16x32_f16 v[140:143], v[156:159], v[96:99], v[140:143]
    ds_read_b128 v[156:159], v2 offset:23552
    s_waitcnt lgkmcnt(5)
    v_mfma_f32_16x16x32_f16 v[128:131], v[160:163], v[44:47], v[128:131]
    v_mfma_f32_16x16x32_f16 v[136:139], v[160:163], v[100:103], v[136:139]
    ds_read_b128 v[160:163], v2 offset:10240
    s_waitcnt lgkmcnt(5)
    v_mfma_f32_16x16x32_f16 v[132:135], v[164:167], v[44:47], v[132:135]
    v_mfma_f32_16x16x32_f16 v[140:143], v[164:167], v[100:103], v[140:143]
    ds_read_b128 v[164:167], v2 offset:24576
    s_waitcnt lgkmcnt(5)
    v_mfma_f32_16x16x32_f16 v[128:131], v[168:171], v[48:51], v[128:131]
    v_mfma_f32_16x16x32_f16 v[136:139], v[168:171], v[104:107], v[136:139]
    ds_read_b128 v[168:171], v2 offset:11264
    s_waitcnt lgkmcnt(5)
    v_mfma_f32_16x16x32_f16 v[132:135], v[172:175], v[48:51], v[132:135]
    v_mfma_f32_16x16x32_f16 v[140:143], v[172:175], v[104:107], v[140:143]
    ds_read_b128 v[172:175], v2 offset:25600
    s_waitcnt lgkmcnt(5)
    v_mfma_f32_16x16x32_f16 v[128:131], v[152:155], v[52:55], v[128:131]
    v_mfma_f32_16x16x32_f16 v[136:139], v[152:155], v[108:111], v[136:139]
    ds_read_b128 v[152:155], v2 offset:12288
    s_waitcnt lgkmcnt(5)
    v_mfma_f32_16x16x32_f16 v[132:135], v[156:159], v[52:55], v[132:135]
    v_mfma_f32_16x16x32_f16 v[140:143], v[156:159], v[108:111], v[140:143]
    ds_read_b128 v[156:159], v2 offset:26624
    s_waitcnt lgkmcnt(5)
    v_mfma_f32_16x16x32_f16 v[128:131], v[160:163], v[56:59], v[128:131]
    v_mfma_f32_16x16x32_f16 v[136:139], v[160:163], v[112:115], v[136:139]
    ds_read_b128 v[160:163], v2 offset:13312
    s_waitcnt lgkmcnt(5)
    v_mfma_f32_16x16x32_f16 v[132:135], v[164:167], v[56:59], v[132:135]
    v_mfma_f32_16x16x32_f16 v[140:143], v[164:167], v[112:115], v[140:143]
    ds_read_b128 v[164:167], v2 offset:27648
    s_waitcnt lgkmcnt(5)
    v_mfma_f32_16x16x32_f16 v[128:131], v[168:171], v[60:63], v[128:131]
    v_mfma_f32_16x16x32_f16 v[136:139], v[168:171], v[116:119], v[136:139]
    s_waitcnt lgkmcnt(4)
    v_mfma_f32_16x16x32_f16 v[132:135], v[172:175], v[60:63], v[132:135]
    v_mfma_f32_16x16x32_f16 v[140:143], v[172:175], v[116:119], v[140:143]
    s_waitcnt lgkmcnt(3)
    v_mfma_f32_16x16x32_f16 v[128:131], v[152:155], v[64:67], v[128:131]
    v_mfma_f32_16x16x32_f16 v[136:139], v[152:155], v[120:123], v[136:139]
    s_waitcnt lgkmcnt(2)
    v_mfma_f32_16x16x32_f16 v[132:135], v[156:159], v[64:67], v[132:135]
    v_mfma_f32_16x16x32_f16 v[140:143], v[156:159], v[120:123], v[140:143]
    s_waitcnt lgkmcnt(1)
    v_mfma_f32_16x16x32_f16 v[128:131], v[160:163], v[68:71], v[128:131]
    v_mfma_f32_16x16x32_f16 v[136:139], v[160:163], v[124:127], v[136:139]
    s_waitcnt lgkmcnt(0)
    v_mfma_f32_16x16x32_f16 v[132:135], v[164:167], v[68:71], v[132:135]
    v_mfma_f32_16x16x32_f16 v[140:143], v[164:167], v[124:127], v[140:143]
    v_mov_b32 v8, 0xff800000
    s_nop 5
    v_cndmask_b32 v132, v8, v132, s[40:41]
    v_cndmask_b32 v133, v8, v133, s[42:43]
    v_cndmask_b32 v134, v8, v134, s[44:45]
    v_cndmask_b32 v135, v8, v135, s[46:47]
    v_cndmask_b32 v140, v8, v140, s[40:41]
    v_cndmask_b32 v141, v8, v141, s[42:43]
    v_cndmask_b32 v142, v8, v142, s[44:45]
    v_cndmask_b32 v143, v8, v143, s[46:47]
    v_max_f32 v13, v128, v129
    v_max_f32 v0, v136, v137
    v_max3_f32 v13, v13, v130, v131
    v_max3_f32 v0, v0, v138, v139
    v_max3_f32 v13, v13, v132, v133
    v_max3_f32 v0, v0, v140, v141
    v_max3_f32 v13, v13, v134, v135
    v_max3_f32 v0, v0, v142, v143
    s_cmp_ge_u32 s21, 63
    s_cbranch_scc1 Fmp_41
    s_cmp_lg_u32 s14, 7
    s_cbranch_scc1 Fgb_43
    v_mov_b32 v8, 0
Fg_42:
    global_load_dword v9, v8, s[52:53] sc1
    s_sub_u32 s25, s25, 1
    s_cbranch_scc1 M_end
    s_waitcnt vmcnt(0)
    v_cmp_eq_u32 vcc, -1, v9
    s_cbranch_vccnz Fg_42
Fgb_43:
    s_barrier
Fmp_41:
    global_load_dwordx4 v[8:11], v2, s[38:39] sc1
    s_sub_u32 s25, s25, 1
    s_cbranch_scc1 M_end
    s_waitcnt vmcnt(0)
    v_pk_maximum3_f16 v152, v8, v9, v10
    v_pk_maximum3_f16 v152, v152, v11, v11
    v_cmp_u_f16 vcc, v152, v152
    s_cbranch_vccnz Fmp_41
    ds_write_b128 v14, v[8:11]
Fd_28:
    s_waitcnt lgkmcnt(0)
    s_barrier
    ds_read_b128 v[152:155], v12 offset:0
    ds_read_b128 v[156:159], v12 offset:512
    ds_read_b128 v[160:163], v12 offset:1024
    ds_read_b128 v[164:167], v12 offset:1536
    ds_read_b128 v[168:171], v12 offset:2048
    ds_read_b128 v[172:175], v12 offset:2560
    s_waitcnt lgkmcnt(5)
    v_mfma_f32_16x16x32_f16 v[144:147], v[152:155], v[16:19], 0
    v_mfma_f32_16x16x32_f16 v[148:151], v[152:155], v[72:75], 0
    ds_read_b128 v[152:155], v12 offset:3072
    s_waitcnt lgkmcnt(5)
    v_mfma_f32_16x16x32_f16 v[144:147], v[156:159], v[20:23], v[144:147]
    v_mfma_f32_16x16x32_f16 v[148:151], v[156:159], v[76:79], v[148:151]
    ds_read_b128 v[156:159], v12 offset:3584
    s_waitcnt lgkmcnt(5)
    v_mfma_f32_16x16x32_f16 v[144:147], v[160:163], v[24:27], v[144:147]
    v_mfma_f32_16x16x32_f16 v[148:151], v[160:163], v[80:83], v[148:151]
    ds_read_b128 v[160:163], v12 offset:4096
    s_waitcnt lgkmcnt(5)
    v_mfma_f32_16x16x32_f16 v[144:147], v[164:167], v[28:31], v[144:147]
    v_mfma_f32_16x16x32_f16 v[148:151], v[164:167], v[84:87], v[148:151]
    ds_read_b128 v[164:167], v12 offset:4608
    s_waitcnt lgkmcnt(5)
    v_mfma_f32_16x16x32_f16 v[144:147], v[168:171], v[32:35], v[144:147]
    v_mfma_f32_16x16x32_f16 v[148:151], v[168:171], v[88:91], v[148:151]
    ds_read_b128 v[168:171], v12 offset:5120
    s_waitcnt lgkmcnt(5)
    v_mfma_f32_16x16x32_f16 v[144:147], v[172:175], v[36:39], v[144:147]
    v_mfma_f32_16x16x32_f16 v[148:151], v[172:175], v[92:95], v[148:151]
    ds_read_b128 v[172:175], v12 offset:5632
    s_waitcnt lgkmcnt(5)
    v_mfma_f32_16x16x32_f16 v[144:147], v[152:155], v[40:43], v[144:147]
    v_mfma_f32_16x16x32_f16 v[148:151], v[152:155], v[96:99], v[148:151]
    ds_read_b128 v[152:155], v12 offset:6144
    s_waitcnt lgkmcnt(5)
    v_mfma_f32_16x16x32_f16 v[144:147], v[156:159], v[44:47], v[144:147]
    v_mfma_f32_16x16x32_f16 v[148:151], v[156:159], v[100:103], v[148:151]
    ds_read_b128 v[156:159], v12 offset:6656
    s_waitcnt lgkmcnt(5)
    v_mfma_f32_16x16x32_f16 v[144:147], v[160:163], v[48:51], v[144:147]
    v_mfma_f32_16x16x32_f16 v[148:151], v[160:163], v[104:107], v[148:151]
    s_waitcnt lgkmcnt(4)
    v_mfma_f32_16x16x32_f16 v[144:147], v[164:167], v[52:55], v[144:147]
    v_mfma_f32_16x16x32_f16 v[148:151], v[164:167], v[108:111], v[148:151]
    s_waitcnt lgkmcnt(3)
    v_mfma_f32_16x16x32_f16 v[144:147], v[168:171], v[56:59], v[144:147]
    v_mfma_f32_16x16x32_f16 v[148:151], v[168:171], v[112:115], v[148:151]
    s_waitcnt lgkmcnt(2)
    v_mfma_f32_16x16x32_f16 v[144:147], v[172:175], v[60:63], v[144:147]
    v_mfma_f32_16x16x32_f16 v[148:151], v[172:175], v[116:119], v[148:151]
    s_waitcnt lgkmcnt(1)
    v_mfma_f32_16x16x32_f16 v[144:147], v[152:155], v[64:67], v[144:147]
    v_mfma_f32_16x16x32_f16 v[148:151], v[152:155], v[120:123], v[148:151]
    s_waitcnt lgkmcnt(0)
    v_mfma_f32_16x16x32_f16 v[144:147], v[156:159], v[68:71], v[144:147]
    v_mfma_f32_16x16x32_f16 v[148:151], v[156:159], v[124:127], v[148:151]
    global_load_dwordx4 v[16:19], v6, s[32:33] offset:-3072 sc1
    global_load_dwordx4 v[20:23], v6, s[32:33] offset:-1024 sc1
    global_load_dwordx4 v[24:27], v6, s[32:33] offset:0 sc1
    global_load_dwordx4 v[28:31], v6, s[32:33] offset:2048 sc1
    global_load_dwordx4 v[32:35], v6, s[32:33] offset:1024 sc1
    global_load_dwordx4 v[36:39], v6, s[32:33] offset:3072 sc1
    global_load_dwordx4 v[40:43], v7, s[32:33] offset:-4096 sc1
    global_load_dwordx4 v[44:47], v7, s[32:33] offset:-2048 sc1
    global_load_dwordx4 v[48:51], v7, s[32:33] offset:-3072 sc1
    global_load_dwordx4 v[52:55], v7, s[32:33] offset:-1024 sc1
    global_load_dwordx4 v[56:59], v7, s[32:33] offset:0 sc1
    global_load_dwordx4 v[60:63], v7, s[32:33] offset:2048 sc1
    global_load_dwordx4 v[64:67], v7, s[32:33] offset:1024 sc1
    global_load_dwordx4 v[68:71], v7, s[32:33] offset:3072 sc1
    global_load_dwordx4 v[72:75], v2, s[36:37] offset:-4096 sc1
    global_load_dwordx4 v[76:79], v2, s[36:37] offset:-3072 sc1
    global_load_dwordx4 v[80:83], v2, s[36:37] offset:-2048 sc1
    global_load_dwordx4 v[84:87], v2, s[36:37] offset:-1024 sc1
    global_load_dwordx4 v[88:91], v2, s[36:37] offset:0 sc1
    global_load_dwordx4 v[92:95], v2, s[36:37] offset:1024 sc1
    global_load_dwordx4 v[96:99], v2, s[36:37] offset:2048 sc1
    global_load_dwordx4 v[100:103], v2, s[36:37] offset:3072 sc1
    s_lshl_b32 s50, s14, 11
    s_add_u32 s50, s50, 36864
    v_add_u32 v8, s50, v2
    s_lshr_b32 s50, s14, 1
    s_lshl_b32 s50, s50, 10
    s_and_b32 s51, s14, 1
    s_lshl_b32 s51, s51, 3
    s_add_u32 s50, s50, s51
    s_add_u32 s50, s50, 53248
    v_add_u32 v9, s50, v2
    v_max3_f32 v152, v13, v144, v145
    v_max3_f32 v153, v0, v148, v149
    v_mov_b32 v154, v152
    v_mov_b32 v155, v153
    s_nop 0
    v_permlane32_swap_b32 v152, v154
    v_permlane32_swap_b32 v153, v155
    v_max_f32 v152, v152, v154
    v_max_f32 v153, v153, v155
    v_mov_b32 v154, v152
    v_mov_b32 v155, v153
    s_nop 0
    v_permlane16_swap_b32 v152, v154
    v_permlane16_swap_b32 v153, v155
    v_max_f32 v152, v152, v154
    v_max_f32 v153, v153, v155
    v_sub_f32 v128, v128, v152
    v_sub_f32 v136, v136, v153
    v_sub_f32 v129, v129, v152
    v_sub_f32 v137, v137, v153
    v_sub_f32 v130, v130, v152
    v_sub_f32 v138, v138, v153
    v_sub_f32 v131, v131, v152
    v_sub_f32 v139, v139, v153
    v_sub_f32 v132, v132, v152
    v_sub_f32 v140, v140, v153
    v_sub_f32 v133, v133, v152
    v_sub_f32 v141, v141, v153
    v_sub_f32 v134, v134, v152
    v_sub_f32 v142, v142, v153
    v_sub_f32 v135, v135, v152
    v_sub_f32 v143, v143, v153
    v_sub_f32 v144, v144, v152
    v_sub_f32 v148, v148, v153
    v_sub_f32 v145, v145, v152
    v_sub_f32 v149, v149, v153
    v_exp_f32 v128, v128
    v_exp_f32 v136, v136
    v_exp_f32 v129, v129
    v_exp_f32 v137, v137
    v_exp_f32 v130, v130
    v_exp_f32 v138, v138
    v_exp_f32 v131, v131
    v_exp_f32 v139, v139
    v_exp_f32 v132, v132
    v_exp_f32 v140, v140
    v_exp_f32 v133, v133
    v_exp_f32 v141, v141
    v_exp_f32 v134, v134
    v_exp_f32 v142, v142
    v_exp_f32 v135, v135
    v_exp_f32 v143, v143
    v_exp_f32 v144, v144
    v_exp_f32 v148, v148
    v_exp_f32 v145, v145
    v_exp_f32 v149, v149
    v_add_f32 v152, v128, v129
    v_add_f32 v153, v136, v137
    v_add_f32 v152, v152, v130
    v_add_f32 v153, v153, v138
    v_add_f32 v152, v152, v131
    v_add_f32 v153, v153, v139
    v_add_f32 v152, v152, v132
    v_add_f32 v153, v153, v140
    v_add_f32 v152, v152, v133
    v_add_f32 v153, v153, v141
    v_add_f32 v152, v152, v134
    v_add_f32 v153, v153, v142
    v_add_f32 v152, v152, v135
    v_add_f32 v153, v153, v143
    v_add_f32 v152, v152, v144
    v_add_f32 v153, v153, v148
    v_add_f32 v152, v152, v145
    v_add_f32 v153, v153, v149
    v_mov_b32 v154, v152
    v_mov_b32 v155, v153
    s_nop 0
    v_permlane32_swap_b32 v152, v154
    v_permlane32_swap_b32 v153, v155
    v_add_f32 v152, v152, v154
    v_add_f32 v153, v153, v155
    v_mov_b32 v154, v152
    v_mov_b32 v155, v153
    s_nop 0
    v_permlane16_swap_b32 v152, v154
    v_permlane16_swap_b32 v153, v155
    v_add_f32 v152, v152, v154
    v_add_f32 v153, v153, v155
    v_rcp_f32 v152, v152
    v_rcp_f32 v153, v153
    v_mul_f32 v128, v128, v152
    v_mul_f32 v136, v136, v153
    v_mul_f32 v129, v129, v152
    v_mul_f32 v137, v137, v153
    v_mul_f32 v130, v130, v152
    v_mul_f32 v138, v138, v153
    v_mul_f32 v131, v131, v152
    v_mul_f32 v139, v139, v153
    v_mul_f32 v132, v132, v152
    v_mul_f32 v140, v140, v153
    v_mul_f32 v133, v133, v152
    v_mul_f32 v141, v141, v153
    v_mul_f32 v134, v134, v152
    v_mul_f32 v142, v142, v153
    v_mul_f32 v135, v135, v152
    v_mul_f32 v143, v143, v153
    v_mul_f32 v144, v144, v152
    v_mul_f32 v148, v148, v153
    v_mul_f32 v145, v145, v152
    v_mul_f32 v149, v149, v153
    v_cvt_pk_f16_f32 v156, v128, v129
    v_cvt_pk_f16_f32 v158, v130, v131
    v_cvt_pk_f16_f32 v157, v136, v137
    v_cvt_pk_f16_f32 v159, v138, v139
    ds_write_b128 v8, v[156:159] offset:0
    v_cvt_pk_f16_f32 v160, v132, v133
    v_cvt_pk_f16_f32 v162, v134, v135
    v_cvt_pk_f16_f32 v161, v140, v141
    v_cvt_pk_f16_f32 v163, v142, v143
    ds_write_b128 v8, v[160:163] offset:1024
    v_cvt_pk_f16_f32 v164, v144, v145
    v_cvt_pk_f16_f32 v165, v148, v149
    ds_write_b64 v9, v[164:165]
    s_waitcnt lgkmcnt(0)
    s_barrier
    s_cmp_eq_u32 s14, 7
    s_cbranch_scc1 Fend_32
    ds_read_b128 v[152:155], v2 offset:53248
    ds_read_b128 v[156:159], v2 offset:54272
    ds_read_b128 v[160:163], v2 offset:55296
    ds_read_b128 v[164:167], v2 offset:56320
    ds_read_b128 v[104:107], v2 offset:36864
    ds_read_b128 v[108:111], v2 offset:37888
    ds_read_b128 v[112:115], v2 offset:38912
    ds_read_b128 v[116:119], v2 offset:39936
    ds_read_b128 v[120:123], v2 offset:40960
    ds_read_b128 v[124:127], v2 offset:41984
    s_waitcnt lgkmcnt(5)
    v_mfma_f32_16x16x32_f16 v[248:251], v[176:179], v[104:107], v[248:251]
    v_mfma_f32_16x16x32_f16 v[252:255], v[180:183], v[104:107], v[252:255]
    ds_read_b128 v[104:107], v2 offset:43008
    s_waitcnt lgkmcnt(5)
    v_mfma_f32_16x16x32_f16 v[248:251], v[184:187], v[108:111], v[248:251]
    v_mfma_f32_16x16x32_f16 v[252:255], v[188:191], v[108:111], v[252:255]
    ds_read_b128 v[108:111], v2 offset:44032
    s_waitcnt lgkmcnt(5)
    v_mfma_f32_16x16x32_f16 v[248:251], v[192:195], v[112:115], v[248:251]
    v_mfma_f32_16x16x32_f16 v[252:255], v[196:199], v[112:115], v[252:255]
    ds_read_b128 v[112:115], v2 offset:45056
    s_waitcnt lgkmcnt(5)
    v_mfma_f32_16x16x32_f16 v[248:251], v[200:203], v[116:119], v[248:251]
    v_mfma_f32_16x16x32_f16 v[252:255], v[204:207], v[116:119], v[252:255]
    ds_read_b128 v[116:119], v2 offset:46080
    s_waitcnt lgkmcnt(5)
    v_mfma_f32_16x16x32_f16 v[248:251], v[208:211], v[120:123], v[248:251]
    v_mfma_f32_16x16x32_f16 v[252:255], v[212:215], v[120:123], v[252:255]
    ds_read_b128 v[120:123], v2 offset:47104
    s_waitcnt lgkmcnt(5)
    v_mfma_f32_16x16x32_f16 v[248:251], v[216:219], v[124:127], v[248:251]
    v_mfma_f32_16x16x32_f16 v[252:255], v[220:223], v[124:127], v[252:255]
    ds_read_b128 v[124:127], v2 offset:48128
    s_waitcnt lgkmcnt(5)
    v_mfma_f32_16x16x32_f16 v[248:251], v[224:227], v[104:107], v[248:251]
    v_mfma_f32_16x16x32_f16 v[252:255], v[228:231], v[104:107], v[252:255]
    ds_read_b128 v[104:107], v2 offset:49152
    s_waitcnt lgkmcnt(5)
    v_mfma_f32_16x16x32_f16 v[248:251], v[232:235], v[108:111], v[248:251]
    v_mfma_f32_16x16x32_f16 v[252:255], v[236:239], v[108:111], v[252:255]
    ds_read_b128 v[108:111], v2 offset:50176
    s_waitcnt lgkmcnt(5)
    v_mfma_f32_16x16x32_f16 v[248:251], v[240:243], v[112:115], v[248:251]
    v_mfma_f32_16x16x32_f16 v[252:255], v[244:247], v[112:115], v[252:255]
    ds_read_b128 v[112:115], v2 offset:51200
    s_waitcnt lgkmcnt(5)
    s_waitcnt vmcnt(20)
    v_mfma_f32_16x16x32_f16 v[248:251], v[16:19], v[116:119], v[248:251]
    v_mfma_f32_16x16x32_f16 v[252:255], v[20:23], v[116:119], v[252:255]
    ds_read_b128 v[116:119], v2 offset:52224
    s_waitcnt lgkmcnt(5)
    s_waitcnt vmcnt(18)
    v_mfma_f32_16x16x32_f16 v[248:251], v[24:27], v[120:123], v[248:251]
    v_mfma_f32_16x16x32_f16 v[252:255], v[28:31], v[120:123], v[252:255]
    s_waitcnt lgkmcnt(4)
    s_waitcnt vmcnt(16)
    v_mfma_f32_16x16x32_f16 v[248:251], v[32:35], v[124:127], v[248:251]
    v_mfma_f32_16x16x32_f16 v[252:255], v[36:39], v[124:127], v[252:255]
    s_waitcnt lgkmcnt(3)
    s_waitcnt vmcnt(14)
    v_mfma_f32_16x16x32_f16 v[248:251], v[40:43], v[104:107], v[248:251]
    v_mfma_f32_16x16x32_f16 v[252:255], v[44:47], v[104:107], v[252:255]
    s_waitcnt lgkmcnt(2)
    s_waitcnt vmcnt(12)
    v_mfma_f32_16x16x32_f16 v[248:251], v[48:51], v[108:111], v[248:251]
    v_mfma_f32_16x16x32_f16 v[252:255], v[52:55], v[108:111], v[252:255]
    s_waitcnt lgkmcnt(1)
    s_waitcnt vmcnt(10)
    v_mfma_f32_16x16x32_f16 v[248:251], v[56:59], v[112:115], v[248:251]
    v_mfma_f32_16x16x32_f16 v[252:255], v[60:63], v[112:115], v[252:255]
    s_waitcnt lgkmcnt(0)
    s_waitcnt vmcnt(8)
    v_mfma_f32_16x16x32_f16 v[248:251], v[64:67], v[116:119], v[248:251]
    v_mfma_f32_16x16x32_f16 v[252:255], v[68:71], v[116:119], v[252:255]
Ftb_45:
    s_waitcnt vmcnt(0)
    v_mfma_f32_16x16x32_f16 v[128:131], v[72:75], v[152:155], v[248:251]
    v_mfma_f32_16x16x32_f16 v[132:135], v[88:91], v[152:155], v[252:255]
    v_mfma_f32_16x16x32_f16 v[128:131], v[76:79], v[156:159], v[128:131]
    v_mfma_f32_16x16x32_f16 v[132:135], v[92:95], v[156:159], v[132:135]
    v_mfma_f32_16x16x32_f16 v[128:131], v[80:83], v[160:163], v[128:131]
    v_mfma_f32_16x16x32_f16 v[132:135], v[96:99], v[160:163], v[132:135]
    v_mfma_f32_16x16x32_f16 v[128:131], v[84:87], v[164:167], v[128:131]
    v_mfma_f32_16x16x32_f16 v[132:135], v[100:103], v[164:167], v[132:135]
    s_nop 6
    v_pk_add_f32 v[8:9], v[128:129], v[130:131]
    v_pk_add_f32 v[10:11], v[132:133], v[134:135]
    v_pk_add_f32 v[8:9], v[8:9], v[10:11]
    v_cmp_u_f32 vcc, v8, v9
    v_cvt_pk_bf16_f32 v8, v128, v129
    v_cvt_pk_bf16_f32 v9, v130, v131
    v_cvt_pk_bf16_f32 v10, v132, v133
    v_cvt_pk_bf16_f32 v11, v134, v135
    s_cbranch_vccnz Ftr_46
Fts_47:
    global_store_dwordx4 v15, v[8:11], s[48:49]
    s_cmp_lt_u32 s55, 0x2d0
    s_cbranch_scc1 Fend_32
    s_endpgm
Ftr_46:
    global_load_dwordx4 v[72:75], v2, s[36:37] offset:-4096 sc1
    global_load_dwordx4 v[76:79], v2, s[36:37] offset:-3072 sc1
    global_load_dwordx4 v[80:83], v2, s[36:37] offset:-2048 sc1
    global_load_dwordx4 v[84:87], v2, s[36:37] offset:-1024 sc1
    global_load_dwordx4 v[88:91], v2, s[36:37] offset:0 sc1
    global_load_dwordx4 v[92:95], v2, s[36:37] offset:1024 sc1
    global_load_dwordx4 v[96:99], v2, s[36:37] offset:2048 sc1
    global_load_dwordx4 v[100:103], v2, s[36:37] offset:3072 sc1
    s_sub_u32 s25, s25, 1
    s_cbranch_scc0 Ftb_45
    s_branch M_end
Fend_32:
    s_cmp_ge_u32 s55, 0x2d0
    s_cbranch_scc1 M_end
    s_waitcnt vmcnt(0)
    s_branch M_next
M_d4:
    s_add_u32 s21, s20, 240
    s_lshr_b32 s21, s21, 3
    s_bfe_u32 s22, s20, 0x10002
    s_and_b32 s23, s20, 3
    s_mov_b32 s25, 0x400000
    s_min_u32 s24, s14, 6
    s_mul_i32 s23, s23, 7
    s_add_u32 s23, s23, s24
    s_mul_i32 s26, s21, 28672
    s_add_u32 s26, s26, 0x0
    s_add_u32 s26, s4, s26
    s_addc_u32 s27, s5, 0
    s_lshl_b32 s28, s21, 4
    s_lshl_b32 s29, s14, 1
    s_add_u32 s28, s28, s29
    s_lshl_b32 s28, s28, 1
    s_add_u32 s28, s28, s22
    s_mul_i32 s28, s28, 14336
    s_add_u32 s28, s28, 0x2d11000
    s_add_u32 s28, s4, s28
    s_addc_u32 s29, s5, 0
    s_mul_i32 s30, s21, 28
    s_add_u32 s30, s30, s23
    s_lshr_b32 s32, s30, 1
    s_lshl_b32 s32, s32, 15
    s_and_b32 s31, s30, 1
    s_lshl_b32 s33, s31, 11
    s_add_u32 s32, s32, s33
    s_add_u32 s32, s32, 0x1111000
    s_add_u32 s32, s4, s32
    s_addc_u32 s33, s5, 0
    s_lshl_b32 s34, s30, 1
    s_add_u32 s34, s34, s22
    s_lshl_b32 s34, s34, 10
    s_add_u32 s34, s34, 0x5010000
    s_add_u32 s34, s4, s34
    s_addc_u32 s35, s5, 0
    s_lshl_b32 s36, s30, 12
    s_add_u32 s36, s36, 0x542d000
    s_add_u32 s36, s4, s36
    s_addc_u32 s37, s5, 0
    s_lshl_b32 s38, s21, 13
    s_lshl_b32 s39, s24, 10
    s_add_u32 s38, s38, s39
    s_add_u32 s38, s38, 0x5390000
    s_add_u32 s39, s39, 28672
    v_add_u32 v14, s39, v2
    s_add_u32 s38, s4, s38
    s_addc_u32 s39, s5, 0
    s_add_u32 s52, s21, 2
    s_min_u32 s52, s52, 63
    s_lshl_b32 s52, s52, 13
    s_add_u32 s52, s52, 0x5390000
    s_add_u32 s52, s4, s52
    s_addc_u32 s53, s5, 0
    s_lshl_b32 s48, s21, 1
    s_add_u32 s48, s48, s22
    s_mul_i32 s48, s48, 14336
    s_lshr_b32 s49, s23, 1
    s_lshl_b32 s49, s49, 6
    s_add_u32 s48, s48, s49
    s_lshl_b32 s49, s31, 3
    s_add_u32 s48, s48, s49
    s_add_u32 s48, s8, s48
    s_addc_u32 s49, s9, 0
    v_mul_u32_u24 v15, 896, v4
    v_lshl_add_u32 v15, v3, 4, v15
    v_add_u32 v5, 8192, v2
    v_add_u32 v6, 16384, v2
    v_add_u32 v7, 24576, v2
    v_lshrrev_b32 v12, 2, v4
    v_lshlrev_b32 v12, 1, v12
    v_and_b32 v13, 1, v4
    v_add_u32 v12, v12, v13
    v_lshlrev_b32 v12, 4, v12
    v_lshl_add_u32 v12, v3, 7, v12
    v_add_u32 v12, 28672, v12
    v_lshlrev_b32 v13, 2, v3
    v_sub_u32 v13, v4, v13
    v_cmp_le_i32 s[40:41], 0, v13
    v_cmp_le_i32 s[42:43], 1, v13
    v_cmp_le_i32 s[44:45], 2, v13
    v_cmp_le_i32 s[46:47], 3, v13
    s_cmp_lg_u32 s14, 3
    s_cbranch_scc1 M1_fg
    s_mul_i32 s50, s21, 373
    s_lshr_b32 s50, s50, 10
    s_add_u32 s50, s50, 34
    s_lshl_b32 s50, s50, 13
    s_add_u32 s50, s50, 0x5390000
    s_add_u32 s50, s4, s50
    s_addc_u32 s51, s5, 0
    v_mov_b32 v8, 128
M1_fgl:
    global_load_dword v9, v8, s[50:51] sc1
    s_sub_u32 s25, s25, 1
    s_cbranch_scc1 M_end
    s_waitcnt vmcnt(0)
    v_cmp_eq_u32 vcc, -1, v9
    s_cbranch_vccnz M1_fgl
    v_mov_b32 v8, 12
    global_load_dword v9, v8, s[10:11] sc1
    v_mov_b32 v8, 161836
    s_waitcnt vmcnt(0)
    ds_write_b32 v8, v9
    s_waitcnt lgkmcnt(0)
M1_fg:
    s_cmp_gt_u32 s14, 2
    s_cbranch_scc1 M1_fw
    s_cmp_eq_u32 s14, 2
    s_cbranch_scc1 M1_fw2
    s_lshl_b32 s50, s21, 1
    s_add_u32 s50, s50, s14
    s_lshl_b32 s50, s50, 10
    s_add_u32 s50, s50, 0x5b6c000
    s_add_u32 s50, s4, s50
    s_addc_u32 s51, s5, 0
    v_min_u32 v20, 55, v1
    v_lshlrev_b32 v20, 4, v20
WU_51:
    global_load_dwordx4 v[16:19], v20, s[50:51] sc1
    s_sub_u32 s25, s25, 1
    s_cbranch_scc1 M_end
    s_waitcnt vmcnt(0)
    v_xor_b32 v16, s19, v16
    v_bitop3_b32 v16, v16, v17, s19 bitop3:0xf6
    v_bitop3_b32 v16, v16, v18, s19 bitop3:0xf6
    v_bitop3_b32 v16, v16, v19, s19 bitop3:0xf6
    v_cmp_ne_u32 vcc, 0, v16
    s_cbranch_vccnz WU_51
    s_branch M1_fw
M1_fw2:
    s_lshr_b32 s50, s21, 1
    s_and_b32 s51, s50, 3
    s_lshr_b32 s50, s50, 2
    s_lshl_b32 s50, s50, 3
    s_add_u32 s50, s50, s51
    s_lshl_b32 s50, s50, 2
    s_add_u32 s50, s50, 16
    v_mov_b32 v8, s50
WC_52:
    global_load_dword v9, v8, s[10:11] sc1
    s_sub_u32 s25, s25, 1
    s_cbranch_scc1 M_end
    s_waitcnt vmcnt(0)
    v_cmp_gt_u32 vcc, 7, v9
    s_cbranch_vccnz WC_52
M1_fw:
    s_barrier
    v_mov_b32 v8, 161836
    ds_read_b32 v9, v8
    s_waitcnt lgkmcnt(0)
    v_readfirstlane_b32 s55, v9
    s_cmp_eq_u32 s22, 1
    s_cbranch_scc1 Ft1_54
    s_mul_i32 s50, s24, 2048
    v_add_u32 v8, s50, v2
    s_add_u32 m0, s50, 0
    s_nop 0
    global_load_lds_dwordx4 v8, s[26:27] offset:0
    global_load_lds_dwordx4 v8, s[26:27] offset:1024
    global_load_dwordx4 v[16:19], v2, s[28:29] offset:-4096 sc1 nt
    global_load_dwordx4 v[20:23], v2, s[28:29] offset:-3072 sc1 nt
    global_load_dwordx4 v[24:27], v2, s[28:29] offset:-2048 sc1 nt
    global_load_dwordx4 v[28:31], v2, s[28:29] offset:-1024 sc1 nt
    global_load_dwordx4 v[32:35], v2, s[28:29] offset:0 sc1 nt
    global_load_dwordx4 v[36:39], v2, s[28:29] offset:1024 sc1 nt
    global_load_dwordx4 v[40:43], v2, s[28:29] offset:2048 sc1 nt
    global_load_dwordx4 v[44:47], v2, s[28:29] offset:3072 sc1 nt
    global_load_dwordx4 v[48:51], v5, s[28:29] offset:-4096 sc1 nt
    global_load_dwordx4 v[52:55], v5, s[28:29] offset:-3072 sc1 nt
    global_load_dwordx4 v[56:59], v5, s[28:29] offset:-2048 sc1 nt
    global_load_dwordx4 v[60:63], v5, s[28:29] offset:-1024 sc1 nt
    global_load_dwordx4 v[64:67], v5, s[28:29] offset:0 sc1 nt
    global_load_dwordx4 v[68:71], v5, s[28:29] offset:1024 sc1 nt
    s_add_u32 s28, s28, 28672
    s_addc_u32 s29, s29, 0
    global_load_dwordx4 v[72:75], v2, s[28:29] offset:-4096 sc1 nt
    global_load_dwordx4 v[76:79], v2, s[28:29] offset:-3072 sc1 nt
    global_load_dwordx4 v[80:83], v2, s[28:29] offset:-2048 sc1 nt
    global_load_dwordx4 v[84:87], v2, s[28:29] offset:-1024 sc1 nt
    global_load_dwordx4 v[88:91], v2, s[28:29] offset:0 sc1 nt
    global_load_dwordx4 v[92:95], v2, s[28:29] offset:1024 sc1 nt
    global_load_dwordx4 v[96:99], v2, s[28:29] offset:2048 sc1 nt
    global_load_dwordx4 v[100:103], v2, s[28:29] offset:3072 sc1 nt
    global_load_dwordx4 v[104:107], v5, s[28:29] offset:-4096 sc1 nt
    global_load_dwordx4 v[108:111], v5, s[28:29] offset:-3072 sc1 nt
    global_load_dwordx4 v[112:115], v5, s[28:29] offset:-2048 sc1 nt
    global_load_dwordx4 v[116:119], v5, s[28:29] offset:-1024 sc1 nt
    global_load_dwordx4 v[120:123], v5, s[28:29] offset:0 sc1 nt
    global_load_dwordx4 v[124:127], v5, s[28:29] offset:1024 sc1 nt
    global_load_dwordx4 v[176:179], v2, s[32:33] offset:-4096 sc1
    global_load_dwordx4 v[180:183], v2, s[32:33] offset:0 sc1
    global_load_dwordx4 v[184:187], v5, s[32:33] offset:-4096 sc1
    global_load_dwordx4 v[188:191], v5, s[32:33] offset:0 sc1
    global_load_dwordx4 v[192:195], v6, s[32:33] offset:-4096 sc1
    global_load_dwordx4 v[196:199], v6, s[32:33] offset:0 sc1
    global_load_dwordx4 v[200:203], v7, s[32:33] offset:-4096 sc1
    global_load_dwordx4 v[204:207], v7, s[32:33] offset:0 sc1
    global_load_dwordx4 v[248:251], v2, s[34:35] offset:0 sc1 nt
    s_waitcnt vmcnt(37)
    s_barrier
    ds_read_b128 v[152:155], v2 offset:0
    ds_read_b128 v[156:159], v2 offset:1024
    ds_read_b128 v[160:163], v2 offset:2048
    ds_read_b128 v[164:167], v2 offset:3072
    ds_read_b128 v[168:171], v2 offset:4096
    s_waitcnt vmcnt(9)
    ds_read_b128 v[172:175], v2 offset:5120
    s_waitcnt lgkmcnt(5)
    v_mfma_f32_16x16x32_f16 v[128:131], v[152:155], v[16:19], 0
    v_mfma_f32_16x16x32_f16 v[136:139], v[152:155], v[72:75], 0
    ds_read_b128 v[152:155], v2 offset:6144
    s_waitcnt lgkmcnt(5)
    v_mfma_f32_16x16x32_f16 v[128:131], v[156:159], v[20:23], v[128:131]
    v_mfma_f32_16x16x32_f16 v[136:139], v[156:159], v[76:79], v[136:139]
    ds_read_b128 v[156:159], v2 offset:7168
    s_waitcnt lgkmcnt(5)
    v_mfma_f32_16x16x32_f16 v[128:131], v[160:163], v[24:27], v[128:131]
    v_mfma_f32_16x16x32_f16 v[136:139], v[160:163], v[80:83], v[136:139]
    ds_read_b128 v[160:163], v2 offset:8192
    s_waitcnt lgkmcnt(5)
    v_mfma_f32_16x16x32_f16 v[128:131], v[164:167], v[28:31], v[128:131]
    v_mfma_f32_16x16x32_f16 v[136:139], v[164:167], v[84:87], v[136:139]
    ds_read_b128 v[164:167], v2 offset:9216
    s_waitcnt lgkmcnt(5)
    v_mfma_f32_16x16x32_f16 v[128:131], v[168:171], v[32:35], v[128:131]
    v_mfma_f32_16x16x32_f16 v[136:139], v[168:171], v[88:91], v[136:139]
    ds_read_b128 v[168:171], v2 offset:10240
    s_waitcnt lgkmcnt(5)
    v_mfma_f32_16x16x32_f16 v[128:131], v[172:175], v[36:39], v[128:131]
    v_mfma_f32_16x16x32_f16 v[136:139], v[172:175], v[92:95], v[136:139]
    ds_read_b128 v[172:175], v2 offset:11264
    s_waitcnt lgkmcnt(5)
    v_mfma_f32_16x16x32_f16 v[128:131], v[152:155], v[40:43], v[128:131]
    v_mfma_f32_16x16x32_f16 v[136:139], v[152:155], v[96:99], v[136:139]
    ds_read_b128 v[152:155], v2 offset:12288
    s_waitcnt lgkmcnt(5)
    v_mfma_f32_16x16x32_f16 v[128:131], v[156:159], v[44:47], v[128:131]
    v_mfma_f32_16x16x32_f16 v[136:139], v[156:159], v[100:103], v[136:139]
    ds_read_b128 v[156:159], v2 offset:13312
    s_waitcnt lgkmcnt(5)
    v_mfma_f32_16x16x32_f16 v[128:131], v[160:163], v[48:51], v[128:131]
    v_mfma_f32_16x16x32_f16 v[136:139], v[160:163], v[104:107], v[136:139]
    s_waitcnt lgkmcnt(4)
    v_mfma_f32_16x16x32_f16 v[128:131], v[164:167], v[52:55], v[128:131]
    v_mfma_f32_16x16x32_f16 v[136:139], v[164:167], v[108:111], v[136:139]
    s_waitcnt lgkmcnt(3)
    v_mfma_f32_16x16x32_f16 v[128:131], v[168:171], v[56:59], v[128:131]
    v_mfma_f32_16x16x32_f16 v[136:139], v[168:171], v[112:115], v[136:139]
    s_waitcnt lgkmcnt(2)
    v_mfma_f32_16x16x32_f16 v[128:131], v[172:175], v[60:63], v[128:131]
    v_mfma_f32_16x16x32_f16 v[136:139], v[172:175], v[116:119], v[136:139]
    s_waitcnt lgkmcnt(1)
    v_mfma_f32_16x16x32_f16 v[128:131], v[152:155], v[64:67], v[128:131]
    v_mfma_f32_16x16x32_f16 v[136:139], v[152:155], v[120:123], v[136:139]
    s_waitcnt lgkmcnt(0)
    v_mfma_f32_16x16x32_f16 v[128:131], v[156:159], v[68:71], v[128:131]
    v_mfma_f32_16x16x32_f16 v[136:139], v[156:159], v[124:127], v[136:139]
    v_mov_b32 v8, 0xff800000
    s_nop 5
    v_cndmask_b32 v128, v8, v128, s[40:41]
    v_cndmask_b32 v129, v8, v129, s[42:43]
    v_cndmask_b32 v130, v8, v130, s[44:45]
    v_cndmask_b32 v131, v8, v131, s[46:47]
    v_cndmask_b32 v136, v8, v136, s[40:41]
    v_cndmask_b32 v137, v8, v137, s[42:43]
    v_cndmask_b32 v138, v8, v138, s[44:45]
    v_cndmask_b32 v139, v8, v139, s[46:47]
    v_max_f32 v13, v128, v129
    v_max_f32 v0, v136, v137
    v_max3_f32 v13, v13, v130, v131
    v_max3_f32 v0, v0, v138, v139
    v_mov_b32 v154, v13
    v_mov_b32 v155, v0
    s_nop 0
    v_permlane32_swap_b32 v13, v154
    v_permlane32_swap_b32 v0, v155
    v_max_f32 v13, v13, v154
    v_max_f32 v0, v0, v155
    v_mov_b32 v154, v13
    v_mov_b32 v155, v0
    s_nop 0
    v_permlane16_swap_b32 v13, v154
    v_permlane16_swap_b32 v0, v155
    v_max_f32 v13, v13, v154
    v_max_f32 v0, v0, v155
    v_sub_f32 v128, v128, v13
    v_sub_f32 v136, v136, v0
    v_sub_f32 v129, v129, v13
    v_sub_f32 v137, v137, v0
    v_sub_f32 v130, v130, v13
    v_sub_f32 v138, v138, v0
    v_sub_f32 v131, v131, v13
    v_sub_f32 v139, v139, v0
    v_exp_f32 v128, v128
    v_exp_f32 v136, v136
    v_exp_f32 v129, v129
    v_exp_f32 v137, v137
    v_exp_f32 v130, v130
    v_exp_f32 v138, v138
    v_exp_f32 v131, v131
    v_exp_f32 v139, v139
    v_add_f32 v252, v128, v129
    v_add_f32 v253, v136, v137
    v_add_f32 v252, v252, v130
    v_add_f32 v253, v253, v138
    v_add_f32 v252, v252, v131
    v_add_f32 v253, v253, v139
    s_cmp_eq_u32 s21, 63
    s_cbranch_scc1 Fl_58
    s_cmp_ge_u32 s21, 61
    s_cbranch_scc1 Fmp_55
    s_cmp_lg_u32 s14, 7
    s_cbranch_scc1 Fgb_57
    v_mov_b32 v8, 0
Fg_56:
    global_load_dword v9, v8, s[52:53] sc1
    s_sub_u32 s25, s25, 1
    s_cbranch_scc1 M_end
    s_waitcnt vmcnt(0)
    v_cmp_eq_u32 vcc, -1, v9
    s_cbranch_vccnz Fg_56
Fgb_57:
    s_barrier
Fmp_55:
    global_load_dwordx4 v[8:11], v2, s[38:39] sc1
    s_sub_u32 s25, s25, 1
    s_cbranch_scc1 M_end
    s_waitcnt vmcnt(0)
    v_pk_maximum3_f16 v152, v8, v9, v10
    v_pk_maximum3_f16 v152, v152, v11, v11
    v_cmp_u_f16 vcc, v152, v152
    s_cbranch_vccnz Fmp_55
    ds_write_b128 v14, v[8:11]
    s_branch Fd_48
Fl_58:
    s_lshl_b32 s50, s24, 10
    s_add_u32 s38, s50, 0x5b54e00
    s_add_u32 s38, s4, s38
    s_addc_u32 s39, s5, 0
    v_and_b32 v14, 0x270, v2
    v_bfe_u32 v8, v1, 3, 1
    v_lshl_add_u32 v14, v8, 8, v14
    v_bfe_u32 v8, v1, 4, 1
    v_lshl_add_u32 v14, v8, 3, v14
    s_add_u32 s50, s50, 28672
    v_add_u32 v14, s50, v14
Fl_58p:
    global_load_dwordx4 v[8:11], v2, s[38:39] offset:-3584 sc1
    global_load_dwordx4 v[156:159], v2, s[38:39] offset:3584 sc1
    s_sub_u32 s25, s25, 1
    s_cbranch_scc1 M_end
    s_waitcnt vmcnt(0)
    v_pk_add_f16 v8, v8, v156
    v_pk_add_f16 v9, v9, v157
    v_pk_add_f16 v10, v10, v158
    v_pk_add_f16 v11, v11, v159
    ds_write2_b64 v14, v[8:9], v[10:11] offset0:0 offset1:16
    v_pk_maximum3_f16 v152, v8, v9, v10
    v_pk_maximum3_f16 v152, v152, v11, v11
    v_cmp_u_f16 vcc, v152, v152
    s_waitcnt lgkmcnt(0)
    s_cbranch_vccnz Fl_58p
Fd_48:
    s_waitcnt lgkmcnt(0)
    s_barrier
    ds_read_b128 v[152:155], v12 offset:0
    ds_read_b128 v[156:159], v12 offset:512
    ds_read_b128 v[160:163], v12 offset:1024
    ds_read_b128 v[164:167], v12 offset:1536
    ds_read_b128 v[168:171], v12 offset:2048
    ds_read_b128 v[172:175], v12 offset:2560
    s_waitcnt lgkmcnt(5)
    v_mfma_f32_16x16x32_f16 v[144:147], v[152:155], v[16:19], 0
    v_mfma_f32_16x16x32_f16 v[148:151], v[152:155], v[72:75], 0
    ds_read_b128 v[152:155], v12 offset:3072
    s_waitcnt lgkmcnt(5)
    v_mfma_f32_16x16x32_f16 v[144:147], v[156:159], v[20:23], v[144:147]
    v_mfma_f32_16x16x32_f16 v[148:151], v[156:159], v[76:79], v[148:151]
    ds_read_b128 v[156:159], v12 offset:3584
    s_waitcnt lgkmcnt(5)
    v_mfma_f32_16x16x32_f16 v[144:147], v[160:163], v[24:27], v[144:147]
    v_mfma_f32_16x16x32_f16 v[148:151], v[160:163], v[80:83], v[148:151]
    ds_read_b128 v[160:163], v12 offset:4096
    s_waitcnt lgkmcnt(5)
    v_mfma_f32_16x16x32_f16 v[144:147], v[164:167], v[28:31], v[144:147]
    v_mfma_f32_16x16x32_f16 v[148:151], v[164:167], v[84:87], v[148:151]
    ds_read_b128 v[164:167], v12 offset:4608
    s_waitcnt lgkmcnt(5)
    v_mfma_f32_16x16x32_f16 v[144:147], v[168:171], v[32:35], v[144:147]
    v_mfma_f32_16x16x32_f16 v[148:151], v[168:171], v[88:91], v[148:151]
    ds_read_b128 v[168:171], v12 offset:5120
    s_waitcnt lgkmcnt(5)
    v_mfma_f32_16x16x32_f16 v[144:147], v[172:175], v[36:39], v[144:147]
    v_mfma_f32_16x16x32_f16 v[148:151], v[172:175], v[92:95], v[148:151]
    ds_read_b128 v[172:175], v12 offset:5632
    s_waitcnt lgkmcnt(5)
    v_mfma_f32_16x16x32_f16 v[144:147], v[152:155], v[40:43], v[144:147]
    v_mfma_f32_16x16x32_f16 v[148:151], v[152:155], v[96:99], v[148:151]
    ds_read_b128 v[152:155], v12 offset:6144
    s_waitcnt lgkmcnt(5)
    v_mfma_f32_16x16x32_f16 v[144:147], v[156:159], v[44:47], v[144:147]
    v_mfma_f32_16x16x32_f16 v[148:151], v[156:159], v[100:103], v[148:151]
    ds_read_b128 v[156:159], v12 offset:6656
    s_waitcnt lgkmcnt(5)
    v_mfma_f32_16x16x32_f16 v[144:147], v[160:163], v[48:51], v[144:147]
    v_mfma_f32_16x16x32_f16 v[148:151], v[160:163], v[104:107], v[148:151]
    s_waitcnt lgkmcnt(4)
    v_mfma_f32_16x16x32_f16 v[144:147], v[164:167], v[52:55], v[144:147]
    v_mfma_f32_16x16x32_f16 v[148:151], v[164:167], v[108:111], v[148:151]
    s_waitcnt lgkmcnt(3)
    v_mfma_f32_16x16x32_f16 v[144:147], v[168:171], v[56:59], v[144:147]
    v_mfma_f32_16x16x32_f16 v[148:151], v[168:171], v[112:115], v[148:151]
    s_waitcnt lgkmcnt(2)
    v_mfma_f32_16x16x32_f16 v[144:147], v[172:175], v[60:63], v[144:147]
    v_mfma_f32_16x16x32_f16 v[148:151], v[172:175], v[116:119], v[148:151]
    s_waitcnt lgkmcnt(1)
    v_mfma_f32_16x16x32_f16 v[144:147], v[152:155], v[64:67], v[144:147]
    v_mfma_f32_16x16x32_f16 v[148:151], v[152:155], v[120:123], v[148:151]
    s_waitcnt lgkmcnt(0)
    v_mfma_f32_16x16x32_f16 v[144:147], v[156:159], v[68:71], v[144:147]
    v_mfma_f32_16x16x32_f16 v[148:151], v[156:159], v[124:127], v[148:151]
    s_lshl_b32 s50, s14, 11
    s_add_u32 s50, s50, 36864
    v_add_u32 v8, s50, v2
    s_lshr_b32 s50, s14, 1
    s_lshl_b32 s50, s50, 10
    s_and_b32 s51, s14, 1
    s_lshl_b32 s51, s51, 3
    s_add_u32 s50, s50, s51
    s_add_u32 s50, s50, 53248
    v_add_u32 v9, s50, v2
    v_max3_f32 v152, v13, v144, v145
    v_max3_f32 v153, v0, v148, v149
    v_mov_b32 v154, v152
    v_mov_b32 v155, v153
    s_nop 0
    v_permlane32_swap_b32 v152, v154
    v_permlane32_swap_b32 v153, v155
    v_max_f32 v152, v152, v154
    v_max_f32 v153, v153, v155
    v_mov_b32 v154, v152
    v_mov_b32 v155, v153
    s_nop 0
    v_permlane16_swap_b32 v152, v154
    v_permlane16_swap_b32 v153, v155
    v_max_f32 v152, v152, v154
    v_max_f32 v153, v153, v155
    v_sub_f32 v13, v13, v152
    v_sub_f32 v0, v0, v153
    v_sub_f32 v144, v144, v152
    v_sub_f32 v148, v148, v153
    v_sub_f32 v145, v145, v152
    v_sub_f32 v149, v149, v153
    v_exp_f32 v13, v13
    v_exp_f32 v0, v0
    v_exp_f32 v144, v144
    v_exp_f32 v148, v148
    v_exp_f32 v145, v145
    v_exp_f32 v149, v149
    v_fma_f32 v152, v13, v252, v144
    v_fma_f32 v153, v0, v253, v148
    v_add_f32 v152, v152, v145
    v_add_f32 v153, v153, v149
    v_mov_b32 v154, v152
    v_mov_b32 v155, v153
    s_nop 0
    v_permlane32_swap_b32 v152, v154
    v_permlane32_swap_b32 v153, v155
    v_add_f32 v152, v152, v154
    v_add_f32 v153, v153, v155
    v_mov_b32 v154, v152
    v_mov_b32 v155, v153
    s_nop 0
    v_permlane16_swap_b32 v152, v154
    v_permlane16_swap_b32 v153, v155
    v_add_f32 v152, v152, v154
    v_add_f32 v153, v153, v155
    v_rcp_f32 v152, v152
    v_rcp_f32 v153, v153
    v_mul_f32 v13, v13, v152
    v_mul_f32 v0, v0, v153
    v_mul_f32 v144, v144, v152
    v_mul_f32 v148, v148, v153
    v_mul_f32 v145, v145, v152
    v_mul_f32 v149, v149, v153
    v_mul_f32 v128, v128, v13
    v_mul_f32 v136, v136, v0
    v_mul_f32 v129, v129, v13
    v_mul_f32 v137, v137, v0
    v_mul_f32 v130, v130, v13
    v_mul_f32 v138, v138, v0
    v_mul_f32 v131, v131, v13
    v_mul_f32 v139, v139, v0
    global_load_dwordx4 v[72:75], v2, s[36:37] offset:-4096 sc1
    global_load_dwordx4 v[76:79], v2, s[36:37] offset:-3072 sc1
    global_load_dwordx4 v[80:83], v2, s[36:37] offset:-2048 sc1
    global_load_dwordx4 v[84:87], v2, s[36:37] offset:-1024 sc1
    v_cvt_pk_f16_f32 v156, v128, v129
    v_cvt_pk_f16_f32 v158, v130, v131
    v_cvt_pk_f16_f32 v157, v136, v137
    v_cvt_pk_f16_f32 v159, v138, v139
    ds_write_b128 v8, v[156:159] offset:0
    v_cvt_pk_f16_f32 v164, v144, v145
    v_cvt_pk_f16_f32 v165, v148, v149
    ds_write_b64 v9, v[164:165]
    s_waitcnt lgkmcnt(0)
    s_barrier
    s_cmp_eq_u32 s14, 7
    s_cbranch_scc1 Fend_53
    ds_read_b128 v[152:155], v2 offset:53248
    ds_read_b128 v[156:159], v2 offset:54272
    ds_read_b128 v[160:163], v2 offset:55296
    ds_read_b128 v[164:167], v2 offset:56320
    ds_read_b128 v[104:107], v2 offset:36864
    ds_read_b128 v[108:111], v2 offset:38912
    ds_read_b128 v[112:115], v2 offset:40960
    ds_read_b128 v[116:119], v2 offset:43008
    ds_read_b128 v[120:123], v2 offset:45056
    global_load_dwordx4 v[88:91], v2, s[36:37] offset:-4096 sc1
    global_load_dwordx4 v[92:95], v2, s[36:37] offset:-3072 sc1
    global_load_dwordx4 v[96:99], v2, s[36:37] offset:-2048 sc1
    global_load_dwordx4 v[100:103], v2, s[36:37] offset:-1024 sc1
    ds_read_b128 v[124:127], v2 offset:47104
    s_waitcnt lgkmcnt(5)
    v_mfma_f32_16x16x32_f16 v[248:251], v[176:179], v[104:107], v[248:251]
    ds_read_b128 v[104:107], v2 offset:49152
    s_waitcnt lgkmcnt(5)
    v_mfma_f32_16x16x32_f16 v[248:251], v[180:183], v[108:111], v[248:251]
    ds_read_b128 v[108:111], v2 offset:51200
    s_waitcnt lgkmcnt(5)
    v_mfma_f32_16x16x32_f16 v[248:251], v[184:187], v[112:115], v[248:251]
    s_waitcnt lgkmcnt(4)
    v_mfma_f32_16x16x32_f16 v[248:251], v[188:191], v[116:119], v[248:251]
    s_waitcnt lgkmcnt(3)
    v_mfma_f32_16x16x32_f16 v[248:251], v[192:195], v[120:123], v[248:251]
    s_waitcnt lgkmcnt(2)
    v_mfma_f32_16x16x32_f16 v[248:251], v[196:199], v[124:127], v[248:251]
    s_waitcnt lgkmcnt(1)
    v_mfma_f32_16x16x32_f16 v[248:251], v[200:203], v[104:107], v[248:251]
    s_waitcnt lgkmcnt(0)
    v_mfma_f32_16x16x32_f16 v[248:251], v[204:207], v[108:111], v[248:251]
Ftb_59:
    s_waitcnt vmcnt(4)
    v_mfma_f32_16x16x32_f16 v[128:131], v[72:75], v[152:155], v[248:251]
    v_mfma_f32_16x16x32_f16 v[128:131], v[76:79], v[156:159], v[128:131]
    v_mfma_f32_16x16x32_f16 v[128:131], v[80:83], v[160:163], v[128:131]
    v_mfma_f32_16x16x32_f16 v[128:131], v[84:87], v[164:167], v[128:131]
    s_nop 7
    v_pk_add_f32 v[8:9], v[128:129], v[130:131]
    v_cmp_u_f32 vcc, v8, v9
    v_cvt_pk_bf16_f32 v8, v128, v129
    v_cvt_pk_bf16_f32 v9, v130, v131
    s_cbranch_vccnz Ftr_60
Fts_61:
    global_store_dwordx2 v15, v[8:9], s[48:49]
    s_cmp_lt_u32 s55, 0x2d0
    s_cbranch_scc1 Fend_53
    s_endpgm
Ftr_60:
    global_load_dwordx4 v[72:75], v2, s[36:37] offset:-4096 sc1
    global_load_dwordx4 v[76:79], v2, s[36:37] offset:-3072 sc1
    global_load_dwordx4 v[80:83], v2, s[36:37] offset:-2048 sc1
    global_load_dwordx4 v[84:87], v2, s[36:37] offset:-1024 sc1
    s_waitcnt vmcnt(4)
    v_mfma_f32_16x16x32_f16 v[128:131], v[88:91], v[152:155], v[248:251]
    v_mfma_f32_16x16x32_f16 v[128:131], v[92:95], v[156:159], v[128:131]
    v_mfma_f32_16x16x32_f16 v[128:131], v[96:99], v[160:163], v[128:131]
    v_mfma_f32_16x16x32_f16 v[128:131], v[100:103], v[164:167], v[128:131]
    s_nop 7
    v_pk_add_f32 v[8:9], v[128:129], v[130:131]
    v_cmp_u_f32 vcc, v8, v9
    v_cvt_pk_bf16_f32 v8, v128, v129
    v_cvt_pk_bf16_f32 v9, v130, v131
    s_cbranch_vccz Fts_61
    global_load_dwordx4 v[88:91], v2, s[36:37] offset:-4096 sc1
    global_load_dwordx4 v[92:95], v2, s[36:37] offset:-3072 sc1
    global_load_dwordx4 v[96:99], v2, s[36:37] offset:-2048 sc1
    global_load_dwordx4 v[100:103], v2, s[36:37] offset:-1024 sc1
    s_sub_u32 s25, s25, 1
    s_cbranch_scc0 Ftb_59
    s_branch M_end
Ft1_54:
    s_mul_i32 s50, s24, 4096
    v_add_u32 v8, s50, v2
    s_add_u32 m0, s50, 0
    s_nop 0
    global_load_lds_dwordx4 v8, s[26:27] offset:0
    global_load_lds_dwordx4 v8, s[26:27] offset:1024
    global_load_lds_dwordx4 v8, s[26:27] offset:2048
    global_load_lds_dwordx4 v8, s[26:27] offset:3072
    global_load_dwordx4 v[16:19], v2, s[28:29] offset:-4096 sc1 nt
    global_load_dwordx4 v[20:23], v2, s[28:29] offset:-3072 sc1 nt
    global_load_dwordx4 v[24:27], v2, s[28:29] offset:-2048 sc1 nt
    global_load_dwordx4 v[28:31], v2, s[28:29] offset:-1024 sc1 nt
    global_load_dwordx4 v[32:35], v2, s[28:29] offset:0 sc1 nt
    global_load_dwordx4 v[36:39], v2, s[28:29] offset:1024 sc1 nt
    global_load_dwordx4 v[40:43], v2, s[28:29] offset:2048 sc1 nt
    global_load_dwordx4 v[44:47], v2, s[28:29] offset:3072 sc1 nt
    global_load_dwordx4 v[48:51], v5, s[28:29] offset:-4096 sc1 nt
    global_load_dwordx4 v[52:55], v5, s[28:29] offset:-3072 sc1 nt
    global_load_dwordx4 v[56:59], v5, s[28:29] offset:-2048 sc1 nt
    global_load_dwordx4 v[60:63], v5, s[28:29] offset:-1024 sc1 nt
    global_load_dwordx4 v[64:67], v5, s[28:29] offset:0 sc1 nt
    global_load_dwordx4 v[68:71], v5, s[28:29] offset:1024 sc1 nt
    s_add_u32 s28, s28, 28672
    s_addc_u32 s29, s29, 0
    global_load_dwordx4 v[72:75], v2, s[28:29] offset:-4096 sc1 nt
    global_load_dwordx4 v[76:79], v2, s[28:29] offset:-3072 sc1 nt
    global_load_dwordx4 v[80:83], v2, s[28:29] offset:-2048 sc1 nt
    global_load_dwordx4 v[84:87], v2, s[28:29] offset:-1024 sc1 nt
    global_load_dwordx4 v[88:91], v2, s[28:29] offset:0 sc1 nt
    global_load_dwordx4 v[92:95], v2, s[28:29] offset:1024 sc1 nt
    global_load_dwordx4 v[96:99], v2, s[28:29] offset:2048 sc1 nt
    global_load_dwordx4 v[100:103], v2, s[28:29] offset:3072 sc1 nt
    global_load_dwordx4 v[104:107], v5, s[28:29] offset:-4096 sc1 nt
    global_load_dwordx4 v[108:111], v5, s[28:29] offset:-3072 sc1 nt
    global_load_dwordx4 v[112:115], v5, s[28:29] offset:-2048 sc1 nt
    global_load_dwordx4 v[116:119], v5, s[28:29] offset:-1024 sc1 nt
    global_load_dwordx4 v[120:123], v5, s[28:29] offset:0 sc1 nt
    global_load_dwordx4 v[124:127], v5, s[28:29] offset:1024 sc1 nt
    global_load_dwordx4 v[176:179], v2, s[32:33] offset:-4096 sc1
    global_load_dwordx4 v[180:183], v2, s[32:33] offset:-3072 sc1
    global_load_dwordx4 v[184:187], v2, s[32:33] offset:0 sc1
    global_load_dwordx4 v[188:191], v2, s[32:33] offset:1024 sc1
    global_load_dwordx4 v[192:195], v5, s[32:33] offset:-4096 sc1
    global_load_dwordx4 v[196:199], v5, s[32:33] offset:-3072 sc1
    global_load_dwordx4 v[200:203], v5, s[32:33] offset:0 sc1
    global_load_dwordx4 v[204:207], v5, s[32:33] offset:1024 sc1
    global_load_dwordx4 v[208:211], v6, s[32:33] offset:-4096 sc1
    global_load_dwordx4 v[212:215], v6, s[32:33] offset:-3072 sc1
    global_load_dwordx4 v[216:219], v6, s[32:33] offset:0 sc1
    global_load_dwordx4 v[220:223], v6, s[32:33] offset:1024 sc1
    global_load_dwordx4 v[224:227], v7, s[32:33] offset:-4096 sc1
    global_load_dwordx4 v[228:231], v7, s[32:33] offset:-3072 sc1
    global_load_dwordx4 v[232:235], v7, s[32:33] offset:0 sc1
    global_load_dwordx4 v[236:239], v7, s[32:33] offset:1024 sc1
    global_load_dwordx4 v[248:251], v2, s[34:35] offset:0 sc1 nt
    s_waitcnt vmcnt(45)
    s_barrier
    ds_read_b128 v[152:155], v2 offset:0
    ds_read_b128 v[156:159], v2 offset:14336
    ds_read_b128 v[160:163], v2 offset:1024
    ds_read_b128 v[164:167], v2 offset:15360
    ds_read_b128 v[168:171], v2 offset:2048
    s_waitcnt vmcnt(17)
    ds_read_b128 v[172:175], v2 offset:16384
    s_waitcnt lgkmcnt(5)
    v_mfma_f32_16x16x32_f16 v[128:131], v[152:155], v[16:19], 0
    v_mfma_f32_16x16x32_f16 v[136:139], v[152:155], v[72:75], 0
    ds_read_b128 v[152:155], v2 offset:3072
    s_waitcnt lgkmcnt(5)
    v_mfma_f32_16x16x32_f16 v[132:135], v[156:159], v[16:19], 0
    v_mfma_f32_16x16x32_f16 v[140:143], v[156:159], v[72:75], 0
    ds_read_b128 v[156:159], v2 offset:17408
    s_waitcnt lgkmcnt(5)
    v_mfma_f32_16x16x32_f16 v[128:131], v[160:163], v[20:23], v[128:131]
    v_mfma_f32_16x16x32_f16 v[136:139], v[160:163], v[76:79], v[136:139]
    ds_read_b128 v[160:163], v2 offset:4096
    s_waitcnt lgkmcnt(5)
    v_mfma_f32_16x16x32_f16 v[132:135], v[164:167], v[20:23], v[132:135]
    v_mfma_f32_16x16x32_f16 v[140:143], v[164:167], v[76:79], v[140:143]
    ds_read_b128 v[164:167], v2 offset:18432
    s_waitcnt lgkmcnt(5)
    v_mfma_f32_16x16x32_f16 v[128:131], v[168:171], v[24:27], v[128:131]
    v_mfma_f32_16x16x32_f16 v[136:139], v[168:171], v[80:83], v[136:139]
    ds_read_b128 v[168:171], v2 offset:5120
    s_waitcnt lgkmcnt(5)
    v_mfma_f32_16x16x32_f16 v[132:135], v[172:175], v[24:27], v[132:135]
    v_mfma_f32_16x16x32_f16 v[140:143], v[172:175], v[80:83], v[140:143]
    ds_read_b128 v[172:175], v2 offset:19456
    s_waitcnt lgkmcnt(5)
    v_mfma_f32_16x16x32_f16 v[128:131], v[152:155], v[28:31], v[128:131]
    v_mfma_f32_16x16x32_f16 v[136:139], v[152:155], v[84:87], v[136:139]
    ds_read_b128 v[152:155], v2 offset:6144
    s_waitcnt lgkmcnt(5)
    v_mfma_f32_16x16x32_f16 v[132:135], v[156:159], v[28:31], v[132:135]
    v_mfma_f32_16x16x32_f16 v[140:143], v[156:159], v[84:87], v[140:143]
    ds_read_b128 v[156:159], v2 offset:20480
    s_waitcnt lgkmcnt(5)
    v_mfma_f32_16x16x32_f16 v[128:131], v[160:163], v[32:35], v[128:131]
    v_mfma_f32_16x16x32_f16 v[136:139], v[160:163], v[88:91], v[136:139]
    ds_read_b128 v[160:163], v2 offset:7168
    s_waitcnt lgkmcnt(5)
    v_mfma_f32_16x16x32_f16 v[132:135], v[164:167], v[32:35], v[132:135]
    v_mfma_f32_16x16x32_f16 v[140:143], v[164:167], v[88:91], v[140:143]
    ds_read_b128 v[164:167], v2 offset:21504
    s_waitcnt lgkmcnt(5)
    v_mfma_f32_16x16x32_f16 v[128:131], v[168:171], v[36:39], v[128:131]
    v_mfma_f32_16x16x32_f16 v[136:139], v[168:171], v[92:95], v[136:139]
    ds_read_b128 v[168:171], v2 offset:8192
    s_waitcnt lgkmcnt(5)
    v_mfma_f32_16x16x32_f16 v[132:135], v[172:175], v[36:39], v[132:135]
    v_mfma_f32_16x16x32_f16 v[140:143], v[172:175], v[92:95], v[140:143]
    ds_read_b128 v[172:175], v2 offset:22528
    s_waitcnt lgkmcnt(5)
    v_mfma_f32_16x16x32_f16 v[128:131], v[152:155], v[40:43], v[128:131]
    v_mfma_f32_16x16x32_f16 v[136:139], v[152:155], v[96:99], v[136:139]
    ds_read_b128 v[152:155], v2 offset:9216
    s_waitcnt lgkmcnt(5)
    v_mfma_f32_16x16x32_f16 v[132:135], v[156:159], v[40:43], v[132:135]
    v_mfma_f32_16x16x32_f16 v[140:143], v[156:159], v[96:99], v[140:143]
    ds_read_b128 v[156:159], v2 offset:23552
    s_waitcnt lgkmcnt(5)
    v_mfma_f32_16x16x32_f16 v[128:131], v[160:163], v[44:47], v[128:131]
    v_mfma_f32_16x16x32_f16 v[136:139], v[160:163], v[100:103], v[136:139]
    ds_read_b128 v[160:163], v2 offset:10240
    s_waitcnt lgkmcnt(5)
    v_mfma_f32_16x16x32_f16 v[132:135], v[164:167], v[44:47], v[132:135]
    v_mfma_f32_16x16x32_f16 v[140:143], v[164:167], v[100:103], v[140:143]
    ds_read_b128 v[164:167], v2 offset:24576
    s_waitcnt lgkmcnt(5)
    v_mfma_f32_16x16x32_f16 v[128:131], v[168:171], v[48:51], v[128:131]
    v_mfma_f32_16x16x32_f16 v[136:139], v[168:171], v[104:107], v[136:139]
    ds_read_b128 v[168:171], v2 offset:11264
    s_waitcnt lgkmcnt(5)
    v_mfma_f32_16x16x32_f16 v[132:135], v[172:175], v[48:51], v[132:135]
    v_mfma_f32_16x16x32_f16 v[140:143], v[172:175], v[104:107], v[140:143]
    ds_read_b128 v[172:175], v2 offset:25600
    s_waitcnt lgkmcnt(5)
    v_mfma_f32_16x16x32_f16 v[128:131], v[152:155], v[52:55], v[128:131]
    v_mfma_f32_16x16x32_f16 v[136:139], v[152:155], v[108:111], v[136:139]
    ds_read_b128 v[152:155], v2 offset:12288
    s_waitcnt lgkmcnt(5)
    v_mfma_f32_16x16x32_f16 v[132:135], v[156:159], v[52:55], v[132:135]
    v_mfma_f32_16x16x32_f16 v[140:143], v[156:159], v[108:111], v[140:143]
    ds_read_b128 v[156:159], v2 offset:26624
    s_waitcnt lgkmcnt(5)
    v_mfma_f32_16x16x32_f16 v[128:131], v[160:163], v[56:59], v[128:131]
    v_mfma_f32_16x16x32_f16 v[136:139], v[160:163], v[112:115], v[136:139]
    ds_read_b128 v[160:163], v2 offset:13312
    s_waitcnt lgkmcnt(5)
    v_mfma_f32_16x16x32_f16 v[132:135], v[164:167], v[56:59], v[132:135]
    v_mfma_f32_16x16x32_f16 v[140:143], v[164:167], v[112:115], v[140:143]
    ds_read_b128 v[164:167], v2 offset:27648
    s_waitcnt lgkmcnt(5)
    v_mfma_f32_16x16x32_f16 v[128:131], v[168:171], v[60:63], v[128:131]
    v_mfma_f32_16x16x32_f16 v[136:139], v[168:171], v[116:119], v[136:139]
    s_waitcnt lgkmcnt(4)
    v_mfma_f32_16x16x32_f16 v[132:135], v[172:175], v[60:63], v[132:135]
    v_mfma_f32_16x16x32_f16 v[140:143], v[172:175], v[116:119], v[140:143]
    s_waitcnt lgkmcnt(3)
    v_mfma_f32_16x16x32_f16 v[128:131], v[152:155], v[64:67], v[128:131]
    v_mfma_f32_16x16x32_f16 v[136:139], v[152:155], v[120:123], v[136:139]
    s_waitcnt lgkmcnt(2)
    v_mfma_f32_16x16x32_f16 v[132:135], v[156:159], v[64:67], v[132:135]
    v_mfma_f32_16x16x32_f16 v[140:143], v[156:159], v[120:123], v[140:143]
    s_waitcnt lgkmcnt(1)
    v_mfma_f32_16x16x32_f16 v[128:131], v[160:163], v[68:71], v[128:131]
    v_mfma_f32_16x16x32_f16 v[136:139], v[160:163], v[124:127], v[136:139]
    s_waitcnt lgkmcnt(0)
    v_mfma_f32_16x16x32_f16 v[132:135], v[164:167], v[68:71], v[132:135]
    v_mfma_f32_16x16x32_f16 v[140:143], v[164:167], v[124:127], v[140:143]
    v_mov_b32 v8, 0xff800000
    s_nop 5
    v_cndmask_b32 v132, v8, v132, s[40:41]
    v_cndmask_b32 v133, v8, v133, s[42:43]
    v_cndmask_b32 v134, v8, v134, s[44:45]
    v_cndmask_b32 v135, v8, v135, s[46:47]
    v_cndmask_b32 v140, v8, v140, s[40:41]
    v_cndmask_b32 v141, v8, v141, s[42:43]
    v_cndmask_b32 v142, v8, v142, s[44:45]
    v_cndmask_b32 v143, v8, v143, s[46:47]
    v_max_f32 v13, v128, v129
    v_max_f32 v0, v136, v137
    v_max3_f32 v13, v13, v130, v131
    v_max3_f32 v0, v0, v138, v139
    v_max3_f32 v13, v13, v132, v133
    v_max3_f32 v0, v0, v140, v141
    v_max3_f32 v13, v13, v134, v135
    v_max3_f32 v0, v0, v142, v143
    v_mov_b32 v154, v13
    v_mov_b32 v155, v0
    s_nop 0
    v_permlane32_swap_b32 v13, v154
    v_permlane32_swap_b32 v0, v155
    v_max_f32 v13, v13, v154
    v_max_f32 v0, v0, v155
    v_mov_b32 v154, v13
    v_mov_b32 v155, v0
    s_nop 0
    v_permlane16_swap_b32 v13, v154
    v_permlane16_swap_b32 v0, v155
    v_max_f32 v13, v13, v154
    v_max_f32 v0, v0, v155
    v_sub_f32 v128, v128, v13
    v_sub_f32 v136, v136, v0
    v_sub_f32 v129, v129, v13
    v_sub_f32 v137, v137, v0
    v_sub_f32 v130, v130, v13
    v_sub_f32 v138, v138, v0
    v_sub_f32 v131, v131, v13
    v_sub_f32 v139, v139, v0
    v_sub_f32 v132, v132, v13
    v_sub_f32 v140, v140, v0
    v_sub_f32 v133, v133, v13
    v_sub_f32 v141, v141, v0
    v_sub_f32 v134, v134, v13
    v_sub_f32 v142, v142, v0
    v_sub_f32 v135, v135, v13
    v_sub_f32 v143, v143, v0
    v_exp_f32 v128, v128
    v_exp_f32 v136, v136
    v_exp_f32 v129, v129
    v_exp_f32 v137, v137
    v_exp_f32 v130, v130
    v_exp_f32 v138, v138
    v_exp_f32 v131, v131
    v_exp_f32 v139, v139
    v_exp_f32 v132, v132
    v_exp_f32 v140, v140
    v_exp_f32 v133, v133
    v_exp_f32 v141, v141
    v_exp_f32 v134, v134
    v_exp_f32 v142, v142
    v_exp_f32 v135, v135
    v_exp_f32 v143, v143
    v_add_f32 v252, v128, v129
    v_add_f32 v253, v136, v137
    v_add_f32 v252, v252, v130
    v_add_f32 v253, v253, v138
    v_add_f32 v252, v252, v131
    v_add_f32 v253, v253, v139
    v_add_f32 v252, v252, v132
    v_add_f32 v253, v253, v140
    v_add_f32 v252, v252, v133
    v_add_f32 v253, v253, v141
    v_add_f32 v252, v252, v134
    v_add_f32 v253, v253, v142
    v_add_f32 v252, v252, v135
    v_add_f32 v253, v253, v143
    s_cmp_eq_u32 s21, 63
    s_cbranch_scc1 Fl_65
    s_cmp_ge_u32 s21, 61
    s_cbranch_scc1 Fmp_62
    s_cmp_lg_u32 s14, 7
    s_cbranch_scc1 Fgb_64
    v_mov_b32 v8, 0
Fg_63:
    global_load_dword v9, v8, s[52:53] sc1
    s_sub_u32 s25, s25, 1
    s_cbranch_scc1 M_end
    s_waitcnt vmcnt(0)
    v_cmp_eq_u32 vcc, -1, v9
    s_cbranch_vccnz Fg_63
Fgb_64:
    s_barrier
Fmp_62:
    global_load_dwordx4 v[8:11], v2, s[38:39] sc1
    s_sub_u32 s25, s25, 1
    s_cbranch_scc1 M_end
    s_waitcnt vmcnt(0)
    v_pk_maximum3_f16 v152, v8, v9, v10
    v_pk_maximum3_f16 v152, v152, v11, v11
    v_cmp_u_f16 vcc, v152, v152
    s_cbranch_vccnz Fmp_62
    ds_write_b128 v14, v[8:11]
    s_branch Fd_49
Fl_65:
    s_lshl_b32 s50, s24, 10
    s_add_u32 s38, s50, 0x5b54e00
    s_add_u32 s38, s4, s38
    s_addc_u32 s39, s5, 0
    v_and_b32 v14, 0x270, v2
    v_bfe_u32 v8, v1, 3, 1
    v_lshl_add_u32 v14, v8, 8, v14
    v_bfe_u32 v8, v1, 4, 1
    v_lshl_add_u32 v14, v8, 3, v14
    s_add_u32 s50, s50, 28672
    v_add_u32 v14, s50, v14
Fl_65p:
    global_load_dwordx4 v[8:11], v2, s[38:39] offset:-3584 sc1
    global_load_dwordx4 v[156:159], v2, s[38:39] offset:3584 sc1
    s_sub_u32 s25, s25, 1
    s_cbranch_scc1 M_end
    s_waitcnt vmcnt(0)
    v_pk_add_f16 v8, v8, v156
    v_pk_add_f16 v9, v9, v157
    v_pk_add_f16 v10, v10, v158
    v_pk_add_f16 v11, v11, v159
    ds_write2_b64 v14, v[8:9], v[10:11] offset0:0 offset1:16
    v_pk_maximum3_f16 v152, v8, v9, v10
    v_pk_maximum3_f16 v152, v152, v11, v11
    v_cmp_u_f16 vcc, v152, v152
    s_waitcnt lgkmcnt(0)
    s_cbranch_vccnz Fl_65p
Fd_49:
    s_waitcnt lgkmcnt(0)
    s_barrier
    ds_read_b128 v[152:155], v12 offset:0
    ds_read_b128 v[156:159], v12 offset:512
    ds_read_b128 v[160:163], v12 offset:1024
    ds_read_b128 v[164:167], v12 offset:1536
    ds_read_b128 v[168:171], v12 offset:2048
    ds_read_b128 v[172:175], v12 offset:2560
    s_waitcnt lgkmcnt(5)
    v_mfma_f32_16x16x32_f16 v[144:147], v[152:155], v[16:19], 0
    v_mfma_f32_16x16x32_f16 v[148:151], v[152:155], v[72:75], 0
    ds_read_b128 v[152:155], v12 offset:3072
    s_waitcnt lgkmcnt(5)
    v_mfma_f32_16x16x32_f16 v[144:147], v[156:159], v[20:23], v[144:147]
    v_mfma_f32_16x16x32_f16 v[148:151], v[156:159], v[76:79], v[148:151]
    ds_read_b128 v[156:159], v12 offset:3584
    s_waitcnt lgkmcnt(5)
    v_mfma_f32_16x16x32_f16 v[144:147], v[160:163], v[24:27], v[144:147]
    v_mfma_f32_16x16x32_f16 v[148:151], v[160:163], v[80:83], v[148:151]
    ds_read_b128 v[160:163], v12 offset:4096
    s_waitcnt lgkmcnt(5)
    v_mfma_f32_16x16x32_f16 v[144:147], v[164:167], v[28:31], v[144:147]
    v_mfma_f32_16x16x32_f16 v[148:151], v[164:167], v[84:87], v[148:151]
    ds_read_b128 v[164:167], v12 offset:4608
    s_waitcnt lgkmcnt(5)
    v_mfma_f32_16x16x32_f16 v[144:147], v[168:171], v[32:35], v[144:147]
    v_mfma_f32_16x16x32_f16 v[148:151], v[168:171], v[88:91], v[148:151]
    ds_read_b128 v[168:171], v12 offset:5120
    s_waitcnt lgkmcnt(5)
    v_mfma_f32_16x16x32_f16 v[144:147], v[172:175], v[36:39], v[144:147]
    v_mfma_f32_16x16x32_f16 v[148:151], v[172:175], v[92:95], v[148:151]
    ds_read_b128 v[172:175], v12 offset:5632
    s_waitcnt lgkmcnt(5)
    v_mfma_f32_16x16x32_f16 v[144:147], v[152:155], v[40:43], v[144:147]
    v_mfma_f32_16x16x32_f16 v[148:151], v[152:155], v[96:99], v[148:151]
    ds_read_b128 v[152:155], v12 offset:6144
    s_waitcnt lgkmcnt(5)
    v_mfma_f32_16x16x32_f16 v[144:147], v[156:159], v[44:47], v[144:147]
    v_mfma_f32_16x16x32_f16 v[148:151], v[156:159], v[100:103], v[148:151]
    ds_read_b128 v[156:159], v12 offset:6656
    s_waitcnt lgkmcnt(5)
    v_mfma_f32_16x16x32_f16 v[144:147], v[160:163], v[48:51], v[144:147]
    v_mfma_f32_16x16x32_f16 v[148:151], v[160:163], v[104:107], v[148:151]
    s_waitcnt lgkmcnt(4)
    v_mfma_f32_16x16x32_f16 v[144:147], v[164:167], v[52:55], v[144:147]
    v_mfma_f32_16x16x32_f16 v[148:151], v[164:167], v[108:111], v[148:151]
    s_waitcnt lgkmcnt(3)
    v_mfma_f32_16x16x32_f16 v[144:147], v[168:171], v[56:59], v[144:147]
    v_mfma_f32_16x16x32_f16 v[148:151], v[168:171], v[112:115], v[148:151]
    s_waitcnt lgkmcnt(2)
    v_mfma_f32_16x16x32_f16 v[144:147], v[172:175], v[60:63], v[144:147]
    v_mfma_f32_16x16x32_f16 v[148:151], v[172:175], v[116:119], v[148:151]
    s_waitcnt lgkmcnt(1)
    v_mfma_f32_16x16x32_f16 v[144:147], v[152:155], v[64:67], v[144:147]
    v_mfma_f32_16x16x32_f16 v[148:151], v[152:155], v[120:123], v[148:151]
    s_waitcnt lgkmcnt(0)
    v_mfma_f32_16x16x32_f16 v[144:147], v[156:159], v[68:71], v[144:147]
    v_mfma_f32_16x16x32_f16 v[148:151], v[156:159], v[124:127], v[148:151]
    s_lshl_b32 s50, s14, 11
    s_add_u32 s50, s50, 36864
    v_add_u32 v8, s50, v2
    s_lshr_b32 s50, s14, 1
    s_lshl_b32 s50, s50, 10
    s_and_b32 s51, s14, 1
    s_lshl_b32 s51, s51, 3
    s_add_u32 s50, s50, s51
    s_add_u32 s50, s50, 53248
    v_add_u32 v9, s50, v2
    v_max3_f32 v152, v13, v144, v145
    v_max3_f32 v153, v0, v148, v149
    v_mov_b32 v154, v152
    v_mov_b32 v155, v153
    s_nop 0
    v_permlane32_swap_b32 v152, v154
    v_permlane32_swap_b32 v153, v155
    v_max_f32 v152, v152, v154
    v_max_f32 v153, v153, v155
    v_mov_b32 v154, v152
    v_mov_b32 v155, v153
    s_nop 0
    v_permlane16_swap_b32 v152, v154
    v_permlane16_swap_b32 v153, v155
    v_max_f32 v152, v152, v154
    v_max_f32 v153, v153, v155
    v_sub_f32 v13, v13, v152
    v_sub_f32 v0, v0, v153
    v_sub_f32 v144, v144, v152
    v_sub_f32 v148, v148, v153
    v_sub_f32 v145, v145, v152
    v_sub_f32 v149, v149, v153
    v_exp_f32 v13, v13
    v_exp_f32 v0, v0
    v_exp_f32 v144, v144
    v_exp_f32 v148, v148
    v_exp_f32 v145, v145
    v_exp_f32 v149, v149
    v_fma_f32 v152, v13, v252, v144
    v_fma_f32 v153, v0, v253, v148
    v_add_f32 v152, v152, v145
    v_add_f32 v153, v153, v149
    v_mov_b32 v154, v152
    v_mov_b32 v155, v153
    s_nop 0
    v_permlane32_swap_b32 v152, v154
    v_permlane32_swap_b32 v153, v155
    v_add_f32 v152, v152, v154
    v_add_f32 v153, v153, v155
    v_mov_b32 v154, v152
    v_mov_b32 v155, v153
    s_nop 0
    v_permlane16_swap_b32 v152, v154
    v_permlane16_swap_b32 v153, v155
    v_add_f32 v152, v152, v154
    v_add_f32 v153, v153, v155
    v_rcp_f32 v152, v152
    v_rcp_f32 v153, v153
    v_mul_f32 v13, v13, v152
    v_mul_f32 v0, v0, v153
    v_mul_f32 v144, v144, v152
    v_mul_f32 v148, v148, v153
    v_mul_f32 v145, v145, v152
    v_mul_f32 v149, v149, v153
    v_mul_f32 v128, v128, v13
    v_mul_f32 v136, v136, v0
    v_mul_f32 v129, v129, v13
    v_mul_f32 v137, v137, v0
    v_mul_f32 v130, v130, v13
    v_mul_f32 v138, v138, v0
    v_mul_f32 v131, v131, v13
    v_mul_f32 v139, v139, v0
    v_mul_f32 v132, v132, v13
    v_mul_f32 v140, v140, v0
    v_mul_f32 v133, v133, v13
    v_mul_f32 v141, v141, v0
    v_mul_f32 v134, v134, v13
    v_mul_f32 v142, v142, v0
    v_mul_f32 v135, v135, v13
    v_mul_f32 v143, v143, v0
    global_load_dwordx4 v[72:75], v2, s[36:37] offset:-4096 sc1
    global_load_dwordx4 v[76:79], v2, s[36:37] offset:-3072 sc1
    global_load_dwordx4 v[80:83], v2, s[36:37] offset:-2048 sc1
    global_load_dwordx4 v[84:87], v2, s[36:37] offset:-1024 sc1
    v_cvt_pk_f16_f32 v156, v128, v129
    v_cvt_pk_f16_f32 v158, v130, v131
    v_cvt_pk_f16_f32 v157, v136, v137
    v_cvt_pk_f16_f32 v159, v138, v139
    ds_write_b128 v8, v[156:159] offset:0
    v_cvt_pk_f16_f32 v160, v132, v133
    v_cvt_pk_f16_f32 v162, v134, v135
    v_cvt_pk_f16_f32 v161, v140, v141
    v_cvt_pk_f16_f32 v163, v142, v143
    ds_write_b128 v8, v[160:163] offset:1024
    v_cvt_pk_f16_f32 v164, v144, v145
    v_cvt_pk_f16_f32 v165, v148, v149
    ds_write_b64 v9, v[164:165]
    s_waitcnt lgkmcnt(0)
    s_barrier
    s_cmp_eq_u32 s14, 7
    s_cbranch_scc1 Fend_53
    ds_read_b128 v[152:155], v2 offset:53248
    ds_read_b128 v[156:159], v2 offset:54272
    ds_read_b128 v[160:163], v2 offset:55296
    ds_read_b128 v[164:167], v2 offset:56320
    ds_read_b128 v[104:107], v2 offset:36864
    ds_read_b128 v[108:111], v2 offset:37888
    ds_read_b128 v[112:115], v2 offset:38912
    ds_read_b128 v[116:119], v2 offset:39936
    ds_read_b128 v[120:123], v2 offset:40960
    global_load_dwordx4 v[88:91], v2, s[36:37] offset:-4096 sc1
    global_load_dwordx4 v[92:95], v2, s[36:37] offset:-3072 sc1
    global_load_dwordx4 v[96:99], v2, s[36:37] offset:-2048 sc1
    global_load_dwordx4 v[100:103], v2, s[36:37] offset:-1024 sc1
    ds_read_b128 v[124:127], v2 offset:41984
    s_waitcnt lgkmcnt(5)
    v_mfma_f32_16x16x32_f16 v[248:251], v[176:179], v[104:107], v[248:251]
    ds_read_b128 v[104:107], v2 offset:43008
    s_waitcnt lgkmcnt(5)
    v_mfma_f32_16x16x32_f16 v[248:251], v[180:183], v[108:111], v[248:251]
    ds_read_b128 v[108:111], v2 offset:44032
    s_waitcnt lgkmcnt(5)
    v_mfma_f32_16x16x32_f16 v[248:251], v[184:187], v[112:115], v[248:251]
    ds_read_b128 v[112:115], v2 offset:45056
    s_waitcnt lgkmcnt(5)
    v_mfma_f32_16x16x32_f16 v[248:251], v[188:191], v[116:119], v[248:251]
    ds_read_b128 v[116:119], v2 offset:46080
    s_waitcnt lgkmcnt(5)
    v_mfma_f32_16x16x32_f16 v[248:251], v[192:195], v[120:123], v[248:251]
    ds_read_b128 v[120:123], v2 offset:47104
    s_waitcnt lgkmcnt(5)
    v_mfma_f32_16x16x32_f16 v[248:251], v[196:199], v[124:127], v[248:251]
    ds_read_b128 v[124:127], v2 offset:48128
    s_waitcnt lgkmcnt(5)
    v_mfma_f32_16x16x32_f16 v[248:251], v[200:203], v[104:107], v[248:251]
    ds_read_b128 v[104:107], v2 offset:49152
    s_waitcnt lgkmcnt(5)
    v_mfma_f32_16x16x32_f16 v[248:251], v[204:207], v[108:111], v[248:251]
    ds_read_b128 v[108:111], v2 offset:50176
    s_waitcnt lgkmcnt(5)
    v_mfma_f32_16x16x32_f16 v[248:251], v[208:211], v[112:115], v[248:251]
    ds_read_b128 v[112:115], v2 offset:51200
    s_waitcnt lgkmcnt(5)
    v_mfma_f32_16x16x32_f16 v[248:251], v[212:215], v[116:119], v[248:251]
    ds_read_b128 v[116:119], v2 offset:52224
    s_waitcnt lgkmcnt(5)
    v_mfma_f32_16x16x32_f16 v[248:251], v[216:219], v[120:123], v[248:251]
    s_waitcnt lgkmcnt(4)
    v_mfma_f32_16x16x32_f16 v[248:251], v[220:223], v[124:127], v[248:251]
    s_waitcnt lgkmcnt(3)
    v_mfma_f32_16x16x32_f16 v[248:251], v[224:227], v[104:107], v[248:251]
    s_waitcnt lgkmcnt(2)
    v_mfma_f32_16x16x32_f16 v[248:251], v[228:231], v[108:111], v[248:251]
    s_waitcnt lgkmcnt(1)
    v_mfma_f32_16x16x32_f16 v[248:251], v[232:235], v[112:115], v[248:251]
    s_waitcnt lgkmcnt(0)
    v_mfma_f32_16x16x32_f16 v[248:251], v[236:239], v[116:119], v[248:251]
Ftb_66:
    s_waitcnt vmcnt(4)
    v_mfma_f32_16x16x32_f16 v[128:131], v[72:75], v[152:155], v[248:251]
    v_mfma_f32_16x16x32_f16 v[128:131], v[76:79], v[156:159], v[128:131]
    v_mfma_f32_16x16x32_f16 v[128:131], v[80:83], v[160:163], v[128:131]
    v_mfma_f32_16x16x32_f16 v[128:131], v[84:87], v[164:167], v[128:131]
    s_nop 7
    v_pk_add_f32 v[8:9], v[128:129], v[130:131]
    v_cmp_u_f32 vcc, v8, v9
    v_cvt_pk_bf16_f32 v8, v128, v129
    v_cvt_pk_bf16_f32 v9, v130, v131
    s_cbranch_vccnz Ftr_67
Fts_68:
    global_store_dwordx2 v15, v[8:9], s[48:49]
    s_cmp_lt_u32 s55, 0x2d0
    s_cbranch_scc1 Fend_53
    s_endpgm
Ftr_67:
    global_load_dwordx4 v[72:75], v2, s[36:37] offset:-4096 sc1
    global_load_dwordx4 v[76:79], v2, s[36:37] offset:-3072 sc1
    global_load_dwordx4 v[80:83], v2, s[36:37] offset:-2048 sc1
    global_load_dwordx4 v[84:87], v2, s[36:37] offset:-1024 sc1
    s_waitcnt vmcnt(4)
    v_mfma_f32_16x16x32_f16 v[128:131], v[88:91], v[152:155], v[248:251]
    v_mfma_f32_16x16x32_f16 v[128:131], v[92:95], v[156:159], v[128:131]
    v_mfma_f32_16x16x32_f16 v[128:131], v[96:99], v[160:163], v[128:131]
    v_mfma_f32_16x16x32_f16 v[128:131], v[100:103], v[164:167], v[128:131]
    s_nop 7
    v_pk_add_f32 v[8:9], v[128:129], v[130:131]
    v_cmp_u_f32 vcc, v8, v9
    v_cvt_pk_bf16_f32 v8, v128, v129
    v_cvt_pk_bf16_f32 v9, v130, v131
    s_cbranch_vccz Fts_68
    global_load_dwordx4 v[88:91], v2, s[36:37] offset:-4096 sc1
    global_load_dwordx4 v[92:95], v2, s[36:37] offset:-3072 sc1
    global_load_dwordx4 v[96:99], v2, s[36:37] offset:-2048 sc1
    global_load_dwordx4 v[100:103], v2, s[36:37] offset:-1024 sc1
    s_sub_u32 s25, s25, 1
    s_cbranch_scc0 Ftb_66
    s_branch M_end
Fend_53:
    s_cmp_ge_u32 s55, 0x2d0
    s_cbranch_scc1 M_end
    s_waitcnt vmcnt(0)
    s_branch M_next
M_end:
    s_endpgm
.section .rodata,"a"
.p2align 6
.amdhsa_kernel parallel_sum__memory_aug_recurrent_mem_tr__dense_activation_relu__prompt_kernel
  .amdhsa_next_free_vgpr 256
  .amdhsa_next_free_sgpr 102
  .amdhsa_accum_offset 256
  .amdhsa_group_segment_fixed_size 0
  .amdhsa_kernarg_size 104
  .amdhsa_user_sgpr_count 2
  .amdhsa_user_sgpr_kernarg_segment_ptr 1
  .amdhsa_system_sgpr_workgroup_id_x 1
.end_amdhsa_kernel
```
